```python
import torch

def _softmax(x, axis=-1):
    return torch.softmax(x, dim=axis)
def _gelu(x):
    return torch.nn.functional.gelu(x, approximate="tanh")
def _silu(x):
    return torch.nn.functional.silu(x)
def _sigmoid(x):
    return torch.sigmoid(x)
def _layernorm(x, axis=-1, eps=1e-5):
    m = x.mean(dim=axis, keepdim=True)
    v = x.var(dim=axis, keepdim=True, unbiased=False)
    return (x - m) / torch.sqrt(v + eps)
def _scatter_add(tgt, idx, src, axis=0):
    return tgt.clone().index_add_(axis, idx, src)
def _segment_sum(src, seg, n):
    out = torch.zeros((n,) + src.shape[1:], dtype=src.dtype)
    return out.index_add_(0, seg, src)
def _pad(x, pw):
    flat = tuple(v for pair in reversed(pw) for v in pair)
    return torch.nn.functional.pad(x, flat)

kernel_name = 'parallel_sum__sliding_local_dilated__dense_activation_squared_relu__prompt'

def setup_inputs():

    _w = (lambda a: (lambda t: t.to(torch.bfloat16) if t.is_floating_point() else t)(torch.as_tensor(a)))
    def _A_setup():
        B, S, D = 1, 2048, 1024
        return {
            "x": _w((lambda *s: torch.randn(*s, dtype=torch.bfloat16) * 0.05)(B, S, D)),
            "wqkv": _w((lambda *s: torch.randn(*s, dtype=torch.bfloat16) * 0.1)(D, 3 * D)),
            "wo": _w((lambda *s: torch.randn(*s, dtype=torch.bfloat16) * 0.05)(D, D)),
        }
    _A_in = _A_setup()

    def _B_setup():
        B, S, D, F = 1, 2048, 1024, 3584
        return {
            "x": _w((lambda *s: torch.randn(*s, dtype=torch.bfloat16) * 0.05)(B, S, D)),
            "w1": _w((lambda *s: torch.randn(*s, dtype=torch.bfloat16) * 0.05)(D, F)),
            "b1": _w((lambda *s: torch.randn(*s, dtype=torch.bfloat16) * 0.4)(F)),
            "w2": _w((lambda *s: torch.randn(*s, dtype=torch.bfloat16) * 0.05)(F, D)),
            "b2": _w((lambda *s: torch.randn(*s, dtype=torch.bfloat16) * 3.2)(D)),
        }
    _B_in = _B_setup()

    return {
        "A_x": _A_in["x"],
        "A_wqkv": _A_in["wqkv"],
        "A_wo": _A_in["wo"],
        "B_x": _B_in["x"],
        "B_w1": _B_in["w1"],
        "B_b1": _B_in["b1"],
        "B_w2": _B_in["w2"],
        "B_b2": _B_in["b2"],
    }

def reference(A_x, A_wqkv, A_wo, B_x, B_w1, B_b1, B_w2, B_b2):
    def _A_ref(x, wqkv, wo):
        B, S, D = x.shape
        H = 32; Dh = D // H
        W, dil = 8, 2
        qkv = (lambda x, *d: x.permute(*d))((x @ wqkv).reshape(B, S, 3, H, Dh), 2, 0, 3, 1, 4)
        q, k, v = qkv[0], qkv[1], qkv[2]
        scale = Dh ** -0.5
        pos = torch.arange(S)
        off = torch.arange(W) * dil
        idx = pos[:, None] - off[None, :]
        mask = idx >= 0
        idx_c = torch.where(mask, idx, 0).reshape(-1)
        kg = k[:, :, idx_c, :].reshape(B, H, S, W, Dh)
        vg = v[:, :, idx_c, :].reshape(B, H, S, W, Dh)
        logits = torch.einsum("bhsd,bhswd->bhsw", q, kg) * scale
        logits = torch.where(mask[None, None, :, :], logits, -1e9)
        attn = _softmax(logits, axis=-1)
        o = torch.einsum("bhsw,bhswd->bhsd", attn, vg)
        return (lambda x, *d: x.permute(*d))(o, 0, 2, 1, 3).reshape(B, S, D) @ wo

    def _B_ref(x, w1, b1, w2, b2):
        h = torch.einsum("bsd,df->bsf", x, w1) + b1
        zero = torch.zeros_like(h)
        r = torch.where(h > zero, h, zero)
        h = r * r
        out = torch.einsum("bsf,fd->bsd", h, w2) + b2
        return out

    x = A_x
    xn = _layernorm(x, axis=-1)
    return x + _A_ref(xn, A_wqkv, A_wo) + _B_ref(xn, B_w1, B_b1, B_w2, B_b2)
```

```asm
; @launch grid=(256,1,1) block=(256,1,1) lds=163840
.amdgcn_target "amdgcn-amd-amdhsa--gfx950"
.text
.globl parallel_sum__sliding_local_dilated__dense_activation_squared_relu__prompt_kernel
.p2align 8
.type parallel_sum__sliding_local_dilated__dense_activation_squared_relu__prompt_kernel,@function
parallel_sum__sliding_local_dilated__dense_activation_squared_relu__prompt_kernel:
  s_cmp_ge_u32 s2, 256
  s_cbranch_scc1 L_k1_end
  s_load_dwordx2 s[4:5], s[0:1], 0
  s_load_dwordx2 s[60:61], s[0:1], 8
  s_load_dwordx4 s[56:59], s[0:1], 32
  s_load_dwordx4 s[12:15], s[0:1], 72
  s_load_dwordx2 s[36:37], s[0:1], 48
  s_load_dwordx2 s[38:39], s[0:1], 16
  s_memrealtime s[18:19]
  v_lshrrev_b32 v104, 6, v0
  v_and_b32 v100, 63, v0
  v_readfirstlane_b32 s25, v104
  s_and_b32 s46, s2, 1
  s_lshl_b32 s46, s46, 2
  s_bfe_u32 s47, s2, 0x20003
  s_add_u32 s26, s46, s47
  s_bfe_u32 s46, s2, 0x20001
  s_lshl_b32 s46, s46, 2
  s_bfe_u32 s47, s2, 0x20005
  s_add_u32 s27, s46, s47
  v_and_b32 v101, 15, v100
  v_lshrrev_b32 v102, 4, v100
  v_lshlrev_b32 v228, 4, v100
  s_lshl_b32 s46, s26, 8
  s_lshl_b32 s47, s25, 6
  s_add_u32 s47, s46, s47
  s_lshl_b32 s47, s47, 11
  s_add_u32 s62, s47, 0x0
  s_add_u32 s63, s47, 0x8000
  s_add_u32 s64, s47, 0x10000
  s_add_u32 s65, s47, 0x18000
  s_max_u32 s47, s46, 16
  s_sub_u32 s47, s47, 16
  s_lshl_b32 s66, s47, 11
  s_lshr_b32 s47, s2, 7
  s_lshl_b32 s47, s47, 4
  s_add_u32 s47, s47, s27
  s_lshl_b32 s47, s47, 2
  s_add_u32 s47, s47, s25
  s_lshl_b32 s47, s47, 1
  s_add_u32 s47, s47, s46
  s_lshl_b32 s67, s47, 11
  v_lshrrev_b32 v108, 3, v100
  v_and_b32 v109, 7, v100
  v_xor_b32 v109, v109, v102
  v_lshlrev_b32 v108, 11, v108
  v_lshl_add_u32 v224, v109, 4, v108
  v_xor_b32 v109, 4, v109
  v_lshl_add_u32 v225, v109, 4, v108
  v_add_u32 v225, 0x4000, v225
  s_mov_b32 s21, 0
  s_mov_b32 s22, 4096
  v_lshlrev_b32 v110, 7, v100
  v_lshrrev_b32 v111, 1, v100
  v_lshlrev_b32 v111, 7, v111
  v_and_b32 v112, 1, v100
  v_lshl_add_u32 v111, v112, 11, v111
  s_and_b32 s48, s2, 127
  s_lshl_b32 s48, s48, 2
  s_add_u32 s48, s48, s25
  s_bfe_u32 s47, s2, 0x10002
  s_lshl_b32 s47, s47, 16
  s_cmp_ge_u32 s2, 128
  s_cselect_b32 s47, 0, s47
  s_mov_b32 s49, 0xe00
  s_cselect_b32 s49, 0xc00, s49
  s_mov_b32 s50, 0xfffffff
  s_cselect_b32 s50, 0xffffff, s50
  s_mov_b32 s51, 0x4000
  s_cselect_b32 s51, 0x5000, s51
  s_mov_b32 s52, 0x15000
  s_cselect_b32 s52, 0x13800, s52
  s_mov_b32 s10, 0x700000
  s_cselect_b32 s10, 0x600000, s10
  s_xor_b32 s62, s62, s47
  s_xor_b32 s63, s63, s47
  s_xor_b32 s64, s64, s47
  s_xor_b32 s65, s65, s47
  s_mul_i32 s48, s48, s49
  s_mul_i32 s24, s25, s51
  s_add_u32 s24, s24, s52
  s_mov_b32 s6, 0x400000
  s_mov_b32 s7, 0x20000
  s_mov_b32 s11, 0x20000
  s_waitcnt lgkmcnt(0)
  s_cmp_ge_u32 s2, 128
  s_cselect_b32 s8, s60, s56
  s_cselect_b32 s9, s61, s57
  s_mov_b32 exec_lo, s50
  s_mov_b32 exec_hi, 0
  buffer_load_dword a224, v110, s[8:11], s48 offen
  s_mov_b32 exec_lo, 0xff
  buffer_load_dword a224, v111, s[4:7], s67 offen
  s_mov_b64 exec, -1
  s_add_u32 m0, s24, 0x800
  s_nop 0
  buffer_load_dwordx4 v224, s[4:7], s62 offen offset:0 lds
  s_add_u32 m0, s24, 0xc00
  s_nop 0
  buffer_load_dwordx4 v225, s[4:7], s62 offen offset:0 lds
  s_add_u32 m0, s24, 0x1000
  s_nop 0
  buffer_load_dwordx4 v224, s[4:7], s63 offen offset:0 lds
  s_add_u32 m0, s24, 0x1400
  s_nop 0
  buffer_load_dwordx4 v225, s[4:7], s63 offen offset:0 lds
  s_add_u32 m0, s24, 0x1800
  s_nop 0
  buffer_load_dwordx4 v224, s[4:7], s64 offen offset:0 lds
  s_add_u32 m0, s24, 0x1c00
  s_nop 0
  buffer_load_dwordx4 v225, s[4:7], s64 offen offset:0 lds
  s_add_u32 m0, s24, 0x2000
  s_nop 0
  buffer_load_dwordx4 v224, s[4:7], s65 offen offset:0 lds
  s_add_u32 m0, s24, 0x2400
  s_nop 0
  buffer_load_dwordx4 v225, s[4:7], s65 offen offset:0 lds
  s_or_b32 s3, s2, s25
  s_cmp_lg_u32 s3, 0
  s_cbranch_scc1 L_k1_notag
  s_mov_b32 s32, s12
  s_mov_b32 s33, s13
  s_mov_b32 s34, 0x8
  s_mov_b32 s35, 0x20000
  s_or_b32 s18, s18, 1
  v_mov_b32 v108, s18
  v_mov_b32 v109, s19
  buffer_store_dwordx2 v[108:109], v228, s[32:35], 0 offen sc1
L_k1_notag:
  s_cmp_ge_u32 s2, 128
  s_cbranch_scc0 L_k1_w1
  s_lshl_b32 s44, s27, 7
  v_lshrrev_b32 v104, 3, v100
  v_bfe_u32 v106, v100, 1, 2
  v_bfe_u32 v107, v100, 4, 1
  v_xor_b32 v106, v106, v107
  v_and_b32 v105, 1, v100
  v_mul_u32_u24 v104, 6144, v104
  v_lshl_add_u32 v107, v105, 4, v104
  s_mul_i32 s49, s25, 98304
  s_add_u32 s50, s49, s44
  v_lshl_add_u32 v229, v106, 5, v107
  v_add_u32 v229, s50, v229
  v_xor_b32 v106, 2, v106
  v_lshl_add_u32 v230, v106, 5, v107
  s_add_u32 s50, s50, 49152
  v_add_u32 v230, s50, v230
  s_mul_i32 s23, s25, 6144
  v_lshrrev_b32 v200, 2, v100
  v_mul_u32_u24 v200, 6144, v200
  s_bfe_u32 s51, s2, 0x20001
  v_and_b32 v108, 3, v100
  v_min_u32 v108, 2, v108
  v_lshl_add_u32 v200, v108, 11, v200
  s_lshl_b32 s51, s51, 9
  s_add_u32 s51, s51, 384
  s_bitcmp1_b32 s2, 1
  s_cselect_b32 s51, 0x7000000, s51
  v_add_u32 v200, s51, v200
  s_bfe_u32 s55, s2, 0x40003
  s_lshl_b32 s55, s55, 2
  s_add_u32 s55, s55, s25
  s_mul_i32 s3, s55, 24576
  s_add_u32 s3, s3, 0x0
  s_mov_b32 exec_lo, 0xffff
  s_mov_b32 exec_hi, 0x0
  buffer_load_dword a224, v200, s[8:11], s3 offen
  s_mov_b64 exec, -1
  s_add_u32 m0, s23, 0x2000
  s_nop 0
  buffer_load_dwordx4 v229, s[8:11], s21 offen offset:0 lds
  s_add_u32 m0, s23, 0x1c00
  s_nop 0
  buffer_load_dwordx4 v229, s[8:11], s21 offen offset:2048 lds
  s_add_u32 m0, s23, 0x2800
  s_nop 0
  buffer_load_dwordx4 v229, s[8:11], s22 offen offset:0 lds
  s_add_u32 m0, s23, 0x2c00
  s_nop 0
  buffer_load_dwordx4 v230, s[8:11], s21 offen offset:0 lds
  s_add_u32 m0, s23, 0x2800
  s_nop 0
  buffer_load_dwordx4 v230, s[8:11], s21 offen offset:2048 lds
  s_add_u32 m0, s23, 0x3400
  s_nop 0
  buffer_load_dwordx4 v230, s[8:11], s22 offen offset:0 lds
  s_add_u32 s21, s21, 0x60000
  s_add_u32 s22, s22, 0x60000
  s_add_u32 m0, s24, 0x2800
  s_nop 0
  buffer_load_dwordx4 v224, s[4:7], s66 offen offset:0 lds
  s_add_u32 m0, s24, 0x2c00
  s_nop 0
  buffer_load_dwordx4 v225, s[4:7], s66 offen offset:0 lds
  s_mov_b32 s100, s14
  s_mov_b32 s101, s15
  s_mov_b32 s32, s12
  s_mov_b32 s33, s13
  s_mov_b32 s34, 0x8
  s_mov_b32 s35, 0x20000
  s_add_u32 s40, s100, 0x3000000
  s_addc_u32 s41, s101, 0
  s_mov_b32 s43, 0x20000
  s_cmp_eq_u32 s25, 0
  s_cselect_b32 s42, 0x8000, 0
  s_add_u32 s16, s100, 0x3000000
  s_addc_u32 s17, s101, 0
  s_mov_b32 s18, 0xc8000
  s_mov_b32 s19, 0x20000
  s_add_u32 s12, s100, 0x400000
  s_addc_u32 s13, s101, 0
  s_mov_b32 s14, 0x1200000
  s_mov_b32 s15, 0x20000
  s_mov_b32 s58, s100
  s_mov_b32 s59, s101
  s_mov_b32 s101, s36
  s_mov_b32 s20, s37
  s_mov_b32 s36, s38
  s_mov_b32 s37, s39
  s_mov_b32 s38, 0x200000
  s_mov_b32 s39, 0x20000
  s_lshl_b32 s100, s2, 2
  s_add_u32 s100, s100, s25
  v_and_b32 v108, 7, v100
  v_lshl_add_u32 v244, v108, 4, v104
  s_min_u32 s51, s25, 2
  s_lshl_b32 s51, s51, 11
  s_add_u32 s51, s51, s44
  v_mov_b32 v246, 0
  v_mov_b32 v247, 0
  s_lshr_b32 s52, s51, 5
  s_and_b32 s53, s26, 3
  s_lshl_b32 s53, s53, 1
  s_lshr_b32 s3, s26, 2
  s_add_u32 s53, s53, s3
  s_mul_i32 s53, s53, 0xc0000
  s_add_u32 s53, s53, s51
  s_lshl_b32 s52, s52, 10
  s_lshr_b32 s51, s26, 1
  s_lshl_b32 s51, s51, 8
  s_add_u32 s52, s52, s51
  s_and_b32 s51, s26, 1
  s_lshl_b32 s51, s51, 3
  s_add_u32 s52, s52, s51
  s_add_u32 s52, s52, 0x40000
  s_cmp_eq_u32 s25, 3
  s_cselect_b32 s52, 0x7000000, s52
  s_cselect_b32 s53, 0x7000000, s53
  v_lshrrev_b32 v109, 1, v108
  v_lshlrev_b32 v245, 10, v109
  v_lshl_add_u32 v245, v105, 7, v245
  v_lshl_add_u32 v245, v102, 6, v245
  s_mov_b32 s51, 0x28
  v_and_b32 v109, s51, v100
  v_lshl_add_u32 v245, v109, 24, v245
  v_lshlrev_b32 v109, 4, v105
  v_mov_b32 v110, 0x3f80
  v_lshlrev_b32 v110, v109, v110
  v_lshrrev_b32 v109, 1, v101
  v_cmp_eq_u32 vcc, 0, v109
  s_nop 1
  v_cndmask_b32 v111, 0, v110, vcc
  v_accvgpr_write_b32 a220, v111
  v_cmp_eq_u32 vcc, 1, v109
  s_nop 1
  v_cndmask_b32 v111, 0, v110, vcc
  v_accvgpr_write_b32 a221, v111
  v_cmp_eq_u32 vcc, 2, v109
  s_nop 1
  v_cndmask_b32 v111, 0, v110, vcc
  v_accvgpr_write_b32 a222, v111
  v_cmp_eq_u32 vcc, 3, v109
  s_nop 1
  v_cndmask_b32 v111, 0, v110, vcc
  v_accvgpr_write_b32 a223, v111
  v_xor_b32 v108, v109, v102
  v_lshlrev_b32 v109, 7, v101
  v_add_u32 v109, s24, v109
  v_add_u32 v109, 2048, v109
  v_lshl_add_u32 v226, v108, 4, v109
  v_xor_b32 v108, 4, v108
  v_lshl_add_u32 v227, v108, 4, v109
  v_bfe_u32 v108, v100, 2, 2
  v_and_b32 v109, 3, v100
  v_bfe_u32 v110, v100, 3, 2
  v_xor_b32 v110, s25, v110
  v_lshrrev_b32 v111, 5, v100
  v_mul_u32_u24 v111, 6144, v111
  v_lshl_add_u32 v111, v109, 3, v111
  v_bfe_u32 v112, v100, 4, 1
  v_mul_u32_u24 v113, 3072, v112
  v_lshl_add_u32 v113, v108, 7, v113
  v_add_u32 v113, v113, v111
  v_xor_b32 v114, 0, v110
  v_lshl_add_u32 v232, v114, 5, v113
  v_add_u32 v236, 49152, v232
  v_xor_b32 v114, 1, v110
  v_lshl_add_u32 v233, v114, 5, v113
  v_add_u32 v237, 49152, v233
  v_xor_b32 v114, 2, v110
  v_lshl_add_u32 v234, v114, 5, v113
  v_add_u32 v238, 49152, v234
  v_xor_b32 v114, 3, v110
  v_lshl_add_u32 v235, v114, 5, v113
  v_add_u32 v239, 49152, v235
  v_lshlrev_b32 v202, 3, v228
  s_mov_b32 s54, 0xffff0000
  v_mov_b32 v108, 0x3f803f80
  v_accvgpr_write_b32 a244, v108
  v_accvgpr_write_b32 a245, v108
  v_accvgpr_write_b32 a246, v108
  v_accvgpr_write_b32 a247, v108
  v_cmp_eq_u32 vcc, 1, v105
  s_add_u32 m0, s23, 0x8000
  s_nop 0
  buffer_load_dwordx4 v229, s[8:11], s21 offen offset:0 lds
  s_add_u32 m0, s23, 0x7c00
  s_nop 0
  buffer_load_dwordx4 v229, s[8:11], s21 offen offset:2048 lds
  s_add_u32 m0, s23, 0x8800
  s_nop 0
  buffer_load_dwordx4 v229, s[8:11], s22 offen offset:0 lds
  s_add_u32 m0, s23, 0x8c00
  s_nop 0
  buffer_load_dwordx4 v230, s[8:11], s21 offen offset:0 lds
  s_add_u32 m0, s23, 0x8800
  s_nop 0
  buffer_load_dwordx4 v230, s[8:11], s21 offen offset:2048 lds
  s_add_u32 m0, s23, 0x9400
  s_nop 0
  buffer_load_dwordx4 v230, s[8:11], s22 offen offset:0 lds
  s_add_u32 s21, s21, 0x60000
  s_add_u32 s22, s22, 0x60000
  s_add_u32 m0, s24, 0x2f80
  s_nop 0
  buffer_load_dwordx4 v224, s[4:7], s62 offen offset:128 lds
  s_add_u32 m0, s24, 0x3380
  s_nop 0
  buffer_load_dwordx4 v225, s[4:7], s62 offen offset:128 lds
  s_add_u32 m0, s24, 0x3780
  s_nop 0
  buffer_load_dwordx4 v224, s[4:7], s63 offen offset:128 lds
  s_add_u32 m0, s24, 0x3b80
  s_nop 0
  buffer_load_dwordx4 v225, s[4:7], s63 offen offset:128 lds
  s_add_u32 m0, s24, 0x3f80
  s_nop 0
  buffer_load_dwordx4 v224, s[4:7], s64 offen offset:128 lds
  s_add_u32 m0, s24, 0x4380
  s_nop 0
  buffer_load_dwordx4 v225, s[4:7], s64 offen offset:128 lds
  s_add_u32 m0, s24, 0x4780
  s_nop 0
  buffer_load_dwordx4 v224, s[4:7], s65 offen offset:128 lds
  s_add_u32 m0, s24, 0x4b80
  s_nop 0
  buffer_load_dwordx4 v225, s[4:7], s65 offen offset:128 lds
  s_add_u32 m0, s24, 0x4f80
  s_nop 0
  buffer_load_dwordx4 v224, s[4:7], s66 offen offset:128 lds
  s_add_u32 m0, s24, 0x5380
  s_nop 0
  buffer_load_dwordx4 v225, s[4:7], s66 offen offset:128 lds
  s_mul_i32 s3, s55, 73728
  s_add_u32 s3, s3, 0x180000
  s_mov_b32 exec_lo, 0xffffffff
  s_mov_b32 exec_hi, 0xffff
  buffer_load_dword a224, v200, s[8:11], s3 offen
  s_mov_b64 exec, -1
  s_waitcnt vmcnt(17)
  s_barrier
  ds_read_b128 a[56:59], v226 offset:0
  ds_read_b128 a[76:79], v227 offset:0
  ds_read_b64_tr_b16 a[0:1], v232 offset:8192
  ds_read_b64_tr_b16 a[2:3], v232 offset:8704
  ds_read_b64_tr_b16 a[4:5], v232 offset:20480
  ds_read_b64_tr_b16 a[6:7], v232 offset:20992
  ds_read_b128 a[60:63], v226 offset:2048
  ds_read_b128 a[80:83], v227 offset:2048
  ds_read_b128 a[64:67], v226 offset:4096
  ds_read_b128 a[84:87], v227 offset:4096
  ds_read_b128 a[68:71], v226 offset:6144
  ds_read_b128 a[88:91], v227 offset:6144
  ds_read_b128 a[72:75], v226 offset:8192
  ds_read_b128 a[92:95], v227 offset:8192
  s_waitcnt lgkmcnt(8)
  v_mfma_f32_16x16x32_bf16 v[0:3], a[0:3], a[56:59], 0
  ds_read_b64_tr_b16 a[8:9], v233 offset:8192
  v_mfma_f32_16x16x32_bf16 v[0:3], a[4:7], a[76:79], v[0:3]
  ds_read_b64_tr_b16 a[10:11], v233 offset:8704
  s_getpc_b64 s[48:49]
L_k1_pc_qkv:
  s_mov_b32 s50, L_k1_spin_qkv-L_k1_pc_qkv
  s_mov_b32 s51, 0x20000
  s_bfe_u32 s60, s2, 0x20003
  s_lshl_b32 s60, s60, 2
  s_add_u32 s60, s60, s25
  s_mul_i32 s60, s60, 2560
  v_lshlrev_b32 v252, 3, v228
  s_mov_b64 exec, 0xfffff
  buffer_load_dword a224, v252, s[48:51], s60 offen
  s_mov_b64 exec, -1
  s_add_u32 m0, s23, 0xe000
  s_waitcnt lgkmcnt(8)
  v_mfma_f32_16x16x32_bf16 v[4:7], a[4:7], a[80:83], 0
  ds_read_b64_tr_b16 a[12:13], v233 offset:20480
  buffer_load_dwordx4 v229, s[8:11], s21 offen offset:0 lds
  v_mfma_f32_16x16x32_bf16 v[4:7], a[0:3], a[60:63], v[4:7]
  ds_read_b64_tr_b16 a[14:15], v233 offset:20992
  s_waitcnt lgkmcnt(8)
  v_mfma_f32_16x16x32_bf16 v[8:11], a[0:3], a[64:67], 0
  ds_read_b64_tr_b16 a[16:17], v234 offset:8192
  s_add_u32 m0, s23, 0xdc00
  v_mfma_f32_16x16x32_bf16 v[8:11], a[4:7], a[84:87], v[8:11]
  ds_read_b64_tr_b16 a[18:19], v234 offset:8704
  buffer_load_dwordx4 v229, s[8:11], s21 offen offset:2048 lds
  s_waitcnt lgkmcnt(8)
  v_mfma_f32_16x16x32_bf16 v[12:15], a[4:7], a[88:91], 0
  ds_read_b64_tr_b16 a[20:21], v234 offset:20480
  v_mfma_f32_16x16x32_bf16 v[12:15], a[0:3], a[68:71], v[12:15]
  ds_read_b64_tr_b16 a[22:23], v234 offset:20992
  s_waitcnt lgkmcnt(4)
  v_mfma_f32_16x16x32_bf16 v[28:31], a[8:11], a[68:71], 0
  ds_read_b64_tr_b16 a[24:25], v235 offset:8192
  s_add_u32 m0, s23, 0xe800
  v_mfma_f32_16x16x32_bf16 v[28:31], a[12:15], a[88:91], v[28:31]
  ds_read_b64_tr_b16 a[26:27], v235 offset:8704
  buffer_load_dwordx4 v229, s[8:11], s22 offen offset:0 lds
  v_mfma_f32_16x16x32_bf16 v[24:27], a[12:15], a[84:87], 0
  ds_read_b64_tr_b16 a[28:29], v235 offset:20480
  v_mfma_f32_16x16x32_bf16 v[24:27], a[8:11], a[64:67], v[24:27]
  ds_read_b64_tr_b16 a[30:31], v235 offset:20992
  s_add_u32 m0, s23, 0xec00
  v_mfma_f32_16x16x32_bf16 v[20:23], a[8:11], a[60:63], 0
  ds_read_b64_tr_b16 a[32:33], v232 offset:9216
  buffer_load_dwordx4 v230, s[8:11], s21 offen offset:0 lds
  v_mfma_f32_16x16x32_bf16 v[20:23], a[12:15], a[80:83], v[20:23]
  ds_read_b64_tr_b16 a[34:35], v232 offset:9728
  v_mfma_f32_16x16x32_bf16 v[16:19], a[12:15], a[76:79], 0
  ds_read_b64_tr_b16 a[36:37], v232 offset:21504
  v_mfma_f32_16x16x32_bf16 v[16:19], a[8:11], a[56:59], v[16:19]
  ds_read_b64_tr_b16 a[38:39], v232 offset:22016
  s_add_u32 m0, s23, 0xe800
  s_waitcnt lgkmcnt(8)
  v_mfma_f32_16x16x32_bf16 v[32:35], a[16:19], a[56:59], 0
  ds_read_b64_tr_b16 a[40:41], v233 offset:9216
  buffer_load_dwordx4 v230, s[8:11], s21 offen offset:2048 lds
  v_mfma_f32_16x16x32_bf16 v[32:35], a[20:23], a[76:79], v[32:35]
  ds_read_b64_tr_b16 a[42:43], v233 offset:9728
  v_mfma_f32_16x16x32_bf16 v[36:39], a[20:23], a[80:83], 0
  ds_read_b64_tr_b16 a[44:45], v233 offset:21504
  s_add_u32 m0, s23, 0xf400
  v_mfma_f32_16x16x32_bf16 v[36:39], a[16:19], a[60:63], v[36:39]
  ds_read_b64_tr_b16 a[46:47], v233 offset:22016
  buffer_load_dwordx4 v230, s[8:11], s22 offen offset:0 lds
  v_mfma_f32_16x16x32_bf16 v[40:43], a[16:19], a[64:67], 0
  ds_read_b64_tr_b16 a[0:1], v234 offset:9216
  v_mfma_f32_16x16x32_bf16 v[40:43], a[20:23], a[84:87], v[40:43]
  ds_read_b64_tr_b16 a[2:3], v234 offset:9728
  v_mfma_f32_16x16x32_bf16 v[44:47], a[20:23], a[88:91], 0
  ds_read_b64_tr_b16 a[4:5], v234 offset:21504
  s_add_u32 m0, s24, 0x700
  v_mfma_f32_16x16x32_bf16 v[44:47], a[16:19], a[68:71], v[44:47]
  ds_read_b64_tr_b16 a[6:7], v234 offset:22016
  buffer_load_dwordx4 v224, s[4:7], s62 offen offset:256 lds
  s_waitcnt lgkmcnt(8)
  v_mfma_f32_16x16x32_bf16 v[60:63], a[24:27], a[68:71], 0
  ds_read_b64_tr_b16 a[8:9], v235 offset:9216
  v_mfma_f32_16x16x32_bf16 v[60:63], a[28:31], a[88:91], v[60:63]
  ds_read_b64_tr_b16 a[10:11], v235 offset:9728
  s_add_u32 m0, s24, 0xb00
  v_mfma_f32_16x16x32_bf16 v[56:59], a[28:31], a[84:87], 0
  ds_read_b64_tr_b16 a[12:13], v235 offset:21504
  buffer_load_dwordx4 v225, s[4:7], s62 offen offset:256 lds
  v_mfma_f32_16x16x32_bf16 v[56:59], a[24:27], a[64:67], v[56:59]
  ds_read_b64_tr_b16 a[14:15], v235 offset:22016
  v_mfma_f32_16x16x32_bf16 v[52:55], a[24:27], a[60:63], 0
  ds_read_b64_tr_b16 a[16:17], v232 offset:10240
  v_mfma_f32_16x16x32_bf16 v[52:55], a[28:31], a[80:83], v[52:55]
  ds_read_b64_tr_b16 a[18:19], v232 offset:10752
  s_add_u32 m0, s24, 0xf00
  v_mfma_f32_16x16x32_bf16 v[48:51], a[28:31], a[76:79], 0
  ds_read_b64_tr_b16 a[20:21], v232 offset:22528
  buffer_load_dwordx4 v224, s[4:7], s63 offen offset:256 lds
  v_mfma_f32_16x16x32_bf16 v[48:51], a[24:27], a[56:59], v[48:51]
  ds_read_b64_tr_b16 a[22:23], v232 offset:23040
  v_mfma_f32_16x16x32_bf16 v[192:195], a[32:35], a[72:75], 0
  ds_read_b64_tr_b16 a[24:25], v233 offset:10240
  s_add_u32 m0, s24, 0x1300
  v_mfma_f32_16x16x32_bf16 v[192:195], a[36:39], a[92:95], v[192:195]
  ds_read_b64_tr_b16 a[26:27], v233 offset:10752
  buffer_load_dwordx4 v225, s[4:7], s63 offen offset:256 lds
  v_mfma_f32_16x16x32_bf16 v[64:67], a[36:39], a[76:79], 0
  ds_read_b64_tr_b16 a[28:29], v233 offset:22528
  v_mfma_f32_16x16x32_bf16 v[64:67], a[32:35], a[56:59], v[64:67]
  ds_read_b64_tr_b16 a[30:31], v233 offset:23040
  v_mfma_f32_16x16x32_bf16 v[68:71], a[32:35], a[60:63], 0
  s_add_u32 m0, s24, 0x1700
  v_mfma_f32_16x16x32_bf16 v[68:71], a[36:39], a[80:83], v[68:71]
  buffer_load_dwordx4 v224, s[4:7], s64 offen offset:256 lds
  v_mfma_f32_16x16x32_bf16 v[72:75], a[36:39], a[84:87], 0
  v_mfma_f32_16x16x32_bf16 v[72:75], a[32:35], a[64:67], v[72:75]
  s_add_u32 m0, s24, 0x1b00
  v_mfma_f32_16x16x32_bf16 v[76:79], a[32:35], a[68:71], 0
  buffer_load_dwordx4 v225, s[4:7], s64 offen offset:256 lds
  v_mfma_f32_16x16x32_bf16 v[76:79], a[36:39], a[88:91], v[76:79]
  ds_read_b64_tr_b16 a[32:33], v234 offset:10240
  s_waitcnt lgkmcnt(8)
  v_mfma_f32_16x16x32_bf16 v[92:95], a[44:47], a[88:91], 0
  ds_read_b64_tr_b16 a[34:35], v234 offset:10752
  v_mfma_f32_16x16x32_bf16 v[92:95], a[40:43], a[68:71], v[92:95]
  ds_read_b64_tr_b16 a[36:37], v234 offset:22528
  s_add_u32 m0, s24, 0x1f00
  v_mfma_f32_16x16x32_bf16 v[88:91], a[40:43], a[64:67], 0
  ds_read_b64_tr_b16 a[38:39], v234 offset:23040
  buffer_load_dwordx4 v224, s[4:7], s65 offen offset:256 lds
  v_mfma_f32_16x16x32_bf16 v[88:91], a[44:47], a[84:87], v[88:91]
  v_mfma_f32_16x16x32_bf16 v[84:87], a[44:47], a[80:83], 0
  s_add_u32 m0, s24, 0x2300
  v_mfma_f32_16x16x32_bf16 v[84:87], a[40:43], a[60:63], v[84:87]
  buffer_load_dwordx4 v225, s[4:7], s65 offen offset:256 lds
  v_mfma_f32_16x16x32_bf16 v[80:83], a[40:43], a[56:59], 0
  v_mfma_f32_16x16x32_bf16 v[80:83], a[44:47], a[76:79], v[80:83]
  ds_read_b64_tr_b16 a[40:41], v235 offset:10240
  v_mfma_f32_16x16x32_bf16 v[96:99], a[4:7], a[76:79], 0
  ds_read_b64_tr_b16 a[42:43], v235 offset:10752
  s_add_u32 m0, s24, 0x2700
  v_mfma_f32_16x16x32_bf16 v[96:99], a[0:3], a[56:59], v[96:99]
  ds_read_b64_tr_b16 a[44:45], v235 offset:22528
  buffer_load_dwordx4 v224, s[4:7], s66 offen offset:256 lds
  v_mfma_f32_16x16x32_bf16 v[100:103], a[0:3], a[60:63], 0
  ds_read_b64_tr_b16 a[46:47], v235 offset:23040
  v_mfma_f32_16x16x32_bf16 v[100:103], a[4:7], a[80:83], v[100:103]
  s_add_u32 m0, s24, 0x2b00
  v_mfma_f32_16x16x32_bf16 v[104:107], a[4:7], a[84:87], 0
  buffer_load_dwordx4 v225, s[4:7], s66 offen offset:256 lds
  s_add_u32 s21, s21, 0x60000
  s_add_u32 s22, s22, 0x60000
  v_mfma_f32_16x16x32_bf16 v[104:107], a[0:3], a[64:67], v[104:107]
  v_mfma_f32_16x16x32_bf16 v[108:111], a[0:3], a[68:71], 0
  v_mfma_f32_16x16x32_bf16 v[108:111], a[4:7], a[88:91], v[108:111]
  s_waitcnt lgkmcnt(0) vmcnt(28)
  s_barrier
  ds_read_b64_tr_b16 a[0:1], v232 offset:32768
  v_mfma_f32_16x16x32_bf16 v[124:127], a[12:15], a[88:91], 0
  s_nop 0
  v_mfma_f32_16x16x32_bf16 v[124:127], a[8:11], a[68:71], v[124:127]
  ds_read_b64_tr_b16 a[2:3], v232 offset:33280
  v_mfma_f32_16x16x32_bf16 v[120:123], a[8:11], a[64:67], 0
  buffer_load_dwordx4 a[228:231], v228, s[4:7], s67 offen offset:0
  v_mfma_f32_16x16x32_bf16 v[120:123], a[12:15], a[84:87], v[120:123]
  ds_read_b64_tr_b16 a[4:5], v232 offset:45056
  v_mfma_f32_16x16x32_bf16 v[116:119], a[12:15], a[80:83], 0
  s_nop 0
  v_mfma_f32_16x16x32_bf16 v[116:119], a[8:11], a[60:63], v[116:119]
  ds_read_b64_tr_b16 a[6:7], v232 offset:45568
  v_mfma_f32_16x16x32_bf16 v[112:115], a[8:11], a[56:59], 0
  buffer_load_dwordx4 a[232:235], v228, s[4:7], s67 offen offset:1024
  v_mfma_f32_16x16x32_bf16 v[112:115], a[12:15], a[76:79], v[112:115]
  ds_read_b64_tr_b16 a[8:9], v233 offset:32768
  v_mfma_f32_16x16x32_bf16 v[196:199], a[92:95], a[20:23], 0
  s_nop 0
  v_mfma_f32_16x16x32_bf16 v[196:199], a[72:75], a[16:19], v[196:199]
  ds_read_b64_tr_b16 a[10:11], v233 offset:33280
  v_mfma_f32_16x16x32_bf16 v[128:131], a[56:59], a[16:19], 0
  buffer_load_dwordx4 a[236:239], v228, s[4:7], s67 offen offset:2048
  v_mfma_f32_16x16x32_bf16 v[128:131], a[76:79], a[20:23], v[128:131]
  ds_read_b64_tr_b16 a[12:13], v233 offset:45056
  v_mfma_f32_16x16x32_bf16 v[132:135], a[80:83], a[20:23], 0
  s_nop 0
  v_mfma_f32_16x16x32_bf16 v[132:135], a[60:63], a[16:19], v[132:135]
  ds_read_b64_tr_b16 a[14:15], v233 offset:45568
  v_mfma_f32_16x16x32_bf16 v[136:139], a[64:67], a[16:19], 0
  s_waitcnt vmcnt(29)
  ds_read_b128 a[96:99], v226 offset:10240
  v_mfma_f32_16x16x32_bf16 v[136:139], a[84:87], a[20:23], v[136:139]
  ds_read_b128 a[116:119], v227 offset:10240
  v_mfma_f32_16x16x32_bf16 v[140:143], a[88:91], a[20:23], 0
  buffer_load_dwordx4 a[240:243], v228, s[4:7], s67 offen offset:3072
  s_add_u32 m0, s23, 0x2000
  v_mfma_f32_16x16x32_bf16 v[140:143], a[68:71], a[16:19], v[140:143]
  ds_read_b64_tr_b16 a[16:17], v234 offset:32768
  v_mfma_f32_16x16x32_bf16 v[156:159], a[68:71], a[24:27], 0
  s_waitcnt vmcnt(28)
  ds_read_b128 a[100:103], v226 offset:12288
  v_mfma_f32_16x16x32_bf16 v[156:159], a[88:91], a[28:31], v[156:159]
  ds_read_b64_tr_b16 a[18:19], v234 offset:33280
  v_mfma_f32_16x16x32_bf16 v[152:155], a[84:87], a[28:31], 0
  ds_read_b128 a[120:123], v227 offset:12288
  v_mfma_f32_16x16x32_bf16 v[152:155], a[64:67], a[24:27], v[152:155]
  ds_read_b64_tr_b16 a[20:21], v234 offset:45056
  v_mfma_f32_16x16x32_bf16 v[148:151], a[60:63], a[24:27], 0
  s_waitcnt vmcnt(26)
  ds_read_b128 a[104:107], v226 offset:14336
  v_mfma_f32_16x16x32_bf16 v[148:151], a[80:83], a[28:31], v[148:151]
  ds_read_b64_tr_b16 a[22:23], v234 offset:45568
  v_mfma_f32_16x16x32_bf16 v[144:147], a[76:79], a[28:31], 0
  ds_read_b128 a[124:127], v227 offset:14336
  v_mfma_f32_16x16x32_bf16 v[144:147], a[56:59], a[24:27], v[144:147]
  ds_read_b64_tr_b16 a[24:25], v235 offset:32768
  v_mfma_f32_16x16x32_bf16 v[160:163], a[56:59], a[32:35], 0
  s_waitcnt vmcnt(24)
  ds_read_b128 a[108:111], v226 offset:16384
  v_mfma_f32_16x16x32_bf16 v[160:163], a[76:79], a[36:39], v[160:163]
  ds_read_b64_tr_b16 a[26:27], v235 offset:33280
  v_mfma_f32_16x16x32_bf16 v[164:167], a[80:83], a[36:39], 0
  ds_read_b128 a[128:131], v227 offset:16384
  v_mfma_f32_16x16x32_bf16 v[164:167], a[60:63], a[32:35], v[164:167]
  ds_read_b64_tr_b16 a[28:29], v235 offset:45056
  v_mfma_f32_16x16x32_bf16 v[168:171], a[64:67], a[32:35], 0
  s_waitcnt vmcnt(22)
  ds_read_b128 a[112:115], v226 offset:18432
  v_mfma_f32_16x16x32_bf16 v[168:171], a[84:87], a[36:39], v[168:171]
  ds_read_b64_tr_b16 a[30:31], v235 offset:45568
  v_mfma_f32_16x16x32_bf16 v[172:175], a[88:91], a[36:39], 0
  ds_read_b128 a[132:135], v227 offset:18432
  v_mfma_f32_16x16x32_bf16 v[172:175], a[68:71], a[32:35], v[172:175]
  ds_read_b64_tr_b16 a[32:33], v232 offset:33792
  v_mfma_f32_16x16x32_bf16 v[188:191], a[68:71], a[40:43], 0
  buffer_load_dwordx4 v229, s[8:11], s21 offen offset:0 lds
  s_add_u32 m0, s23, 0x1c00
  v_mfma_f32_16x16x32_bf16 v[188:191], a[88:91], a[44:47], v[188:191]
  ds_read_b64_tr_b16 a[34:35], v232 offset:34304
  v_mfma_f32_16x16x32_bf16 v[184:187], a[84:87], a[44:47], 0
  buffer_load_dwordx4 v229, s[8:11], s21 offen offset:2048 lds
  s_add_u32 m0, s23, 0x2800
  v_mfma_f32_16x16x32_bf16 v[184:187], a[64:67], a[40:43], v[184:187]
  ds_read_b64_tr_b16 a[36:37], v232 offset:46080
  v_mfma_f32_16x16x32_bf16 v[180:183], a[60:63], a[40:43], 0
  buffer_load_dwordx4 v229, s[8:11], s22 offen offset:0 lds
  s_add_u32 m0, s23, 0x2c00
  v_mfma_f32_16x16x32_bf16 v[180:183], a[80:83], a[44:47], v[180:183]
  ds_read_b64_tr_b16 a[38:39], v232 offset:46592
  v_mfma_f32_16x16x32_bf16 v[176:179], a[76:79], a[44:47], 0
  buffer_load_dwordx4 v230, s[8:11], s21 offen offset:0 lds
  s_add_u32 m0, s23, 0x2800
  v_mfma_f32_16x16x32_bf16 v[176:179], a[56:59], a[40:43], v[176:179]
  ds_read_b64_tr_b16 a[40:41], v233 offset:33792
  s_waitcnt lgkmcnt(8)
  v_mfma_f32_16x16x32_bf16 v[0:3], a[0:3], a[96:99], v[0:3]
  buffer_load_dwordx4 v230, s[8:11], s21 offen offset:2048 lds
  s_add_u32 m0, s23, 0x3400
  v_mfma_f32_16x16x32_bf16 v[0:3], a[4:7], a[116:119], v[0:3]
  ds_read_b64_tr_b16 a[42:43], v233 offset:34304
  v_mfma_f32_16x16x32_bf16 v[4:7], a[4:7], a[120:123], v[4:7]
  buffer_load_dwordx4 v230, s[8:11], s22 offen offset:0 lds
  s_add_u32 s21, s21, 0x60000
  s_add_u32 s22, s22, 0x60000
  v_mfma_f32_16x16x32_bf16 v[4:7], a[0:3], a[100:103], v[4:7]
  ds_read_b64_tr_b16 a[44:45], v233 offset:46080
  s_add_u32 m0, s24, 0x2e80
  v_mfma_f32_16x16x32_bf16 v[8:11], a[0:3], a[104:107], v[8:11]
  buffer_load_dwordx4 v224, s[4:7], s62 offen offset:384 lds
  v_mfma_f32_16x16x32_bf16 v[8:11], a[4:7], a[124:127], v[8:11]
  ds_read_b64_tr_b16 a[46:47], v233 offset:46592
  v_mfma_f32_16x16x32_bf16 v[12:15], a[4:7], a[128:131], v[12:15]
  v_mfma_f32_16x16x32_bf16 v[12:15], a[0:3], a[108:111], v[12:15]
  ds_read_b64_tr_b16 a[0:1], v234 offset:33792
  s_add_u32 m0, s24, 0x3280
  v_mfma_f32_16x16x32_bf16 v[28:31], a[8:11], a[108:111], v[28:31]
  buffer_load_dwordx4 v225, s[4:7], s62 offen offset:384 lds
  v_mfma_f32_16x16x32_bf16 v[28:31], a[12:15], a[128:131], v[28:31]
  ds_read_b64_tr_b16 a[2:3], v234 offset:34304
  v_mfma_f32_16x16x32_bf16 v[24:27], a[12:15], a[124:127], v[24:27]
  v_mfma_f32_16x16x32_bf16 v[24:27], a[8:11], a[104:107], v[24:27]
  ds_read_b64_tr_b16 a[4:5], v234 offset:46080
  v_mfma_f32_16x16x32_bf16 v[20:23], a[8:11], a[100:103], v[20:23]
  v_mfma_f32_16x16x32_bf16 v[20:23], a[12:15], a[120:123], v[20:23]
  ds_read_b64_tr_b16 a[6:7], v234 offset:46592
  s_add_u32 m0, s24, 0x3680
  v_mfma_f32_16x16x32_bf16 v[16:19], a[12:15], a[116:119], v[16:19]
  buffer_load_dwordx4 v224, s[4:7], s63 offen offset:384 lds
  v_mfma_f32_16x16x32_bf16 v[16:19], a[8:11], a[96:99], v[16:19]
  ds_read_b64_tr_b16 a[8:9], v235 offset:33792
  v_mfma_f32_16x16x32_bf16 v[32:35], a[16:19], a[96:99], v[32:35]
  v_mfma_f32_16x16x32_bf16 v[32:35], a[20:23], a[116:119], v[32:35]
  ds_read_b64_tr_b16 a[10:11], v235 offset:34304
  v_mfma_f32_16x16x32_bf16 v[36:39], a[20:23], a[120:123], v[36:39]
  s_add_u32 m0, s24, 0x3a80
  v_mfma_f32_16x16x32_bf16 v[36:39], a[16:19], a[100:103], v[36:39]
  ds_read_b64_tr_b16 a[12:13], v235 offset:46080
  v_mfma_f32_16x16x32_bf16 v[40:43], a[16:19], a[104:107], v[40:43]
  buffer_load_dwordx4 v225, s[4:7], s63 offen offset:384 lds
  v_mfma_f32_16x16x32_bf16 v[40:43], a[20:23], a[124:127], v[40:43]
  ds_read_b64_tr_b16 a[14:15], v235 offset:46592
  v_mfma_f32_16x16x32_bf16 v[44:47], a[20:23], a[128:131], v[44:47]
  v_mfma_f32_16x16x32_bf16 v[44:47], a[16:19], a[108:111], v[44:47]
  ds_read_b64_tr_b16 a[16:17], v232 offset:34816
  s_waitcnt lgkmcnt(8)
  v_mfma_f32_16x16x32_bf16 v[60:63], a[24:27], a[108:111], v[60:63]
  s_add_u32 m0, s24, 0x3e80
  v_mfma_f32_16x16x32_bf16 v[60:63], a[28:31], a[128:131], v[60:63]
  ds_read_b64_tr_b16 a[18:19], v232 offset:35328
  v_mfma_f32_16x16x32_bf16 v[56:59], a[28:31], a[124:127], v[56:59]
  buffer_load_dwordx4 v224, s[4:7], s64 offen offset:384 lds
  v_mfma_f32_16x16x32_bf16 v[56:59], a[24:27], a[104:107], v[56:59]
  ds_read_b64_tr_b16 a[20:21], v232 offset:47104
  v_mfma_f32_16x16x32_bf16 v[52:55], a[24:27], a[100:103], v[52:55]
  v_mfma_f32_16x16x32_bf16 v[52:55], a[28:31], a[120:123], v[52:55]
  ds_read_b64_tr_b16 a[22:23], v232 offset:47616
  s_add_u32 m0, s24, 0x4280
  v_mfma_f32_16x16x32_bf16 v[48:51], a[28:31], a[116:119], v[48:51]
  buffer_load_dwordx4 v225, s[4:7], s64 offen offset:384 lds
  v_mfma_f32_16x16x32_bf16 v[48:51], a[24:27], a[96:99], v[48:51]
  ds_read_b64_tr_b16 a[24:25], v233 offset:34816
  v_mfma_f32_16x16x32_bf16 v[192:195], a[32:35], a[112:115], v[192:195]
  v_mfma_f32_16x16x32_bf16 v[192:195], a[36:39], a[132:135], v[192:195]
  ds_read_b64_tr_b16 a[26:27], v233 offset:35328
  v_mfma_f32_16x16x32_bf16 v[64:67], a[36:39], a[116:119], v[64:67]
  v_mfma_f32_16x16x32_bf16 v[64:67], a[32:35], a[96:99], v[64:67]
  ds_read_b64_tr_b16 a[28:29], v233 offset:47104
  s_add_u32 m0, s24, 0x4680
  v_mfma_f32_16x16x32_bf16 v[68:71], a[32:35], a[100:103], v[68:71]
  buffer_load_dwordx4 v224, s[4:7], s65 offen offset:384 lds
  v_mfma_f32_16x16x32_bf16 v[68:71], a[36:39], a[120:123], v[68:71]
  ds_read_b64_tr_b16 a[30:31], v233 offset:47616
  v_mfma_f32_16x16x32_bf16 v[72:75], a[36:39], a[124:127], v[72:75]
  v_mfma_f32_16x16x32_bf16 v[72:75], a[32:35], a[104:107], v[72:75]
  v_mfma_f32_16x16x32_bf16 v[76:79], a[32:35], a[108:111], v[76:79]
  s_add_u32 m0, s24, 0x4a80
  v_mfma_f32_16x16x32_bf16 v[76:79], a[36:39], a[128:131], v[76:79]
  ds_read_b64_tr_b16 a[32:33], v234 offset:34816
  v_mfma_f32_16x16x32_bf16 v[92:95], a[44:47], a[128:131], v[92:95]
  buffer_load_dwordx4 v225, s[4:7], s65 offen offset:384 lds
  v_mfma_f32_16x16x32_bf16 v[92:95], a[40:43], a[108:111], v[92:95]
  ds_read_b64_tr_b16 a[34:35], v234 offset:35328
  v_mfma_f32_16x16x32_bf16 v[88:91], a[40:43], a[104:107], v[88:91]
  v_mfma_f32_16x16x32_bf16 v[88:91], a[44:47], a[124:127], v[88:91]
  ds_read_b64_tr_b16 a[36:37], v234 offset:47104
  v_mfma_f32_16x16x32_bf16 v[84:87], a[44:47], a[120:123], v[84:87]
  s_add_u32 m0, s24, 0x4e80
  v_mfma_f32_16x16x32_bf16 v[84:87], a[40:43], a[100:103], v[84:87]
  ds_read_b64_tr_b16 a[38:39], v234 offset:47616
  v_mfma_f32_16x16x32_bf16 v[80:83], a[40:43], a[96:99], v[80:83]
  buffer_load_dwordx4 v224, s[4:7], s66 offen offset:384 lds
  v_mfma_f32_16x16x32_bf16 v[80:83], a[44:47], a[116:119], v[80:83]
  ds_read_b64_tr_b16 a[40:41], v235 offset:34816
  s_waitcnt lgkmcnt(8)
  v_mfma_f32_16x16x32_bf16 v[96:99], a[4:7], a[116:119], v[96:99]
  ds_read_b64_tr_b16 a[42:43], v235 offset:35328
  v_mfma_f32_16x16x32_bf16 v[96:99], a[0:3], a[96:99], v[96:99]
  ds_read_b64_tr_b16 a[44:45], v235 offset:47104
  s_add_u32 m0, s24, 0x5280
  v_mfma_f32_16x16x32_bf16 v[100:103], a[0:3], a[100:103], v[100:103]
  ds_read_b64_tr_b16 a[46:47], v235 offset:47616
  v_mfma_f32_16x16x32_bf16 v[100:103], a[4:7], a[120:123], v[100:103]
  s_waitcnt vmcnt(27)
  ds_read_b128 a[56:59], v226 offset:0
  v_mfma_f32_16x16x32_bf16 v[104:107], a[4:7], a[124:127], v[104:107]
  ds_read_b128 a[76:79], v227 offset:0
  v_mfma_f32_16x16x32_bf16 v[104:107], a[0:3], a[104:107], v[104:107]
  s_waitcnt vmcnt(25)
  ds_read_b128 a[60:63], v226 offset:2048
  v_mfma_f32_16x16x32_bf16 v[108:111], a[0:3], a[108:111], v[108:111]
  ds_read_b128 a[80:83], v227 offset:2048
  v_mfma_f32_16x16x32_bf16 v[108:111], a[4:7], a[128:131], v[108:111]
  s_waitcnt lgkmcnt(0)
  s_barrier
  ds_read_b64_tr_b16 a[0:1], v236 offset:8192
  v_mfma_f32_16x16x32_bf16 v[124:127], a[12:15], a[128:131], v[124:127]
  buffer_load_dwordx4 v225, s[4:7], s66 offen offset:384 lds
  s_add_u32 m0, s23, 0x8000
  v_mfma_f32_16x16x32_bf16 v[124:127], a[8:11], a[108:111], v[124:127]
  ds_read_b64_tr_b16 a[2:3], v236 offset:8704
  v_mfma_f32_16x16x32_bf16 v[120:123], a[8:11], a[104:107], v[120:123]
  s_waitcnt vmcnt(24)
  ds_read_b128 a[64:67], v226 offset:4096
  v_mfma_f32_16x16x32_bf16 v[120:123], a[12:15], a[124:127], v[120:123]
  ds_read_b64_tr_b16 a[4:5], v236 offset:20480
  v_mfma_f32_16x16x32_bf16 v[116:119], a[12:15], a[120:123], v[116:119]
  ds_read_b128 a[84:87], v227 offset:4096
  v_mfma_f32_16x16x32_bf16 v[116:119], a[8:11], a[100:103], v[116:119]
  ds_read_b64_tr_b16 a[6:7], v236 offset:20992
  v_mfma_f32_16x16x32_bf16 v[112:115], a[8:11], a[96:99], v[112:115]
  buffer_load_dwordx4 v229, s[8:11], s21 offen offset:0 lds
  s_add_u32 m0, s23, 0x7c00
  v_mfma_f32_16x16x32_bf16 v[112:115], a[12:15], a[116:119], v[112:115]
  ds_read_b64_tr_b16 a[8:9], v237 offset:8192
  v_mfma_f32_16x16x32_bf16 v[196:199], a[132:135], a[20:23], v[196:199]
  s_waitcnt vmcnt(23)
  ds_read_b128 a[68:71], v226 offset:6144
  v_mfma_f32_16x16x32_bf16 v[196:199], a[112:115], a[16:19], v[196:199]
  ds_read_b64_tr_b16 a[10:11], v237 offset:8704
  v_mfma_f32_16x16x32_bf16 v[128:131], a[96:99], a[16:19], v[128:131]
  ds_read_b128 a[88:91], v227 offset:6144
  v_mfma_f32_16x16x32_bf16 v[128:131], a[116:119], a[20:23], v[128:131]
  ds_read_b64_tr_b16 a[12:13], v237 offset:20480
  v_mfma_f32_16x16x32_bf16 v[132:135], a[120:123], a[20:23], v[132:135]
  buffer_load_dwordx4 v229, s[8:11], s21 offen offset:2048 lds
  s_add_u32 m0, s23, 0x8800
  v_mfma_f32_16x16x32_bf16 v[132:135], a[100:103], a[16:19], v[132:135]
  ds_read_b64_tr_b16 a[14:15], v237 offset:20992
  v_mfma_f32_16x16x32_bf16 v[136:139], a[104:107], a[16:19], v[136:139]
  s_waitcnt vmcnt(22)
  ds_read_b128 a[72:75], v226 offset:8192
  v_mfma_f32_16x16x32_bf16 v[136:139], a[124:127], a[20:23], v[136:139]
  ds_read_b128 a[92:95], v227 offset:8192
  v_mfma_f32_16x16x32_bf16 v[140:143], a[128:131], a[20:23], v[140:143]
  buffer_load_dwordx4 v229, s[8:11], s22 offen offset:0 lds
  s_add_u32 m0, s23, 0x8c00
  v_mfma_f32_16x16x32_bf16 v[140:143], a[108:111], a[16:19], v[140:143]
  ds_read_b64_tr_b16 a[16:17], v238 offset:8192
  v_mfma_f32_16x16x32_bf16 v[156:159], a[108:111], a[24:27], v[156:159]
  buffer_load_dwordx4 v230, s[8:11], s21 offen offset:0 lds
  s_add_u32 m0, s23, 0x8800
  v_mfma_f32_16x16x32_bf16 v[156:159], a[128:131], a[28:31], v[156:159]
  ds_read_b64_tr_b16 a[18:19], v238 offset:8704
  v_mfma_f32_16x16x32_bf16 v[152:155], a[124:127], a[28:31], v[152:155]
  buffer_load_dwordx4 v230, s[8:11], s21 offen offset:2048 lds
  s_add_u32 m0, s23, 0x9400
  v_mfma_f32_16x16x32_bf16 v[152:155], a[104:107], a[24:27], v[152:155]
  ds_read_b64_tr_b16 a[20:21], v238 offset:20480
  v_mfma_f32_16x16x32_bf16 v[148:151], a[100:103], a[24:27], v[148:151]
  buffer_load_dwordx4 v230, s[8:11], s22 offen offset:0 lds
  s_add_u32 m0, s24, 0x600
  v_mfma_f32_16x16x32_bf16 v[148:151], a[120:123], a[28:31], v[148:151]
  ds_read_b64_tr_b16 a[22:23], v238 offset:20992
  v_mfma_f32_16x16x32_bf16 v[144:147], a[116:119], a[28:31], v[144:147]
  buffer_load_dwordx4 v224, s[4:7], s62 offen offset:512 lds
  s_add_u32 m0, s24, 0xa00
  v_mfma_f32_16x16x32_bf16 v[144:147], a[96:99], a[24:27], v[144:147]
  ds_read_b64_tr_b16 a[24:25], v239 offset:8192
  v_mfma_f32_16x16x32_bf16 v[160:163], a[96:99], a[32:35], v[160:163]
  buffer_load_dwordx4 v225, s[4:7], s62 offen offset:512 lds
  s_add_u32 m0, s24, 0xe00
  v_mfma_f32_16x16x32_bf16 v[160:163], a[116:119], a[36:39], v[160:163]
  ds_read_b64_tr_b16 a[26:27], v239 offset:8704
  v_mfma_f32_16x16x32_bf16 v[164:167], a[120:123], a[36:39], v[164:167]
  buffer_load_dwordx4 v224, s[4:7], s63 offen offset:512 lds
  s_add_u32 m0, s24, 0x1200
  v_mfma_f32_16x16x32_bf16 v[164:167], a[100:103], a[32:35], v[164:167]
  ds_read_b64_tr_b16 a[28:29], v239 offset:20480
  v_mfma_f32_16x16x32_bf16 v[168:171], a[104:107], a[32:35], v[168:171]
  buffer_load_dwordx4 v225, s[4:7], s63 offen offset:512 lds
  s_add_u32 m0, s24, 0x1600
  v_mfma_f32_16x16x32_bf16 v[168:171], a[124:127], a[36:39], v[168:171]
  ds_read_b64_tr_b16 a[30:31], v239 offset:20992
  v_mfma_f32_16x16x32_bf16 v[172:175], a[128:131], a[36:39], v[172:175]
  s_waitcnt lgkmcnt(8)
  buffer_load_dwordx4 v224, s[4:7], s64 offen offset:512 lds
  s_add_u32 m0, s24, 0x1a00
  v_mfma_f32_16x16x32_bf16 v[172:175], a[108:111], a[32:35], v[172:175]
  ds_read_b64_tr_b16 a[32:33], v236 offset:9216
  v_mfma_f32_16x16x32_bf16 v[188:191], a[108:111], a[40:43], v[188:191]
  buffer_load_dwordx4 v225, s[4:7], s64 offen offset:512 lds
  s_add_u32 m0, s24, 0x1e00
  v_mfma_f32_16x16x32_bf16 v[188:191], a[128:131], a[44:47], v[188:191]
  ds_read_b64_tr_b16 a[34:35], v236 offset:9728
  v_mfma_f32_16x16x32_bf16 v[184:187], a[124:127], a[44:47], v[184:187]
  buffer_load_dwordx4 v224, s[4:7], s65 offen offset:512 lds
  v_mfma_f32_16x16x32_bf16 v[184:187], a[104:107], a[40:43], v[184:187]
  ds_read_b64_tr_b16 a[36:37], v236 offset:21504
  s_add_u32 m0, s24, 0x2200
  v_mfma_f32_16x16x32_bf16 v[180:183], a[100:103], a[40:43], v[180:183]
  buffer_load_dwordx4 v225, s[4:7], s65 offen offset:512 lds
  v_mfma_f32_16x16x32_bf16 v[180:183], a[120:123], a[44:47], v[180:183]
  ds_read_b64_tr_b16 a[38:39], v236 offset:22016
  v_mfma_f32_16x16x32_bf16 v[176:179], a[116:119], a[44:47], v[176:179]
  s_add_u32 m0, s24, 0x2600
  v_mfma_f32_16x16x32_bf16 v[176:179], a[96:99], a[40:43], v[176:179]
  ds_read_b64_tr_b16 a[40:41], v237 offset:9216
  v_mfma_f32_16x16x32_bf16 v[0:3], a[0:3], a[56:59], v[0:3]
  buffer_load_dwordx4 v224, s[4:7], s66 offen offset:512 lds
  s_waitcnt vmcnt(31)
  v_mfma_f32_16x16x32_bf16 v[248:251], a[244:247], a[228:231], 0
  v_mfma_f32_16x16x32_bf16 v[0:3], a[4:7], a[76:79], v[0:3]
  ds_read_b64_tr_b16 a[42:43], v237 offset:9728
  s_add_u32 m0, s24, 0x2a00
  v_mfma_f32_16x16x32_bf16 v[4:7], a[4:7], a[80:83], v[4:7]
  buffer_load_dwordx4 v225, s[4:7], s66 offen offset:512 lds
  s_add_u32 s21, s21, 0x60000
  s_add_u32 s22, s22, 0x60000
  v_mfma_f32_16x16x32_bf16 v[4:7], a[0:3], a[60:63], v[4:7]
  ds_read_b64_tr_b16 a[44:45], v237 offset:21504
  v_mfma_f32_16x16x32_bf16 v[248:251], a[244:247], a[232:235], v[248:251]
  v_mfma_f32_16x16x32_bf16 v[8:11], a[0:3], a[64:67], v[8:11]
  v_mfma_f32_16x16x32_bf16 v[252:255], a[244:247], a[236:239], 0
  v_mfma_f32_16x16x32_bf16 v[8:11], a[4:7], a[84:87], v[8:11]
  ds_read_b64_tr_b16 a[46:47], v237 offset:22016
  v_mfma_f32_16x16x32_bf16 v[252:255], a[244:247], a[240:243], v[252:255]
  v_mfma_f32_16x16x32_bf16 v[12:15], a[4:7], a[88:91], v[12:15]
  v_mfma_f32_16x16x32_bf16 v[12:15], a[0:3], a[68:71], v[12:15]
  ds_read_b64_tr_b16 a[0:1], v238 offset:9216
  v_mfma_f32_16x16x32_bf16 v[28:31], a[8:11], a[68:71], v[28:31]
  v_mfma_f32_16x16x32_bf16 v[28:31], a[12:15], a[88:91], v[28:31]
  ds_read_b64_tr_b16 a[2:3], v238 offset:9728
  v_mfma_f32_16x16x32_bf16 v[24:27], a[12:15], a[84:87], v[24:27]
  v_mfma_f32_16x16x32_bf16 v[24:27], a[8:11], a[64:67], v[24:27]
  ds_read_b64_tr_b16 a[4:5], v238 offset:21504
  v_mfma_f32_16x16x32_bf16 v[20:23], a[8:11], a[60:63], v[20:23]
  v_mfma_f32_16x16x32_bf16 v[20:23], a[12:15], a[80:83], v[20:23]
  ds_read_b64_tr_b16 a[6:7], v238 offset:22016
  v_mfma_f32_16x16x32_bf16 v[16:19], a[12:15], a[76:79], v[16:19]
  v_add_f32_dpp v248, v248, v248 row_ror:8 row_mask:0xf bank_mask:0xf
  v_mfma_f32_16x16x32_bf16 v[16:19], a[8:11], a[56:59], v[16:19]
  ds_read_b64_tr_b16 a[8:9], v239 offset:9216
  v_add_f32_dpp v252, v252, v252 row_ror:8 row_mask:0xf bank_mask:0xf
  s_waitcnt lgkmcnt(8)
  v_mfma_f32_16x16x32_bf16 v[32:35], a[16:19], a[56:59], v[32:35]
  v_add_f32_dpp v248, v248, v248 row_ror:4 row_mask:0xf bank_mask:0xf
  v_mfma_f32_16x16x32_bf16 v[32:35], a[20:23], a[76:79], v[32:35]
  ds_read_b64_tr_b16 a[10:11], v239 offset:9728
  v_add_f32_dpp v252, v252, v252 row_ror:4 row_mask:0xf bank_mask:0xf
  v_mfma_f32_16x16x32_bf16 v[36:39], a[20:23], a[80:83], v[36:39]
  v_add_f32_dpp v248, v248, v248 row_ror:2 row_mask:0xf bank_mask:0xf
  v_mfma_f32_16x16x32_bf16 v[36:39], a[16:19], a[60:63], v[36:39]
  ds_read_b64_tr_b16 a[12:13], v239 offset:21504
  v_add_f32_dpp v252, v252, v252 row_ror:2 row_mask:0xf bank_mask:0xf
  v_mfma_f32_16x16x32_bf16 v[40:43], a[16:19], a[64:67], v[40:43]
  v_add_f32_dpp v248, v248, v248 row_ror:1 row_mask:0xf bank_mask:0xf
  v_mfma_f32_16x16x32_bf16 v[40:43], a[20:23], a[84:87], v[40:43]
  ds_read_b64_tr_b16 a[14:15], v239 offset:22016
  v_add_f32_dpp v252, v252, v252 row_ror:1 row_mask:0xf bank_mask:0xf
  v_mfma_f32_16x16x32_bf16 v[44:47], a[20:23], a[88:91], v[44:47]
  v_mul_f32 v248, 0x3a800000, v248
  v_mul_f32 v252, 0x3a800000, v252
  v_mfma_f32_16x16x32_bf16 v[44:47], a[16:19], a[68:71], v[44:47]
  ds_read_b64_tr_b16 a[16:17], v236 offset:10240
  v_mov_b32 v249, 0
  v_mfma_f32_16x16x32_bf16 v[60:63], a[24:27], a[68:71], v[60:63]
  s_waitcnt vmcnt(24)
  ds_read_b128 a[96:99], v226 offset:10240
  v_mov_b32 v253, 0
  v_mfma_f32_16x16x32_bf16 v[60:63], a[28:31], a[88:91], v[60:63]
  ds_read_b64_tr_b16 a[18:19], v236 offset:10752
  v_accvgpr_read_b32 v250, a228
  v_mfma_f32_16x16x32_bf16 v[56:59], a[28:31], a[84:87], v[56:59]
  ds_read_b128 a[116:119], v227 offset:10240
  v_and_b32 v251, s54, v250
  v_mfma_f32_16x16x32_bf16 v[56:59], a[24:27], a[64:67], v[56:59]
  ds_read_b64_tr_b16 a[20:21], v236 offset:22528
  v_lshlrev_b32 v250, 16, v250
  v_mfma_f32_16x16x32_bf16 v[52:55], a[24:27], a[60:63], v[52:55]
  v_sub_f32 v251, v251, v248
  v_sub_f32 v250, v250, v248
  v_mfma_f32_16x16x32_bf16 v[52:55], a[28:31], a[80:83], v[52:55]
  ds_read_b64_tr_b16 a[22:23], v236 offset:23040
  v_fmac_f32 v249, v251, v251
  v_mfma_f32_16x16x32_bf16 v[48:51], a[28:31], a[76:79], v[48:51]
  s_waitcnt vmcnt(22)
  ds_read_b128 a[100:103], v226 offset:12288
  v_fmac_f32 v249, v250, v250
  v_mfma_f32_16x16x32_bf16 v[48:51], a[24:27], a[56:59], v[48:51]
  ds_read_b64_tr_b16 a[24:25], v237 offset:10240
  v_accvgpr_read_b32 v254, a236
  v_mfma_f32_16x16x32_bf16 v[192:195], a[32:35], a[72:75], v[192:195]
  ds_read_b128 a[120:123], v227 offset:12288
  s_add_u32 m0, s24, 0x2d80
  v_mfma_f32_16x16x32_bf16 v[192:195], a[36:39], a[92:95], v[192:195]
  ds_read_b64_tr_b16 a[26:27], v237 offset:10752
  v_and_b32 v255, s54, v254
  v_mfma_f32_16x16x32_bf16 v[64:67], a[36:39], a[76:79], v[64:67]
  s_waitcnt vmcnt(20)
  ds_read_b128 a[104:107], v226 offset:14336
  v_lshlrev_b32 v254, 16, v254
  v_mfma_f32_16x16x32_bf16 v[64:67], a[32:35], a[56:59], v[64:67]
  ds_read_b64_tr_b16 a[28:29], v237 offset:22528
  v_sub_f32 v255, v255, v252
  v_mfma_f32_16x16x32_bf16 v[68:71], a[32:35], a[60:63], v[68:71]
  ds_read_b128 a[124:127], v227 offset:14336
  v_sub_f32 v254, v254, v252
  v_mfma_f32_16x16x32_bf16 v[68:71], a[36:39], a[80:83], v[68:71]
  ds_read_b64_tr_b16 a[30:31], v237 offset:23040
  v_fmac_f32 v253, v255, v255
  v_mfma_f32_16x16x32_bf16 v[72:75], a[36:39], a[84:87], v[72:75]
  s_waitcnt lgkmcnt(8)
  buffer_load_dwordx4 v224, s[4:7], s62 offen offset:640 lds
  s_add_u32 m0, s24, 0x3180
  v_mfma_f32_16x16x32_bf16 v[72:75], a[32:35], a[64:67], v[72:75]
  s_waitcnt vmcnt(19)
  ds_read_b128 a[108:111], v226 offset:16384
  v_fmac_f32 v253, v254, v254
  v_mfma_f32_16x16x32_bf16 v[76:79], a[32:35], a[68:71], v[76:79]
  ds_read_b128 a[128:131], v227 offset:16384
  v_accvgpr_read_b32 v250, a229
  v_mfma_f32_16x16x32_bf16 v[76:79], a[36:39], a[88:91], v[76:79]
  ds_read_b64_tr_b16 a[32:33], v238 offset:10240
  v_and_b32 v251, s54, v250
  v_mfma_f32_16x16x32_bf16 v[92:95], a[44:47], a[88:91], v[92:95]
  buffer_load_dwordx4 v225, s[4:7], s62 offen offset:640 lds
  s_add_u32 m0, s24, 0x3580
  v_mfma_f32_16x16x32_bf16 v[92:95], a[40:43], a[68:71], v[92:95]
  ds_read_b64_tr_b16 a[34:35], v238 offset:10752
  v_lshlrev_b32 v250, 16, v250
  v_mfma_f32_16x16x32_bf16 v[88:91], a[40:43], a[64:67], v[88:91]
  s_waitcnt vmcnt(18)
  ds_read_b128 a[112:115], v226 offset:18432
  v_sub_f32 v251, v251, v248
  v_mfma_f32_16x16x32_bf16 v[88:91], a[44:47], a[84:87], v[88:91]
  ds_read_b64_tr_b16 a[36:37], v238 offset:22528
  v_sub_f32 v250, v250, v248
  v_mfma_f32_16x16x32_bf16 v[84:87], a[44:47], a[80:83], v[84:87]
  ds_read_b128 a[132:135], v227 offset:18432
  v_fmac_f32 v249, v251, v251
  v_mfma_f32_16x16x32_bf16 v[84:87], a[40:43], a[60:63], v[84:87]
  ds_read_b64_tr_b16 a[38:39], v238 offset:23040
  v_fmac_f32 v249, v250, v250
  v_mfma_f32_16x16x32_bf16 v[80:83], a[40:43], a[56:59], v[80:83]
  s_waitcnt lgkmcnt(8)
  buffer_load_dwordx4 v224, s[4:7], s63 offen offset:640 lds
  s_add_u32 m0, s24, 0x3980
  v_mfma_f32_16x16x32_bf16 v[80:83], a[44:47], a[76:79], v[80:83]
  ds_read_b64_tr_b16 a[40:41], v239 offset:10240
  v_accvgpr_read_b32 v254, a237
  v_mfma_f32_16x16x32_bf16 v[96:99], a[4:7], a[76:79], v[96:99]
  ds_read_b64_tr_b16 a[42:43], v239 offset:10752
  v_and_b32 v255, s54, v254
  v_mfma_f32_16x16x32_bf16 v[96:99], a[0:3], a[56:59], v[96:99]
  ds_read_b64_tr_b16 a[44:45], v239 offset:22528
  v_lshlrev_b32 v254, 16, v254
  v_mfma_f32_16x16x32_bf16 v[100:103], a[0:3], a[60:63], v[100:103]
  ds_read_b64_tr_b16 a[46:47], v239 offset:23040
  v_sub_f32 v255, v255, v252
  v_mfma_f32_16x16x32_bf16 v[100:103], a[4:7], a[80:83], v[100:103]
  buffer_load_dwordx4 v225, s[4:7], s63 offen offset:640 lds
  s_add_u32 m0, s24, 0x3d80
  v_mfma_f32_16x16x32_bf16 v[104:107], a[4:7], a[84:87], v[104:107]
  buffer_load_dwordx4 v224, s[4:7], s64 offen offset:640 lds
  s_add_u32 s60, s53, 0x0
  v_mfma_f32_16x16x32_bf16 v[104:107], a[0:3], a[64:67], v[104:107]
  buffer_load_dwordx4 a[136:139], v244, s[8:11], s60 offen
  s_add_u32 m0, s24, 0x4180
  v_mfma_f32_16x16x32_bf16 v[108:111], a[0:3], a[68:71], v[108:111]
  buffer_load_dwordx4 v225, s[4:7], s64 offen offset:640 lds
  s_add_u32 m0, s24, 0x4580
  v_mfma_f32_16x16x32_bf16 v[108:111], a[4:7], a[88:91], v[108:111]
  s_waitcnt lgkmcnt(0)
  s_barrier
  ds_read_b64_tr_b16 a[0:1], v232 offset:8192
  v_sub_f32 v254, v254, v252
  v_mfma_f32_16x16x32_bf16 v[124:127], a[12:15], a[88:91], v[124:127]
  buffer_load_dwordx4 v224, s[4:7], s65 offen offset:640 lds
  s_add_u32 m0, s24, 0x4980
  v_mfma_f32_16x16x32_bf16 v[124:127], a[8:11], a[68:71], v[124:127]
  ds_read_b64_tr_b16 a[2:3], v232 offset:8704
  v_fmac_f32 v253, v255, v255
  v_mfma_f32_16x16x32_bf16 v[120:123], a[8:11], a[64:67], v[120:123]
  buffer_load_dwordx4 v225, s[4:7], s65 offen offset:640 lds
  s_add_u32 m0, s24, 0x4d80
  v_mfma_f32_16x16x32_bf16 v[120:123], a[12:15], a[84:87], v[120:123]
  ds_read_b64_tr_b16 a[4:5], v232 offset:20480
  v_fmac_f32 v253, v254, v254
  v_mfma_f32_16x16x32_bf16 v[116:119], a[12:15], a[80:83], v[116:119]
  buffer_load_dwordx4 v224, s[4:7], s66 offen offset:640 lds
  s_add_u32 m0, s24, 0x5180
  v_mfma_f32_16x16x32_bf16 v[116:119], a[8:11], a[60:63], v[116:119]
  ds_read_b64_tr_b16 a[6:7], v232 offset:20992
  v_accvgpr_read_b32 v250, a230
  v_mfma_f32_16x16x32_bf16 v[112:115], a[8:11], a[56:59], v[112:115]
  buffer_load_dwordx4 v225, s[4:7], s66 offen offset:640 lds
  s_add_u32 s60, s53, 0xc000
  v_mfma_f32_16x16x32_bf16 v[112:115], a[12:15], a[76:79], v[112:115]
  ds_read_b64_tr_b16 a[8:9], v233 offset:8192
  v_and_b32 v251, s54, v250
  v_mfma_f32_16x16x32_bf16 v[196:199], a[92:95], a[20:23], v[196:199]
  buffer_load_dwordx4 a[140:143], v244, s[8:11], s60 offen
  s_add_u32 m0, s23, 0xe000
  v_mfma_f32_16x16x32_bf16 v[196:199], a[72:75], a[16:19], v[196:199]
  ds_read_b64_tr_b16 a[10:11], v233 offset:8704
  v_lshlrev_b32 v250, 16, v250
  v_mfma_f32_16x16x32_bf16 v[128:131], a[56:59], a[16:19], v[128:131]
  buffer_load_dwordx4 v229, s[8:11], s21 offen offset:0 lds
  v_sub_f32 v251, v251, v248
  v_mfma_f32_16x16x32_bf16 v[128:131], a[76:79], a[20:23], v[128:131]
  ds_read_b64_tr_b16 a[12:13], v233 offset:20480
  v_sub_f32 v250, v250, v248
  v_mfma_f32_16x16x32_bf16 v[132:135], a[80:83], a[20:23], v[132:135]
  s_add_u32 m0, s23, 0xdc00
  v_fmac_f32 v249, v251, v251
  v_mfma_f32_16x16x32_bf16 v[132:135], a[60:63], a[16:19], v[132:135]
  ds_read_b64_tr_b16 a[14:15], v233 offset:20992
  v_fmac_f32 v249, v250, v250
  v_mfma_f32_16x16x32_bf16 v[136:139], a[64:67], a[16:19], v[136:139]
  buffer_load_dwordx4 v229, s[8:11], s21 offen offset:2048 lds
  v_accvgpr_read_b32 v254, a238
  v_mfma_f32_16x16x32_bf16 v[136:139], a[84:87], a[20:23], v[136:139]
  v_and_b32 v255, s54, v254
  v_lshlrev_b32 v254, 16, v254
  v_mfma_f32_16x16x32_bf16 v[140:143], a[88:91], a[20:23], v[140:143]
  s_add_u32 s60, s53, 0x18000
  v_sub_f32 v255, v255, v252
  v_mfma_f32_16x16x32_bf16 v[140:143], a[68:71], a[16:19], v[140:143]
  ds_read_b64_tr_b16 a[16:17], v234 offset:8192
  v_sub_f32 v254, v254, v252
  v_mfma_f32_16x16x32_bf16 v[156:159], a[68:71], a[24:27], v[156:159]
  buffer_load_dwordx4 a[144:147], v244, s[8:11], s60 offen
  v_fmac_f32 v253, v255, v255
  v_mfma_f32_16x16x32_bf16 v[156:159], a[88:91], a[28:31], v[156:159]
  ds_read_b64_tr_b16 a[18:19], v234 offset:8704
  v_fmac_f32 v253, v254, v254
  v_mfma_f32_16x16x32_bf16 v[152:155], a[84:87], a[28:31], v[152:155]
  s_add_u32 m0, s23, 0xe800
  v_accvgpr_read_b32 v250, a231
  v_mfma_f32_16x16x32_bf16 v[152:155], a[64:67], a[24:27], v[152:155]
  ds_read_b64_tr_b16 a[20:21], v234 offset:20480
  v_and_b32 v251, s54, v250
  v_mfma_f32_16x16x32_bf16 v[148:151], a[60:63], a[24:27], v[148:151]
  buffer_load_dwordx4 v229, s[8:11], s22 offen offset:0 lds
  v_lshlrev_b32 v250, 16, v250
  v_mfma_f32_16x16x32_bf16 v[148:151], a[80:83], a[28:31], v[148:151]
  ds_read_b64_tr_b16 a[22:23], v234 offset:20992
  v_sub_f32 v251, v251, v248
  v_mfma_f32_16x16x32_bf16 v[144:147], a[76:79], a[28:31], v[144:147]
  s_add_u32 m0, s23, 0xec00
  v_sub_f32 v250, v250, v248
  v_mfma_f32_16x16x32_bf16 v[144:147], a[56:59], a[24:27], v[144:147]
  ds_read_b64_tr_b16 a[24:25], v235 offset:8192
  v_fmac_f32 v249, v251, v251
  v_mfma_f32_16x16x32_bf16 v[160:163], a[56:59], a[32:35], v[160:163]
  buffer_load_dwordx4 v230, s[8:11], s21 offen offset:0 lds
  v_fmac_f32 v249, v250, v250
  v_mfma_f32_16x16x32_bf16 v[160:163], a[76:79], a[36:39], v[160:163]
  ds_read_b64_tr_b16 a[26:27], v235 offset:8704
  v_accvgpr_read_b32 v254, a239
  v_mfma_f32_16x16x32_bf16 v[164:167], a[80:83], a[36:39], v[164:167]
  v_and_b32 v255, s54, v254
  v_lshlrev_b32 v254, 16, v254
  v_mfma_f32_16x16x32_bf16 v[164:167], a[60:63], a[32:35], v[164:167]
  ds_read_b64_tr_b16 a[28:29], v235 offset:20480
  s_add_u32 s60, s53, 0x24000
  v_mfma_f32_16x16x32_bf16 v[168:171], a[64:67], a[32:35], v[168:171]
  buffer_load_dwordx4 a[148:151], v244, s[8:11], s60 offen
  v_sub_f32 v255, v255, v252
  v_mfma_f32_16x16x32_bf16 v[168:171], a[84:87], a[36:39], v[168:171]
  ds_read_b64_tr_b16 a[30:31], v235 offset:20992
  v_sub_f32 v254, v254, v252
  v_mfma_f32_16x16x32_bf16 v[172:175], a[88:91], a[36:39], v[172:175]
  v_fmac_f32 v253, v255, v255
  v_fmac_f32 v253, v254, v254
  v_mfma_f32_16x16x32_bf16 v[172:175], a[68:71], a[32:35], v[172:175]
  ds_read_b64_tr_b16 a[32:33], v232 offset:9216
  s_add_u32 m0, s23, 0xe800
  v_mfma_f32_16x16x32_bf16 v[188:191], a[68:71], a[40:43], v[188:191]
  buffer_load_dwordx4 v230, s[8:11], s21 offen offset:2048 lds
  v_accvgpr_read_b32 v250, a232
  v_mfma_f32_16x16x32_bf16 v[188:191], a[88:91], a[44:47], v[188:191]
  ds_read_b64_tr_b16 a[34:35], v232 offset:9728
  v_and_b32 v251, s54, v250
  v_mfma_f32_16x16x32_bf16 v[184:187], a[84:87], a[44:47], v[184:187]
  v_lshlrev_b32 v250, 16, v250
  v_sub_f32 v251, v251, v248
  v_mfma_f32_16x16x32_bf16 v[184:187], a[64:67], a[40:43], v[184:187]
  ds_read_b64_tr_b16 a[36:37], v232 offset:21504
  s_add_u32 m0, s23, 0xf400
  v_mfma_f32_16x16x32_bf16 v[180:183], a[60:63], a[40:43], v[180:183]
  buffer_load_dwordx4 v230, s[8:11], s22 offen offset:0 lds
  v_sub_f32 v250, v250, v248
  v_mfma_f32_16x16x32_bf16 v[180:183], a[80:83], a[44:47], v[180:183]
  ds_read_b64_tr_b16 a[38:39], v232 offset:22016
  v_fmac_f32 v249, v251, v251
  v_mfma_f32_16x16x32_bf16 v[176:179], a[76:79], a[44:47], v[176:179]
  v_fmac_f32 v249, v250, v250
  v_accvgpr_read_b32 v254, a240
  v_mfma_f32_16x16x32_bf16 v[176:179], a[56:59], a[40:43], v[176:179]
  ds_read_b64_tr_b16 a[40:41], v233 offset:9216
  s_nop 0
  s_waitcnt lgkmcnt(8)
  v_mfma_f32_16x16x32_bf16 v[0:3], a[0:3], a[96:99], v[0:3]
  buffer_load_dwordx2 a[226:227], off, s[32:35], 0 sc1
  s_add_u32 s21, s21, 0x60000
  s_add_u32 s22, s22, 0x60000
  v_mfma_f32_16x16x32_bf16 v[0:3], a[4:7], a[116:119], v[0:3]
  ds_read_b64_tr_b16 a[42:43], v233 offset:9728
  v_and_b32 v255, s54, v254
  v_mfma_f32_16x16x32_bf16 v[4:7], a[4:7], a[120:123], v[4:7]
  s_waitcnt vmcnt(29)
  ds_read_b128 a[56:59], v226 offset:0
  v_lshlrev_b32 v254, 16, v254
  v_mfma_f32_16x16x32_bf16 v[4:7], a[0:3], a[100:103], v[4:7]
  ds_read_b64_tr_b16 a[44:45], v233 offset:21504
  v_sub_f32 v255, v255, v252
  v_mfma_f32_16x16x32_bf16 v[8:11], a[0:3], a[104:107], v[8:11]
  ds_read_b128 a[76:79], v227 offset:0
  v_sub_f32 v254, v254, v252
  v_mfma_f32_16x16x32_bf16 v[8:11], a[4:7], a[124:127], v[8:11]
  ds_read_b64_tr_b16 a[46:47], v233 offset:22016
  v_fmac_f32 v253, v255, v255
  v_mfma_f32_16x16x32_bf16 v[12:15], a[4:7], a[128:131], v[12:15]
  v_fmac_f32 v253, v254, v254
  v_accvgpr_read_b32 v250, a233
  v_mfma_f32_16x16x32_bf16 v[12:15], a[0:3], a[108:111], v[12:15]
  ds_read_b64_tr_b16 a[0:1], v234 offset:9216
  v_and_b32 v251, s54, v250
  v_mfma_f32_16x16x32_bf16 v[28:31], a[8:11], a[108:111], v[28:31]
  s_add_u32 m0, s24, 0x500
  v_lshlrev_b32 v250, 16, v250
  v_mfma_f32_16x16x32_bf16 v[28:31], a[12:15], a[128:131], v[28:31]
  ds_read_b64_tr_b16 a[2:3], v234 offset:9728
  v_sub_f32 v251, v251, v248
  v_mfma_f32_16x16x32_bf16 v[24:27], a[12:15], a[124:127], v[24:27]
  s_waitcnt vmcnt(27)
  ds_read_b128 a[60:63], v226 offset:2048
  v_sub_f32 v250, v250, v248
  v_mfma_f32_16x16x32_bf16 v[24:27], a[8:11], a[104:107], v[24:27]
  ds_read_b64_tr_b16 a[4:5], v234 offset:21504
  v_fmac_f32 v249, v251, v251
  v_mfma_f32_16x16x32_bf16 v[20:23], a[8:11], a[100:103], v[20:23]
  ds_read_b128 a[80:83], v227 offset:2048
  v_fmac_f32 v249, v250, v250
  v_mfma_f32_16x16x32_bf16 v[20:23], a[12:15], a[120:123], v[20:23]
  ds_read_b64_tr_b16 a[6:7], v234 offset:22016
  v_accvgpr_read_b32 v254, a241
  v_mfma_f32_16x16x32_bf16 v[16:19], a[12:15], a[116:119], v[16:19]
  s_waitcnt lgkmcnt(7)
  buffer_load_dwordx4 v224, s[4:7], s62 offen offset:768 lds
  s_add_u32 m0, s24, 0x900
  v_mfma_f32_16x16x32_bf16 v[16:19], a[8:11], a[96:99], v[16:19]
  ds_read_b64_tr_b16 a[8:9], v235 offset:9216
  v_and_b32 v255, s54, v254
  v_mfma_f32_16x16x32_bf16 v[32:35], a[16:19], a[96:99], v[32:35]
  buffer_load_dwordx4 v225, s[4:7], s62 offen offset:768 lds
  s_add_u32 m0, s24, 0xd00
  v_mfma_f32_16x16x32_bf16 v[32:35], a[20:23], a[116:119], v[32:35]
  ds_read_b64_tr_b16 a[10:11], v235 offset:9728
  v_lshlrev_b32 v254, 16, v254
  v_mfma_f32_16x16x32_bf16 v[36:39], a[20:23], a[120:123], v[36:39]
  s_waitcnt lgkmcnt(3)
  buffer_load_dwordx4 v224, s[4:7], s63 offen offset:768 lds
  v_sub_f32 v255, v255, v252
  v_mfma_f32_16x16x32_bf16 v[36:39], a[16:19], a[100:103], v[36:39]
  ds_read_b64_tr_b16 a[12:13], v235 offset:21504
  v_sub_f32 v254, v254, v252
  v_mfma_f32_16x16x32_bf16 v[40:43], a[16:19], a[104:107], v[40:43]
  s_waitcnt vmcnt(28)
  ds_read_b128 a[64:67], v226 offset:4096
  s_add_u32 m0, s24, 0x1100
  v_mfma_f32_16x16x32_bf16 v[40:43], a[20:23], a[124:127], v[40:43]
  ds_read_b64_tr_b16 a[14:15], v235 offset:22016
  v_fmac_f32 v253, v255, v255
  v_mfma_f32_16x16x32_bf16 v[44:47], a[20:23], a[128:131], v[44:47]
  ds_read_b128 a[84:87], v227 offset:4096
  v_fmac_f32 v253, v254, v254
  v_mfma_f32_16x16x32_bf16 v[44:47], a[16:19], a[108:111], v[44:47]
  ds_read_b64_tr_b16 a[16:17], v232 offset:10240
  v_accvgpr_read_b32 v250, a234
  v_mfma_f32_16x16x32_bf16 v[60:63], a[24:27], a[108:111], v[60:63]
  buffer_load_dwordx4 v225, s[4:7], s63 offen offset:768 lds
  s_add_u32 m0, s24, 0x1500
  v_mfma_f32_16x16x32_bf16 v[60:63], a[28:31], a[128:131], v[60:63]
  ds_read_b64_tr_b16 a[18:19], v232 offset:10752
  v_and_b32 v251, s54, v250
  v_mfma_f32_16x16x32_bf16 v[56:59], a[28:31], a[124:127], v[56:59]
  s_waitcnt lgkmcnt(2)
  buffer_load_dwordx4 v224, s[4:7], s64 offen offset:768 lds
  v_lshlrev_b32 v250, 16, v250
  v_mfma_f32_16x16x32_bf16 v[56:59], a[24:27], a[104:107], v[56:59]
  ds_read_b64_tr_b16 a[20:21], v232 offset:22528
  v_sub_f32 v251, v251, v248
  v_mfma_f32_16x16x32_bf16 v[52:55], a[24:27], a[100:103], v[52:55]
  s_add_u32 s60, s53, 0x30000
  v_sub_f32 v250, v250, v248
  v_mfma_f32_16x16x32_bf16 v[52:55], a[28:31], a[120:123], v[52:55]
  ds_read_b64_tr_b16 a[22:23], v232 offset:23040
  v_fmac_f32 v249, v251, v251
  v_mfma_f32_16x16x32_bf16 v[48:51], a[28:31], a[116:119], v[48:51]
  s_waitcnt vmcnt(28)
  ds_read_b128 a[68:71], v226 offset:6144
  v_fmac_f32 v249, v250, v250
  v_mfma_f32_16x16x32_bf16 v[48:51], a[24:27], a[96:99], v[48:51]
  ds_read_b64_tr_b16 a[24:25], v233 offset:10240
  v_accvgpr_read_b32 v254, a242
  v_mfma_f32_16x16x32_bf16 v[192:195], a[32:35], a[112:115], v[192:195]
  ds_read_b128 a[88:91], v227 offset:6144
  v_and_b32 v255, s54, v254
  v_mfma_f32_16x16x32_bf16 v[192:195], a[36:39], a[132:135], v[192:195]
  ds_read_b64_tr_b16 a[26:27], v233 offset:10752
  v_lshlrev_b32 v254, 16, v254
  v_mfma_f32_16x16x32_bf16 v[64:67], a[36:39], a[116:119], v[64:67]
  buffer_load_dwordx4 a[152:155], v244, s[8:11], s60 offen
  s_add_u32 m0, s24, 0x1900
  v_mfma_f32_16x16x32_bf16 v[64:67], a[32:35], a[96:99], v[64:67]
  ds_read_b64_tr_b16 a[28:29], v233 offset:22528
  v_sub_f32 v255, v255, v252
  v_mfma_f32_16x16x32_bf16 v[68:71], a[32:35], a[100:103], v[68:71]
  buffer_load_dwordx4 v225, s[4:7], s64 offen offset:768 lds
  s_add_u32 m0, s24, 0x1d00
  v_mfma_f32_16x16x32_bf16 v[68:71], a[36:39], a[120:123], v[68:71]
  ds_read_b64_tr_b16 a[30:31], v233 offset:23040
  v_sub_f32 v254, v254, v252
  v_mfma_f32_16x16x32_bf16 v[72:75], a[36:39], a[124:127], v[72:75]
  s_waitcnt lgkmcnt(3)
  buffer_load_dwordx4 v224, s[4:7], s65 offen offset:768 lds
  v_fmac_f32 v253, v255, v255
  v_mfma_f32_16x16x32_bf16 v[72:75], a[32:35], a[104:107], v[72:75]
  s_waitcnt vmcnt(29)
  ds_read_b128 a[72:75], v226 offset:8192
  v_fmac_f32 v253, v254, v254
  v_mfma_f32_16x16x32_bf16 v[76:79], a[32:35], a[108:111], v[76:79]
  ds_read_b128 a[92:95], v227 offset:8192
  s_add_u32 m0, s24, 0x2100
  v_mfma_f32_16x16x32_bf16 v[76:79], a[36:39], a[128:131], v[76:79]
  ds_read_b64_tr_b16 a[32:33], v234 offset:10240
  v_accvgpr_read_b32 v250, a235
  v_mfma_f32_16x16x32_bf16 v[92:95], a[44:47], a[128:131], v[92:95]
  buffer_load_dwordx4 v225, s[4:7], s65 offen offset:768 lds
  v_and_b32 v251, s54, v250
  v_mfma_f32_16x16x32_bf16 v[92:95], a[40:43], a[108:111], v[92:95]
  ds_read_b64_tr_b16 a[34:35], v234 offset:10752
  v_lshlrev_b32 v250, 16, v250
  v_mfma_f32_16x16x32_bf16 v[88:91], a[40:43], a[104:107], v[88:91]
  s_add_u32 m0, s24, 0x2500
  v_sub_f32 v251, v251, v248
  v_mfma_f32_16x16x32_bf16 v[88:91], a[44:47], a[124:127], v[88:91]
  ds_read_b64_tr_b16 a[36:37], v234 offset:22528
  v_sub_f32 v250, v250, v248
  v_mfma_f32_16x16x32_bf16 v[84:87], a[44:47], a[120:123], v[84:87]
  s_waitcnt lgkmcnt(3)
  buffer_load_dwordx4 v224, s[4:7], s66 offen offset:768 lds
  v_fmac_f32 v249, v251, v251
  v_mfma_f32_16x16x32_bf16 v[84:87], a[40:43], a[100:103], v[84:87]
  ds_read_b64_tr_b16 a[38:39], v234 offset:23040
  v_fmac_f32 v249, v250, v250
  v_mfma_f32_16x16x32_bf16 v[80:83], a[40:43], a[96:99], v[80:83]
  s_add_u32 m0, s24, 0x2900
  v_accvgpr_read_b32 v254, a243
  v_mfma_f32_16x16x32_bf16 v[80:83], a[44:47], a[116:119], v[80:83]
  ds_read_b64_tr_b16 a[40:41], v235 offset:10240
  v_and_b32 v255, s54, v254
  v_mfma_f32_16x16x32_bf16 v[96:99], a[4:7], a[116:119], v[96:99]
  ds_read_b64_tr_b16 a[42:43], v235 offset:10752
  v_lshlrev_b32 v254, 16, v254
  v_mfma_f32_16x16x32_bf16 v[96:99], a[0:3], a[96:99], v[96:99]
  ds_read_b64_tr_b16 a[44:45], v235 offset:22528
  v_sub_f32 v255, v255, v252
  v_mfma_f32_16x16x32_bf16 v[100:103], a[0:3], a[100:103], v[100:103]
  ds_read_b64_tr_b16 a[46:47], v235 offset:23040
  v_sub_f32 v254, v254, v252
  v_mfma_f32_16x16x32_bf16 v[100:103], a[4:7], a[120:123], v[100:103]
  buffer_load_dwordx4 v225, s[4:7], s66 offen offset:768 lds
  s_add_u32 s60, s53, 0x3c000
  v_mfma_f32_16x16x32_bf16 v[104:107], a[4:7], a[124:127], v[104:107]
  buffer_load_dwordx4 a[156:159], v244, s[8:11], s60 offen
  v_fmac_f32 v253, v255, v255
  v_mfma_f32_16x16x32_bf16 v[104:107], a[0:3], a[104:107], v[104:107]
  v_fmac_f32 v253, v254, v254
  v_mfma_f32_16x16x32_bf16 v[108:111], a[0:3], a[108:111], v[108:111]
  v_mfma_f32_16x16x32_bf16 v[108:111], a[4:7], a[128:131], v[108:111]
  s_waitcnt lgkmcnt(0)
  s_barrier
  ds_read_b64_tr_b16 a[0:1], v232 offset:32768
  v_add_f32_dpp v249, v249, v249 row_ror:8 row_mask:0xf bank_mask:0xf
  v_mfma_f32_16x16x32_bf16 v[124:127], a[12:15], a[128:131], v[124:127]
  s_add_u32 m0, s23, 0x2000
  v_add_f32_dpp v253, v253, v253 row_ror:8 row_mask:0xf bank_mask:0xf
  v_mfma_f32_16x16x32_bf16 v[124:127], a[8:11], a[108:111], v[124:127]
  ds_read_b64_tr_b16 a[2:3], v232 offset:33280
  v_add_f32_dpp v249, v249, v249 row_ror:4 row_mask:0xf bank_mask:0xf
  v_mfma_f32_16x16x32_bf16 v[120:123], a[8:11], a[104:107], v[120:123]
  buffer_load_dwordx4 v229, s[8:11], s21 offen offset:0 lds
  v_add_f32_dpp v253, v253, v253 row_ror:4 row_mask:0xf bank_mask:0xf
  v_mfma_f32_16x16x32_bf16 v[120:123], a[12:15], a[124:127], v[120:123]
  ds_read_b64_tr_b16 a[4:5], v232 offset:45056
  v_add_f32_dpp v249, v249, v249 row_ror:2 row_mask:0xf bank_mask:0xf
  v_mfma_f32_16x16x32_bf16 v[116:119], a[12:15], a[120:123], v[116:119]
  v_add_f32_dpp v253, v253, v253 row_ror:2 row_mask:0xf bank_mask:0xf
  v_mfma_f32_16x16x32_bf16 v[116:119], a[8:11], a[100:103], v[116:119]
  ds_read_b64_tr_b16 a[6:7], v232 offset:45568
  s_add_u32 m0, s23, 0x1c00
  v_mfma_f32_16x16x32_bf16 v[112:115], a[8:11], a[96:99], v[112:115]
  buffer_load_dwordx4 v229, s[8:11], s21 offen offset:2048 lds
  v_add_f32_dpp v249, v249, v249 row_ror:1 row_mask:0xf bank_mask:0xf
  v_mfma_f32_16x16x32_bf16 v[112:115], a[12:15], a[116:119], v[112:115]
  ds_read_b64_tr_b16 a[8:9], v233 offset:32768
  v_add_f32_dpp v253, v253, v253 row_ror:1 row_mask:0xf bank_mask:0xf
  v_mfma_f32_16x16x32_bf16 v[196:199], a[132:135], a[20:23], v[196:199]
  v_mov_b32 v250, v249
  v_mfma_f32_16x16x32_bf16 v[196:199], a[112:115], a[16:19], v[196:199]
  ds_read_b64_tr_b16 a[10:11], v233 offset:33280
  v_mov_b32 v254, v253
  v_mfma_f32_16x16x32_bf16 v[128:131], a[96:99], a[16:19], v[128:131]
  v_mfma_f32_16x16x32_bf16 v[128:131], a[116:119], a[20:23], v[128:131]
  ds_read_b64_tr_b16 a[12:13], v233 offset:45056
  s_add_u32 m0, s23, 0x2800
  v_mfma_f32_16x16x32_bf16 v[132:135], a[120:123], a[20:23], v[132:135]
  buffer_load_dwordx4 v229, s[8:11], s22 offen offset:0 lds
  v_permlane16_swap_b32 v249, v250
  v_mfma_f32_16x16x32_bf16 v[132:135], a[100:103], a[16:19], v[132:135]
  ds_read_b64_tr_b16 a[14:15], v233 offset:45568
  v_permlane16_swap_b32 v253, v254
  v_mfma_f32_16x16x32_bf16 v[136:139], a[104:107], a[16:19], v[136:139]
  v_add_f32 v249, v249, v250
  v_mfma_f32_16x16x32_bf16 v[136:139], a[124:127], a[20:23], v[136:139]
  v_add_f32 v253, v253, v254
  v_mfma_f32_16x16x32_bf16 v[140:143], a[128:131], a[20:23], v[140:143]
  v_mov_b32 v250, v249
  v_mfma_f32_16x16x32_bf16 v[140:143], a[108:111], a[16:19], v[140:143]
  ds_read_b64_tr_b16 a[16:17], v234 offset:32768
  s_add_u32 s60, s53, 0x48000
  v_mfma_f32_16x16x32_bf16 v[156:159], a[108:111], a[24:27], v[156:159]
  buffer_load_dwordx4 a[160:163], v244, s[8:11], s60 offen
  v_mov_b32 v254, v253
  v_mfma_f32_16x16x32_bf16 v[156:159], a[128:131], a[28:31], v[156:159]
  ds_read_b64_tr_b16 a[18:19], v234 offset:33280
  v_mfma_f32_16x16x32_bf16 v[152:155], a[124:127], a[28:31], v[152:155]
  v_permlane32_swap_b32 v249, v250
  v_mfma_f32_16x16x32_bf16 v[152:155], a[104:107], a[24:27], v[152:155]
  ds_read_b64_tr_b16 a[20:21], v234 offset:45056
  v_permlane32_swap_b32 v253, v254
  v_mfma_f32_16x16x32_bf16 v[148:151], a[100:103], a[24:27], v[148:151]
  v_add_f32 v249, v249, v250
  v_mfma_f32_16x16x32_bf16 v[148:151], a[120:123], a[28:31], v[148:151]
  ds_read_b64_tr_b16 a[22:23], v234 offset:45568
  s_add_u32 m0, s23, 0x2c00
  v_mfma_f32_16x16x32_bf16 v[144:147], a[116:119], a[28:31], v[144:147]
  buffer_load_dwordx4 v230, s[8:11], s21 offen offset:0 lds
  v_add_f32 v253, v253, v254
  v_mfma_f32_16x16x32_bf16 v[144:147], a[96:99], a[24:27], v[144:147]
  ds_read_b64_tr_b16 a[24:25], v235 offset:32768
  v_cndmask_b32 v248, v248, v252, vcc
  v_mfma_f32_16x16x32_bf16 v[160:163], a[96:99], a[32:35], v[160:163]
  v_cndmask_b32 v249, v249, v253, vcc
  v_mfma_f32_16x16x32_bf16 v[160:163], a[116:119], a[36:39], v[160:163]
  ds_read_b64_tr_b16 a[26:27], v235 offset:33280
  v_mul_f32 v249, 0x3a800000, v249
  v_mfma_f32_16x16x32_bf16 v[164:167], a[120:123], a[36:39], v[164:167]
  s_add_u32 m0, s23, 0x2800
  v_cvt_pk_bf16_f32 v252, -v248, -v248
  v_mfma_f32_16x16x32_bf16 v[164:167], a[100:103], a[32:35], v[164:167]
  ds_read_b64_tr_b16 a[28:29], v235 offset:45056
  v_cvt_pk_bf16_f32 v249, v249, v249
  v_mfma_f32_16x16x32_bf16 v[168:171], a[104:107], a[32:35], v[168:171]
  buffer_load_dwordx4 v230, s[8:11], s21 offen offset:2048 lds
  v_and_b32 v249, s54, v249
  v_mfma_f32_16x16x32_bf16 v[168:171], a[124:127], a[36:39], v[168:171]
  ds_read_b64_tr_b16 a[30:31], v235 offset:45568
  v_add_f32 v249, 0x3727c5ac, v249
  v_mfma_f32_16x16x32_bf16 v[172:175], a[128:131], a[36:39], v[172:175]
  v_cvt_pk_bf16_f32 v249, v249, v249
  v_mfma_f32_16x16x32_bf16 v[172:175], a[108:111], a[32:35], v[172:175]
  ds_read_b64_tr_b16 a[32:33], v232 offset:33792
  v_and_b32 v249, s54, v249
  v_mfma_f32_16x16x32_bf16 v[188:191], a[108:111], a[40:43], v[188:191]
  s_add_u32 m0, s23, 0x3400
  v_sqrt_f32 v249, v249
  v_mfma_f32_16x16x32_bf16 v[188:191], a[128:131], a[44:47], v[188:191]
  ds_read_b64_tr_b16 a[34:35], v232 offset:34304
  v_mov_b32 v254, v252
  v_mfma_f32_16x16x32_bf16 v[184:187], a[124:127], a[44:47], v[184:187]
  buffer_load_dwordx4 v230, s[8:11], s22 offen offset:0 lds
  v_cvt_pk_bf16_f32 v253, -v248, v249
  v_mfma_f32_16x16x32_bf16 v[184:187], a[104:107], a[40:43], v[184:187]
  ds_read_b64_tr_b16 a[36:37], v232 offset:46080
  v_and_b32 v249, s54, v253
  v_mfma_f32_16x16x32_bf16 v[180:183], a[100:103], a[40:43], v[180:183]
  v_rcp_f32 v249, v249
  v_mfma_f32_16x16x32_bf16 v[180:183], a[120:123], a[44:47], v[180:183]
  ds_read_b64_tr_b16 a[38:39], v232 offset:46592
  v_mov_b32 v255, v253
  v_mfma_f32_16x16x32_bf16 v[176:179], a[116:119], a[44:47], v[176:179]
  s_add_u32 s60, s53, 0x54000
  v_lshrrev_b32 v250, 2, v228
  v_mfma_f32_16x16x32_bf16 v[176:179], a[96:99], a[40:43], v[176:179]
  ds_read_b64_tr_b16 a[40:41], v233 offset:33792
  s_lshr_b32 s61, s67, 7
  s_add_u32 s61, s61, 0x10000
  s_mov_b64 exec, 3
  buffer_store_dwordx4 v[252:255], v228, s[16:19], s61 offen sc1
  s_mov_b64 exec, -1
  s_waitcnt lgkmcnt(8)
  v_mfma_f32_16x16x32_bf16 v[0:3], a[0:3], a[56:59], v[0:3]
  buffer_load_dwordx4 a[164:167], v244, s[8:11], s60 offen
  s_add_u32 s21, s21, 0x60000
  s_add_u32 s22, s22, 0x60000
  v_mfma_f32_16x16x32_bf16 v[0:3], a[4:7], a[76:79], v[0:3]
  ds_read_b64_tr_b16 a[42:43], v233 offset:34304
  s_lshr_b32 s61, s67, 9
  s_add_u32 s61, s61, 0x20000
  s_mov_b64 exec, 3
  buffer_store_dword v249, v250, s[16:19], s61 offen sc1
  s_mov_b64 exec, -1
  v_mfma_f32_16x16x32_bf16 v[4:7], a[4:7], a[80:83], v[4:7]
  s_waitcnt vmcnt(41)
  ds_read_b128 a[96:99], v226 offset:10240
  v_mfma_f32_16x16x32_bf16 v[4:7], a[0:3], a[60:63], v[4:7]
  ds_read_b64_tr_b16 a[44:45], v233 offset:46080
  v_mfma_f32_16x16x32_bf16 v[8:11], a[0:3], a[64:67], v[8:11]
  ds_read_b128 a[116:119], v227 offset:10240
  v_mfma_f32_16x16x32_bf16 v[8:11], a[4:7], a[84:87], v[8:11]
  ds_read_b64_tr_b16 a[46:47], v233 offset:46592
  v_mfma_f32_16x16x32_bf16 v[12:15], a[4:7], a[88:91], v[12:15]
  s_waitcnt vmcnt(37)
  v_mfma_f32_16x16x32_bf16 v[248:251], a[220:223], a[136:139], 0
  v_mfma_f32_16x16x32_bf16 v[12:15], a[0:3], a[68:71], v[12:15]
  ds_read_b64_tr_b16 a[0:1], v234 offset:33792
  v_mfma_f32_16x16x32_bf16 v[28:31], a[8:11], a[68:71], v[28:31]
  s_add_u32 m0, s24, 0x2c80
  v_mfma_f32_16x16x32_bf16 v[28:31], a[12:15], a[88:91], v[28:31]
  ds_read_b64_tr_b16 a[2:3], v234 offset:34304
  v_mfma_f32_16x16x32_bf16 v[24:27], a[12:15], a[84:87], v[24:27]
  ds_read_b128 a[100:103], v226 offset:12288
  s_waitcnt vmcnt(31)
  v_mfma_f32_16x16x32_bf16 v[248:251], a[220:223], a[140:143], v[248:251]
  v_mfma_f32_16x16x32_bf16 v[24:27], a[8:11], a[64:67], v[24:27]
  ds_read_b64_tr_b16 a[4:5], v234 offset:46080
  v_mfma_f32_16x16x32_bf16 v[20:23], a[8:11], a[60:63], v[20:23]
  ds_read_b128 a[120:123], v227 offset:12288
  v_mfma_f32_16x16x32_bf16 v[20:23], a[12:15], a[80:83], v[20:23]
  ds_read_b64_tr_b16 a[6:7], v234 offset:46592
  v_mfma_f32_16x16x32_bf16 v[16:19], a[12:15], a[76:79], v[16:19]
  s_waitcnt lgkmcnt(7)
  buffer_load_dwordx4 v224, s[4:7], s62 offen offset:896 lds
  s_add_u32 m0, s24, 0x3080
  v_mfma_f32_16x16x32_bf16 v[16:19], a[8:11], a[56:59], v[16:19]
  ds_read_b64_tr_b16 a[8:9], v235 offset:33792
  v_mfma_f32_16x16x32_bf16 v[32:35], a[16:19], a[56:59], v[32:35]
  buffer_load_dwordx4 v225, s[4:7], s62 offen offset:896 lds
  s_add_u32 m0, s24, 0x3480
  v_mfma_f32_16x16x32_bf16 v[32:35], a[20:23], a[76:79], v[32:35]
  ds_read_b64_tr_b16 a[10:11], v235 offset:34304
  v_mfma_f32_16x16x32_bf16 v[36:39], a[20:23], a[80:83], v[36:39]
  s_waitcnt lgkmcnt(3)
  buffer_load_dwordx4 v224, s[4:7], s63 offen offset:896 lds
  v_mfma_f32_16x16x32_bf16 v[36:39], a[16:19], a[60:63], v[36:39]
  ds_read_b64_tr_b16 a[12:13], v235 offset:46080
  v_mfma_f32_16x16x32_bf16 v[40:43], a[16:19], a[64:67], v[40:43]
  ds_read_b128 a[104:107], v226 offset:14336
  s_add_u32 m0, s24, 0x3880
  v_mfma_f32_16x16x32_bf16 v[40:43], a[20:23], a[84:87], v[40:43]
  ds_read_b64_tr_b16 a[14:15], v235 offset:46592
  v_mfma_f32_16x16x32_bf16 v[44:47], a[20:23], a[88:91], v[44:47]
  ds_read_b128 a[124:127], v227 offset:14336
  v_mfma_f32_16x16x32_bf16 v[44:47], a[16:19], a[68:71], v[44:47]
  ds_read_b64_tr_b16 a[16:17], v232 offset:34816
  v_mfma_f32_16x16x32_bf16 v[60:63], a[24:27], a[68:71], v[60:63]
  buffer_load_dwordx4 v225, s[4:7], s63 offen offset:896 lds
  s_add_u32 m0, s24, 0x3c80
  v_mfma_f32_16x16x32_bf16 v[60:63], a[28:31], a[88:91], v[60:63]
  ds_read_b64_tr_b16 a[18:19], v232 offset:35328
  v_mfma_f32_16x16x32_bf16 v[56:59], a[28:31], a[84:87], v[56:59]
  s_waitcnt lgkmcnt(2)
  buffer_load_dwordx4 v224, s[4:7], s64 offen offset:896 lds
  v_mfma_f32_16x16x32_bf16 v[56:59], a[24:27], a[64:67], v[56:59]
  ds_read_b64_tr_b16 a[20:21], v232 offset:47104
  v_mfma_f32_16x16x32_bf16 v[52:55], a[24:27], a[60:63], v[52:55]
  s_add_u32 s60, s53, 0x60000
  v_mfma_f32_16x16x32_bf16 v[52:55], a[28:31], a[80:83], v[52:55]
  ds_read_b64_tr_b16 a[22:23], v232 offset:47616
  v_mfma_f32_16x16x32_bf16 v[48:51], a[28:31], a[76:79], v[48:51]
  ds_read_b128 a[108:111], v226 offset:16384
  v_mfma_f32_16x16x32_bf16 v[48:51], a[24:27], a[56:59], v[48:51]
  ds_read_b64_tr_b16 a[24:25], v233 offset:34816
  v_mfma_f32_16x16x32_bf16 v[192:195], a[32:35], a[72:75], v[192:195]
  ds_read_b128 a[128:131], v227 offset:16384
  v_mfma_f32_16x16x32_bf16 v[192:195], a[36:39], a[92:95], v[192:195]
  ds_read_b64_tr_b16 a[26:27], v233 offset:35328
  v_mfma_f32_16x16x32_bf16 v[64:67], a[36:39], a[76:79], v[64:67]
  buffer_load_dwordx4 a[168:171], v244, s[8:11], s60 offen
  s_add_u32 m0, s24, 0x4080
  v_mfma_f32_16x16x32_bf16 v[64:67], a[32:35], a[56:59], v[64:67]
  ds_read_b64_tr_b16 a[28:29], v233 offset:47104
  v_mfma_f32_16x16x32_bf16 v[68:71], a[32:35], a[60:63], v[68:71]
  buffer_load_dwordx4 v225, s[4:7], s64 offen offset:896 lds
  s_add_u32 m0, s24, 0x4480
  v_mfma_f32_16x16x32_bf16 v[68:71], a[36:39], a[80:83], v[68:71]
  ds_read_b64_tr_b16 a[30:31], v233 offset:47616
  v_mfma_f32_16x16x32_bf16 v[72:75], a[36:39], a[84:87], v[72:75]
  s_waitcnt lgkmcnt(3)
  buffer_load_dwordx4 v224, s[4:7], s65 offen offset:896 lds
  v_mfma_f32_16x16x32_bf16 v[72:75], a[32:35], a[64:67], v[72:75]
  ds_read_b128 a[112:115], v226 offset:18432
  v_mfma_f32_16x16x32_bf16 v[76:79], a[32:35], a[68:71], v[76:79]
  ds_read_b128 a[132:135], v227 offset:18432
  s_add_u32 m0, s24, 0x4880
  v_mfma_f32_16x16x32_bf16 v[76:79], a[36:39], a[88:91], v[76:79]
  ds_read_b64_tr_b16 a[32:33], v234 offset:34816
  v_mfma_f32_16x16x32_bf16 v[92:95], a[44:47], a[88:91], v[92:95]
  buffer_load_dwordx4 v225, s[4:7], s65 offen offset:896 lds
  v_mfma_f32_16x16x32_bf16 v[92:95], a[40:43], a[68:71], v[92:95]
  ds_read_b64_tr_b16 a[34:35], v234 offset:35328
  v_mfma_f32_16x16x32_bf16 v[88:91], a[40:43], a[64:67], v[88:91]
  s_add_u32 m0, s24, 0x4c80
  v_mfma_f32_16x16x32_bf16 v[88:91], a[44:47], a[84:87], v[88:91]
  ds_read_b64_tr_b16 a[36:37], v234 offset:47104
  v_mfma_f32_16x16x32_bf16 v[84:87], a[44:47], a[80:83], v[84:87]
  s_waitcnt lgkmcnt(3)
  buffer_load_dwordx4 v224, s[4:7], s66 offen offset:896 lds
  v_mfma_f32_16x16x32_bf16 v[84:87], a[40:43], a[60:63], v[84:87]
  ds_read_b64_tr_b16 a[38:39], v234 offset:47616
  v_mfma_f32_16x16x32_bf16 v[80:83], a[40:43], a[56:59], v[80:83]
  s_add_u32 m0, s24, 0x5080
  v_mfma_f32_16x16x32_bf16 v[80:83], a[44:47], a[76:79], v[80:83]
  ds_read_b64_tr_b16 a[40:41], v235 offset:34816
  v_mfma_f32_16x16x32_bf16 v[96:99], a[4:7], a[76:79], v[96:99]
  ds_read_b64_tr_b16 a[42:43], v235 offset:35328
  s_waitcnt vmcnt(38)
  v_mfma_f32_16x16x32_bf16 v[248:251], a[220:223], a[144:147], v[248:251]
  v_mfma_f32_16x16x32_bf16 v[96:99], a[0:3], a[56:59], v[96:99]
  ds_read_b64_tr_b16 a[44:45], v235 offset:47104
  v_mfma_f32_16x16x32_bf16 v[100:103], a[0:3], a[60:63], v[100:103]
  ds_read_b64_tr_b16 a[46:47], v235 offset:47616
  v_mfma_f32_16x16x32_bf16 v[100:103], a[4:7], a[80:83], v[100:103]
  buffer_load_dwordx4 v225, s[4:7], s66 offen offset:896 lds
  s_add_u32 s60, s53, 0x6c000
  v_mfma_f32_16x16x32_bf16 v[104:107], a[4:7], a[84:87], v[104:107]
  buffer_load_dwordx4 a[172:175], v244, s[8:11], s60 offen
  s_waitcnt vmcnt(37)
  v_mfma_f32_16x16x32_bf16 v[248:251], a[220:223], a[148:151], v[248:251]
  v_mfma_f32_16x16x32_bf16 v[104:107], a[0:3], a[64:67], v[104:107]
  v_mfma_f32_16x16x32_bf16 v[108:111], a[0:3], a[68:71], v[108:111]
  v_mfma_f32_16x16x32_bf16 v[108:111], a[4:7], a[88:91], v[108:111]
  s_waitcnt lgkmcnt(0) vmcnt(35)
  s_barrier
  ds_read_b64_tr_b16 a[0:1], v236 offset:8192
  v_mfma_f32_16x16x32_bf16 v[124:127], a[12:15], a[88:91], v[124:127]
  s_add_u32 m0, s23, 0x8000
  v_mfma_f32_16x16x32_bf16 v[124:127], a[8:11], a[68:71], v[124:127]
  ds_read_b64_tr_b16 a[2:3], v236 offset:8704
  v_mfma_f32_16x16x32_bf16 v[120:123], a[8:11], a[64:67], v[120:123]
  buffer_load_dwordx4 v229, s[8:11], s21 offen offset:0 lds
  v_mfma_f32_16x16x32_bf16 v[120:123], a[12:15], a[84:87], v[120:123]
  ds_read_b64_tr_b16 a[4:5], v236 offset:20480
  v_mfma_f32_16x16x32_bf16 v[116:119], a[12:15], a[80:83], v[116:119]
  v_mfma_f32_16x16x32_bf16 v[116:119], a[8:11], a[60:63], v[116:119]
  ds_read_b64_tr_b16 a[6:7], v236 offset:20992
  s_add_u32 m0, s23, 0x7c00
  v_mfma_f32_16x16x32_bf16 v[112:115], a[8:11], a[56:59], v[112:115]
  buffer_load_dwordx4 v229, s[8:11], s21 offen offset:2048 lds
  v_mfma_f32_16x16x32_bf16 v[112:115], a[12:15], a[76:79], v[112:115]
  ds_read_b64_tr_b16 a[8:9], v237 offset:8192
  v_mfma_f32_16x16x32_bf16 v[196:199], a[92:95], a[20:23], v[196:199]
  v_mfma_f32_16x16x32_bf16 v[196:199], a[72:75], a[16:19], v[196:199]
  ds_read_b64_tr_b16 a[10:11], v237 offset:8704
  v_mfma_f32_16x16x32_bf16 v[128:131], a[56:59], a[16:19], v[128:131]
  v_mfma_f32_16x16x32_bf16 v[128:131], a[76:79], a[20:23], v[128:131]
  ds_read_b64_tr_b16 a[12:13], v237 offset:20480
  s_add_u32 m0, s23, 0x8800
  v_mfma_f32_16x16x32_bf16 v[132:135], a[80:83], a[20:23], v[132:135]
  buffer_load_dwordx4 v229, s[8:11], s22 offen offset:0 lds
  v_mfma_f32_16x16x32_bf16 v[132:135], a[60:63], a[16:19], v[132:135]
  ds_read_b64_tr_b16 a[14:15], v237 offset:20992
  v_mfma_f32_16x16x32_bf16 v[136:139], a[64:67], a[16:19], v[136:139]
  v_mfma_f32_16x16x32_bf16 v[136:139], a[84:87], a[20:23], v[136:139]
  v_mfma_f32_16x16x32_bf16 v[140:143], a[88:91], a[20:23], v[140:143]
  v_mfma_f32_16x16x32_bf16 v[140:143], a[68:71], a[16:19], v[140:143]
  ds_read_b64_tr_b16 a[16:17], v238 offset:8192
  s_add_u32 s60, s53, 0x78000
  v_mfma_f32_16x16x32_bf16 v[156:159], a[68:71], a[24:27], v[156:159]
  buffer_load_dwordx4 a[176:179], v244, s[8:11], s60 offen
  v_mfma_f32_16x16x32_bf16 v[156:159], a[88:91], a[28:31], v[156:159]
  ds_read_b64_tr_b16 a[18:19], v238 offset:8704
  v_mfma_f32_16x16x32_bf16 v[152:155], a[84:87], a[28:31], v[152:155]
  v_mfma_f32_16x16x32_bf16 v[152:155], a[64:67], a[24:27], v[152:155]
  ds_read_b64_tr_b16 a[20:21], v238 offset:20480
  v_mfma_f32_16x16x32_bf16 v[148:151], a[60:63], a[24:27], v[148:151]
  v_mfma_f32_16x16x32_bf16 v[148:151], a[80:83], a[28:31], v[148:151]
  ds_read_b64_tr_b16 a[22:23], v238 offset:20992
  s_add_u32 m0, s23, 0x8c00
  v_mfma_f32_16x16x32_bf16 v[144:147], a[76:79], a[28:31], v[144:147]
  buffer_load_dwordx4 v230, s[8:11], s21 offen offset:0 lds
  v_mfma_f32_16x16x32_bf16 v[144:147], a[56:59], a[24:27], v[144:147]
  ds_read_b64_tr_b16 a[24:25], v239 offset:8192
  v_mfma_f32_16x16x32_bf16 v[160:163], a[56:59], a[32:35], v[160:163]
  v_mfma_f32_16x16x32_bf16 v[160:163], a[76:79], a[36:39], v[160:163]
  ds_read_b64_tr_b16 a[26:27], v239 offset:8704
  v_mfma_f32_16x16x32_bf16 v[164:167], a[80:83], a[36:39], v[164:167]
  s_add_u32 m0, s23, 0x8800
  v_mfma_f32_16x16x32_bf16 v[164:167], a[60:63], a[32:35], v[164:167]
  ds_read_b64_tr_b16 a[28:29], v239 offset:20480
  v_mfma_f32_16x16x32_bf16 v[168:171], a[64:67], a[32:35], v[168:171]
  buffer_load_dwordx4 v230, s[8:11], s21 offen offset:2048 lds
  v_mfma_f32_16x16x32_bf16 v[168:171], a[84:87], a[36:39], v[168:171]
  ds_read_b64_tr_b16 a[30:31], v239 offset:20992
  v_mfma_f32_16x16x32_bf16 v[172:175], a[88:91], a[36:39], v[172:175]
  v_mfma_f32_16x16x32_bf16 v[172:175], a[68:71], a[32:35], v[172:175]
  ds_read_b64_tr_b16 a[32:33], v236 offset:9216
  v_mfma_f32_16x16x32_bf16 v[188:191], a[68:71], a[40:43], v[188:191]
  s_add_u32 m0, s23, 0x9400
  v_mfma_f32_16x16x32_bf16 v[188:191], a[88:91], a[44:47], v[188:191]
  ds_read_b64_tr_b16 a[34:35], v236 offset:9728
  v_mfma_f32_16x16x32_bf16 v[184:187], a[84:87], a[44:47], v[184:187]
  buffer_load_dwordx4 v230, s[8:11], s22 offen offset:0 lds
  v_mfma_f32_16x16x32_bf16 v[184:187], a[64:67], a[40:43], v[184:187]
  ds_read_b64_tr_b16 a[36:37], v236 offset:21504
  v_mfma_f32_16x16x32_bf16 v[180:183], a[60:63], a[40:43], v[180:183]
  v_mfma_f32_16x16x32_bf16 v[180:183], a[80:83], a[44:47], v[180:183]
  ds_read_b64_tr_b16 a[38:39], v236 offset:22016
  v_mfma_f32_16x16x32_bf16 v[176:179], a[76:79], a[44:47], v[176:179]
  s_add_u32 s60, s53, 0x84000
  v_mfma_f32_16x16x32_bf16 v[176:179], a[56:59], a[40:43], v[176:179]
  ds_read_b64_tr_b16 a[40:41], v237 offset:9216
  s_waitcnt lgkmcnt(8)
  v_mfma_f32_16x16x32_bf16 v[0:3], a[0:3], a[96:99], v[0:3]
  buffer_load_dwordx4 a[180:183], v244, s[8:11], s60 offen
  s_add_u32 s21, s21, 0x60000
  s_add_u32 s22, s22, 0x60000
  v_mfma_f32_16x16x32_bf16 v[0:3], a[4:7], a[116:119], v[0:3]
  ds_read_b64_tr_b16 a[42:43], v237 offset:9728
  s_waitcnt vmcnt(36)
  v_mfma_f32_16x16x32_bf16 v[248:251], a[220:223], a[152:155], v[248:251]
  v_mfma_f32_16x16x32_bf16 v[4:7], a[4:7], a[120:123], v[4:7]
  ds_read_b128 a[56:59], v226 offset:0
  v_mfma_f32_16x16x32_bf16 v[4:7], a[0:3], a[100:103], v[4:7]
  ds_read_b64_tr_b16 a[44:45], v237 offset:21504
  v_mfma_f32_16x16x32_bf16 v[8:11], a[0:3], a[104:107], v[8:11]
  ds_read_b128 a[76:79], v227 offset:0
  v_mfma_f32_16x16x32_bf16 v[8:11], a[4:7], a[124:127], v[8:11]
  ds_read_b64_tr_b16 a[46:47], v237 offset:22016
  s_waitcnt vmcnt(30)
  v_mfma_f32_16x16x32_bf16 v[248:251], a[220:223], a[156:159], v[248:251]
  v_mfma_f32_16x16x32_bf16 v[12:15], a[4:7], a[128:131], v[12:15]
  v_mfma_f32_16x16x32_bf16 v[12:15], a[0:3], a[108:111], v[12:15]
  ds_read_b64_tr_b16 a[0:1], v238 offset:9216
  v_mfma_f32_16x16x32_bf16 v[28:31], a[8:11], a[108:111], v[28:31]
  s_add_u32 m0, s24, 0x400
  v_mfma_f32_16x16x32_bf16 v[28:31], a[12:15], a[128:131], v[28:31]
  ds_read_b64_tr_b16 a[2:3], v238 offset:9728
  v_mfma_f32_16x16x32_bf16 v[24:27], a[12:15], a[124:127], v[24:27]
  ds_read_b128 a[60:63], v226 offset:2048
  v_mfma_f32_16x16x32_bf16 v[24:27], a[8:11], a[104:107], v[24:27]
  ds_read_b64_tr_b16 a[4:5], v238 offset:21504
  v_mfma_f32_16x16x32_bf16 v[20:23], a[8:11], a[100:103], v[20:23]
  ds_read_b128 a[80:83], v227 offset:2048
  v_mfma_f32_16x16x32_bf16 v[20:23], a[12:15], a[120:123], v[20:23]
  ds_read_b64_tr_b16 a[6:7], v238 offset:22016
  v_mfma_f32_16x16x32_bf16 v[16:19], a[12:15], a[116:119], v[16:19]
  s_waitcnt lgkmcnt(7)
  buffer_load_dwordx4 v224, s[4:7], s62 offen offset:1024 lds
  s_add_u32 m0, s24, 0x800
  v_mfma_f32_16x16x32_bf16 v[16:19], a[8:11], a[96:99], v[16:19]
  ds_read_b64_tr_b16 a[8:9], v239 offset:9216
  v_mfma_f32_16x16x32_bf16 v[32:35], a[16:19], a[96:99], v[32:35]
  buffer_load_dwordx4 v225, s[4:7], s62 offen offset:1024 lds
  s_add_u32 m0, s24, 0xc00
  v_mfma_f32_16x16x32_bf16 v[32:35], a[20:23], a[116:119], v[32:35]
  ds_read_b64_tr_b16 a[10:11], v239 offset:9728
  v_mfma_f32_16x16x32_bf16 v[36:39], a[20:23], a[120:123], v[36:39]
  s_waitcnt lgkmcnt(3)
  buffer_load_dwordx4 v224, s[4:7], s63 offen offset:1024 lds
  v_mfma_f32_16x16x32_bf16 v[36:39], a[16:19], a[100:103], v[36:39]
  ds_read_b64_tr_b16 a[12:13], v239 offset:21504
  s_add_u32 m0, s24, 0x1000
  v_mfma_f32_16x16x32_bf16 v[40:43], a[16:19], a[104:107], v[40:43]
  ds_read_b128 a[64:67], v226 offset:4096
  v_mfma_f32_16x16x32_bf16 v[40:43], a[20:23], a[124:127], v[40:43]
  ds_read_b64_tr_b16 a[14:15], v239 offset:22016
  v_mfma_f32_16x16x32_bf16 v[44:47], a[20:23], a[128:131], v[44:47]
  ds_read_b128 a[84:87], v227 offset:4096
  v_mfma_f32_16x16x32_bf16 v[44:47], a[16:19], a[108:111], v[44:47]
  ds_read_b64_tr_b16 a[16:17], v236 offset:10240
  v_mfma_f32_16x16x32_bf16 v[60:63], a[24:27], a[108:111], v[60:63]
  buffer_load_dwordx4 v225, s[4:7], s63 offen offset:1024 lds
  s_add_u32 s60, s53, 0x90000
  v_mfma_f32_16x16x32_bf16 v[60:63], a[28:31], a[128:131], v[60:63]
  ds_read_b64_tr_b16 a[18:19], v236 offset:10752
  v_mfma_f32_16x16x32_bf16 v[56:59], a[28:31], a[124:127], v[56:59]
  buffer_load_dwordx4 a[184:187], v244, s[8:11], s60 offen
  s_add_u32 m0, s24, 0x1400
  v_mfma_f32_16x16x32_bf16 v[56:59], a[24:27], a[104:107], v[56:59]
  ds_read_b64_tr_b16 a[20:21], v236 offset:22528
  v_mfma_f32_16x16x32_bf16 v[52:55], a[24:27], a[100:103], v[52:55]
  s_waitcnt lgkmcnt(3)
  buffer_load_dwordx4 v224, s[4:7], s64 offen offset:1024 lds
  v_mfma_f32_16x16x32_bf16 v[52:55], a[28:31], a[120:123], v[52:55]
  ds_read_b64_tr_b16 a[22:23], v236 offset:23040
  v_mfma_f32_16x16x32_bf16 v[48:51], a[28:31], a[116:119], v[48:51]
  ds_read_b128 a[68:71], v226 offset:6144
  s_add_u32 m0, s24, 0x1800
  v_mfma_f32_16x16x32_bf16 v[48:51], a[24:27], a[96:99], v[48:51]
  ds_read_b64_tr_b16 a[24:25], v237 offset:10240
  v_mfma_f32_16x16x32_bf16 v[192:195], a[32:35], a[112:115], v[192:195]
  ds_read_b128 a[88:91], v227 offset:6144
  v_mfma_f32_16x16x32_bf16 v[192:195], a[36:39], a[132:135], v[192:195]
  ds_read_b64_tr_b16 a[26:27], v237 offset:10752
  v_mfma_f32_16x16x32_bf16 v[64:67], a[36:39], a[116:119], v[64:67]
  buffer_load_dwordx4 v225, s[4:7], s64 offen offset:1024 lds
  s_add_u32 m0, s24, 0x1c00
  v_mfma_f32_16x16x32_bf16 v[64:67], a[32:35], a[96:99], v[64:67]
  ds_read_b64_tr_b16 a[28:29], v237 offset:22528
  v_mfma_f32_16x16x32_bf16 v[68:71], a[32:35], a[100:103], v[68:71]
  s_waitcnt lgkmcnt(2)
  buffer_load_dwordx4 v224, s[4:7], s65 offen offset:1024 lds
  v_mfma_f32_16x16x32_bf16 v[68:71], a[36:39], a[120:123], v[68:71]
  ds_read_b64_tr_b16 a[30:31], v237 offset:23040
  v_mfma_f32_16x16x32_bf16 v[72:75], a[36:39], a[124:127], v[72:75]
  s_add_u32 s60, s53, 0x9c000
  v_mfma_f32_16x16x32_bf16 v[72:75], a[32:35], a[104:107], v[72:75]
  ds_read_b128 a[72:75], v226 offset:8192
  v_mfma_f32_16x16x32_bf16 v[76:79], a[32:35], a[108:111], v[76:79]
  ds_read_b128 a[92:95], v227 offset:8192
  v_mfma_f32_16x16x32_bf16 v[76:79], a[36:39], a[128:131], v[76:79]
  ds_read_b64_tr_b16 a[32:33], v238 offset:10240
  v_mfma_f32_16x16x32_bf16 v[92:95], a[44:47], a[128:131], v[92:95]
  buffer_load_dwordx4 a[188:191], v244, s[8:11], s60 offen
  s_add_u32 m0, s24, 0x2000
  v_mfma_f32_16x16x32_bf16 v[92:95], a[40:43], a[108:111], v[92:95]
  ds_read_b64_tr_b16 a[34:35], v238 offset:10752
  v_mfma_f32_16x16x32_bf16 v[88:91], a[40:43], a[104:107], v[88:91]
  buffer_load_dwordx4 v225, s[4:7], s65 offen offset:1024 lds
  v_mfma_f32_16x16x32_bf16 v[88:91], a[44:47], a[124:127], v[88:91]
  ds_read_b64_tr_b16 a[36:37], v238 offset:22528
  s_add_u32 m0, s24, 0x2400
  v_mfma_f32_16x16x32_bf16 v[84:87], a[44:47], a[120:123], v[84:87]
  s_waitcnt lgkmcnt(3)
  buffer_load_dwordx4 v224, s[4:7], s66 offen offset:1024 lds
  v_mfma_f32_16x16x32_bf16 v[84:87], a[40:43], a[100:103], v[84:87]
  ds_read_b64_tr_b16 a[38:39], v238 offset:23040
  v_mfma_f32_16x16x32_bf16 v[80:83], a[40:43], a[96:99], v[80:83]
  v_mfma_f32_16x16x32_bf16 v[80:83], a[44:47], a[116:119], v[80:83]
  ds_read_b64_tr_b16 a[40:41], v239 offset:10240
  s_add_u32 m0, s24, 0x2800
  v_mfma_f32_16x16x32_bf16 v[96:99], a[4:7], a[116:119], v[96:99]
  ds_read_b64_tr_b16 a[42:43], v239 offset:10752
  s_waitcnt vmcnt(37)
  v_mfma_f32_16x16x32_bf16 v[248:251], a[220:223], a[160:163], v[248:251]
  v_mfma_f32_16x16x32_bf16 v[96:99], a[0:3], a[96:99], v[96:99]
  ds_read_b64_tr_b16 a[44:45], v239 offset:22528
  v_mfma_f32_16x16x32_bf16 v[100:103], a[0:3], a[100:103], v[100:103]
  ds_read_b64_tr_b16 a[46:47], v239 offset:23040
  v_mfma_f32_16x16x32_bf16 v[100:103], a[4:7], a[120:123], v[100:103]
  buffer_load_dwordx4 v225, s[4:7], s66 offen offset:1024 lds
  s_and_b32 s60, s2, 1
  s_lshl_b32 s60, s60, 6
  s_add_u32 s60, s60, s55
  s_bfe_u32 s3, s2, 0x20001
  s_lshl_b32 s3, s3, 8
  s_add_u32 s60, s60, s3
  s_add_u32 s60, s60, 0
  s_lshl_b32 s60, s60, 11
  v_mfma_f32_16x16x32_bf16 v[104:107], a[4:7], a[124:127], v[104:107]
  s_mov_b64 exec, 0xffff
  buffer_load_dword a224, v202, s[36:39], s60 offen
  s_mov_b64 exec, -1
  s_waitcnt vmcnt(34)
  v_mfma_f32_16x16x32_bf16 v[248:251], a[220:223], a[164:167], v[248:251]
  v_mfma_f32_16x16x32_bf16 v[104:107], a[0:3], a[104:107], v[104:107]
  v_mfma_f32_16x16x32_bf16 v[108:111], a[0:3], a[108:111], v[108:111]
  v_mfma_f32_16x16x32_bf16 v[108:111], a[4:7], a[128:131], v[108:111]
  s_waitcnt lgkmcnt(0) vmcnt(33)
  s_barrier
  ds_read_b64_tr_b16 a[0:1], v232 offset:8192
  v_mfma_f32_16x16x32_bf16 v[124:127], a[12:15], a[128:131], v[124:127]
  v_accvgpr_read_b32 v252, a226
  v_accvgpr_read_b32 v253, a227
  s_nop 0
  v_readfirstlane_b32 s56, v252
  v_readfirstlane_b32 s57, v253
  s_nop 3
  s_cmp_lg_u32 s56, 0
  s_cbranch_scc0 L_k1_tspin_qkv
L_k1_tback_qkv:
  s_add_u32 m0, s23, 0xe000
  v_mfma_f32_16x16x32_bf16 v[124:127], a[8:11], a[108:111], v[124:127]
  ds_read_b64_tr_b16 a[2:3], v232 offset:8704
  v_mfma_f32_16x16x32_bf16 v[120:123], a[8:11], a[104:107], v[120:123]
  buffer_load_dwordx4 v229, s[8:11], s21 offen offset:0 lds
  v_mfma_f32_16x16x32_bf16 v[120:123], a[12:15], a[124:127], v[120:123]
  ds_read_b64_tr_b16 a[4:5], v232 offset:20480
  v_mfma_f32_16x16x32_bf16 v[116:119], a[12:15], a[120:123], v[116:119]
  s_add_u32 m0, s23, 0xdc00
  v_mfma_f32_16x16x32_bf16 v[116:119], a[8:11], a[100:103], v[116:119]
  ds_read_b64_tr_b16 a[6:7], v232 offset:20992
  v_mfma_f32_16x16x32_bf16 v[112:115], a[8:11], a[96:99], v[112:115]
  buffer_load_dwordx4 v229, s[8:11], s21 offen offset:2048 lds
  v_mfma_f32_16x16x32_bf16 v[112:115], a[12:15], a[116:119], v[112:115]
  ds_read_b64_tr_b16 a[8:9], v233 offset:8192
  v_mfma_f32_16x16x32_bf16 v[196:199], a[132:135], a[20:23], v[196:199]
  v_mfma_f32_16x16x32_bf16 v[196:199], a[112:115], a[16:19], v[196:199]
  ds_read_b64_tr_b16 a[10:11], v233 offset:8704
  s_add_u32 s60, s53, 0xa8000
  v_mfma_f32_16x16x32_bf16 v[128:131], a[96:99], a[16:19], v[128:131]
  buffer_load_dwordx4 a[192:195], v244, s[8:11], s60 offen
  v_mfma_f32_16x16x32_bf16 v[128:131], a[116:119], a[20:23], v[128:131]
  ds_read_b64_tr_b16 a[12:13], v233 offset:20480
  v_mfma_f32_16x16x32_bf16 v[132:135], a[120:123], a[20:23], v[132:135]
  v_mfma_f32_16x16x32_bf16 v[132:135], a[100:103], a[16:19], v[132:135]
  ds_read_b64_tr_b16 a[14:15], v233 offset:20992
  s_add_u32 m0, s23, 0xe800
  v_mfma_f32_16x16x32_bf16 v[136:139], a[104:107], a[16:19], v[136:139]
  buffer_load_dwordx4 v229, s[8:11], s22 offen offset:0 lds
  v_mfma_f32_16x16x32_bf16 v[136:139], a[124:127], a[20:23], v[136:139]
  v_mfma_f32_16x16x32_bf16 v[140:143], a[128:131], a[20:23], v[140:143]
  v_mfma_f32_16x16x32_bf16 v[140:143], a[108:111], a[16:19], v[140:143]
  ds_read_b64_tr_b16 a[16:17], v234 offset:8192
  v_mfma_f32_16x16x32_bf16 v[156:159], a[108:111], a[24:27], v[156:159]
  s_add_u32 s60, s53, 0xb4000
  v_mfma_f32_16x16x32_bf16 v[156:159], a[128:131], a[28:31], v[156:159]
  ds_read_b64_tr_b16 a[18:19], v234 offset:8704
  v_mfma_f32_16x16x32_bf16 v[152:155], a[124:127], a[28:31], v[152:155]
  buffer_load_dwordx4 a[196:199], v244, s[8:11], s60 offen
  v_mfma_f32_16x16x32_bf16 v[152:155], a[104:107], a[24:27], v[152:155]
  ds_read_b64_tr_b16 a[20:21], v234 offset:20480
  v_mfma_f32_16x16x32_bf16 v[148:151], a[100:103], a[24:27], v[148:151]
  v_mfma_f32_16x16x32_bf16 v[148:151], a[120:123], a[28:31], v[148:151]
  ds_read_b64_tr_b16 a[22:23], v234 offset:20992
  s_add_u32 m0, s23, 0xec00
  v_mfma_f32_16x16x32_bf16 v[144:147], a[116:119], a[28:31], v[144:147]
  buffer_load_dwordx4 v230, s[8:11], s21 offen offset:0 lds
  v_mfma_f32_16x16x32_bf16 v[144:147], a[96:99], a[24:27], v[144:147]
  ds_read_b64_tr_b16 a[24:25], v235 offset:8192
  v_mfma_f32_16x16x32_bf16 v[160:163], a[96:99], a[32:35], v[160:163]
  v_mfma_f32_16x16x32_bf16 v[160:163], a[116:119], a[36:39], v[160:163]
  ds_read_b64_tr_b16 a[26:27], v235 offset:8704
  s_add_u32 m0, s23, 0xe800
  v_mfma_f32_16x16x32_bf16 v[164:167], a[120:123], a[36:39], v[164:167]
  buffer_load_dwordx4 v230, s[8:11], s21 offen offset:2048 lds
  v_mfma_f32_16x16x32_bf16 v[164:167], a[100:103], a[32:35], v[164:167]
  ds_read_b64_tr_b16 a[28:29], v235 offset:20480
  v_mfma_f32_16x16x32_bf16 v[168:171], a[104:107], a[32:35], v[168:171]
  v_mfma_f32_16x16x32_bf16 v[168:171], a[124:127], a[36:39], v[168:171]
  ds_read_b64_tr_b16 a[30:31], v235 offset:20992
  v_mfma_f32_16x16x32_bf16 v[172:175], a[128:131], a[36:39], v[172:175]
  s_and_b32 s60, s2, 1
  s_lshl_b32 s60, s60, 6
  s_add_u32 s60, s60, s55
  s_bfe_u32 s3, s2, 0x20001
  s_lshl_b32 s3, s3, 8
  s_add_u32 s60, s60, s3
  s_add_u32 s60, s60, 128
  s_lshl_b32 s60, s60, 11
  v_mfma_f32_16x16x32_bf16 v[172:175], a[108:111], a[32:35], v[172:175]
  ds_read_b64_tr_b16 a[32:33], v232 offset:9216
  v_mfma_f32_16x16x32_bf16 v[188:191], a[108:111], a[40:43], v[188:191]
  s_mov_b64 exec, 0xffff
  buffer_load_dword a224, v202, s[36:39], s60 offen
  s_mov_b64 exec, -1
  v_mfma_f32_16x16x32_bf16 v[188:191], a[128:131], a[44:47], v[188:191]
  ds_read_b64_tr_b16 a[34:35], v232 offset:9728
  v_mfma_f32_16x16x32_bf16 v[184:187], a[124:127], a[44:47], v[184:187]
  s_add_u32 m0, s23, 0xf400
  v_mfma_f32_16x16x32_bf16 v[184:187], a[104:107], a[40:43], v[184:187]
  ds_read_b64_tr_b16 a[36:37], v232 offset:21504
  v_mfma_f32_16x16x32_bf16 v[180:183], a[100:103], a[40:43], v[180:183]
  buffer_load_dwordx4 v230, s[8:11], s22 offen offset:0 lds
  v_mfma_f32_16x16x32_bf16 v[180:183], a[120:123], a[44:47], v[180:183]
  ds_read_b64_tr_b16 a[38:39], v232 offset:22016
  v_mfma_f32_16x16x32_bf16 v[176:179], a[116:119], a[44:47], v[176:179]
  v_mfma_f32_16x16x32_bf16 v[176:179], a[96:99], a[40:43], v[176:179]
  ds_read_b64_tr_b16 a[40:41], v233 offset:9216
  s_lshl_b32 s60, s2, 7
  s_waitcnt lgkmcnt(8)
  v_mfma_f32_16x16x32_bf16 v[0:3], a[0:3], a[56:59], v[0:3]
  s_mov_b64 exec, 1
  buffer_store_dwordx2 a[226:227], off, s[40:43], s60 offset:0 sc1
  s_mov_b64 exec, -1
  s_add_u32 s21, s21, 0x60000
  s_add_u32 s22, s22, 0x60000
  v_mfma_f32_16x16x32_bf16 v[0:3], a[4:7], a[76:79], v[0:3]
  ds_read_b64_tr_b16 a[42:43], v233 offset:9728
  v_lshlrev_b32 v244, 3, v228
  s_add_u32 s28, s58, 0x2000000
  s_addc_u32 s29, s59, 0
  s_mov_b32 s30, 0xc00000
  s_mov_b32 s31, 0x20000
  v_mfma_f32_16x16x32_bf16 v[4:7], a[4:7], a[80:83], v[4:7]
  s_waitcnt vmcnt(41)
  ds_read_b128 a[96:99], v226 offset:10240
  s_waitcnt vmcnt(37)
  v_mfma_f32_16x16x32_bf16 v[248:251], a[220:223], a[168:171], v[248:251]
  v_mfma_f32_16x16x32_bf16 v[4:7], a[0:3], a[60:63], v[4:7]
  ds_read_b64_tr_b16 a[44:45], v233 offset:21504
  v_mfma_f32_16x16x32_bf16 v[8:11], a[0:3], a[64:67], v[8:11]
  ds_read_b128 a[116:119], v227 offset:10240
  v_mfma_f32_16x16x32_bf16 v[8:11], a[4:7], a[84:87], v[8:11]
  ds_read_b64_tr_b16 a[46:47], v233 offset:22016
  v_mfma_f32_16x16x32_bf16 v[12:15], a[4:7], a[88:91], v[12:15]
  s_waitcnt vmcnt(31)
  v_mfma_f32_16x16x32_bf16 v[248:251], a[220:223], a[172:175], v[248:251]
  v_mfma_f32_16x16x32_bf16 v[12:15], a[0:3], a[68:71], v[12:15]
  ds_read_b64_tr_b16 a[0:1], v234 offset:9216
  v_mfma_f32_16x16x32_bf16 v[28:31], a[8:11], a[68:71], v[28:31]
  s_add_u32 m0, s24, 0x2b80
  v_mfma_f32_16x16x32_bf16 v[28:31], a[12:15], a[88:91], v[28:31]
  ds_read_b64_tr_b16 a[2:3], v234 offset:9728
  v_mfma_f32_16x16x32_bf16 v[24:27], a[12:15], a[84:87], v[24:27]
  ds_read_b128 a[100:103], v226 offset:12288
  v_mfma_f32_16x16x32_bf16 v[24:27], a[8:11], a[64:67], v[24:27]
  ds_read_b64_tr_b16 a[4:5], v234 offset:21504
  v_mfma_f32_16x16x32_bf16 v[20:23], a[8:11], a[60:63], v[20:23]
  ds_read_b128 a[120:123], v227 offset:12288
  v_mfma_f32_16x16x32_bf16 v[20:23], a[12:15], a[80:83], v[20:23]
  ds_read_b64_tr_b16 a[6:7], v234 offset:22016
  v_mfma_f32_16x16x32_bf16 v[16:19], a[12:15], a[76:79], v[16:19]
  s_waitcnt lgkmcnt(7)
  buffer_load_dwordx4 v224, s[4:7], s62 offen offset:1152 lds
  s_add_u32 m0, s24, 0x2f80
  v_mfma_f32_16x16x32_bf16 v[16:19], a[8:11], a[56:59], v[16:19]
  ds_read_b64_tr_b16 a[8:9], v235 offset:9216
  v_mfma_f32_16x16x32_bf16 v[32:35], a[16:19], a[56:59], v[32:35]
  buffer_load_dwordx4 v225, s[4:7], s62 offen offset:1152 lds
  v_mfma_f32_16x16x32_bf16 v[32:35], a[20:23], a[76:79], v[32:35]
  ds_read_b64_tr_b16 a[10:11], v235 offset:9728
  s_add_u32 m0, s24, 0x3380
  v_mfma_f32_16x16x32_bf16 v[36:39], a[20:23], a[80:83], v[36:39]
  s_waitcnt lgkmcnt(3)
  buffer_load_dwordx4 v224, s[4:7], s63 offen offset:1152 lds
  v_mfma_f32_16x16x32_bf16 v[36:39], a[16:19], a[60:63], v[36:39]
  ds_read_b64_tr_b16 a[12:13], v235 offset:21504
  v_mfma_f32_16x16x32_bf16 v[40:43], a[16:19], a[64:67], v[40:43]
  ds_read_b128 a[104:107], v226 offset:14336
  v_mfma_f32_16x16x32_bf16 v[40:43], a[20:23], a[84:87], v[40:43]
  ds_read_b64_tr_b16 a[14:15], v235 offset:22016
  v_mfma_f32_16x16x32_bf16 v[44:47], a[20:23], a[88:91], v[44:47]
  ds_read_b128 a[124:127], v227 offset:14336
  s_add_u32 m0, s24, 0x3780
  v_mfma_f32_16x16x32_bf16 v[44:47], a[16:19], a[68:71], v[44:47]
  ds_read_b64_tr_b16 a[16:17], v232 offset:10240
  v_mfma_f32_16x16x32_bf16 v[60:63], a[24:27], a[68:71], v[60:63]
  buffer_load_dwordx4 v225, s[4:7], s63 offen offset:1152 lds
  v_mfma_f32_16x16x32_bf16 v[60:63], a[28:31], a[88:91], v[60:63]
  ds_read_b64_tr_b16 a[18:19], v232 offset:10752
  v_mfma_f32_16x16x32_bf16 v[56:59], a[28:31], a[84:87], v[56:59]
  v_mfma_f32_16x16x32_bf16 v[56:59], a[24:27], a[64:67], v[56:59]
  ds_read_b64_tr_b16 a[20:21], v232 offset:22528
  s_add_u32 m0, s24, 0x3b80
  v_mfma_f32_16x16x32_bf16 v[52:55], a[24:27], a[60:63], v[52:55]
  s_waitcnt lgkmcnt(3)
  buffer_load_dwordx4 v224, s[4:7], s64 offen offset:1152 lds
  v_mfma_f32_16x16x32_bf16 v[52:55], a[28:31], a[80:83], v[52:55]
  ds_read_b64_tr_b16 a[22:23], v232 offset:23040
  v_mfma_f32_16x16x32_bf16 v[48:51], a[28:31], a[76:79], v[48:51]
  ds_read_b128 a[108:111], v226 offset:16384
  v_mfma_f32_16x16x32_bf16 v[48:51], a[24:27], a[56:59], v[48:51]
  ds_read_b64_tr_b16 a[24:25], v233 offset:10240
  v_mfma_f32_16x16x32_bf16 v[192:195], a[32:35], a[72:75], v[192:195]
  ds_read_b128 a[128:131], v227 offset:16384
  s_add_u32 m0, s24, 0x3f80
  v_mfma_f32_16x16x32_bf16 v[192:195], a[36:39], a[92:95], v[192:195]
  ds_read_b64_tr_b16 a[26:27], v233 offset:10752
  v_mfma_f32_16x16x32_bf16 v[64:67], a[36:39], a[76:79], v[64:67]
  buffer_load_dwordx4 v225, s[4:7], s64 offen offset:1152 lds
  v_mfma_f32_16x16x32_bf16 v[64:67], a[32:35], a[56:59], v[64:67]
  ds_read_b64_tr_b16 a[28:29], v233 offset:22528
  v_mfma_f32_16x16x32_bf16 v[68:71], a[32:35], a[60:63], v[68:71]
  v_mfma_f32_16x16x32_bf16 v[68:71], a[36:39], a[80:83], v[68:71]
  ds_read_b64_tr_b16 a[30:31], v233 offset:23040
  s_add_u32 m0, s24, 0x4380
  v_mfma_f32_16x16x32_bf16 v[72:75], a[36:39], a[84:87], v[72:75]
  s_waitcnt lgkmcnt(3)
  buffer_load_dwordx4 v224, s[4:7], s65 offen offset:1152 lds
  v_mfma_f32_16x16x32_bf16 v[72:75], a[32:35], a[64:67], v[72:75]
  ds_read_b128 a[112:115], v226 offset:18432
  v_mfma_f32_16x16x32_bf16 v[76:79], a[32:35], a[68:71], v[76:79]
  ds_read_b128 a[132:135], v227 offset:18432
  v_mfma_f32_16x16x32_bf16 v[76:79], a[36:39], a[88:91], v[76:79]
  ds_read_b64_tr_b16 a[32:33], v234 offset:10240
  v_mfma_f32_16x16x32_bf16 v[92:95], a[44:47], a[88:91], v[92:95]
  s_add_u32 m0, s24, 0x4780
  v_mfma_f32_16x16x32_bf16 v[92:95], a[40:43], a[68:71], v[92:95]
  ds_read_b64_tr_b16 a[34:35], v234 offset:10752
  v_mfma_f32_16x16x32_bf16 v[88:91], a[40:43], a[64:67], v[88:91]
  buffer_load_dwordx4 v225, s[4:7], s65 offen offset:1152 lds
  v_mfma_f32_16x16x32_bf16 v[88:91], a[44:47], a[84:87], v[88:91]
  ds_read_b64_tr_b16 a[36:37], v234 offset:22528
  v_mfma_f32_16x16x32_bf16 v[84:87], a[44:47], a[80:83], v[84:87]
  v_mfma_f32_16x16x32_bf16 v[84:87], a[40:43], a[60:63], v[84:87]
  ds_read_b64_tr_b16 a[38:39], v234 offset:23040
  s_add_u32 m0, s24, 0x4b80
  v_mfma_f32_16x16x32_bf16 v[80:83], a[40:43], a[56:59], v[80:83]
  s_waitcnt lgkmcnt(4)
  buffer_load_dwordx4 v224, s[4:7], s66 offen offset:1152 lds
  v_mfma_f32_16x16x32_bf16 v[80:83], a[44:47], a[76:79], v[80:83]
  ds_read_b64_tr_b16 a[40:41], v235 offset:10240
  v_mfma_f32_16x16x32_bf16 v[96:99], a[4:7], a[76:79], v[96:99]
  ds_read_b64_tr_b16 a[42:43], v235 offset:10752
  s_waitcnt vmcnt(36)
  v_mfma_f32_16x16x32_bf16 v[248:251], a[220:223], a[176:179], v[248:251]
  v_mfma_f32_16x16x32_bf16 v[96:99], a[0:3], a[56:59], v[96:99]
  ds_read_b64_tr_b16 a[44:45], v235 offset:22528
  v_mfma_f32_16x16x32_bf16 v[100:103], a[0:3], a[60:63], v[100:103]
  ds_read_b64_tr_b16 a[46:47], v235 offset:23040
  s_add_u32 m0, s24, 0x4f80
  v_mfma_f32_16x16x32_bf16 v[100:103], a[4:7], a[80:83], v[100:103]
  buffer_load_dwordx4 v225, s[4:7], s66 offen offset:1152 lds
  v_mfma_f32_16x16x32_bf16 v[104:107], a[4:7], a[84:87], v[104:107]
  s_waitcnt vmcnt(33)
  v_mfma_f32_16x16x32_bf16 v[248:251], a[220:223], a[180:183], v[248:251]
  v_mfma_f32_16x16x32_bf16 v[104:107], a[0:3], a[64:67], v[104:107]
  v_mfma_f32_16x16x32_bf16 v[108:111], a[0:3], a[68:71], v[108:111]
  v_mfma_f32_16x16x32_bf16 v[108:111], a[4:7], a[88:91], v[108:111]
  s_waitcnt lgkmcnt(0)
  s_barrier
  ds_read_b64_tr_b16 a[0:1], v232 offset:32768
  v_mfma_f32_16x16x32_bf16 v[124:127], a[12:15], a[88:91], v[124:127]
  s_add_u32 m0, s23, 0x2000
  v_mfma_f32_16x16x32_bf16 v[124:127], a[8:11], a[68:71], v[124:127]
  ds_read_b64_tr_b16 a[2:3], v232 offset:33280
  v_mfma_f32_16x16x32_bf16 v[120:123], a[8:11], a[64:67], v[120:123]
  buffer_load_dwordx4 v229, s[8:11], s21 offen offset:0 lds
  v_mfma_f32_16x16x32_bf16 v[120:123], a[12:15], a[84:87], v[120:123]
  ds_read_b64_tr_b16 a[4:5], v232 offset:45056
  v_mfma_f32_16x16x32_bf16 v[116:119], a[12:15], a[80:83], v[116:119]
  v_mfma_f32_16x16x32_bf16 v[116:119], a[8:11], a[60:63], v[116:119]
  ds_read_b64_tr_b16 a[6:7], v232 offset:45568
  s_add_u32 m0, s23, 0x1c00
  v_mfma_f32_16x16x32_bf16 v[112:115], a[8:11], a[56:59], v[112:115]
  buffer_load_dwordx4 v229, s[8:11], s21 offen offset:2048 lds
  v_mfma_f32_16x16x32_bf16 v[112:115], a[12:15], a[76:79], v[112:115]
  ds_read_b64_tr_b16 a[8:9], v233 offset:32768
  v_mfma_f32_16x16x32_bf16 v[196:199], a[92:95], a[20:23], v[196:199]
  v_mfma_f32_16x16x32_bf16 v[196:199], a[72:75], a[16:19], v[196:199]
  ds_read_b64_tr_b16 a[10:11], v233 offset:33280
  v_mfma_f32_16x16x32_bf16 v[128:131], a[56:59], a[16:19], v[128:131]
  v_mfma_f32_16x16x32_bf16 v[128:131], a[76:79], a[20:23], v[128:131]
  ds_read_b64_tr_b16 a[12:13], v233 offset:45056
  s_add_u32 m0, s23, 0x2800
  v_mfma_f32_16x16x32_bf16 v[132:135], a[80:83], a[20:23], v[132:135]
  buffer_load_dwordx4 v229, s[8:11], s22 offen offset:0 lds
  v_mfma_f32_16x16x32_bf16 v[132:135], a[60:63], a[16:19], v[132:135]
  ds_read_b64_tr_b16 a[14:15], v233 offset:45568
  v_mfma_f32_16x16x32_bf16 v[136:139], a[64:67], a[16:19], v[136:139]
  v_mfma_f32_16x16x32_bf16 v[136:139], a[84:87], a[20:23], v[136:139]
  v_mfma_f32_16x16x32_bf16 v[140:143], a[88:91], a[20:23], v[140:143]
  v_mfma_f32_16x16x32_bf16 v[140:143], a[68:71], a[16:19], v[140:143]
  ds_read_b64_tr_b16 a[16:17], v234 offset:32768
  s_mov_b32 s36, s101
  s_mov_b32 s37, s20
  s_mov_b32 s38, 0x700000
  s_and_b32 s60, s2, 1
  s_lshl_b32 s60, s60, 6
  s_add_u32 s60, s60, s55
  s_bfe_u32 s3, s2, 0x20001
  s_mul_i32 s3, s3, 896
  s_add_u32 s60, s60, s3
  s_add_u32 s60, s60, 0
  s_lshl_b32 s60, s60, 11
  v_mfma_f32_16x16x32_bf16 v[156:159], a[68:71], a[24:27], v[156:159]
  s_mov_b64 exec, 0xffff
  buffer_load_dword a224, v202, s[36:39], s60 offen
  s_mov_b64 exec, -1
  v_mfma_f32_16x16x32_bf16 v[156:159], a[88:91], a[28:31], v[156:159]
  ds_read_b64_tr_b16 a[18:19], v234 offset:33280
  v_mfma_f32_16x16x32_bf16 v[152:155], a[84:87], a[28:31], v[152:155]
  v_mfma_f32_16x16x32_bf16 v[152:155], a[64:67], a[24:27], v[152:155]
  ds_read_b64_tr_b16 a[20:21], v234 offset:45056
  v_mfma_f32_16x16x32_bf16 v[148:151], a[60:63], a[24:27], v[148:151]
  v_mfma_f32_16x16x32_bf16 v[148:151], a[80:83], a[28:31], v[148:151]
  ds_read_b64_tr_b16 a[22:23], v234 offset:45568
  s_add_u32 m0, s23, 0x2c00
  v_mfma_f32_16x16x32_bf16 v[144:147], a[76:79], a[28:31], v[144:147]
  buffer_load_dwordx4 v230, s[8:11], s21 offen offset:0 lds
  v_mfma_f32_16x16x32_bf16 v[144:147], a[56:59], a[24:27], v[144:147]
  ds_read_b64_tr_b16 a[24:25], v235 offset:32768
  v_mfma_f32_16x16x32_bf16 v[160:163], a[56:59], a[32:35], v[160:163]
  v_mfma_f32_16x16x32_bf16 v[160:163], a[76:79], a[36:39], v[160:163]
  ds_read_b64_tr_b16 a[26:27], v235 offset:33280
  v_mfma_f32_16x16x32_bf16 v[164:167], a[80:83], a[36:39], v[164:167]
  s_add_u32 m0, s23, 0x2800
  v_mfma_f32_16x16x32_bf16 v[164:167], a[60:63], a[32:35], v[164:167]
  ds_read_b64_tr_b16 a[28:29], v235 offset:45056
  v_mfma_f32_16x16x32_bf16 v[168:171], a[64:67], a[32:35], v[168:171]
  buffer_load_dwordx4 v230, s[8:11], s21 offen offset:2048 lds
  v_mfma_f32_16x16x32_bf16 v[168:171], a[84:87], a[36:39], v[168:171]
  ds_read_b64_tr_b16 a[30:31], v235 offset:45568
  v_mfma_f32_16x16x32_bf16 v[172:175], a[88:91], a[36:39], v[172:175]
  v_mfma_f32_16x16x32_bf16 v[172:175], a[68:71], a[32:35], v[172:175]
  ds_read_b64_tr_b16 a[32:33], v232 offset:33792
  v_mfma_f32_16x16x32_bf16 v[188:191], a[68:71], a[40:43], v[188:191]
  s_add_u32 m0, s23, 0x3400
  v_mfma_f32_16x16x32_bf16 v[188:191], a[88:91], a[44:47], v[188:191]
  ds_read_b64_tr_b16 a[34:35], v232 offset:34304
  v_mfma_f32_16x16x32_bf16 v[184:187], a[84:87], a[44:47], v[184:187]
  buffer_load_dwordx4 v230, s[8:11], s22 offen offset:0 lds
  v_mfma_f32_16x16x32_bf16 v[184:187], a[64:67], a[40:43], v[184:187]
  ds_read_b64_tr_b16 a[36:37], v232 offset:46080
  v_mfma_f32_16x16x32_bf16 v[180:183], a[60:63], a[40:43], v[180:183]
  v_mfma_f32_16x16x32_bf16 v[180:183], a[80:83], a[44:47], v[180:183]
  ds_read_b64_tr_b16 a[38:39], v232 offset:46592
  v_mfma_f32_16x16x32_bf16 v[176:179], a[76:79], a[44:47], v[176:179]
  s_lshl_b32 s60, s100, 7
  s_add_u32 s60, s60, 0xa8000
  v_mfma_f32_16x16x32_bf16 v[176:179], a[56:59], a[40:43], v[176:179]
  ds_read_b64_tr_b16 a[40:41], v233 offset:33792
  s_waitcnt lgkmcnt(8)
  v_mfma_f32_16x16x32_bf16 v[0:3], a[0:3], a[96:99], v[0:3]
  buffer_load_dword a224, off, s[16:19], s60
  s_add_u32 s21, s21, 0x60000
  s_add_u32 s22, s22, 0x60000
  v_mfma_f32_16x16x32_bf16 v[0:3], a[4:7], a[116:119], v[0:3]
  ds_read_b64_tr_b16 a[42:43], v233 offset:34304
  s_waitcnt vmcnt(36)
  v_mfma_f32_16x16x32_bf16 v[248:251], a[220:223], a[184:187], v[248:251]
  v_mfma_f32_16x16x32_bf16 v[4:7], a[4:7], a[120:123], v[4:7]
  ds_read_b128 a[56:59], v226 offset:0
  v_mfma_f32_16x16x32_bf16 v[4:7], a[0:3], a[100:103], v[4:7]
  ds_read_b64_tr_b16 a[44:45], v233 offset:46080
  v_mfma_f32_16x16x32_bf16 v[8:11], a[0:3], a[104:107], v[8:11]
  ds_read_b128 a[76:79], v227 offset:0
  v_mfma_f32_16x16x32_bf16 v[8:11], a[4:7], a[124:127], v[8:11]
  ds_read_b64_tr_b16 a[46:47], v233 offset:46592
  s_waitcnt vmcnt(32)
  v_mfma_f32_16x16x32_bf16 v[248:251], a[220:223], a[188:191], v[248:251]
  v_mfma_f32_16x16x32_bf16 v[12:15], a[4:7], a[128:131], v[12:15]
  v_mfma_f32_16x16x32_bf16 v[12:15], a[0:3], a[108:111], v[12:15]
  ds_read_b64_tr_b16 a[0:1], v234 offset:33792
  v_mfma_f32_16x16x32_bf16 v[28:31], a[8:11], a[108:111], v[28:31]
  s_add_u32 m0, s24, 0x300
  v_mfma_f32_16x16x32_bf16 v[28:31], a[12:15], a[128:131], v[28:31]
  ds_read_b64_tr_b16 a[2:3], v234 offset:34304
  v_mfma_f32_16x16x32_bf16 v[24:27], a[12:15], a[124:127], v[24:27]
  ds_read_b128 a[60:63], v226 offset:2048
  v_mfma_f32_16x16x32_bf16 v[24:27], a[8:11], a[104:107], v[24:27]
  ds_read_b64_tr_b16 a[4:5], v234 offset:46080
  v_mfma_f32_16x16x32_bf16 v[20:23], a[8:11], a[100:103], v[20:23]
  ds_read_b128 a[80:83], v227 offset:2048
  v_mfma_f32_16x16x32_bf16 v[20:23], a[12:15], a[120:123], v[20:23]
  ds_read_b64_tr_b16 a[6:7], v234 offset:46592
  v_mfma_f32_16x16x32_bf16 v[16:19], a[12:15], a[116:119], v[16:19]
  s_waitcnt lgkmcnt(7)
  buffer_load_dwordx4 v224, s[4:7], s62 offen offset:1280 lds
  s_add_u32 m0, s24, 0x700
  v_mfma_f32_16x16x32_bf16 v[16:19], a[8:11], a[96:99], v[16:19]
  ds_read_b64_tr_b16 a[8:9], v235 offset:33792
  v_mfma_f32_16x16x32_bf16 v[32:35], a[16:19], a[96:99], v[32:35]
  buffer_load_dwordx4 v225, s[4:7], s62 offen offset:1280 lds
  s_add_u32 m0, s24, 0xb00
  v_mfma_f32_16x16x32_bf16 v[32:35], a[20:23], a[116:119], v[32:35]
  ds_read_b64_tr_b16 a[10:11], v235 offset:34304
  v_mfma_f32_16x16x32_bf16 v[36:39], a[20:23], a[120:123], v[36:39]
  s_waitcnt lgkmcnt(3)
  buffer_load_dwordx4 v224, s[4:7], s63 offen offset:1280 lds
  v_mfma_f32_16x16x32_bf16 v[36:39], a[16:19], a[100:103], v[36:39]
  ds_read_b64_tr_b16 a[12:13], v235 offset:46080
  v_mfma_f32_16x16x32_bf16 v[40:43], a[16:19], a[104:107], v[40:43]
  ds_read_b128 a[64:67], v226 offset:4096
  v_mfma_f32_16x16x32_bf16 v[40:43], a[20:23], a[124:127], v[40:43]
  ds_read_b64_tr_b16 a[14:15], v235 offset:46592
  s_add_u32 m0, s24, 0xf00
  v_mfma_f32_16x16x32_bf16 v[44:47], a[20:23], a[128:131], v[44:47]
  ds_read_b128 a[84:87], v227 offset:4096
  v_mfma_f32_16x16x32_bf16 v[44:47], a[16:19], a[108:111], v[44:47]
  ds_read_b64_tr_b16 a[16:17], v232 offset:34816
  v_mfma_f32_16x16x32_bf16 v[60:63], a[24:27], a[108:111], v[60:63]
  buffer_load_dwordx4 v225, s[4:7], s63 offen offset:1280 lds
  v_mfma_f32_16x16x32_bf16 v[60:63], a[28:31], a[128:131], v[60:63]
  ds_read_b64_tr_b16 a[18:19], v232 offset:35328
  s_add_u32 m0, s24, 0x1300
  v_mfma_f32_16x16x32_bf16 v[56:59], a[28:31], a[124:127], v[56:59]
  s_waitcnt lgkmcnt(2)
  buffer_load_dwordx4 v224, s[4:7], s64 offen offset:1280 lds
  v_mfma_f32_16x16x32_bf16 v[56:59], a[24:27], a[104:107], v[56:59]
  ds_read_b64_tr_b16 a[20:21], v232 offset:47104
  v_mfma_f32_16x16x32_bf16 v[52:55], a[24:27], a[100:103], v[52:55]
  v_mfma_f32_16x16x32_bf16 v[52:55], a[28:31], a[120:123], v[52:55]
  ds_read_b64_tr_b16 a[22:23], v232 offset:47616
  v_mfma_f32_16x16x32_bf16 v[48:51], a[28:31], a[116:119], v[48:51]
  s_waitcnt vmcnt(36)
  ds_read_b128 a[68:71], v226 offset:6144
  s_add_u32 m0, s24, 0x1700
  v_mfma_f32_16x16x32_bf16 v[48:51], a[24:27], a[96:99], v[48:51]
  ds_read_b64_tr_b16 a[24:25], v233 offset:34816
  v_mfma_f32_16x16x32_bf16 v[192:195], a[32:35], a[112:115], v[192:195]
  ds_read_b128 a[88:91], v227 offset:6144
  v_mfma_f32_16x16x32_bf16 v[192:195], a[36:39], a[132:135], v[192:195]
  ds_read_b64_tr_b16 a[26:27], v233 offset:35328
  v_mfma_f32_16x16x32_bf16 v[64:67], a[36:39], a[116:119], v[64:67]
  buffer_load_dwordx4 v225, s[4:7], s64 offen offset:1280 lds
  s_add_u32 m0, s24, 0x1b00
  v_mfma_f32_16x16x32_bf16 v[64:67], a[32:35], a[96:99], v[64:67]
  ds_read_b64_tr_b16 a[28:29], v233 offset:47104
  v_mfma_f32_16x16x32_bf16 v[68:71], a[32:35], a[100:103], v[68:71]
  s_waitcnt lgkmcnt(2)
  buffer_load_dwordx4 v224, s[4:7], s65 offen offset:1280 lds
  v_mfma_f32_16x16x32_bf16 v[68:71], a[36:39], a[120:123], v[68:71]
  ds_read_b64_tr_b16 a[30:31], v233 offset:47616
  v_mfma_f32_16x16x32_bf16 v[72:75], a[36:39], a[124:127], v[72:75]
  v_mfma_f32_16x16x32_bf16 v[72:75], a[32:35], a[104:107], v[72:75]
  s_waitcnt vmcnt(36)
  ds_read_b128 a[72:75], v226 offset:8192
  s_add_u32 m0, s24, 0x1f00
  v_mfma_f32_16x16x32_bf16 v[76:79], a[32:35], a[108:111], v[76:79]
  ds_read_b128 a[92:95], v227 offset:8192
  v_mfma_f32_16x16x32_bf16 v[76:79], a[36:39], a[128:131], v[76:79]
  ds_read_b64_tr_b16 a[32:33], v234 offset:34816
  v_mfma_f32_16x16x32_bf16 v[92:95], a[44:47], a[128:131], v[92:95]
  buffer_load_dwordx4 v225, s[4:7], s65 offen offset:1280 lds
  v_mfma_f32_16x16x32_bf16 v[92:95], a[40:43], a[108:111], v[92:95]
  ds_read_b64_tr_b16 a[34:35], v234 offset:35328
  s_add_u32 m0, s24, 0x2300
  v_mfma_f32_16x16x32_bf16 v[88:91], a[40:43], a[104:107], v[88:91]
  s_waitcnt lgkmcnt(2)
  buffer_load_dwordx4 v224, s[4:7], s66 offen offset:1280 lds
  v_mfma_f32_16x16x32_bf16 v[88:91], a[44:47], a[124:127], v[88:91]
  ds_read_b64_tr_b16 a[36:37], v234 offset:47104
  v_mfma_f32_16x16x32_bf16 v[84:87], a[44:47], a[120:123], v[84:87]
  v_mfma_f32_16x16x32_bf16 v[84:87], a[40:43], a[100:103], v[84:87]
  ds_read_b64_tr_b16 a[38:39], v234 offset:47616
  v_mfma_f32_16x16x32_bf16 v[80:83], a[40:43], a[96:99], v[80:83]
  s_add_u32 m0, s24, 0x2700
  v_mfma_f32_16x16x32_bf16 v[80:83], a[44:47], a[116:119], v[80:83]
  ds_read_b64_tr_b16 a[40:41], v235 offset:34816
  v_mfma_f32_16x16x32_bf16 v[96:99], a[4:7], a[116:119], v[96:99]
  ds_read_b64_tr_b16 a[42:43], v235 offset:35328
  s_waitcnt vmcnt(34)
  v_mfma_f32_16x16x32_bf16 v[248:251], a[220:223], a[192:195], v[248:251]
  v_mfma_f32_16x16x32_bf16 v[96:99], a[0:3], a[96:99], v[96:99]
  ds_read_b64_tr_b16 a[44:45], v235 offset:47104
  v_mfma_f32_16x16x32_bf16 v[100:103], a[0:3], a[100:103], v[100:103]
  ds_read_b64_tr_b16 a[46:47], v235 offset:47616
  v_mfma_f32_16x16x32_bf16 v[100:103], a[4:7], a[120:123], v[100:103]
  buffer_load_dwordx4 v225, s[4:7], s66 offen offset:1280 lds
  s_getpc_b64 s[32:33]
L_k1_pc3_qkv_0:
  s_mov_b32 s34, L_k1_spin_qkv-L_k1_pc3_qkv_0
  s_bfe_u32 s60, s2, 0x40003
  s_lshl_b32 s60, s60, 2
  s_add_u32 s60, s60, s25
  s_lshl_b32 s60, s60, 9
  v_mfma_f32_16x16x32_bf16 v[104:107], a[4:7], a[124:127], v[104:107]
  s_mov_b64 exec, 15
  buffer_load_dword a224, v244, s[32:35], s60 offen
  s_mov_b64 exec, -1
  s_waitcnt vmcnt(34)
  v_mfma_f32_16x16x32_bf16 v[248:251], a[220:223], a[196:199], v[248:251]
  v_mfma_f32_16x16x32_bf16 v[104:107], a[0:3], a[104:107], v[104:107]
  v_mfma_f32_16x16x32_bf16 v[108:111], a[0:3], a[108:111], v[108:111]
  v_mfma_f32_16x16x32_bf16 v[108:111], a[4:7], a[128:131], v[108:111]
  s_waitcnt lgkmcnt(0) vmcnt(30)
  s_barrier
  ds_read_b64_tr_b16 a[0:1], v236 offset:8192
  v_mfma_f32_16x16x32_bf16 v[124:127], a[12:15], a[128:131], v[124:127]
  s_add_u32 m0, s23, 0x8000
  v_mfma_f32_16x16x32_bf16 v[124:127], a[8:11], a[108:111], v[124:127]
  ds_read_b64_tr_b16 a[2:3], v236 offset:8704
  v_mfma_f32_16x16x32_bf16 v[120:123], a[8:11], a[104:107], v[120:123]
  buffer_load_dwordx4 v229, s[8:11], s21 offen offset:0 lds
  v_mfma_f32_16x16x32_bf16 v[120:123], a[12:15], a[124:127], v[120:123]
  ds_read_b64_tr_b16 a[4:5], v236 offset:20480
  v_mfma_f32_16x16x32_bf16 v[116:119], a[12:15], a[120:123], v[116:119]
  v_mfma_f32_16x16x32_bf16 v[116:119], a[8:11], a[100:103], v[116:119]
  ds_read_b64_tr_b16 a[6:7], v236 offset:20992
  v_mfma_f32_16x16x32_bf16 v[112:115], a[8:11], a[96:99], v[112:115]
  s_add_u32 m0, s23, 0x7c00
  v_mfma_f32_16x16x32_bf16 v[112:115], a[12:15], a[116:119], v[112:115]
  ds_read_b64_tr_b16 a[8:9], v237 offset:8192
  v_mfma_f32_16x16x32_bf16 v[196:199], a[132:135], a[20:23], v[196:199]
  buffer_load_dwordx4 v229, s[8:11], s21 offen offset:2048 lds
  v_add_f32_dpp v248, v248, v248 row_ror:8 row_mask:0xf bank_mask:0xf
  v_mfma_f32_16x16x32_bf16 v[196:199], a[112:115], a[16:19], v[196:199]
  ds_read_b64_tr_b16 a[10:11], v237 offset:8704
  v_add_f32_dpp v249, v249, v249 row_ror:8 row_mask:0xf bank_mask:0xf
  v_mfma_f32_16x16x32_bf16 v[128:131], a[96:99], a[16:19], v[128:131]
  v_add_f32_dpp v250, v250, v250 row_ror:8 row_mask:0xf bank_mask:0xf
  v_mfma_f32_16x16x32_bf16 v[128:131], a[116:119], a[20:23], v[128:131]
  ds_read_b64_tr_b16 a[12:13], v237 offset:20480
  v_add_f32_dpp v251, v251, v251 row_ror:8 row_mask:0xf bank_mask:0xf
  v_mfma_f32_16x16x32_bf16 v[132:135], a[120:123], a[20:23], v[132:135]
  v_and_b32 v254, s54, v248
  v_mfma_f32_16x16x32_bf16 v[132:135], a[100:103], a[16:19], v[132:135]
  ds_read_b64_tr_b16 a[14:15], v237 offset:20992
  s_add_u32 m0, s23, 0x8800
  v_mfma_f32_16x16x32_bf16 v[136:139], a[104:107], a[16:19], v[136:139]
  buffer_load_dwordx4 v229, s[8:11], s22 offen offset:0 lds
  v_sub_f32 v254, v248, v254
  v_mfma_f32_16x16x32_bf16 v[136:139], a[124:127], a[20:23], v[136:139]
  v_and_b32 v255, s54, v254
  v_mfma_f32_16x16x32_bf16 v[140:143], a[128:131], a[20:23], v[140:143]
  v_sub_f32 v255, v254, v255
  v_mfma_f32_16x16x32_bf16 v[140:143], a[108:111], a[16:19], v[140:143]
  ds_read_b64_tr_b16 a[16:17], v238 offset:8192
  s_mov_b32 s61, 0x07060302
  v_perm_b32 v252, v254, v248, s61
  v_mfma_f32_16x16x32_bf16 v[156:159], a[108:111], a[24:27], v[156:159]
  s_mov_b32 s61, 0x05040302
  v_perm_b32 v253, v246, v255, s61
  v_mfma_f32_16x16x32_bf16 v[156:159], a[128:131], a[28:31], v[156:159]
  ds_read_b64_tr_b16 a[18:19], v238 offset:8704
  s_add_u32 m0, s23, 0x8c00
  v_mfma_f32_16x16x32_bf16 v[152:155], a[124:127], a[28:31], v[152:155]
  buffer_load_dwordx4 v230, s[8:11], s21 offen offset:0 lds
  buffer_store_dwordx2 v[252:253], v245, s[16:19], s52 offen offset:0 sc1
  v_mfma_f32_16x16x32_bf16 v[152:155], a[104:107], a[24:27], v[152:155]
  ds_read_b64_tr_b16 a[20:21], v238 offset:20480
  v_mfma_f32_16x16x32_bf16 v[148:151], a[100:103], a[24:27], v[148:151]
  v_and_b32 v254, s54, v249
  v_mfma_f32_16x16x32_bf16 v[148:151], a[120:123], a[28:31], v[148:151]
  ds_read_b64_tr_b16 a[22:23], v238 offset:20992
  v_sub_f32 v254, v249, v254
  v_mfma_f32_16x16x32_bf16 v[144:147], a[116:119], a[28:31], v[144:147]
  v_and_b32 v255, s54, v254
  v_mfma_f32_16x16x32_bf16 v[144:147], a[96:99], a[24:27], v[144:147]
  ds_read_b64_tr_b16 a[24:25], v239 offset:8192
  v_sub_f32 v255, v254, v255
  v_mfma_f32_16x16x32_bf16 v[160:163], a[96:99], a[32:35], v[160:163]
  s_add_u32 m0, s23, 0x8800
  s_mov_b32 s61, 0x07060302
  v_perm_b32 v252, v254, v249, s61
  v_mfma_f32_16x16x32_bf16 v[160:163], a[116:119], a[36:39], v[160:163]
  ds_read_b64_tr_b16 a[26:27], v239 offset:8704
  s_mov_b32 s61, 0x07060302
  v_perm_b32 v253, v246, v255, s61
  v_mfma_f32_16x16x32_bf16 v[164:167], a[120:123], a[36:39], v[164:167]
  buffer_load_dwordx4 v230, s[8:11], s21 offen offset:2048 lds
  buffer_store_dwordx2 v[252:253], v245, s[16:19], s52 offen offset:16 sc1
  v_mfma_f32_16x16x32_bf16 v[164:167], a[100:103], a[32:35], v[164:167]
  ds_read_b64_tr_b16 a[28:29], v239 offset:20480
  v_mfma_f32_16x16x32_bf16 v[168:171], a[104:107], a[32:35], v[168:171]
  v_and_b32 v254, s54, v250
  v_mfma_f32_16x16x32_bf16 v[168:171], a[124:127], a[36:39], v[168:171]
  ds_read_b64_tr_b16 a[30:31], v239 offset:20992
  v_sub_f32 v254, v250, v254
  v_mfma_f32_16x16x32_bf16 v[172:175], a[128:131], a[36:39], v[172:175]
  s_add_u32 m0, s23, 0x9400
  v_and_b32 v255, s54, v254
  v_mfma_f32_16x16x32_bf16 v[172:175], a[108:111], a[32:35], v[172:175]
  ds_read_b64_tr_b16 a[32:33], v236 offset:9216
  v_sub_f32 v255, v254, v255
  v_mfma_f32_16x16x32_bf16 v[188:191], a[108:111], a[40:43], v[188:191]
  buffer_load_dwordx4 v230, s[8:11], s22 offen offset:0 lds
  s_mov_b32 s61, 0x07060302
  v_perm_b32 v252, v254, v250, s61
  v_mfma_f32_16x16x32_bf16 v[188:191], a[128:131], a[44:47], v[188:191]
  ds_read_b64_tr_b16 a[34:35], v236 offset:9728
  s_mov_b32 s61, 0x05040302
  v_perm_b32 v253, v247, v255, s61
  v_mfma_f32_16x16x32_bf16 v[184:187], a[124:127], a[44:47], v[184:187]
  buffer_store_dwordx2 v[252:253], v245, s[16:19], s52 offen offset:32 sc1
  v_mfma_f32_16x16x32_bf16 v[184:187], a[104:107], a[40:43], v[184:187]
  ds_read_b64_tr_b16 a[36:37], v236 offset:21504
  v_mfma_f32_16x16x32_bf16 v[180:183], a[100:103], a[40:43], v[180:183]
  v_and_b32 v254, s54, v251
  v_mfma_f32_16x16x32_bf16 v[180:183], a[120:123], a[44:47], v[180:183]
  ds_read_b64_tr_b16 a[38:39], v236 offset:22016
  s_and_b32 s60, s2, 1
  s_lshl_b32 s60, s60, 6
  s_add_u32 s60, s60, s55
  s_bfe_u32 s3, s2, 0x20001
  s_mul_i32 s3, s3, 896
  s_add_u32 s60, s60, s3
  s_add_u32 s60, s60, 128
  s_lshl_b32 s60, s60, 11
  v_mfma_f32_16x16x32_bf16 v[176:179], a[116:119], a[44:47], v[176:179]
  s_mov_b64 exec, 0xffff
  buffer_load_dword a224, v202, s[36:39], s60 offen
  s_mov_b64 exec, -1
  s_add_u32 s21, s21, 0x60000
  s_add_u32 s22, s22, 0x60000
  v_mfma_f32_16x16x32_bf16 v[176:179], a[96:99], a[40:43], v[176:179]
  ds_read_b64_tr_b16 a[40:41], v237 offset:9216
  v_sub_f32 v254, v251, v254
  s_waitcnt lgkmcnt(8)
  v_mfma_f32_16x16x32_bf16 v[0:3], a[0:3], a[56:59], v[0:3]
  s_waitcnt vmcnt(37)
  ds_read_b128 a[96:99], v226 offset:10240
  v_and_b32 v255, s54, v254
  v_mfma_f32_16x16x32_bf16 v[0:3], a[4:7], a[76:79], v[0:3]
  ds_read_b64_tr_b16 a[42:43], v237 offset:9728
  v_sub_f32 v255, v254, v255
  v_mfma_f32_16x16x32_bf16 v[4:7], a[4:7], a[80:83], v[4:7]
  ds_read_b128 a[116:119], v227 offset:10240
  s_mov_b32 s61, 0x07060302
  v_perm_b32 v252, v254, v251, s61
  v_mfma_f32_16x16x32_bf16 v[4:7], a[0:3], a[60:63], v[4:7]
  ds_read_b64_tr_b16 a[44:45], v237 offset:21504
  s_mov_b32 s61, 0x07060302
  v_perm_b32 v253, v247, v255, s61
  v_mfma_f32_16x16x32_bf16 v[8:11], a[0:3], a[64:67], v[8:11]
  buffer_store_dwordx2 v[252:253], v245, s[16:19], s52 offen offset:48 sc1
  v_mfma_f32_16x16x32_bf16 v[8:11], a[4:7], a[84:87], v[8:11]
  ds_read_b64_tr_b16 a[46:47], v237 offset:22016
  v_mfma_f32_16x16x32_bf16 v[12:15], a[4:7], a[88:91], v[12:15]
  v_mfma_f32_16x16x32_bf16 v[12:15], a[0:3], a[68:71], v[12:15]
  ds_read_b64_tr_b16 a[0:1], v238 offset:9216
  v_mfma_f32_16x16x32_bf16 v[28:31], a[8:11], a[68:71], v[28:31]
  s_add_u32 m0, s24, 0x2a80
  v_mfma_f32_16x16x32_bf16 v[28:31], a[12:15], a[88:91], v[28:31]
  ds_read_b64_tr_b16 a[2:3], v238 offset:9728
  v_mfma_f32_16x16x32_bf16 v[24:27], a[12:15], a[84:87], v[24:27]
  s_waitcnt vmcnt(36)
  ds_read_b128 a[100:103], v226 offset:12288
  v_mfma_f32_16x16x32_bf16 v[24:27], a[8:11], a[64:67], v[24:27]
  ds_read_b64_tr_b16 a[4:5], v238 offset:21504
  v_mfma_f32_16x16x32_bf16 v[20:23], a[8:11], a[60:63], v[20:23]
  ds_read_b128 a[120:123], v227 offset:12288
  v_mfma_f32_16x16x32_bf16 v[20:23], a[12:15], a[80:83], v[20:23]
  ds_read_b64_tr_b16 a[6:7], v238 offset:22016
  v_mfma_f32_16x16x32_bf16 v[16:19], a[12:15], a[76:79], v[16:19]
  s_waitcnt lgkmcnt(8)
  buffer_load_dwordx4 v224, s[4:7], s62 offen offset:1408 lds
  s_add_u32 m0, s24, 0x2e80
  v_mfma_f32_16x16x32_bf16 v[16:19], a[8:11], a[56:59], v[16:19]
  ds_read_b64_tr_b16 a[8:9], v239 offset:9216
  v_mfma_f32_16x16x32_bf16 v[32:35], a[16:19], a[56:59], v[32:35]
  buffer_load_dwordx4 v225, s[4:7], s62 offen offset:1408 lds
  v_mfma_f32_16x16x32_bf16 v[32:35], a[20:23], a[76:79], v[32:35]
  ds_read_b64_tr_b16 a[10:11], v239 offset:9728
  s_add_u32 m0, s24, 0x3280
  v_mfma_f32_16x16x32_bf16 v[36:39], a[20:23], a[80:83], v[36:39]
  s_waitcnt lgkmcnt(3)
  buffer_load_dwordx4 v224, s[4:7], s63 offen offset:1408 lds
  v_mfma_f32_16x16x32_bf16 v[36:39], a[16:19], a[60:63], v[36:39]
  ds_read_b64_tr_b16 a[12:13], v239 offset:21504
  v_mfma_f32_16x16x32_bf16 v[40:43], a[16:19], a[64:67], v[40:43]
  s_waitcnt vmcnt(37)
  ds_read_b128 a[104:107], v226 offset:14336
  v_mfma_f32_16x16x32_bf16 v[40:43], a[20:23], a[84:87], v[40:43]
  ds_read_b64_tr_b16 a[14:15], v239 offset:22016
  v_mfma_f32_16x16x32_bf16 v[44:47], a[20:23], a[88:91], v[44:47]
  ds_read_b128 a[124:127], v227 offset:14336
  s_add_u32 m0, s24, 0x3680
  v_mfma_f32_16x16x32_bf16 v[44:47], a[16:19], a[68:71], v[44:47]
  ds_read_b64_tr_b16 a[16:17], v236 offset:10240
  v_mfma_f32_16x16x32_bf16 v[60:63], a[24:27], a[68:71], v[60:63]
  buffer_load_dwordx4 v225, s[4:7], s63 offen offset:1408 lds
  v_mfma_f32_16x16x32_bf16 v[60:63], a[28:31], a[88:91], v[60:63]
  ds_read_b64_tr_b16 a[18:19], v236 offset:10752
  v_mfma_f32_16x16x32_bf16 v[56:59], a[28:31], a[84:87], v[56:59]
  v_mfma_f32_16x16x32_bf16 v[56:59], a[24:27], a[64:67], v[56:59]
  ds_read_b64_tr_b16 a[20:21], v236 offset:22528
  s_add_u32 m0, s24, 0x3a80
  v_mfma_f32_16x16x32_bf16 v[52:55], a[24:27], a[60:63], v[52:55]
  s_waitcnt lgkmcnt(3)
  buffer_load_dwordx4 v224, s[4:7], s64 offen offset:1408 lds
  v_mfma_f32_16x16x32_bf16 v[52:55], a[28:31], a[80:83], v[52:55]
  ds_read_b64_tr_b16 a[22:23], v236 offset:23040
  v_mfma_f32_16x16x32_bf16 v[48:51], a[28:31], a[76:79], v[48:51]
  s_waitcnt vmcnt(37)
  ds_read_b128 a[108:111], v226 offset:16384
  v_mfma_f32_16x16x32_bf16 v[48:51], a[24:27], a[56:59], v[48:51]
  ds_read_b64_tr_b16 a[24:25], v237 offset:10240
  v_mfma_f32_16x16x32_bf16 v[192:195], a[32:35], a[72:75], v[192:195]
  ds_read_b128 a[128:131], v227 offset:16384
  s_add_u32 m0, s24, 0x3e80
  v_mfma_f32_16x16x32_bf16 v[192:195], a[36:39], a[92:95], v[192:195]
  ds_read_b64_tr_b16 a[26:27], v237 offset:10752
  v_mfma_f32_16x16x32_bf16 v[64:67], a[36:39], a[76:79], v[64:67]
  buffer_load_dwordx4 v225, s[4:7], s64 offen offset:1408 lds
  v_mfma_f32_16x16x32_bf16 v[64:67], a[32:35], a[56:59], v[64:67]
  ds_read_b64_tr_b16 a[28:29], v237 offset:22528
  v_mfma_f32_16x16x32_bf16 v[68:71], a[32:35], a[60:63], v[68:71]
  v_mfma_f32_16x16x32_bf16 v[68:71], a[36:39], a[80:83], v[68:71]
  ds_read_b64_tr_b16 a[30:31], v237 offset:23040
  s_add_u32 m0, s24, 0x4280
  v_mfma_f32_16x16x32_bf16 v[72:75], a[36:39], a[84:87], v[72:75]
  s_waitcnt lgkmcnt(3)
  buffer_load_dwordx4 v224, s[4:7], s65 offen offset:1408 lds
  v_mfma_f32_16x16x32_bf16 v[72:75], a[32:35], a[64:67], v[72:75]
  s_waitcnt vmcnt(37)
  ds_read_b128 a[112:115], v226 offset:18432
  v_mfma_f32_16x16x32_bf16 v[76:79], a[32:35], a[68:71], v[76:79]
  ds_read_b128 a[132:135], v227 offset:18432
  v_mfma_f32_16x16x32_bf16 v[76:79], a[36:39], a[88:91], v[76:79]
  ds_read_b64_tr_b16 a[32:33], v238 offset:10240
  v_mfma_f32_16x16x32_bf16 v[92:95], a[44:47], a[88:91], v[92:95]
  s_add_u32 m0, s24, 0x4680
  v_mfma_f32_16x16x32_bf16 v[92:95], a[40:43], a[68:71], v[92:95]
  ds_read_b64_tr_b16 a[34:35], v238 offset:10752
  v_mfma_f32_16x16x32_bf16 v[88:91], a[40:43], a[64:67], v[88:91]
  buffer_load_dwordx4 v225, s[4:7], s65 offen offset:1408 lds
  v_mfma_f32_16x16x32_bf16 v[88:91], a[44:47], a[84:87], v[88:91]
  ds_read_b64_tr_b16 a[36:37], v238 offset:22528
  v_mfma_f32_16x16x32_bf16 v[84:87], a[44:47], a[80:83], v[84:87]
  v_mfma_f32_16x16x32_bf16 v[84:87], a[40:43], a[60:63], v[84:87]
  ds_read_b64_tr_b16 a[38:39], v238 offset:23040
  s_add_u32 m0, s24, 0x4a80
  v_mfma_f32_16x16x32_bf16 v[80:83], a[40:43], a[56:59], v[80:83]
  s_waitcnt lgkmcnt(4)
  buffer_load_dwordx4 v224, s[4:7], s66 offen offset:1408 lds
  v_mfma_f32_16x16x32_bf16 v[80:83], a[44:47], a[76:79], v[80:83]
  ds_read_b64_tr_b16 a[40:41], v239 offset:10240
  v_mfma_f32_16x16x32_bf16 v[96:99], a[4:7], a[76:79], v[96:99]
  ds_read_b64_tr_b16 a[42:43], v239 offset:10752
  v_mfma_f32_16x16x32_bf16 v[96:99], a[0:3], a[56:59], v[96:99]
  ds_read_b64_tr_b16 a[44:45], v239 offset:22528
  v_mfma_f32_16x16x32_bf16 v[100:103], a[0:3], a[60:63], v[100:103]
  ds_read_b64_tr_b16 a[46:47], v239 offset:23040
  s_add_u32 m0, s24, 0x4e80
  v_mfma_f32_16x16x32_bf16 v[100:103], a[4:7], a[80:83], v[100:103]
  buffer_load_dwordx4 v225, s[4:7], s66 offen offset:1408 lds
  v_mfma_f32_16x16x32_bf16 v[104:107], a[4:7], a[84:87], v[104:107]
  v_mfma_f32_16x16x32_bf16 v[104:107], a[0:3], a[64:67], v[104:107]
  v_mfma_f32_16x16x32_bf16 v[108:111], a[0:3], a[68:71], v[108:111]
  v_mfma_f32_16x16x32_bf16 v[108:111], a[4:7], a[88:91], v[108:111]
  s_waitcnt lgkmcnt(0) vmcnt(33)
  s_barrier
  ds_read_b64_tr_b16 a[0:1], v232 offset:8192
  v_mfma_f32_16x16x32_bf16 v[124:127], a[12:15], a[88:91], v[124:127]
  s_add_u32 m0, s23, 0xe000
  v_mfma_f32_16x16x32_bf16 v[124:127], a[8:11], a[68:71], v[124:127]
  ds_read_b64_tr_b16 a[2:3], v232 offset:8704
  v_mfma_f32_16x16x32_bf16 v[120:123], a[8:11], a[64:67], v[120:123]
  buffer_load_dwordx4 v229, s[8:11], s21 offen offset:0 lds
  v_mfma_f32_16x16x32_bf16 v[120:123], a[12:15], a[84:87], v[120:123]
  ds_read_b64_tr_b16 a[4:5], v232 offset:20480
  v_mfma_f32_16x16x32_bf16 v[116:119], a[12:15], a[80:83], v[116:119]
  v_mfma_f32_16x16x32_bf16 v[116:119], a[8:11], a[60:63], v[116:119]
  ds_read_b64_tr_b16 a[6:7], v232 offset:20992
  v_mfma_f32_16x16x32_bf16 v[112:115], a[8:11], a[56:59], v[112:115]
  s_add_u32 m0, s23, 0xdc00
  v_mfma_f32_16x16x32_bf16 v[112:115], a[12:15], a[76:79], v[112:115]
  ds_read_b64_tr_b16 a[8:9], v233 offset:8192
  v_mfma_f32_16x16x32_bf16 v[196:199], a[92:95], a[20:23], v[196:199]
  buffer_load_dwordx4 v229, s[8:11], s21 offen offset:2048 lds
  v_mfma_f32_16x16x32_bf16 v[196:199], a[72:75], a[16:19], v[196:199]
  ds_read_b64_tr_b16 a[10:11], v233 offset:8704
  v_mfma_f32_16x16x32_bf16 v[128:131], a[56:59], a[16:19], v[128:131]
  v_mfma_f32_16x16x32_bf16 v[128:131], a[76:79], a[20:23], v[128:131]
  ds_read_b64_tr_b16 a[12:13], v233 offset:20480
  v_mfma_f32_16x16x32_bf16 v[132:135], a[80:83], a[20:23], v[132:135]
  v_mfma_f32_16x16x32_bf16 v[132:135], a[60:63], a[16:19], v[132:135]
  ds_read_b64_tr_b16 a[14:15], v233 offset:20992
  s_add_u32 m0, s23, 0xe800
  v_mfma_f32_16x16x32_bf16 v[136:139], a[64:67], a[16:19], v[136:139]
  buffer_load_dwordx4 v229, s[8:11], s22 offen offset:0 lds
  v_mfma_f32_16x16x32_bf16 v[136:139], a[84:87], a[20:23], v[136:139]
  v_mfma_f32_16x16x32_bf16 v[140:143], a[88:91], a[20:23], v[140:143]
  v_mfma_f32_16x16x32_bf16 v[140:143], a[68:71], a[16:19], v[140:143]
  ds_read_b64_tr_b16 a[16:17], v234 offset:8192
  v_mfma_f32_16x16x32_bf16 v[156:159], a[68:71], a[24:27], v[156:159]
  v_mfma_f32_16x16x32_bf16 v[156:159], a[88:91], a[28:31], v[156:159]
  ds_read_b64_tr_b16 a[18:19], v234 offset:8704
  s_add_u32 m0, s23, 0xec00
  v_mfma_f32_16x16x32_bf16 v[152:155], a[84:87], a[28:31], v[152:155]
  buffer_load_dwordx4 v230, s[8:11], s21 offen offset:0 lds
  v_mfma_f32_16x16x32_bf16 v[152:155], a[64:67], a[24:27], v[152:155]
  ds_read_b64_tr_b16 a[20:21], v234 offset:20480
  v_mfma_f32_16x16x32_bf16 v[148:151], a[60:63], a[24:27], v[148:151]
  v_mfma_f32_16x16x32_bf16 v[148:151], a[80:83], a[28:31], v[148:151]
  ds_read_b64_tr_b16 a[22:23], v234 offset:20992
  v_mfma_f32_16x16x32_bf16 v[144:147], a[76:79], a[28:31], v[144:147]
  v_mfma_f32_16x16x32_bf16 v[144:147], a[56:59], a[24:27], v[144:147]
  ds_read_b64_tr_b16 a[24:25], v235 offset:8192
  v_mfma_f32_16x16x32_bf16 v[160:163], a[56:59], a[32:35], v[160:163]
  s_add_u32 m0, s23, 0xe800
  v_mfma_f32_16x16x32_bf16 v[160:163], a[76:79], a[36:39], v[160:163]
  ds_read_b64_tr_b16 a[26:27], v235 offset:8704
  v_mfma_f32_16x16x32_bf16 v[164:167], a[80:83], a[36:39], v[164:167]
  buffer_load_dwordx4 v230, s[8:11], s21 offen offset:2048 lds
  v_mfma_f32_16x16x32_bf16 v[164:167], a[60:63], a[32:35], v[164:167]
  ds_read_b64_tr_b16 a[28:29], v235 offset:20480
  v_mfma_f32_16x16x32_bf16 v[168:171], a[64:67], a[32:35], v[168:171]
  v_mfma_f32_16x16x32_bf16 v[168:171], a[84:87], a[36:39], v[168:171]
  ds_read_b64_tr_b16 a[30:31], v235 offset:20992
  v_mfma_f32_16x16x32_bf16 v[172:175], a[88:91], a[36:39], v[172:175]
  s_add_u32 m0, s23, 0xf400
  v_mfma_f32_16x16x32_bf16 v[172:175], a[68:71], a[32:35], v[172:175]
  ds_read_b64_tr_b16 a[32:33], v232 offset:9216
  v_mfma_f32_16x16x32_bf16 v[188:191], a[68:71], a[40:43], v[188:191]
  buffer_load_dwordx4 v230, s[8:11], s22 offen offset:0 lds
  v_mfma_f32_16x16x32_bf16 v[188:191], a[88:91], a[44:47], v[188:191]
  ds_read_b64_tr_b16 a[34:35], v232 offset:9728
  v_mfma_f32_16x16x32_bf16 v[184:187], a[84:87], a[44:47], v[184:187]
  v_mfma_f32_16x16x32_bf16 v[184:187], a[64:67], a[40:43], v[184:187]
  ds_read_b64_tr_b16 a[36:37], v232 offset:21504
  v_mfma_f32_16x16x32_bf16 v[180:183], a[60:63], a[40:43], v[180:183]
  v_mfma_f32_16x16x32_bf16 v[180:183], a[80:83], a[44:47], v[180:183]
  ds_read_b64_tr_b16 a[38:39], v232 offset:22016
  s_and_b32 s60, s2, 1
  s_lshl_b32 s60, s60, 6
  s_add_u32 s60, s60, s55
  s_bfe_u32 s3, s2, 0x20001
  s_mul_i32 s3, s3, 896
  s_add_u32 s60, s60, s3
  s_add_u32 s60, s60, 256
  s_lshl_b32 s60, s60, 11
  v_mfma_f32_16x16x32_bf16 v[176:179], a[76:79], a[44:47], v[176:179]
  s_mov_b64 exec, 0xffff
  buffer_load_dword a224, v202, s[36:39], s60 offen
  s_mov_b64 exec, -1
  s_add_u32 s21, s21, 0x60000
  s_add_u32 s22, s22, 0x60000
  v_mfma_f32_16x16x32_bf16 v[176:179], a[56:59], a[40:43], v[176:179]
  ds_read_b64_tr_b16 a[40:41], v233 offset:9216
  s_waitcnt lgkmcnt(8)
  v_mfma_f32_16x16x32_bf16 v[0:3], a[0:3], a[96:99], v[0:3]
  s_waitcnt vmcnt(37)
  ds_read_b128 a[56:59], v226 offset:0
  v_mfma_f32_16x16x32_bf16 v[0:3], a[4:7], a[116:119], v[0:3]
  ds_read_b64_tr_b16 a[42:43], v233 offset:9728
  v_mfma_f32_16x16x32_bf16 v[4:7], a[4:7], a[120:123], v[4:7]
  ds_read_b128 a[76:79], v227 offset:0
  v_mfma_f32_16x16x32_bf16 v[4:7], a[0:3], a[100:103], v[4:7]
  ds_read_b64_tr_b16 a[44:45], v233 offset:21504
  v_mfma_f32_16x16x32_bf16 v[8:11], a[0:3], a[104:107], v[8:11]
  v_mfma_f32_16x16x32_bf16 v[8:11], a[4:7], a[124:127], v[8:11]
  ds_read_b64_tr_b16 a[46:47], v233 offset:22016
  v_mfma_f32_16x16x32_bf16 v[12:15], a[4:7], a[128:131], v[12:15]
  v_mfma_f32_16x16x32_bf16 v[12:15], a[0:3], a[108:111], v[12:15]
  ds_read_b64_tr_b16 a[0:1], v234 offset:9216
  v_mfma_f32_16x16x32_bf16 v[28:31], a[8:11], a[108:111], v[28:31]
  s_add_u32 m0, s24, 0x200
  v_mfma_f32_16x16x32_bf16 v[28:31], a[12:15], a[128:131], v[28:31]
  ds_read_b64_tr_b16 a[2:3], v234 offset:9728
  v_mfma_f32_16x16x32_bf16 v[24:27], a[12:15], a[124:127], v[24:27]
  s_waitcnt vmcnt(35)
  ds_read_b128 a[60:63], v226 offset:2048
  v_mfma_f32_16x16x32_bf16 v[24:27], a[8:11], a[104:107], v[24:27]
  ds_read_b64_tr_b16 a[4:5], v234 offset:21504
  v_mfma_f32_16x16x32_bf16 v[20:23], a[8:11], a[100:103], v[20:23]
  ds_read_b128 a[80:83], v227 offset:2048
  v_mfma_f32_16x16x32_bf16 v[20:23], a[12:15], a[120:123], v[20:23]
  ds_read_b64_tr_b16 a[6:7], v234 offset:22016
  v_mfma_f32_16x16x32_bf16 v[16:19], a[12:15], a[116:119], v[16:19]
  s_waitcnt lgkmcnt(8)
  buffer_load_dwordx4 v224, s[4:7], s62 offen offset:1536 lds
  s_add_u32 m0, s24, 0x600
  v_mfma_f32_16x16x32_bf16 v[16:19], a[8:11], a[96:99], v[16:19]
  ds_read_b64_tr_b16 a[8:9], v235 offset:9216
  v_mfma_f32_16x16x32_bf16 v[32:35], a[16:19], a[96:99], v[32:35]
  buffer_load_dwordx4 v225, s[4:7], s62 offen offset:1536 lds
  v_mfma_f32_16x16x32_bf16 v[32:35], a[20:23], a[116:119], v[32:35]
  ds_read_b64_tr_b16 a[10:11], v235 offset:9728
  s_add_u32 m0, s24, 0xa00
  v_mfma_f32_16x16x32_bf16 v[36:39], a[20:23], a[120:123], v[36:39]
  s_waitcnt lgkmcnt(3)
  buffer_load_dwordx4 v224, s[4:7], s63 offen offset:1536 lds
  v_mfma_f32_16x16x32_bf16 v[36:39], a[16:19], a[100:103], v[36:39]
  ds_read_b64_tr_b16 a[12:13], v235 offset:21504
  v_mfma_f32_16x16x32_bf16 v[40:43], a[16:19], a[104:107], v[40:43]
  s_waitcnt vmcnt(36)
  ds_read_b128 a[64:67], v226 offset:4096
  v_mfma_f32_16x16x32_bf16 v[40:43], a[20:23], a[124:127], v[40:43]
  ds_read_b64_tr_b16 a[14:15], v235 offset:22016
  v_mfma_f32_16x16x32_bf16 v[44:47], a[20:23], a[128:131], v[44:47]
  ds_read_b128 a[84:87], v227 offset:4096
  s_add_u32 m0, s24, 0xe00
  v_mfma_f32_16x16x32_bf16 v[44:47], a[16:19], a[108:111], v[44:47]
  ds_read_b64_tr_b16 a[16:17], v232 offset:10240
  v_mfma_f32_16x16x32_bf16 v[60:63], a[24:27], a[108:111], v[60:63]
  buffer_load_dwordx4 v225, s[4:7], s63 offen offset:1536 lds
  v_mfma_f32_16x16x32_bf16 v[60:63], a[28:31], a[128:131], v[60:63]
  ds_read_b64_tr_b16 a[18:19], v232 offset:10752
  v_mfma_f32_16x16x32_bf16 v[56:59], a[28:31], a[124:127], v[56:59]
  v_mfma_f32_16x16x32_bf16 v[56:59], a[24:27], a[104:107], v[56:59]
  ds_read_b64_tr_b16 a[20:21], v232 offset:22528
  s_add_u32 m0, s24, 0x1200
  v_mfma_f32_16x16x32_bf16 v[52:55], a[24:27], a[100:103], v[52:55]
  s_waitcnt lgkmcnt(3)
  buffer_load_dwordx4 v224, s[4:7], s64 offen offset:1536 lds
  v_mfma_f32_16x16x32_bf16 v[52:55], a[28:31], a[120:123], v[52:55]
  ds_read_b64_tr_b16 a[22:23], v232 offset:23040
  v_mfma_f32_16x16x32_bf16 v[48:51], a[28:31], a[116:119], v[48:51]
  s_waitcnt vmcnt(36)
  ds_read_b128 a[68:71], v226 offset:6144
  v_mfma_f32_16x16x32_bf16 v[48:51], a[24:27], a[96:99], v[48:51]
  ds_read_b64_tr_b16 a[24:25], v233 offset:10240
  v_mfma_f32_16x16x32_bf16 v[192:195], a[32:35], a[112:115], v[192:195]
  ds_read_b128 a[88:91], v227 offset:6144
  s_add_u32 m0, s24, 0x1600
  v_mfma_f32_16x16x32_bf16 v[192:195], a[36:39], a[132:135], v[192:195]
  ds_read_b64_tr_b16 a[26:27], v233 offset:10752
  v_mfma_f32_16x16x32_bf16 v[64:67], a[36:39], a[116:119], v[64:67]
  buffer_load_dwordx4 v225, s[4:7], s64 offen offset:1536 lds
  v_mfma_f32_16x16x32_bf16 v[64:67], a[32:35], a[96:99], v[64:67]
  ds_read_b64_tr_b16 a[28:29], v233 offset:22528
  v_mfma_f32_16x16x32_bf16 v[68:71], a[32:35], a[100:103], v[68:71]
  v_mfma_f32_16x16x32_bf16 v[68:71], a[36:39], a[120:123], v[68:71]
  ds_read_b64_tr_b16 a[30:31], v233 offset:23040
  s_add_u32 m0, s24, 0x1a00
  v_mfma_f32_16x16x32_bf16 v[72:75], a[36:39], a[124:127], v[72:75]
  s_waitcnt lgkmcnt(3)
  buffer_load_dwordx4 v224, s[4:7], s65 offen offset:1536 lds
  v_mfma_f32_16x16x32_bf16 v[72:75], a[32:35], a[104:107], v[72:75]
  s_waitcnt vmcnt(36)
  ds_read_b128 a[72:75], v226 offset:8192
  v_mfma_f32_16x16x32_bf16 v[76:79], a[32:35], a[108:111], v[76:79]
  ds_read_b128 a[92:95], v227 offset:8192
  v_mfma_f32_16x16x32_bf16 v[76:79], a[36:39], a[128:131], v[76:79]
  ds_read_b64_tr_b16 a[32:33], v234 offset:10240
  v_mfma_f32_16x16x32_bf16 v[92:95], a[44:47], a[128:131], v[92:95]
  s_add_u32 m0, s24, 0x1e00
  v_mfma_f32_16x16x32_bf16 v[92:95], a[40:43], a[108:111], v[92:95]
  ds_read_b64_tr_b16 a[34:35], v234 offset:10752
  v_mfma_f32_16x16x32_bf16 v[88:91], a[40:43], a[104:107], v[88:91]
  buffer_load_dwordx4 v225, s[4:7], s65 offen offset:1536 lds
  v_mfma_f32_16x16x32_bf16 v[88:91], a[44:47], a[124:127], v[88:91]
  ds_read_b64_tr_b16 a[36:37], v234 offset:22528
  v_mfma_f32_16x16x32_bf16 v[84:87], a[44:47], a[120:123], v[84:87]
  v_mfma_f32_16x16x32_bf16 v[84:87], a[40:43], a[100:103], v[84:87]
  ds_read_b64_tr_b16 a[38:39], v234 offset:23040
  s_add_u32 m0, s24, 0x2200
  v_mfma_f32_16x16x32_bf16 v[80:83], a[40:43], a[96:99], v[80:83]
  s_waitcnt lgkmcnt(4)
  buffer_load_dwordx4 v224, s[4:7], s66 offen offset:1536 lds
  v_mfma_f32_16x16x32_bf16 v[80:83], a[44:47], a[116:119], v[80:83]
  ds_read_b64_tr_b16 a[40:41], v235 offset:10240
  v_mfma_f32_16x16x32_bf16 v[96:99], a[4:7], a[116:119], v[96:99]
  ds_read_b64_tr_b16 a[42:43], v235 offset:10752
  v_mfma_f32_16x16x32_bf16 v[96:99], a[0:3], a[96:99], v[96:99]
  ds_read_b64_tr_b16 a[44:45], v235 offset:22528
  v_mfma_f32_16x16x32_bf16 v[100:103], a[0:3], a[100:103], v[100:103]
  ds_read_b64_tr_b16 a[46:47], v235 offset:23040
  s_add_u32 m0, s24, 0x2600
  v_mfma_f32_16x16x32_bf16 v[100:103], a[4:7], a[120:123], v[100:103]
  buffer_load_dwordx4 v225, s[4:7], s66 offen offset:1536 lds
  v_mfma_f32_16x16x32_bf16 v[104:107], a[4:7], a[124:127], v[104:107]
  v_mfma_f32_16x16x32_bf16 v[104:107], a[0:3], a[104:107], v[104:107]
  v_mfma_f32_16x16x32_bf16 v[108:111], a[0:3], a[108:111], v[108:111]
  v_mfma_f32_16x16x32_bf16 v[108:111], a[4:7], a[128:131], v[108:111]
  s_waitcnt lgkmcnt(0) vmcnt(27)
  s_barrier
  ds_read_b64_tr_b16 a[0:1], v232 offset:32768
  v_mfma_f32_16x16x32_bf16 v[124:127], a[12:15], a[128:131], v[124:127]
  s_add_u32 m0, s23, 0x2000
  v_mfma_f32_16x16x32_bf16 v[124:127], a[8:11], a[108:111], v[124:127]
  ds_read_b64_tr_b16 a[2:3], v232 offset:33280
  v_mfma_f32_16x16x32_bf16 v[120:123], a[8:11], a[104:107], v[120:123]
  buffer_load_dwordx4 v229, s[8:11], s21 offen offset:0 lds
  v_mfma_f32_16x16x32_bf16 v[120:123], a[12:15], a[124:127], v[120:123]
  ds_read_b64_tr_b16 a[4:5], v232 offset:45056
  v_mfma_f32_16x16x32_bf16 v[116:119], a[12:15], a[120:123], v[116:119]
  v_mfma_f32_16x16x32_bf16 v[116:119], a[8:11], a[100:103], v[116:119]
  ds_read_b64_tr_b16 a[6:7], v232 offset:45568
  s_add_u32 m0, s23, 0x1c00
  v_mfma_f32_16x16x32_bf16 v[112:115], a[8:11], a[96:99], v[112:115]
  buffer_load_dwordx4 v229, s[8:11], s21 offen offset:2048 lds
  v_mfma_f32_16x16x32_bf16 v[112:115], a[12:15], a[116:119], v[112:115]
  ds_read_b64_tr_b16 a[8:9], v233 offset:32768
  v_mfma_f32_16x16x32_bf16 v[196:199], a[132:135], a[20:23], v[196:199]
  v_mfma_f32_16x16x32_bf16 v[196:199], a[112:115], a[16:19], v[196:199]
  ds_read_b64_tr_b16 a[10:11], v233 offset:33280
  v_mfma_f32_16x16x32_bf16 v[128:131], a[96:99], a[16:19], v[128:131]
  v_mfma_f32_16x16x32_bf16 v[128:131], a[116:119], a[20:23], v[128:131]
  ds_read_b64_tr_b16 a[12:13], v233 offset:45056
  s_add_u32 m0, s23, 0x2800
  v_mfma_f32_16x16x32_bf16 v[132:135], a[120:123], a[20:23], v[132:135]
  buffer_load_dwordx4 v229, s[8:11], s22 offen offset:0 lds
  v_mfma_f32_16x16x32_bf16 v[132:135], a[100:103], a[16:19], v[132:135]
  ds_read_b64_tr_b16 a[14:15], v233 offset:45568
  v_mfma_f32_16x16x32_bf16 v[136:139], a[104:107], a[16:19], v[136:139]
  v_mfma_f32_16x16x32_bf16 v[136:139], a[124:127], a[20:23], v[136:139]
  v_mfma_f32_16x16x32_bf16 v[140:143], a[128:131], a[20:23], v[140:143]
  v_mfma_f32_16x16x32_bf16 v[140:143], a[108:111], a[16:19], v[140:143]
  ds_read_b64_tr_b16 a[16:17], v234 offset:32768
  s_and_b32 s60, s2, 1
  s_lshl_b32 s60, s60, 6
  s_add_u32 s60, s60, s55
  s_bfe_u32 s3, s2, 0x20001
  s_mul_i32 s3, s3, 896
  s_add_u32 s60, s60, s3
  s_add_u32 s60, s60, 384
  s_lshl_b32 s60, s60, 11
  v_mfma_f32_16x16x32_bf16 v[156:159], a[108:111], a[24:27], v[156:159]
  s_mov_b64 exec, 0xffff
  buffer_load_dword a224, v202, s[36:39], s60 offen
  s_mov_b64 exec, -1
  v_mfma_f32_16x16x32_bf16 v[156:159], a[128:131], a[28:31], v[156:159]
  ds_read_b64_tr_b16 a[18:19], v234 offset:33280
  v_mfma_f32_16x16x32_bf16 v[152:155], a[124:127], a[28:31], v[152:155]
  v_mfma_f32_16x16x32_bf16 v[152:155], a[104:107], a[24:27], v[152:155]
  ds_read_b64_tr_b16 a[20:21], v234 offset:45056
  v_mfma_f32_16x16x32_bf16 v[148:151], a[100:103], a[24:27], v[148:151]
  v_mfma_f32_16x16x32_bf16 v[148:151], a[120:123], a[28:31], v[148:151]
  ds_read_b64_tr_b16 a[22:23], v234 offset:45568
  s_add_u32 m0, s23, 0x2c00
  v_mfma_f32_16x16x32_bf16 v[144:147], a[116:119], a[28:31], v[144:147]
  buffer_load_dwordx4 v230, s[8:11], s21 offen offset:0 lds
  v_mfma_f32_16x16x32_bf16 v[144:147], a[96:99], a[24:27], v[144:147]
  ds_read_b64_tr_b16 a[24:25], v235 offset:32768
  v_mfma_f32_16x16x32_bf16 v[160:163], a[96:99], a[32:35], v[160:163]
  v_mfma_f32_16x16x32_bf16 v[160:163], a[116:119], a[36:39], v[160:163]
  ds_read_b64_tr_b16 a[26:27], v235 offset:33280
  v_mfma_f32_16x16x32_bf16 v[164:167], a[120:123], a[36:39], v[164:167]
  s_add_u32 m0, s23, 0x2800
  v_mfma_f32_16x16x32_bf16 v[164:167], a[100:103], a[32:35], v[164:167]
  ds_read_b64_tr_b16 a[28:29], v235 offset:45056
  v_mfma_f32_16x16x32_bf16 v[168:171], a[104:107], a[32:35], v[168:171]
  buffer_load_dwordx4 v230, s[8:11], s21 offen offset:2048 lds
  v_mfma_f32_16x16x32_bf16 v[168:171], a[124:127], a[36:39], v[168:171]
  ds_read_b64_tr_b16 a[30:31], v235 offset:45568
  v_mfma_f32_16x16x32_bf16 v[172:175], a[128:131], a[36:39], v[172:175]
  v_mfma_f32_16x16x32_bf16 v[172:175], a[108:111], a[32:35], v[172:175]
  ds_read_b64_tr_b16 a[32:33], v232 offset:33792
  v_mfma_f32_16x16x32_bf16 v[188:191], a[108:111], a[40:43], v[188:191]
  s_add_u32 m0, s23, 0x3400
  v_mfma_f32_16x16x32_bf16 v[188:191], a[128:131], a[44:47], v[188:191]
  ds_read_b64_tr_b16 a[34:35], v232 offset:34304
  v_mfma_f32_16x16x32_bf16 v[184:187], a[124:127], a[44:47], v[184:187]
  buffer_load_dwordx4 v230, s[8:11], s22 offen offset:0 lds
  v_mfma_f32_16x16x32_bf16 v[184:187], a[104:107], a[40:43], v[184:187]
  ds_read_b64_tr_b16 a[36:37], v232 offset:46080
  v_mfma_f32_16x16x32_bf16 v[180:183], a[100:103], a[40:43], v[180:183]
  v_mfma_f32_16x16x32_bf16 v[180:183], a[120:123], a[44:47], v[180:183]
  ds_read_b64_tr_b16 a[38:39], v232 offset:46592
  v_mfma_f32_16x16x32_bf16 v[176:179], a[116:119], a[44:47], v[176:179]
  s_lshl_b32 s60, s2, 7
  v_mfma_f32_16x16x32_bf16 v[176:179], a[96:99], a[40:43], v[176:179]
  ds_read_b64_tr_b16 a[40:41], v233 offset:33792
  s_waitcnt lgkmcnt(8)
  v_mfma_f32_16x16x32_bf16 v[0:3], a[0:3], a[56:59], v[0:3]
  s_mov_b64 exec, 1
  buffer_store_dwordx2 a[226:227], off, s[40:43], s60 offset:64 sc1
  s_mov_b64 exec, -1
  s_add_u32 s21, s21, 0x60000
  s_add_u32 s22, s22, 0x60000
  v_mfma_f32_16x16x32_bf16 v[0:3], a[4:7], a[76:79], v[0:3]
  ds_read_b64_tr_b16 a[42:43], v233 offset:34304
  v_mfma_f32_16x16x32_bf16 v[4:7], a[4:7], a[80:83], v[4:7]
  s_waitcnt vmcnt(33)
  ds_read_b128 a[96:99], v226 offset:10240
  v_mfma_f32_16x16x32_bf16 v[4:7], a[0:3], a[60:63], v[4:7]
  ds_read_b64_tr_b16 a[44:45], v233 offset:46080
  v_mfma_f32_16x16x32_bf16 v[8:11], a[0:3], a[64:67], v[8:11]
  ds_read_b128 a[116:119], v227 offset:10240
  v_mfma_f32_16x16x32_bf16 v[8:11], a[4:7], a[84:87], v[8:11]
  ds_read_b64_tr_b16 a[46:47], v233 offset:46592
  v_mfma_f32_16x16x32_bf16 v[12:15], a[4:7], a[88:91], v[12:15]
  v_mfma_f32_16x16x32_bf16 v[12:15], a[0:3], a[68:71], v[12:15]
  ds_read_b64_tr_b16 a[0:1], v234 offset:33792
  v_mfma_f32_16x16x32_bf16 v[28:31], a[8:11], a[68:71], v[28:31]
  s_add_u32 m0, s24, 0x2980
  v_mfma_f32_16x16x32_bf16 v[28:31], a[12:15], a[88:91], v[28:31]
  ds_read_b64_tr_b16 a[2:3], v234 offset:34304
  v_mfma_f32_16x16x32_bf16 v[24:27], a[12:15], a[84:87], v[24:27]
  s_waitcnt vmcnt(31)
  ds_read_b128 a[100:103], v226 offset:12288
  v_mfma_f32_16x16x32_bf16 v[24:27], a[8:11], a[64:67], v[24:27]
  ds_read_b64_tr_b16 a[4:5], v234 offset:46080
  v_mfma_f32_16x16x32_bf16 v[20:23], a[8:11], a[60:63], v[20:23]
  ds_read_b128 a[120:123], v227 offset:12288
  v_mfma_f32_16x16x32_bf16 v[20:23], a[12:15], a[80:83], v[20:23]
  ds_read_b64_tr_b16 a[6:7], v234 offset:46592
  v_mfma_f32_16x16x32_bf16 v[16:19], a[12:15], a[76:79], v[16:19]
  s_waitcnt lgkmcnt(7)
  buffer_load_dwordx4 v224, s[4:7], s62 offen offset:1664 lds
  s_add_u32 m0, s24, 0x2d80
  v_mfma_f32_16x16x32_bf16 v[16:19], a[8:11], a[56:59], v[16:19]
  ds_read_b64_tr_b16 a[8:9], v235 offset:33792
  v_mfma_f32_16x16x32_bf16 v[32:35], a[16:19], a[56:59], v[32:35]
  buffer_load_dwordx4 v225, s[4:7], s62 offen offset:1664 lds
  v_mfma_f32_16x16x32_bf16 v[32:35], a[20:23], a[76:79], v[32:35]
  ds_read_b64_tr_b16 a[10:11], v235 offset:34304
  s_add_u32 m0, s24, 0x3180
  v_mfma_f32_16x16x32_bf16 v[36:39], a[20:23], a[80:83], v[36:39]
  s_waitcnt lgkmcnt(3)
  buffer_load_dwordx4 v224, s[4:7], s63 offen offset:1664 lds
  v_mfma_f32_16x16x32_bf16 v[36:39], a[16:19], a[60:63], v[36:39]
  ds_read_b64_tr_b16 a[12:13], v235 offset:46080
  v_mfma_f32_16x16x32_bf16 v[40:43], a[16:19], a[64:67], v[40:43]
  s_waitcnt vmcnt(32)
  ds_read_b128 a[104:107], v226 offset:14336
  v_mfma_f32_16x16x32_bf16 v[40:43], a[20:23], a[84:87], v[40:43]
  ds_read_b64_tr_b16 a[14:15], v235 offset:46592
  v_mfma_f32_16x16x32_bf16 v[44:47], a[20:23], a[88:91], v[44:47]
  ds_read_b128 a[124:127], v227 offset:14336
  s_add_u32 m0, s24, 0x3580
  v_mfma_f32_16x16x32_bf16 v[44:47], a[16:19], a[68:71], v[44:47]
  ds_read_b64_tr_b16 a[16:17], v232 offset:34816
  v_mfma_f32_16x16x32_bf16 v[60:63], a[24:27], a[68:71], v[60:63]
  buffer_load_dwordx4 v225, s[4:7], s63 offen offset:1664 lds
  v_mfma_f32_16x16x32_bf16 v[60:63], a[28:31], a[88:91], v[60:63]
  ds_read_b64_tr_b16 a[18:19], v232 offset:35328
  v_mfma_f32_16x16x32_bf16 v[56:59], a[28:31], a[84:87], v[56:59]
  v_mfma_f32_16x16x32_bf16 v[56:59], a[24:27], a[64:67], v[56:59]
  ds_read_b64_tr_b16 a[20:21], v232 offset:47104
  s_add_u32 m0, s24, 0x3980
  v_mfma_f32_16x16x32_bf16 v[52:55], a[24:27], a[60:63], v[52:55]
  s_waitcnt lgkmcnt(3)
  buffer_load_dwordx4 v224, s[4:7], s64 offen offset:1664 lds
  v_mfma_f32_16x16x32_bf16 v[52:55], a[28:31], a[80:83], v[52:55]
  ds_read_b64_tr_b16 a[22:23], v232 offset:47616
  v_mfma_f32_16x16x32_bf16 v[48:51], a[28:31], a[76:79], v[48:51]
  s_waitcnt vmcnt(32)
  ds_read_b128 a[108:111], v226 offset:16384
  v_mfma_f32_16x16x32_bf16 v[48:51], a[24:27], a[56:59], v[48:51]
  ds_read_b64_tr_b16 a[24:25], v233 offset:34816
  v_mfma_f32_16x16x32_bf16 v[192:195], a[32:35], a[72:75], v[192:195]
  ds_read_b128 a[128:131], v227 offset:16384
  s_add_u32 m0, s24, 0x3d80
  v_mfma_f32_16x16x32_bf16 v[192:195], a[36:39], a[92:95], v[192:195]
  ds_read_b64_tr_b16 a[26:27], v233 offset:35328
  v_mfma_f32_16x16x32_bf16 v[64:67], a[36:39], a[76:79], v[64:67]
  buffer_load_dwordx4 v225, s[4:7], s64 offen offset:1664 lds
  v_mfma_f32_16x16x32_bf16 v[64:67], a[32:35], a[56:59], v[64:67]
  ds_read_b64_tr_b16 a[28:29], v233 offset:47104
  v_mfma_f32_16x16x32_bf16 v[68:71], a[32:35], a[60:63], v[68:71]
  v_mfma_f32_16x16x32_bf16 v[68:71], a[36:39], a[80:83], v[68:71]
  ds_read_b64_tr_b16 a[30:31], v233 offset:47616
  s_add_u32 m0, s24, 0x4180
  v_mfma_f32_16x16x32_bf16 v[72:75], a[36:39], a[84:87], v[72:75]
  s_waitcnt lgkmcnt(3)
  buffer_load_dwordx4 v224, s[4:7], s65 offen offset:1664 lds
  v_mfma_f32_16x16x32_bf16 v[72:75], a[32:35], a[64:67], v[72:75]
  s_waitcnt vmcnt(32)
  ds_read_b128 a[112:115], v226 offset:18432
  v_mfma_f32_16x16x32_bf16 v[76:79], a[32:35], a[68:71], v[76:79]
  ds_read_b128 a[132:135], v227 offset:18432
  v_mfma_f32_16x16x32_bf16 v[76:79], a[36:39], a[88:91], v[76:79]
  ds_read_b64_tr_b16 a[32:33], v234 offset:34816
  v_mfma_f32_16x16x32_bf16 v[92:95], a[44:47], a[88:91], v[92:95]
  s_add_u32 m0, s24, 0x4580
  v_mfma_f32_16x16x32_bf16 v[92:95], a[40:43], a[68:71], v[92:95]
  ds_read_b64_tr_b16 a[34:35], v234 offset:35328
  v_mfma_f32_16x16x32_bf16 v[88:91], a[40:43], a[64:67], v[88:91]
  buffer_load_dwordx4 v225, s[4:7], s65 offen offset:1664 lds
  v_mfma_f32_16x16x32_bf16 v[88:91], a[44:47], a[84:87], v[88:91]
  ds_read_b64_tr_b16 a[36:37], v234 offset:47104
  v_mfma_f32_16x16x32_bf16 v[84:87], a[44:47], a[80:83], v[84:87]
  v_mfma_f32_16x16x32_bf16 v[84:87], a[40:43], a[60:63], v[84:87]
  ds_read_b64_tr_b16 a[38:39], v234 offset:47616
  s_add_u32 m0, s24, 0x4980
  v_mfma_f32_16x16x32_bf16 v[80:83], a[40:43], a[56:59], v[80:83]
  s_waitcnt lgkmcnt(4)
  buffer_load_dwordx4 v224, s[4:7], s66 offen offset:1664 lds
  v_mfma_f32_16x16x32_bf16 v[80:83], a[44:47], a[76:79], v[80:83]
  ds_read_b64_tr_b16 a[40:41], v235 offset:34816
  v_mfma_f32_16x16x32_bf16 v[96:99], a[4:7], a[76:79], v[96:99]
  ds_read_b64_tr_b16 a[42:43], v235 offset:35328
  v_mfma_f32_16x16x32_bf16 v[96:99], a[0:3], a[56:59], v[96:99]
  ds_read_b64_tr_b16 a[44:45], v235 offset:47104
  v_mfma_f32_16x16x32_bf16 v[100:103], a[0:3], a[60:63], v[100:103]
  ds_read_b64_tr_b16 a[46:47], v235 offset:47616
  s_add_u32 m0, s24, 0x4d80
  v_mfma_f32_16x16x32_bf16 v[100:103], a[4:7], a[80:83], v[100:103]
  buffer_load_dwordx4 v225, s[4:7], s66 offen offset:1664 lds
  v_mfma_f32_16x16x32_bf16 v[104:107], a[4:7], a[84:87], v[104:107]
  v_mfma_f32_16x16x32_bf16 v[104:107], a[0:3], a[64:67], v[104:107]
  v_mfma_f32_16x16x32_bf16 v[108:111], a[0:3], a[68:71], v[108:111]
  v_mfma_f32_16x16x32_bf16 v[108:111], a[4:7], a[88:91], v[108:111]
  s_waitcnt lgkmcnt(0) vmcnt(29)
  s_barrier
  ds_read_b64_tr_b16 a[0:1], v236 offset:8192
  v_mfma_f32_16x16x32_bf16 v[124:127], a[12:15], a[88:91], v[124:127]
  s_add_u32 m0, s23, 0x8000
  v_mfma_f32_16x16x32_bf16 v[124:127], a[8:11], a[68:71], v[124:127]
  ds_read_b64_tr_b16 a[2:3], v236 offset:8704
  v_mfma_f32_16x16x32_bf16 v[120:123], a[8:11], a[64:67], v[120:123]
  buffer_load_dwordx4 v229, s[8:11], s21 offen offset:0 lds
  v_mfma_f32_16x16x32_bf16 v[120:123], a[12:15], a[84:87], v[120:123]
  ds_read_b64_tr_b16 a[4:5], v236 offset:20480
  v_mfma_f32_16x16x32_bf16 v[116:119], a[12:15], a[80:83], v[116:119]
  v_mfma_f32_16x16x32_bf16 v[116:119], a[8:11], a[60:63], v[116:119]
  ds_read_b64_tr_b16 a[6:7], v236 offset:20992
  v_mfma_f32_16x16x32_bf16 v[112:115], a[8:11], a[56:59], v[112:115]
  s_add_u32 m0, s23, 0x7c00
  v_mfma_f32_16x16x32_bf16 v[112:115], a[12:15], a[76:79], v[112:115]
  ds_read_b64_tr_b16 a[8:9], v237 offset:8192
  v_mfma_f32_16x16x32_bf16 v[196:199], a[92:95], a[20:23], v[196:199]
  buffer_load_dwordx4 v229, s[8:11], s21 offen offset:2048 lds
  v_mfma_f32_16x16x32_bf16 v[196:199], a[72:75], a[16:19], v[196:199]
  ds_read_b64_tr_b16 a[10:11], v237 offset:8704
  v_mfma_f32_16x16x32_bf16 v[128:131], a[56:59], a[16:19], v[128:131]
  v_mfma_f32_16x16x32_bf16 v[128:131], a[76:79], a[20:23], v[128:131]
  ds_read_b64_tr_b16 a[12:13], v237 offset:20480
  v_mfma_f32_16x16x32_bf16 v[132:135], a[80:83], a[20:23], v[132:135]
  v_mfma_f32_16x16x32_bf16 v[132:135], a[60:63], a[16:19], v[132:135]
  ds_read_b64_tr_b16 a[14:15], v237 offset:20992
  s_add_u32 m0, s23, 0x8800
  v_mfma_f32_16x16x32_bf16 v[136:139], a[64:67], a[16:19], v[136:139]
  buffer_load_dwordx4 v229, s[8:11], s22 offen offset:0 lds
  v_mfma_f32_16x16x32_bf16 v[136:139], a[84:87], a[20:23], v[136:139]
  v_mfma_f32_16x16x32_bf16 v[140:143], a[88:91], a[20:23], v[140:143]
  v_mfma_f32_16x16x32_bf16 v[140:143], a[68:71], a[16:19], v[140:143]
  ds_read_b64_tr_b16 a[16:17], v238 offset:8192
  v_mfma_f32_16x16x32_bf16 v[156:159], a[68:71], a[24:27], v[156:159]
  v_mfma_f32_16x16x32_bf16 v[156:159], a[88:91], a[28:31], v[156:159]
  ds_read_b64_tr_b16 a[18:19], v238 offset:8704
  s_add_u32 m0, s23, 0x8c00
  v_mfma_f32_16x16x32_bf16 v[152:155], a[84:87], a[28:31], v[152:155]
  buffer_load_dwordx4 v230, s[8:11], s21 offen offset:0 lds
  v_mfma_f32_16x16x32_bf16 v[152:155], a[64:67], a[24:27], v[152:155]
  ds_read_b64_tr_b16 a[20:21], v238 offset:20480
  v_mfma_f32_16x16x32_bf16 v[148:151], a[60:63], a[24:27], v[148:151]
  v_mfma_f32_16x16x32_bf16 v[148:151], a[80:83], a[28:31], v[148:151]
  ds_read_b64_tr_b16 a[22:23], v238 offset:20992
  v_mfma_f32_16x16x32_bf16 v[144:147], a[76:79], a[28:31], v[144:147]
  v_mfma_f32_16x16x32_bf16 v[144:147], a[56:59], a[24:27], v[144:147]
  ds_read_b64_tr_b16 a[24:25], v239 offset:8192
  v_mfma_f32_16x16x32_bf16 v[160:163], a[56:59], a[32:35], v[160:163]
  s_add_u32 m0, s23, 0x8800
  v_mfma_f32_16x16x32_bf16 v[160:163], a[76:79], a[36:39], v[160:163]
  ds_read_b64_tr_b16 a[26:27], v239 offset:8704
  v_mfma_f32_16x16x32_bf16 v[164:167], a[80:83], a[36:39], v[164:167]
  buffer_load_dwordx4 v230, s[8:11], s21 offen offset:2048 lds
  v_mfma_f32_16x16x32_bf16 v[164:167], a[60:63], a[32:35], v[164:167]
  ds_read_b64_tr_b16 a[28:29], v239 offset:20480
  v_mfma_f32_16x16x32_bf16 v[168:171], a[64:67], a[32:35], v[168:171]
  v_mfma_f32_16x16x32_bf16 v[168:171], a[84:87], a[36:39], v[168:171]
  ds_read_b64_tr_b16 a[30:31], v239 offset:20992
  v_mfma_f32_16x16x32_bf16 v[172:175], a[88:91], a[36:39], v[172:175]
  s_add_u32 m0, s23, 0x9400
  v_mfma_f32_16x16x32_bf16 v[172:175], a[68:71], a[32:35], v[172:175]
  ds_read_b64_tr_b16 a[32:33], v236 offset:9216
  v_mfma_f32_16x16x32_bf16 v[188:191], a[68:71], a[40:43], v[188:191]
  buffer_load_dwordx4 v230, s[8:11], s22 offen offset:0 lds
  v_mfma_f32_16x16x32_bf16 v[188:191], a[88:91], a[44:47], v[188:191]
  ds_read_b64_tr_b16 a[34:35], v236 offset:9728
  v_mfma_f32_16x16x32_bf16 v[184:187], a[84:87], a[44:47], v[184:187]
  v_mfma_f32_16x16x32_bf16 v[184:187], a[64:67], a[40:43], v[184:187]
  ds_read_b64_tr_b16 a[36:37], v236 offset:21504
  v_mfma_f32_16x16x32_bf16 v[180:183], a[60:63], a[40:43], v[180:183]
  v_mfma_f32_16x16x32_bf16 v[180:183], a[80:83], a[44:47], v[180:183]
  ds_read_b64_tr_b16 a[38:39], v236 offset:22016
  s_and_b32 s60, s2, 1
  s_lshl_b32 s60, s60, 6
  s_add_u32 s60, s60, s55
  s_bfe_u32 s3, s2, 0x20001
  s_mul_i32 s3, s3, 896
  s_add_u32 s60, s60, s3
  s_add_u32 s60, s60, 512
  s_lshl_b32 s60, s60, 11
  v_mfma_f32_16x16x32_bf16 v[176:179], a[76:79], a[44:47], v[176:179]
  s_mov_b64 exec, 0xffff
  buffer_load_dword a224, v202, s[36:39], s60 offen
  s_mov_b64 exec, -1
  s_add_u32 s21, s21, 0x60000
  s_add_u32 s22, s22, 0x60000
  v_mfma_f32_16x16x32_bf16 v[176:179], a[56:59], a[40:43], v[176:179]
  ds_read_b64_tr_b16 a[40:41], v237 offset:9216
  s_waitcnt lgkmcnt(8)
  v_mfma_f32_16x16x32_bf16 v[0:3], a[0:3], a[96:99], v[0:3]
  s_waitcnt vmcnt(33)
  ds_read_b128 a[56:59], v226 offset:0
  v_mfma_f32_16x16x32_bf16 v[0:3], a[4:7], a[116:119], v[0:3]
  ds_read_b64_tr_b16 a[42:43], v237 offset:9728
  v_mfma_f32_16x16x32_bf16 v[4:7], a[4:7], a[120:123], v[4:7]
  ds_read_b128 a[76:79], v227 offset:0
  v_mfma_f32_16x16x32_bf16 v[4:7], a[0:3], a[100:103], v[4:7]
  ds_read_b64_tr_b16 a[44:45], v237 offset:21504
  v_mfma_f32_16x16x32_bf16 v[8:11], a[0:3], a[104:107], v[8:11]
  v_mfma_f32_16x16x32_bf16 v[8:11], a[4:7], a[124:127], v[8:11]
  ds_read_b64_tr_b16 a[46:47], v237 offset:22016
  v_mfma_f32_16x16x32_bf16 v[12:15], a[4:7], a[128:131], v[12:15]
  v_mfma_f32_16x16x32_bf16 v[12:15], a[0:3], a[108:111], v[12:15]
  ds_read_b64_tr_b16 a[0:1], v238 offset:9216
  v_mfma_f32_16x16x32_bf16 v[28:31], a[8:11], a[108:111], v[28:31]
  s_add_u32 m0, s24, 0x100
  v_mfma_f32_16x16x32_bf16 v[28:31], a[12:15], a[128:131], v[28:31]
  ds_read_b64_tr_b16 a[2:3], v238 offset:9728
  v_mfma_f32_16x16x32_bf16 v[24:27], a[12:15], a[124:127], v[24:27]
  s_waitcnt vmcnt(31)
  ds_read_b128 a[60:63], v226 offset:2048
  v_mfma_f32_16x16x32_bf16 v[24:27], a[8:11], a[104:107], v[24:27]
  ds_read_b64_tr_b16 a[4:5], v238 offset:21504
  v_mfma_f32_16x16x32_bf16 v[20:23], a[8:11], a[100:103], v[20:23]
  ds_read_b128 a[80:83], v227 offset:2048
  v_mfma_f32_16x16x32_bf16 v[20:23], a[12:15], a[120:123], v[20:23]
  ds_read_b64_tr_b16 a[6:7], v238 offset:22016
  v_mfma_f32_16x16x32_bf16 v[16:19], a[12:15], a[116:119], v[16:19]
  s_waitcnt lgkmcnt(8)
  buffer_load_dwordx4 v224, s[4:7], s62 offen offset:1792 lds
  s_add_u32 m0, s24, 0x500
  v_mfma_f32_16x16x32_bf16 v[16:19], a[8:11], a[96:99], v[16:19]
  ds_read_b64_tr_b16 a[8:9], v239 offset:9216
  v_mfma_f32_16x16x32_bf16 v[32:35], a[16:19], a[96:99], v[32:35]
  buffer_load_dwordx4 v225, s[4:7], s62 offen offset:1792 lds
  s_add_u32 m0, s24, 0x900
  v_mfma_f32_16x16x32_bf16 v[32:35], a[20:23], a[116:119], v[32:35]
  ds_read_b64_tr_b16 a[10:11], v239 offset:9728
  v_mfma_f32_16x16x32_bf16 v[36:39], a[20:23], a[120:123], v[36:39]
  s_waitcnt lgkmcnt(3)
  buffer_load_dwordx4 v224, s[4:7], s63 offen offset:1792 lds
  v_mfma_f32_16x16x32_bf16 v[36:39], a[16:19], a[100:103], v[36:39]
  ds_read_b64_tr_b16 a[12:13], v239 offset:21504
  v_mfma_f32_16x16x32_bf16 v[40:43], a[16:19], a[104:107], v[40:43]
  s_waitcnt vmcnt(32)
  ds_read_b128 a[64:67], v226 offset:4096
  v_mfma_f32_16x16x32_bf16 v[40:43], a[20:23], a[124:127], v[40:43]
  ds_read_b64_tr_b16 a[14:15], v239 offset:22016
  s_add_u32 m0, s24, 0xd00
  v_mfma_f32_16x16x32_bf16 v[44:47], a[20:23], a[128:131], v[44:47]
  ds_read_b128 a[84:87], v227 offset:4096
  v_mfma_f32_16x16x32_bf16 v[44:47], a[16:19], a[108:111], v[44:47]
  ds_read_b64_tr_b16 a[16:17], v236 offset:10240
  v_mfma_f32_16x16x32_bf16 v[60:63], a[24:27], a[108:111], v[60:63]
  buffer_load_dwordx4 v225, s[4:7], s63 offen offset:1792 lds
  v_mfma_f32_16x16x32_bf16 v[60:63], a[28:31], a[128:131], v[60:63]
  ds_read_b64_tr_b16 a[18:19], v236 offset:10752
  s_add_u32 m0, s24, 0x1100
  v_mfma_f32_16x16x32_bf16 v[56:59], a[28:31], a[124:127], v[56:59]
  s_waitcnt lgkmcnt(2)
  buffer_load_dwordx4 v224, s[4:7], s64 offen offset:1792 lds
  v_mfma_f32_16x16x32_bf16 v[56:59], a[24:27], a[104:107], v[56:59]
  ds_read_b64_tr_b16 a[20:21], v236 offset:22528
  v_mfma_f32_16x16x32_bf16 v[52:55], a[24:27], a[100:103], v[52:55]
  v_mfma_f32_16x16x32_bf16 v[52:55], a[28:31], a[120:123], v[52:55]
  ds_read_b64_tr_b16 a[22:23], v236 offset:23040
  v_mfma_f32_16x16x32_bf16 v[48:51], a[28:31], a[116:119], v[48:51]
  s_waitcnt vmcnt(32)
  ds_read_b128 a[68:71], v226 offset:6144
  s_add_u32 m0, s24, 0x1500
  v_mfma_f32_16x16x32_bf16 v[48:51], a[24:27], a[96:99], v[48:51]
  ds_read_b64_tr_b16 a[24:25], v237 offset:10240
  v_mfma_f32_16x16x32_bf16 v[192:195], a[32:35], a[112:115], v[192:195]
  ds_read_b128 a[88:91], v227 offset:6144
  v_mfma_f32_16x16x32_bf16 v[192:195], a[36:39], a[132:135], v[192:195]
  ds_read_b64_tr_b16 a[26:27], v237 offset:10752
  v_mfma_f32_16x16x32_bf16 v[64:67], a[36:39], a[116:119], v[64:67]
  buffer_load_dwordx4 v225, s[4:7], s64 offen offset:1792 lds
  s_add_u32 m0, s24, 0x1900
  v_mfma_f32_16x16x32_bf16 v[64:67], a[32:35], a[96:99], v[64:67]
  ds_read_b64_tr_b16 a[28:29], v237 offset:22528
  v_mfma_f32_16x16x32_bf16 v[68:71], a[32:35], a[100:103], v[68:71]
  s_waitcnt lgkmcnt(2)
  buffer_load_dwordx4 v224, s[4:7], s65 offen offset:1792 lds
  v_mfma_f32_16x16x32_bf16 v[68:71], a[36:39], a[120:123], v[68:71]
  ds_read_b64_tr_b16 a[30:31], v237 offset:23040
  v_mfma_f32_16x16x32_bf16 v[72:75], a[36:39], a[124:127], v[72:75]
  v_mfma_f32_16x16x32_bf16 v[72:75], a[32:35], a[104:107], v[72:75]
  s_waitcnt vmcnt(32)
  ds_read_b128 a[72:75], v226 offset:8192
  s_add_u32 m0, s24, 0x1d00
  v_mfma_f32_16x16x32_bf16 v[76:79], a[32:35], a[108:111], v[76:79]
  ds_read_b128 a[92:95], v227 offset:8192
  v_mfma_f32_16x16x32_bf16 v[76:79], a[36:39], a[128:131], v[76:79]
  ds_read_b64_tr_b16 a[32:33], v238 offset:10240
  v_mfma_f32_16x16x32_bf16 v[92:95], a[44:47], a[128:131], v[92:95]
  buffer_load_dwordx4 v225, s[4:7], s65 offen offset:1792 lds
  v_mfma_f32_16x16x32_bf16 v[92:95], a[40:43], a[108:111], v[92:95]
  ds_read_b64_tr_b16 a[34:35], v238 offset:10752
  s_add_u32 m0, s24, 0x2100
  v_mfma_f32_16x16x32_bf16 v[88:91], a[40:43], a[104:107], v[88:91]
  s_waitcnt lgkmcnt(2)
  buffer_load_dwordx4 v224, s[4:7], s66 offen offset:1792 lds
  v_mfma_f32_16x16x32_bf16 v[88:91], a[44:47], a[124:127], v[88:91]
  ds_read_b64_tr_b16 a[36:37], v238 offset:22528
  v_mfma_f32_16x16x32_bf16 v[84:87], a[44:47], a[120:123], v[84:87]
  v_mfma_f32_16x16x32_bf16 v[84:87], a[40:43], a[100:103], v[84:87]
  ds_read_b64_tr_b16 a[38:39], v238 offset:23040
  v_mfma_f32_16x16x32_bf16 v[80:83], a[40:43], a[96:99], v[80:83]
  s_add_u32 m0, s24, 0x2500
  v_mfma_f32_16x16x32_bf16 v[80:83], a[44:47], a[116:119], v[80:83]
  ds_read_b64_tr_b16 a[40:41], v239 offset:10240
  v_mfma_f32_16x16x32_bf16 v[96:99], a[4:7], a[116:119], v[96:99]
  ds_read_b64_tr_b16 a[42:43], v239 offset:10752
  v_mfma_f32_16x16x32_bf16 v[96:99], a[0:3], a[96:99], v[96:99]
  ds_read_b64_tr_b16 a[44:45], v239 offset:22528
  v_mfma_f32_16x16x32_bf16 v[100:103], a[0:3], a[100:103], v[100:103]
  ds_read_b64_tr_b16 a[46:47], v239 offset:23040
  v_mfma_f32_16x16x32_bf16 v[100:103], a[4:7], a[120:123], v[100:103]
  buffer_load_dwordx4 v225, s[4:7], s66 offen offset:1792 lds
  s_getpc_b64 s[32:33]
L_k1_pc3_qkv_1:
  s_mov_b32 s34, L_k1_spin_qkv-L_k1_pc3_qkv_1
  s_bfe_u32 s60, s2, 0x40003
  s_lshl_b32 s60, s60, 2
  s_add_u32 s60, s60, s25
  s_lshl_b32 s60, s60, 9
  v_mfma_f32_16x16x32_bf16 v[104:107], a[4:7], a[124:127], v[104:107]
  s_mov_b64 exec, 15
  buffer_load_dword a224, v244, s[32:35], s60 offen
  s_mov_b64 exec, -1
  v_mfma_f32_16x16x32_bf16 v[104:107], a[0:3], a[104:107], v[104:107]
  v_mfma_f32_16x16x32_bf16 v[108:111], a[0:3], a[108:111], v[108:111]
  v_mfma_f32_16x16x32_bf16 v[108:111], a[4:7], a[128:131], v[108:111]
  s_waitcnt lgkmcnt(0) vmcnt(29)
  s_barrier
  ds_read_b64_tr_b16 a[0:1], v232 offset:8192
  v_mfma_f32_16x16x32_bf16 v[124:127], a[12:15], a[128:131], v[124:127]
  s_add_u32 m0, s23, 0xe000
  v_mfma_f32_16x16x32_bf16 v[124:127], a[8:11], a[108:111], v[124:127]
  ds_read_b64_tr_b16 a[2:3], v232 offset:8704
  v_mfma_f32_16x16x32_bf16 v[120:123], a[8:11], a[104:107], v[120:123]
  buffer_load_dwordx4 v229, s[8:11], s21 offen offset:0 lds
  v_mfma_f32_16x16x32_bf16 v[120:123], a[12:15], a[124:127], v[120:123]
  ds_read_b64_tr_b16 a[4:5], v232 offset:20480
  v_mfma_f32_16x16x32_bf16 v[116:119], a[12:15], a[120:123], v[116:119]
  v_mfma_f32_16x16x32_bf16 v[116:119], a[8:11], a[100:103], v[116:119]
  ds_read_b64_tr_b16 a[6:7], v232 offset:20992
  v_mfma_f32_16x16x32_bf16 v[112:115], a[8:11], a[96:99], v[112:115]
  s_add_u32 m0, s23, 0xdc00
  v_mfma_f32_16x16x32_bf16 v[112:115], a[12:15], a[116:119], v[112:115]
  ds_read_b64_tr_b16 a[8:9], v233 offset:8192
  v_mfma_f32_16x16x32_bf16 v[196:199], a[132:135], a[20:23], v[196:199]
  buffer_load_dwordx4 v229, s[8:11], s21 offen offset:2048 lds
  v_mfma_f32_16x16x32_bf16 v[196:199], a[112:115], a[16:19], v[196:199]
  ds_read_b64_tr_b16 a[10:11], v233 offset:8704
  v_mfma_f32_16x16x32_bf16 v[128:131], a[96:99], a[16:19], v[128:131]
  v_mfma_f32_16x16x32_bf16 v[128:131], a[116:119], a[20:23], v[128:131]
  ds_read_b64_tr_b16 a[12:13], v233 offset:20480
  v_mfma_f32_16x16x32_bf16 v[132:135], a[120:123], a[20:23], v[132:135]
  v_mfma_f32_16x16x32_bf16 v[132:135], a[100:103], a[16:19], v[132:135]
  ds_read_b64_tr_b16 a[14:15], v233 offset:20992
  s_add_u32 m0, s23, 0xe800
  v_mfma_f32_16x16x32_bf16 v[136:139], a[104:107], a[16:19], v[136:139]
  buffer_load_dwordx4 v229, s[8:11], s22 offen offset:0 lds
  v_mfma_f32_16x16x32_bf16 v[136:139], a[124:127], a[20:23], v[136:139]
  v_mfma_f32_16x16x32_bf16 v[140:143], a[128:131], a[20:23], v[140:143]
  v_mfma_f32_16x16x32_bf16 v[140:143], a[108:111], a[16:19], v[140:143]
  ds_read_b64_tr_b16 a[16:17], v234 offset:8192
  v_mfma_f32_16x16x32_bf16 v[156:159], a[108:111], a[24:27], v[156:159]
  v_mfma_f32_16x16x32_bf16 v[156:159], a[128:131], a[28:31], v[156:159]
  ds_read_b64_tr_b16 a[18:19], v234 offset:8704
  s_add_u32 m0, s23, 0xec00
  v_mfma_f32_16x16x32_bf16 v[152:155], a[124:127], a[28:31], v[152:155]
  buffer_load_dwordx4 v230, s[8:11], s21 offen offset:0 lds
  v_mfma_f32_16x16x32_bf16 v[152:155], a[104:107], a[24:27], v[152:155]
  ds_read_b64_tr_b16 a[20:21], v234 offset:20480
  v_mfma_f32_16x16x32_bf16 v[148:151], a[100:103], a[24:27], v[148:151]
  v_mfma_f32_16x16x32_bf16 v[148:151], a[120:123], a[28:31], v[148:151]
  ds_read_b64_tr_b16 a[22:23], v234 offset:20992
  v_mfma_f32_16x16x32_bf16 v[144:147], a[116:119], a[28:31], v[144:147]
  v_mfma_f32_16x16x32_bf16 v[144:147], a[96:99], a[24:27], v[144:147]
  ds_read_b64_tr_b16 a[24:25], v235 offset:8192
  v_mfma_f32_16x16x32_bf16 v[160:163], a[96:99], a[32:35], v[160:163]
  s_add_u32 m0, s23, 0xe800
  v_mfma_f32_16x16x32_bf16 v[160:163], a[116:119], a[36:39], v[160:163]
  ds_read_b64_tr_b16 a[26:27], v235 offset:8704
  v_mfma_f32_16x16x32_bf16 v[164:167], a[120:123], a[36:39], v[164:167]
  buffer_load_dwordx4 v230, s[8:11], s21 offen offset:2048 lds
  v_mfma_f32_16x16x32_bf16 v[164:167], a[100:103], a[32:35], v[164:167]
  ds_read_b64_tr_b16 a[28:29], v235 offset:20480
  v_mfma_f32_16x16x32_bf16 v[168:171], a[104:107], a[32:35], v[168:171]
  v_mfma_f32_16x16x32_bf16 v[168:171], a[124:127], a[36:39], v[168:171]
  ds_read_b64_tr_b16 a[30:31], v235 offset:20992
  v_mfma_f32_16x16x32_bf16 v[172:175], a[128:131], a[36:39], v[172:175]
  s_add_u32 m0, s23, 0xf400
  v_mfma_f32_16x16x32_bf16 v[172:175], a[108:111], a[32:35], v[172:175]
  ds_read_b64_tr_b16 a[32:33], v232 offset:9216
  v_mfma_f32_16x16x32_bf16 v[188:191], a[108:111], a[40:43], v[188:191]
  buffer_load_dwordx4 v230, s[8:11], s22 offen offset:0 lds
  v_mfma_f32_16x16x32_bf16 v[188:191], a[128:131], a[44:47], v[188:191]
  ds_read_b64_tr_b16 a[34:35], v232 offset:9728
  v_mfma_f32_16x16x32_bf16 v[184:187], a[124:127], a[44:47], v[184:187]
  v_mfma_f32_16x16x32_bf16 v[184:187], a[104:107], a[40:43], v[184:187]
  ds_read_b64_tr_b16 a[36:37], v232 offset:21504
  v_mfma_f32_16x16x32_bf16 v[180:183], a[100:103], a[40:43], v[180:183]
  v_mfma_f32_16x16x32_bf16 v[180:183], a[120:123], a[44:47], v[180:183]
  ds_read_b64_tr_b16 a[38:39], v232 offset:22016
  s_and_b32 s60, s2, 1
  s_lshl_b32 s60, s60, 6
  s_add_u32 s60, s60, s55
  s_bfe_u32 s3, s2, 0x20001
  s_mul_i32 s3, s3, 896
  s_add_u32 s60, s60, s3
  s_add_u32 s60, s60, 640
  s_lshl_b32 s60, s60, 11
  v_mfma_f32_16x16x32_bf16 v[176:179], a[116:119], a[44:47], v[176:179]
  s_mov_b64 exec, 0xffff
  buffer_load_dword a224, v202, s[36:39], s60 offen
  s_mov_b64 exec, -1
  s_add_u32 s21, s21, 0x60000
  s_add_u32 s22, s22, 0x60000
  v_mfma_f32_16x16x32_bf16 v[176:179], a[96:99], a[40:43], v[176:179]
  ds_read_b64_tr_b16 a[40:41], v233 offset:9216
  s_waitcnt lgkmcnt(8)
  v_mfma_f32_16x16x32_bf16 v[0:3], a[0:3], a[56:59], v[0:3]
  s_waitcnt vmcnt(33)
  ds_read_b128 a[96:99], v226 offset:10240
  v_mfma_f32_16x16x32_bf16 v[0:3], a[4:7], a[76:79], v[0:3]
  ds_read_b64_tr_b16 a[42:43], v233 offset:9728
  v_mfma_f32_16x16x32_bf16 v[4:7], a[4:7], a[80:83], v[4:7]
  ds_read_b128 a[116:119], v227 offset:10240
  v_mfma_f32_16x16x32_bf16 v[4:7], a[0:3], a[60:63], v[4:7]
  ds_read_b64_tr_b16 a[44:45], v233 offset:21504
  v_mfma_f32_16x16x32_bf16 v[8:11], a[0:3], a[64:67], v[8:11]
  v_mfma_f32_16x16x32_bf16 v[8:11], a[4:7], a[84:87], v[8:11]
  ds_read_b64_tr_b16 a[46:47], v233 offset:22016
  v_mfma_f32_16x16x32_bf16 v[12:15], a[4:7], a[88:91], v[12:15]
  v_mfma_f32_16x16x32_bf16 v[12:15], a[0:3], a[68:71], v[12:15]
  ds_read_b64_tr_b16 a[0:1], v234 offset:9216
  v_mfma_f32_16x16x32_bf16 v[28:31], a[8:11], a[68:71], v[28:31]
  s_add_u32 m0, s24, 0x2880
  v_mfma_f32_16x16x32_bf16 v[28:31], a[12:15], a[88:91], v[28:31]
  ds_read_b64_tr_b16 a[2:3], v234 offset:9728
  v_mfma_f32_16x16x32_bf16 v[24:27], a[12:15], a[84:87], v[24:27]
  s_waitcnt vmcnt(31)
  ds_read_b128 a[100:103], v226 offset:12288
  v_mfma_f32_16x16x32_bf16 v[24:27], a[8:11], a[64:67], v[24:27]
  ds_read_b64_tr_b16 a[4:5], v234 offset:21504
  v_mfma_f32_16x16x32_bf16 v[20:23], a[8:11], a[60:63], v[20:23]
  ds_read_b128 a[120:123], v227 offset:12288
  v_mfma_f32_16x16x32_bf16 v[20:23], a[12:15], a[80:83], v[20:23]
  ds_read_b64_tr_b16 a[6:7], v234 offset:22016
  v_mfma_f32_16x16x32_bf16 v[16:19], a[12:15], a[76:79], v[16:19]
  s_waitcnt lgkmcnt(8)
  buffer_load_dwordx4 v224, s[4:7], s62 offen offset:1920 lds
  s_add_u32 m0, s24, 0x2c80
  v_mfma_f32_16x16x32_bf16 v[16:19], a[8:11], a[56:59], v[16:19]
  ds_read_b64_tr_b16 a[8:9], v235 offset:9216
  v_mfma_f32_16x16x32_bf16 v[32:35], a[16:19], a[56:59], v[32:35]
  buffer_load_dwordx4 v225, s[4:7], s62 offen offset:1920 lds
  v_mfma_f32_16x16x32_bf16 v[32:35], a[20:23], a[76:79], v[32:35]
  ds_read_b64_tr_b16 a[10:11], v235 offset:9728
  s_add_u32 m0, s24, 0x3080
  v_mfma_f32_16x16x32_bf16 v[36:39], a[20:23], a[80:83], v[36:39]
  s_waitcnt lgkmcnt(3)
  buffer_load_dwordx4 v224, s[4:7], s63 offen offset:1920 lds
  v_mfma_f32_16x16x32_bf16 v[36:39], a[16:19], a[60:63], v[36:39]
  ds_read_b64_tr_b16 a[12:13], v235 offset:21504
  v_mfma_f32_16x16x32_bf16 v[40:43], a[16:19], a[64:67], v[40:43]
  s_waitcnt vmcnt(32)
  ds_read_b128 a[104:107], v226 offset:14336
  v_mfma_f32_16x16x32_bf16 v[40:43], a[20:23], a[84:87], v[40:43]
  ds_read_b64_tr_b16 a[14:15], v235 offset:22016
  v_mfma_f32_16x16x32_bf16 v[44:47], a[20:23], a[88:91], v[44:47]
  ds_read_b128 a[124:127], v227 offset:14336
  s_add_u32 m0, s24, 0x3480
  v_mfma_f32_16x16x32_bf16 v[44:47], a[16:19], a[68:71], v[44:47]
  ds_read_b64_tr_b16 a[16:17], v232 offset:10240
  v_mfma_f32_16x16x32_bf16 v[60:63], a[24:27], a[68:71], v[60:63]
  buffer_load_dwordx4 v225, s[4:7], s63 offen offset:1920 lds
  v_mfma_f32_16x16x32_bf16 v[60:63], a[28:31], a[88:91], v[60:63]
  ds_read_b64_tr_b16 a[18:19], v232 offset:10752
  v_mfma_f32_16x16x32_bf16 v[56:59], a[28:31], a[84:87], v[56:59]
  v_mfma_f32_16x16x32_bf16 v[56:59], a[24:27], a[64:67], v[56:59]
  ds_read_b64_tr_b16 a[20:21], v232 offset:22528
  s_add_u32 m0, s24, 0x3880
  v_mfma_f32_16x16x32_bf16 v[52:55], a[24:27], a[60:63], v[52:55]
  s_waitcnt lgkmcnt(3)
  buffer_load_dwordx4 v224, s[4:7], s64 offen offset:1920 lds
  v_mfma_f32_16x16x32_bf16 v[52:55], a[28:31], a[80:83], v[52:55]
  ds_read_b64_tr_b16 a[22:23], v232 offset:23040
  v_mfma_f32_16x16x32_bf16 v[48:51], a[28:31], a[76:79], v[48:51]
  s_waitcnt vmcnt(32)
  ds_read_b128 a[108:111], v226 offset:16384
  v_mfma_f32_16x16x32_bf16 v[48:51], a[24:27], a[56:59], v[48:51]
  ds_read_b64_tr_b16 a[24:25], v233 offset:10240
  v_mfma_f32_16x16x32_bf16 v[192:195], a[32:35], a[72:75], v[192:195]
  ds_read_b128 a[128:131], v227 offset:16384
  s_add_u32 m0, s24, 0x3c80
  v_mfma_f32_16x16x32_bf16 v[192:195], a[36:39], a[92:95], v[192:195]
  ds_read_b64_tr_b16 a[26:27], v233 offset:10752
  v_mfma_f32_16x16x32_bf16 v[64:67], a[36:39], a[76:79], v[64:67]
  buffer_load_dwordx4 v225, s[4:7], s64 offen offset:1920 lds
  v_mfma_f32_16x16x32_bf16 v[64:67], a[32:35], a[56:59], v[64:67]
  ds_read_b64_tr_b16 a[28:29], v233 offset:22528
  v_mfma_f32_16x16x32_bf16 v[68:71], a[32:35], a[60:63], v[68:71]
  v_mfma_f32_16x16x32_bf16 v[68:71], a[36:39], a[80:83], v[68:71]
  ds_read_b64_tr_b16 a[30:31], v233 offset:23040
  s_add_u32 m0, s24, 0x4080
  v_mfma_f32_16x16x32_bf16 v[72:75], a[36:39], a[84:87], v[72:75]
  s_waitcnt lgkmcnt(3)
  buffer_load_dwordx4 v224, s[4:7], s65 offen offset:1920 lds
  v_mfma_f32_16x16x32_bf16 v[72:75], a[32:35], a[64:67], v[72:75]
  s_waitcnt vmcnt(32)
  ds_read_b128 a[112:115], v226 offset:18432
  v_mfma_f32_16x16x32_bf16 v[76:79], a[32:35], a[68:71], v[76:79]
  ds_read_b128 a[132:135], v227 offset:18432
  v_mfma_f32_16x16x32_bf16 v[76:79], a[36:39], a[88:91], v[76:79]
  ds_read_b64_tr_b16 a[32:33], v234 offset:10240
  v_mfma_f32_16x16x32_bf16 v[92:95], a[44:47], a[88:91], v[92:95]
  s_add_u32 m0, s24, 0x4480
  v_mfma_f32_16x16x32_bf16 v[92:95], a[40:43], a[68:71], v[92:95]
  ds_read_b64_tr_b16 a[34:35], v234 offset:10752
  v_mfma_f32_16x16x32_bf16 v[88:91], a[40:43], a[64:67], v[88:91]
  buffer_load_dwordx4 v225, s[4:7], s65 offen offset:1920 lds
  v_mfma_f32_16x16x32_bf16 v[88:91], a[44:47], a[84:87], v[88:91]
  ds_read_b64_tr_b16 a[36:37], v234 offset:22528
  v_mfma_f32_16x16x32_bf16 v[84:87], a[44:47], a[80:83], v[84:87]
  v_mfma_f32_16x16x32_bf16 v[84:87], a[40:43], a[60:63], v[84:87]
  ds_read_b64_tr_b16 a[38:39], v234 offset:23040
  s_add_u32 m0, s24, 0x4880
  v_mfma_f32_16x16x32_bf16 v[80:83], a[40:43], a[56:59], v[80:83]
  s_waitcnt lgkmcnt(4)
  buffer_load_dwordx4 v224, s[4:7], s66 offen offset:1920 lds
  v_mfma_f32_16x16x32_bf16 v[80:83], a[44:47], a[76:79], v[80:83]
  ds_read_b64_tr_b16 a[40:41], v235 offset:10240
  v_mfma_f32_16x16x32_bf16 v[96:99], a[4:7], a[76:79], v[96:99]
  ds_read_b64_tr_b16 a[42:43], v235 offset:10752
  v_mfma_f32_16x16x32_bf16 v[96:99], a[0:3], a[56:59], v[96:99]
  ds_read_b64_tr_b16 a[44:45], v235 offset:22528
  v_mfma_f32_16x16x32_bf16 v[100:103], a[0:3], a[60:63], v[100:103]
  ds_read_b64_tr_b16 a[46:47], v235 offset:23040
  s_add_u32 m0, s24, 0x4c80
  v_mfma_f32_16x16x32_bf16 v[100:103], a[4:7], a[80:83], v[100:103]
  buffer_load_dwordx4 v225, s[4:7], s66 offen offset:1920 lds
  v_mfma_f32_16x16x32_bf16 v[104:107], a[4:7], a[84:87], v[104:107]
  v_mfma_f32_16x16x32_bf16 v[104:107], a[0:3], a[64:67], v[104:107]
  v_mfma_f32_16x16x32_bf16 v[108:111], a[0:3], a[68:71], v[108:111]
  v_mfma_f32_16x16x32_bf16 v[108:111], a[4:7], a[88:91], v[108:111]
  s_waitcnt lgkmcnt(0) vmcnt(29)
  s_barrier
  ds_read_b64_tr_b16 a[0:1], v232 offset:32768
  v_mfma_f32_16x16x32_bf16 v[124:127], a[12:15], a[88:91], v[124:127]
  s_add_u32 m0, s23, 0x2000
  v_mfma_f32_16x16x32_bf16 v[124:127], a[8:11], a[68:71], v[124:127]
  ds_read_b64_tr_b16 a[2:3], v232 offset:33280
  v_mfma_f32_16x16x32_bf16 v[120:123], a[8:11], a[64:67], v[120:123]
  buffer_load_dwordx4 v229, s[8:11], s21 offen offset:0 lds
  v_mfma_f32_16x16x32_bf16 v[120:123], a[12:15], a[84:87], v[120:123]
  ds_read_b64_tr_b16 a[4:5], v232 offset:45056
  v_mfma_f32_16x16x32_bf16 v[116:119], a[12:15], a[80:83], v[116:119]
  v_mfma_f32_16x16x32_bf16 v[116:119], a[8:11], a[60:63], v[116:119]
  ds_read_b64_tr_b16 a[6:7], v232 offset:45568
  s_add_u32 m0, s23, 0x1c00
  v_mfma_f32_16x16x32_bf16 v[112:115], a[8:11], a[56:59], v[112:115]
  buffer_load_dwordx4 v229, s[8:11], s21 offen offset:2048 lds
  v_mfma_f32_16x16x32_bf16 v[112:115], a[12:15], a[76:79], v[112:115]
  ds_read_b64_tr_b16 a[8:9], v233 offset:32768
  v_mfma_f32_16x16x32_bf16 v[196:199], a[92:95], a[20:23], v[196:199]
  v_mfma_f32_16x16x32_bf16 v[196:199], a[72:75], a[16:19], v[196:199]
  ds_read_b64_tr_b16 a[10:11], v233 offset:33280
  v_mfma_f32_16x16x32_bf16 v[128:131], a[56:59], a[16:19], v[128:131]
  v_mfma_f32_16x16x32_bf16 v[128:131], a[76:79], a[20:23], v[128:131]
  ds_read_b64_tr_b16 a[12:13], v233 offset:45056
  s_add_u32 m0, s23, 0x2800
  v_mfma_f32_16x16x32_bf16 v[132:135], a[80:83], a[20:23], v[132:135]
  buffer_load_dwordx4 v229, s[8:11], s22 offen offset:0 lds
  v_mfma_f32_16x16x32_bf16 v[132:135], a[60:63], a[16:19], v[132:135]
  ds_read_b64_tr_b16 a[14:15], v233 offset:45568
  v_mfma_f32_16x16x32_bf16 v[136:139], a[64:67], a[16:19], v[136:139]
  v_mfma_f32_16x16x32_bf16 v[136:139], a[84:87], a[20:23], v[136:139]
  v_mfma_f32_16x16x32_bf16 v[140:143], a[88:91], a[20:23], v[140:143]
  v_mfma_f32_16x16x32_bf16 v[140:143], a[68:71], a[16:19], v[140:143]
  ds_read_b64_tr_b16 a[16:17], v234 offset:32768
  s_and_b32 s60, s2, 1
  s_lshl_b32 s60, s60, 6
  s_add_u32 s60, s60, s55
  s_bfe_u32 s3, s2, 0x20001
  s_mul_i32 s3, s3, 896
  s_add_u32 s60, s60, s3
  s_add_u32 s60, s60, 768
  s_lshl_b32 s60, s60, 11
  v_mfma_f32_16x16x32_bf16 v[156:159], a[68:71], a[24:27], v[156:159]
  s_mov_b64 exec, 0xffff
  buffer_load_dword a224, v202, s[36:39], s60 offen
  s_mov_b64 exec, -1
  v_mfma_f32_16x16x32_bf16 v[156:159], a[88:91], a[28:31], v[156:159]
  ds_read_b64_tr_b16 a[18:19], v234 offset:33280
  v_mfma_f32_16x16x32_bf16 v[152:155], a[84:87], a[28:31], v[152:155]
  v_mfma_f32_16x16x32_bf16 v[152:155], a[64:67], a[24:27], v[152:155]
  ds_read_b64_tr_b16 a[20:21], v234 offset:45056
  v_mfma_f32_16x16x32_bf16 v[148:151], a[60:63], a[24:27], v[148:151]
  v_mfma_f32_16x16x32_bf16 v[148:151], a[80:83], a[28:31], v[148:151]
  ds_read_b64_tr_b16 a[22:23], v234 offset:45568
  s_add_u32 m0, s23, 0x2c00
  v_mfma_f32_16x16x32_bf16 v[144:147], a[76:79], a[28:31], v[144:147]
  buffer_load_dwordx4 v230, s[8:11], s21 offen offset:0 lds
  v_mfma_f32_16x16x32_bf16 v[144:147], a[56:59], a[24:27], v[144:147]
  ds_read_b64_tr_b16 a[24:25], v235 offset:32768
  v_mfma_f32_16x16x32_bf16 v[160:163], a[56:59], a[32:35], v[160:163]
  v_mfma_f32_16x16x32_bf16 v[160:163], a[76:79], a[36:39], v[160:163]
  ds_read_b64_tr_b16 a[26:27], v235 offset:33280
  v_mfma_f32_16x16x32_bf16 v[164:167], a[80:83], a[36:39], v[164:167]
  s_add_u32 m0, s23, 0x2800
  v_mfma_f32_16x16x32_bf16 v[164:167], a[60:63], a[32:35], v[164:167]
  ds_read_b64_tr_b16 a[28:29], v235 offset:45056
  v_mfma_f32_16x16x32_bf16 v[168:171], a[64:67], a[32:35], v[168:171]
  buffer_load_dwordx4 v230, s[8:11], s21 offen offset:2048 lds
  v_mfma_f32_16x16x32_bf16 v[168:171], a[84:87], a[36:39], v[168:171]
  ds_read_b64_tr_b16 a[30:31], v235 offset:45568
  v_mfma_f32_16x16x32_bf16 v[172:175], a[88:91], a[36:39], v[172:175]
  v_mfma_f32_16x16x32_bf16 v[172:175], a[68:71], a[32:35], v[172:175]
  ds_read_b64_tr_b16 a[32:33], v232 offset:33792
  v_mfma_f32_16x16x32_bf16 v[188:191], a[68:71], a[40:43], v[188:191]
  s_add_u32 m0, s23, 0x3400
  v_mfma_f32_16x16x32_bf16 v[188:191], a[88:91], a[44:47], v[188:191]
  ds_read_b64_tr_b16 a[34:35], v232 offset:34304
  v_mfma_f32_16x16x32_bf16 v[184:187], a[84:87], a[44:47], v[184:187]
  buffer_load_dwordx4 v230, s[8:11], s22 offen offset:0 lds
  v_mfma_f32_16x16x32_bf16 v[184:187], a[64:67], a[40:43], v[184:187]
  ds_read_b64_tr_b16 a[36:37], v232 offset:46080
  v_mfma_f32_16x16x32_bf16 v[180:183], a[60:63], a[40:43], v[180:183]
  v_mfma_f32_16x16x32_bf16 v[180:183], a[80:83], a[44:47], v[180:183]
  ds_read_b64_tr_b16 a[38:39], v232 offset:46592
  v_mfma_f32_16x16x32_bf16 v[176:179], a[76:79], a[44:47], v[176:179]
  v_and_b32 v254, 0x30, v228
  v_lshlrev_b32 v254, 4, v254
  v_and_b32 v255, 0x1c0, v228
  v_lshl_add_u32 v254, v255, 6, v254
  s_and_b32 s60, s2, 0x19
  s_lshl_b32 s60, s60, 7
  v_or_b32 v254, s60, v254
  s_mov_b32 exec_lo, 0
  v_and_b32 v254, 0x10, v228
  v_lshlrev_b32 v254, 3, v254
  v_and_b32 v255, 0x60, v228
  v_lshl_add_u32 v254, v255, 5, v254
  s_and_b32 s60, s2, 0xe6
  s_lshl_b32 s60, s60, 7
  s_add_u32 s60, s60, 64
  v_add_u32 v254, s60, v254
  s_mov_b32 exec_hi, 0xffffff00
  s_max_u32 s60, s26, 1
  s_sub_u32 s60, s60, 1
  s_lshr_b32 s3, s60, 2
  s_and_b32 s60, s60, 3
  s_lshl_b32 s60, s60, 3
  s_or_b32 s60, s60, s3
  s_or_b32 s60, s60, 0xc6
  s_lshl_b32 s60, s60, 7
  v_and_b32 v254, 0x10, v228
  v_lshlrev_b32 v254, 8, v254
  v_add_u32 v254, s60, v254
  s_mov_b64 exec, -1
  v_mfma_f32_16x16x32_bf16 v[176:179], a[56:59], a[40:43], v[176:179]
  ds_read_b64_tr_b16 a[40:41], v233 offset:33792
  s_waitcnt lgkmcnt(8)
  v_mfma_f32_16x16x32_bf16 v[0:3], a[0:3], a[96:99], v[0:3]
  buffer_load_dwordx2 v[252:253], v254, s[16:19], 0 offen sc1
  s_add_u32 s21, s21, 0x60000
  s_add_u32 s22, s22, 0x60000
  v_mfma_f32_16x16x32_bf16 v[0:3], a[4:7], a[116:119], v[0:3]
  ds_read_b64_tr_b16 a[42:43], v233 offset:34304
  v_mfma_f32_16x16x32_bf16 v[4:7], a[4:7], a[120:123], v[4:7]
  s_waitcnt vmcnt(34)
  ds_read_b128 a[56:59], v226 offset:0
  v_mfma_f32_16x16x32_bf16 v[4:7], a[0:3], a[100:103], v[4:7]
  ds_read_b64_tr_b16 a[44:45], v233 offset:46080
  v_mfma_f32_16x16x32_bf16 v[8:11], a[0:3], a[104:107], v[8:11]
  ds_read_b128 a[76:79], v227 offset:0
  v_mfma_f32_16x16x32_bf16 v[8:11], a[4:7], a[124:127], v[8:11]
  ds_read_b64_tr_b16 a[46:47], v233 offset:46592
  v_mfma_f32_16x16x32_bf16 v[12:15], a[4:7], a[128:131], v[12:15]
  v_mfma_f32_16x16x32_bf16 v[12:15], a[0:3], a[108:111], v[12:15]
  ds_read_b64_tr_b16 a[0:1], v234 offset:33792
  v_mfma_f32_16x16x32_bf16 v[28:31], a[8:11], a[108:111], v[28:31]
  s_getpc_b64 s[32:33]
L_k1_pc2_qkv:
  s_add_u32 s32, s32, L_k2_start-L_k1_pc2_qkv
  s_addc_u32 s33, s33, 0
  s_mov_b32 s34, L_k2_spin-L_k2_start
  s_lshr_b32 s60, s2, 3
  s_lshl_b32 s60, s60, 2
  s_add_u32 s60, s60, s25
  s_lshl_b32 s60, s60, 8
  v_mfma_f32_16x16x32_bf16 v[28:31], a[12:15], a[128:131], v[28:31]
  ds_read_b64_tr_b16 a[2:3], v234 offset:34304
  v_mfma_f32_16x16x32_bf16 v[24:27], a[12:15], a[124:127], v[24:27]
  s_waitcnt vmcnt(32)
  ds_read_b128 a[60:63], v226 offset:2048
  v_mfma_f32_16x16x32_bf16 v[24:27], a[8:11], a[104:107], v[24:27]
  ds_read_b64_tr_b16 a[4:5], v234 offset:46080
  v_mfma_f32_16x16x32_bf16 v[20:23], a[8:11], a[100:103], v[20:23]
  ds_read_b128 a[80:83], v227 offset:2048
  v_mfma_f32_16x16x32_bf16 v[20:23], a[12:15], a[120:123], v[20:23]
  ds_read_b64_tr_b16 a[6:7], v234 offset:46592
  v_mfma_f32_16x16x32_bf16 v[16:19], a[12:15], a[116:119], v[16:19]
  s_mov_b64 exec, 3
  buffer_load_dword a224, v244, s[32:35], s60 offen
  s_mov_b64 exec, -1
  v_mfma_f32_16x16x32_bf16 v[16:19], a[8:11], a[96:99], v[16:19]
  ds_read_b64_tr_b16 a[8:9], v235 offset:33792
  v_mfma_f32_16x16x32_bf16 v[32:35], a[16:19], a[96:99], v[32:35]
  v_mfma_f32_16x16x32_bf16 v[32:35], a[20:23], a[116:119], v[32:35]
  ds_read_b64_tr_b16 a[10:11], v235 offset:34304
  v_mfma_f32_16x16x32_bf16 v[36:39], a[20:23], a[120:123], v[36:39]
  v_mfma_f32_16x16x32_bf16 v[36:39], a[16:19], a[100:103], v[36:39]
  ds_read_b64_tr_b16 a[12:13], v235 offset:46080
  v_mfma_f32_16x16x32_bf16 v[40:43], a[16:19], a[104:107], v[40:43]
  s_waitcnt vmcnt(31)
  ds_read_b128 a[64:67], v226 offset:4096
  v_mfma_f32_16x16x32_bf16 v[40:43], a[20:23], a[124:127], v[40:43]
  ds_read_b64_tr_b16 a[14:15], v235 offset:46592
  v_mfma_f32_16x16x32_bf16 v[44:47], a[20:23], a[128:131], v[44:47]
  ds_read_b128 a[84:87], v227 offset:4096
  v_mfma_f32_16x16x32_bf16 v[44:47], a[16:19], a[108:111], v[44:47]
  ds_read_b64_tr_b16 a[16:17], v232 offset:34816
  s_waitcnt lgkmcnt(8)
  v_mfma_f32_16x16x32_bf16 v[60:63], a[24:27], a[108:111], v[60:63]
  v_mfma_f32_16x16x32_bf16 v[60:63], a[28:31], a[128:131], v[60:63]
  ds_read_b64_tr_b16 a[18:19], v232 offset:35328
  v_mfma_f32_16x16x32_bf16 v[56:59], a[28:31], a[124:127], v[56:59]
  v_mfma_f32_16x16x32_bf16 v[56:59], a[24:27], a[104:107], v[56:59]
  ds_read_b64_tr_b16 a[20:21], v232 offset:47104
  v_mfma_f32_16x16x32_bf16 v[52:55], a[24:27], a[100:103], v[52:55]
  v_mfma_f32_16x16x32_bf16 v[52:55], a[28:31], a[120:123], v[52:55]
  ds_read_b64_tr_b16 a[22:23], v232 offset:47616
  v_mfma_f32_16x16x32_bf16 v[48:51], a[28:31], a[116:119], v[48:51]
  s_waitcnt vmcnt(29)
  ds_read_b128 a[68:71], v226 offset:6144
  v_mfma_f32_16x16x32_bf16 v[48:51], a[24:27], a[96:99], v[48:51]
  ds_read_b64_tr_b16 a[24:25], v233 offset:34816
  v_mfma_f32_16x16x32_bf16 v[192:195], a[32:35], a[112:115], v[192:195]
  ds_read_b128 a[88:91], v227 offset:6144
  v_mfma_f32_16x16x32_bf16 v[192:195], a[36:39], a[132:135], v[192:195]
  ds_read_b64_tr_b16 a[26:27], v233 offset:35328
  v_mfma_f32_16x16x32_bf16 v[64:67], a[36:39], a[116:119], v[64:67]
  v_mfma_f32_16x16x32_bf16 v[64:67], a[32:35], a[96:99], v[64:67]
  ds_read_b64_tr_b16 a[28:29], v233 offset:47104
  v_mfma_f32_16x16x32_bf16 v[68:71], a[32:35], a[100:103], v[68:71]
  v_mfma_f32_16x16x32_bf16 v[68:71], a[36:39], a[120:123], v[68:71]
  ds_read_b64_tr_b16 a[30:31], v233 offset:47616
  v_mfma_f32_16x16x32_bf16 v[72:75], a[36:39], a[124:127], v[72:75]
  v_mfma_f32_16x16x32_bf16 v[72:75], a[32:35], a[104:107], v[72:75]
  s_waitcnt vmcnt(27)
  ds_read_b128 a[72:75], v226 offset:8192
  v_mfma_f32_16x16x32_bf16 v[76:79], a[32:35], a[108:111], v[76:79]
  ds_read_b128 a[92:95], v227 offset:8192
  v_mfma_f32_16x16x32_bf16 v[76:79], a[36:39], a[128:131], v[76:79]
  ds_read_b64_tr_b16 a[32:33], v234 offset:34816
  v_mfma_f32_16x16x32_bf16 v[92:95], a[44:47], a[128:131], v[92:95]
  v_mfma_f32_16x16x32_bf16 v[92:95], a[40:43], a[108:111], v[92:95]
  ds_read_b64_tr_b16 a[34:35], v234 offset:35328
  v_mfma_f32_16x16x32_bf16 v[88:91], a[40:43], a[104:107], v[88:91]
  v_mfma_f32_16x16x32_bf16 v[88:91], a[44:47], a[124:127], v[88:91]
  ds_read_b64_tr_b16 a[36:37], v234 offset:47104
  v_mfma_f32_16x16x32_bf16 v[84:87], a[44:47], a[120:123], v[84:87]
  v_mfma_f32_16x16x32_bf16 v[84:87], a[40:43], a[100:103], v[84:87]
  ds_read_b64_tr_b16 a[38:39], v234 offset:47616
  v_mfma_f32_16x16x32_bf16 v[80:83], a[40:43], a[96:99], v[80:83]
  v_mfma_f32_16x16x32_bf16 v[80:83], a[44:47], a[116:119], v[80:83]
  ds_read_b64_tr_b16 a[40:41], v235 offset:34816
  s_waitcnt lgkmcnt(8)
  v_mfma_f32_16x16x32_bf16 v[96:99], a[4:7], a[116:119], v[96:99]
  ds_read_b64_tr_b16 a[42:43], v235 offset:35328
  v_mfma_f32_16x16x32_bf16 v[96:99], a[0:3], a[96:99], v[96:99]
  ds_read_b64_tr_b16 a[44:45], v235 offset:47104
  v_mfma_f32_16x16x32_bf16 v[100:103], a[0:3], a[100:103], v[100:103]
  ds_read_b64_tr_b16 a[46:47], v235 offset:47616
  v_mfma_f32_16x16x32_bf16 v[100:103], a[4:7], a[120:123], v[100:103]
  v_mfma_f32_16x16x32_bf16 v[104:107], a[4:7], a[124:127], v[104:107]
  v_mfma_f32_16x16x32_bf16 v[104:107], a[0:3], a[104:107], v[104:107]
  v_mfma_f32_16x16x32_bf16 v[108:111], a[0:3], a[108:111], v[108:111]
  v_mfma_f32_16x16x32_bf16 v[108:111], a[4:7], a[128:131], v[108:111]
  s_waitcnt lgkmcnt(0) vmcnt(20)
  s_barrier
  ds_read_b64_tr_b16 a[0:1], v236 offset:8192
  v_mfma_f32_16x16x32_bf16 v[124:127], a[12:15], a[128:131], v[124:127]
  s_waitcnt vmcnt(1)
  v_cmp_ne_u64 vcc, s[56:57], v[252:253]
  s_cbranch_vccnz L_k1_spin_qkv
L_k1_back_qkv:
  v_and_b32 v244, 0xff, v228
  s_lshr_b32 s60, s62, 7
  s_add_u32 s60, s60, 0x10000
  v_mfma_f32_16x16x32_bf16 v[124:127], a[8:11], a[108:111], v[124:127]
  ds_read_b64_tr_b16 a[2:3], v236 offset:8704
  v_lshrrev_b32 v252, 7, v228
  v_mfma_f32_16x16x32_bf16 v[120:123], a[8:11], a[104:107], v[120:123]
  buffer_load_dwordx4 a[200:203], v244, s[16:19], s60 offen sc1
  v_lshlrev_b32 v252, 11, v252
  v_mfma_f32_16x16x32_bf16 v[120:123], a[12:15], a[124:127], v[120:123]
  ds_read_b64_tr_b16 a[4:5], v236 offset:20480
  v_bfe_u32 v253, v228, 5, 2
  v_mfma_f32_16x16x32_bf16 v[116:119], a[12:15], a[120:123], v[116:119]
  v_lshrrev_b32 v254, 8, v228
  v_mfma_f32_16x16x32_bf16 v[116:119], a[8:11], a[100:103], v[116:119]
  ds_read_b64_tr_b16 a[6:7], v236 offset:20992
  s_lshr_b32 s60, s63, 7
  s_add_u32 s60, s60, 0x10000
  v_mfma_f32_16x16x32_bf16 v[112:115], a[8:11], a[96:99], v[112:115]
  buffer_load_dwordx4 a[204:207], v244, s[16:19], s60 offen sc1
  v_xor_b32 v253, v253, v254
  v_mfma_f32_16x16x32_bf16 v[112:115], a[12:15], a[116:119], v[112:115]
  ds_read_b64_tr_b16 a[8:9], v237 offset:8192
  v_lshl_add_u32 v252, v253, 5, v252
  v_mfma_f32_16x16x32_bf16 v[196:199], a[132:135], a[20:23], v[196:199]
  v_and_b32 v253, 16, v228
  v_mfma_f32_16x16x32_bf16 v[196:199], a[112:115], a[16:19], v[196:199]
  ds_read_b64_tr_b16 a[10:11], v237 offset:8704
  v_add_u32 v252, v252, v253
  v_mfma_f32_16x16x32_bf16 v[128:131], a[96:99], a[16:19], v[128:131]
  s_lshr_b32 s60, s64, 7
  s_add_u32 s60, s60, 0x10000
  s_lshr_b32 s3, s2, 5
  s_lshl_b32 s3, s3, 2
  s_lshr_b32 s3, 0x76345210, s3
  s_and_b32 s3, s3, 7
  s_lshl_b32 s3, s3, 1
  s_bfe_u32 s23, s2, 0x10001
  s_add_u32 s3, s3, s23
  s_lshl_b32 s24, s3, 7
  v_mfma_f32_16x16x32_bf16 v[128:131], a[116:119], a[20:23], v[128:131]
  ds_read_b64_tr_b16 a[12:13], v237 offset:20480
  s_lshl_b32 s3, s25, 15
  s_add_u32 s3, s3, s24
  v_add_u32 v224, s3, v252
  v_mfma_f32_16x16x32_bf16 v[132:135], a[120:123], a[20:23], v[132:135]
  buffer_load_dwordx4 a[208:211], v244, s[16:19], s60 offen sc1
  v_add_u32 v225, 0x4000, v224
  v_mfma_f32_16x16x32_bf16 v[132:135], a[100:103], a[16:19], v[132:135]
  ds_read_b64_tr_b16 a[14:15], v237 offset:20992
  v_xor_b32 v229, 0x80, v224
  v_mfma_f32_16x16x32_bf16 v[136:139], a[104:107], a[16:19], v[136:139]
  v_xor_b32 v230, 0x80, v225
  v_mfma_f32_16x16x32_bf16 v[136:139], a[124:127], a[20:23], v[136:139]
  s_lshr_b32 s60, s65, 7
  s_add_u32 s60, s60, 0x10000
  s_lshl_b32 s23, s25, 11
  v_mfma_f32_16x16x32_bf16 v[140:143], a[128:131], a[20:23], v[140:143]
  buffer_load_dwordx4 a[212:215], v244, s[16:19], s60 offen sc1
  s_bfe_u32 s3, s2, 0x20001
  s_mul_i32 s20, s3, 1835008
  v_mfma_f32_16x16x32_bf16 v[140:143], a[108:111], a[16:19], v[140:143]
  ds_read_b64_tr_b16 a[16:17], v238 offset:8192
  s_bfe_u32 s3, s2, 0x20005
  s_cmp_eq_u32 s3, 0
  s_mov_b32 s40, 0xa7419630
  s_mov_b32 s41, 0xb852
  v_mfma_f32_16x16x32_bf16 v[156:159], a[108:111], a[24:27], v[156:159]
  s_bfe_u32 s3, s2, 0x20005
  s_cmp_eq_u32 s3, 1
  s_cselect_b32 s40, 0x1a740963, s40
  s_cselect_b32 s41, 0x2b85, s41
  v_mfma_f32_16x16x32_bf16 v[156:159], a[128:131], a[28:31], v[156:159]
  ds_read_b64_tr_b16 a[18:19], v238 offset:8704
  s_bfe_u32 s3, s2, 0x20005
  s_cmp_eq_u32 s3, 2
  s_cselect_b32 s40, 0x41a73096, s40
  s_cselect_b32 s41, 0x52b8, s41
  v_mfma_f32_16x16x32_bf16 v[152:155], a[124:127], a[28:31], v[152:155]
  s_lshr_b32 s60, s66, 7
  s_add_u32 s60, s60, 0x10000
  s_bfe_u32 s3, s2, 0x20005
  s_cmp_eq_u32 s3, 3
  s_cselect_b32 s40, 0x741a6309, s40
  s_cselect_b32 s41, 0x852b, s41
  v_mfma_f32_16x16x32_bf16 v[152:155], a[104:107], a[24:27], v[152:155]
  ds_read_b64_tr_b16 a[20:21], v238 offset:20480
  s_bfe_u32 s21, s40, 0x40000
  s_lshl_b32 s21, s21, 17
  s_add_u32 s21, s21, s20
  v_mfma_f32_16x16x32_bf16 v[148:151], a[100:103], a[24:27], v[148:151]
  buffer_load_dwordx4 a[216:219], v244, s[16:19], s60 offen sc1
  v_mfma_f32_16x16x32_bf16 v[148:151], a[120:123], a[28:31], v[148:151]
  ds_read_b64_tr_b16 a[22:23], v238 offset:20992
  v_mfma_f32_16x16x32_bf16 v[144:147], a[116:119], a[28:31], v[144:147]
  v_mfma_f32_16x16x32_bf16 v[144:147], a[96:99], a[24:27], v[144:147]
  ds_read_b64_tr_b16 a[24:25], v239 offset:8192
  v_lshrrev_b32 v245, 2, v244
  v_lshrrev_b32 v246, 4, v228
  v_and_b32 v246, 0x30, v246
  v_and_b32 v247, 4, v245
  v_add_u32 v246, v246, v247
  v_add_u32 v247, 8, v246
  v_cmp_le_u32 s[48:49], v246, v245
  v_cmp_le_u32 s[50:51], v247, v245
  v_add_u32 v248, 64, v246
  v_add_u32 v249, 64, v247
  v_cndmask_b32 v246, v246, v248, s[48:49]
  v_cndmask_b32 v247, v247, v249, s[50:51]
  v_lshrrev_b32 v248, 2, v228
  s_lshr_b32 s60, s62, 9
  s_add_u32 s60, s60, 0x1ffc0
  v_mfma_f32_16x16x32_bf16 v[160:163], a[96:99], a[32:35], v[160:163]
  buffer_load_dword v204, v248, s[16:19], s60 offen sc1
  v_mfma_f32_16x16x32_bf16 v[160:163], a[116:119], a[36:39], v[160:163]
  ds_read_b64_tr_b16 a[26:27], v239 offset:8704
  v_mfma_f32_16x16x32_bf16 v[164:167], a[120:123], a[36:39], v[164:167]
  v_mfma_f32_16x16x32_bf16 v[164:167], a[100:103], a[32:35], v[164:167]
  ds_read_b64_tr_b16 a[28:29], v239 offset:20480
  v_mfma_f32_16x16x32_bf16 v[168:171], a[104:107], a[32:35], v[168:171]
  s_nop 0
  v_mfma_f32_16x16x32_bf16 v[168:171], a[124:127], a[36:39], v[168:171]
  ds_read_b64_tr_b16 a[30:31], v239 offset:20992
  v_mfma_f32_16x16x32_bf16 v[172:175], a[128:131], a[36:39], v[172:175]
  buffer_load_dword v205, v248, s[16:19], s60 offen offset:64 sc1
  v_mfma_f32_16x16x32_bf16 v[172:175], a[108:111], a[32:35], v[172:175]
  ds_read_b64_tr_b16 a[32:33], v236 offset:9216
  v_mfma_f32_16x16x32_bf16 v[188:191], a[108:111], a[40:43], v[188:191]
  v_mfma_f32_16x16x32_bf16 v[188:191], a[128:131], a[44:47], v[188:191]
  ds_read_b64_tr_b16 a[34:35], v236 offset:9728
  s_xor_b32 s60, s25, 0
  s_lshl_b32 s60, s60, 5
  s_add_u32 s60, s60, s44
  s_lshl_b32 s60, s60, 5
  s_add_u32 s60, s60, 0x40000
  v_mfma_f32_16x16x32_bf16 v[184:187], a[124:127], a[44:47], v[184:187]
  buffer_load_dwordx4 a[136:139], v228, s[16:19], s60 offen sc1
  v_mfma_f32_16x16x32_bf16 v[184:187], a[104:107], a[40:43], v[184:187]
  ds_read_b64_tr_b16 a[36:37], v236 offset:21504
  v_mfma_f32_16x16x32_bf16 v[180:183], a[100:103], a[40:43], v[180:183]
  v_mfma_f32_16x16x32_bf16 v[180:183], a[120:123], a[44:47], v[180:183]
  ds_read_b64_tr_b16 a[38:39], v236 offset:22016
  v_mfma_f32_16x16x32_bf16 v[176:179], a[116:119], a[44:47], v[176:179]
  s_xor_b32 s60, s25, 1
  s_lshl_b32 s60, s60, 5
  s_add_u32 s60, s60, s44
  s_lshl_b32 s60, s60, 5
  s_add_u32 s60, s60, 0x40000
  v_mfma_f32_16x16x32_bf16 v[176:179], a[96:99], a[40:43], v[176:179]
  ds_read_b64_tr_b16 a[40:41], v237 offset:9216
  s_waitcnt lgkmcnt(8)
  v_mfma_f32_16x16x32_bf16 v[0:3], a[0:3], a[56:59], v[0:3]
  buffer_load_dwordx4 a[140:143], v228, s[16:19], s60 offen sc1
  s_xor_b32 s60, s25, 2
  s_lshl_b32 s60, s60, 5
  s_add_u32 s60, s60, s44
  s_lshl_b32 s60, s60, 5
  s_add_u32 s60, s60, 0x40000
  v_mfma_f32_16x16x32_bf16 v[0:3], a[4:7], a[76:79], v[0:3]
  ds_read_b64_tr_b16 a[42:43], v237 offset:9728
  buffer_load_dwordx4 a[144:147], v228, s[16:19], s60 offen sc1
  v_mfma_f32_16x16x32_bf16 v[4:7], a[4:7], a[80:83], v[4:7]
  ds_read_b128 a[96:99], v226 offset:10240
  v_mfma_f32_16x16x32_bf16 v[4:7], a[0:3], a[60:63], v[4:7]
  ds_read_b64_tr_b16 a[44:45], v237 offset:21504
  v_mfma_f32_16x16x32_bf16 v[8:11], a[0:3], a[64:67], v[8:11]
  ds_read_b128 a[116:119], v227 offset:10240
  v_mfma_f32_16x16x32_bf16 v[8:11], a[4:7], a[84:87], v[8:11]
  ds_read_b64_tr_b16 a[46:47], v237 offset:22016
  s_xor_b32 s60, s25, 3
  s_lshl_b32 s60, s60, 5
  s_add_u32 s60, s60, s44
  s_lshl_b32 s60, s60, 5
  s_add_u32 s60, s60, 0x40000
  v_mfma_f32_16x16x32_bf16 v[12:15], a[4:7], a[88:91], v[12:15]
  ds_read_b128 a[100:103], v226 offset:12288
  buffer_load_dwordx4 a[148:151], v228, s[16:19], s60 offen sc1
  v_mfma_f32_16x16x32_bf16 v[12:15], a[0:3], a[68:71], v[12:15]
  ds_read_b64_tr_b16 a[0:1], v238 offset:9216
  v_mfma_f32_16x16x32_bf16 v[28:31], a[8:11], a[68:71], v[28:31]
  ds_read_b128 a[120:123], v227 offset:12288
  v_mfma_f32_16x16x32_bf16 v[28:31], a[12:15], a[88:91], v[28:31]
  ds_read_b64_tr_b16 a[2:3], v238 offset:9728
  v_mfma_f32_16x16x32_bf16 v[24:27], a[12:15], a[84:87], v[24:27]
  ds_read_b128 a[104:107], v226 offset:14336
  s_xor_b32 s60, s25, 0
  s_lshl_b32 s60, s60, 5
  s_add_u32 s60, s60, s44
  s_lshl_b32 s60, s60, 5
  s_add_u32 s60, s60, 0x50000
  v_mfma_f32_16x16x32_bf16 v[24:27], a[8:11], a[64:67], v[24:27]
  ds_read_b64_tr_b16 a[4:5], v238 offset:21504
  buffer_load_dwordx4 a[152:155], v228, s[16:19], s60 offen sc1
  v_mfma_f32_16x16x32_bf16 v[20:23], a[8:11], a[60:63], v[20:23]
  ds_read_b128 a[124:127], v227 offset:14336
  v_mfma_f32_16x16x32_bf16 v[20:23], a[12:15], a[80:83], v[20:23]
  ds_read_b64_tr_b16 a[6:7], v238 offset:22016
  v_mfma_f32_16x16x32_bf16 v[16:19], a[12:15], a[76:79], v[16:19]
  ds_read_b128 a[108:111], v226 offset:16384
  v_mfma_f32_16x16x32_bf16 v[16:19], a[8:11], a[56:59], v[16:19]
  ds_read_b64_tr_b16 a[8:9], v239 offset:9216
  s_xor_b32 s60, s25, 1
  s_lshl_b32 s60, s60, 5
  s_add_u32 s60, s60, s44
  s_lshl_b32 s60, s60, 5
  s_add_u32 s60, s60, 0x50000
  v_mfma_f32_16x16x32_bf16 v[32:35], a[16:19], a[56:59], v[32:35]
  ds_read_b128 a[128:131], v227 offset:16384
  buffer_load_dwordx4 a[156:159], v228, s[16:19], s60 offen sc1
  v_mfma_f32_16x16x32_bf16 v[32:35], a[20:23], a[76:79], v[32:35]
  ds_read_b64_tr_b16 a[10:11], v239 offset:9728
  v_mfma_f32_16x16x32_bf16 v[36:39], a[20:23], a[80:83], v[36:39]
  ds_read_b128 a[112:115], v226 offset:18432
  v_mfma_f32_16x16x32_bf16 v[36:39], a[16:19], a[60:63], v[36:39]
  ds_read_b64_tr_b16 a[12:13], v239 offset:21504
  v_mfma_f32_16x16x32_bf16 v[40:43], a[16:19], a[64:67], v[40:43]
  ds_read_b128 a[132:135], v227 offset:18432
  s_xor_b32 s60, s25, 2
  s_lshl_b32 s60, s60, 5
  s_add_u32 s60, s60, s44
  s_lshl_b32 s60, s60, 5
  s_add_u32 s60, s60, 0x50000
  v_mfma_f32_16x16x32_bf16 v[40:43], a[20:23], a[84:87], v[40:43]
  ds_read_b64_tr_b16 a[14:15], v239 offset:22016
  buffer_load_dwordx4 a[160:163], v228, s[16:19], s60 offen sc1
  v_mfma_f32_16x16x32_bf16 v[44:47], a[20:23], a[88:91], v[44:47]
  v_mfma_f32_16x16x32_bf16 v[44:47], a[16:19], a[68:71], v[44:47]
  s_barrier
  ds_read_b64_tr_b16 a[16:17], v232 offset:8192
  s_waitcnt lgkmcnt(8)
  v_mfma_f32_16x16x32_bf16 v[60:63], a[24:27], a[68:71], v[60:63]
  s_waitcnt lgkmcnt(0)
  s_barrier
  v_mfma_f32_16x16x32_bf16 v[60:63], a[28:31], a[88:91], v[60:63]
  ds_read_b64_tr_b16 a[18:19], v232 offset:8704
  s_xor_b32 s60, s25, 3
  s_lshl_b32 s60, s60, 5
  s_add_u32 s60, s60, s44
  s_lshl_b32 s60, s60, 5
  s_add_u32 s60, s60, 0x50000
  v_mfma_f32_16x16x32_bf16 v[56:59], a[28:31], a[84:87], v[56:59]
  buffer_load_dwordx4 a[164:167], v228, s[16:19], s60 offen sc1
  s_mov_b32 s101, s24
  s_mov_b32 s67, 0
  v_mfma_f32_16x16x32_bf16 v[56:59], a[24:27], a[64:67], v[56:59]
  ds_read_b64_tr_b16 a[20:21], v232 offset:20480
  s_lshl_b32 s3, s26, 2
  s_add_u32 s3, s3, s25
  s_lshl_b32 s3, s3, 1
  s_bfe_u32 s43, s2, 0x10002
  s_add_u32 s43, s43, s3
  v_mfma_f32_16x16x32_bf16 v[52:55], a[24:27], a[60:63], v[52:55]
  s_mul_i32 s3, s43, 294912
  v_add_u32 v226, s3, v228
  v_mfma_f32_16x16x32_bf16 v[52:55], a[28:31], a[80:83], v[52:55]
  ds_read_b64_tr_b16 a[22:23], v232 offset:20992
  s_xor_b32 s3, s43, 1
  s_mul_i32 s3, s3, 294912
  v_add_u32 v227, s3, v228
  v_mfma_f32_16x16x32_bf16 v[48:51], a[28:31], a[76:79], v[48:51]
  s_xor_b32 s60, s25, 0
  s_lshl_b32 s60, s60, 5
  s_add_u32 s60, s60, s44
  s_lshl_b32 s60, s60, 5
  s_add_u32 s60, s60, 0x60000
  s_bfe_u32 s3, s2, 0x20001
  s_mul_i32 s42, s3, 57344
  s_add_u32 s42, s42, 65536
  v_mfma_f32_16x16x32_bf16 v[48:51], a[24:27], a[56:59], v[48:51]
  ds_read_b64_tr_b16 a[24:25], v233 offset:8192
  buffer_load_dwordx4 a[168:171], v228, s[16:19], s60 offen sc1
  v_mfma_f32_16x16x32_bf16 v[192:195], a[32:35], a[72:75], v[192:195]
  s_bfe_u32 s22, s40, 0x4000c
  s_lshl_b32 s22, s22, 12
  s_add_u32 s22, s22, s42
  v_mfma_f32_16x16x32_bf16 v[192:195], a[36:39], a[92:95], v[192:195]
  ds_read_b64_tr_b16 a[26:27], v233 offset:8704
  v_bfe_u32 v252, v228, 4, 2
  v_mfma_f32_16x16x32_bf16 v[64:67], a[36:39], a[76:79], v[64:67]
  v_lshlrev_b32 v253, 1, v252
  v_mfma_f32_16x16x32_bf16 v[64:67], a[32:35], a[56:59], v[64:67]
  ds_read_b64_tr_b16 a[28:29], v233 offset:20480
  s_xor_b32 s60, s25, 1
  s_lshl_b32 s60, s60, 5
  s_add_u32 s60, s60, s44
  s_lshl_b32 s60, s60, 5
  s_add_u32 s60, s60, 0x60000
  v_mfma_f32_16x16x32_bf16 v[68:71], a[32:35], a[60:63], v[68:71]
  buffer_load_dwordx4 a[172:175], v228, s[16:19], s60 offen sc1
  v_xor_b32 v231, s2, v253
  v_mfma_f32_16x16x32_bf16 v[68:71], a[36:39], a[80:83], v[68:71]
  ds_read_b64_tr_b16 a[30:31], v233 offset:20992
  v_lshlrev_b32 v253, 5, v252
  v_mfma_f32_16x16x32_bf16 v[72:75], a[36:39], a[84:87], v[72:75]
  s_and_b32 s3, s2, 0x1f
  s_or_b32 s3, s3, 0x80
  s_mov_b32 exec_hi, 0
  v_add_u32 v231, s3, v253
  s_mov_b32 exec_hi, -1
  v_mfma_f32_16x16x32_bf16 v[72:75], a[32:35], a[64:67], v[72:75]
  s_bfe_u32 s3, s2, 0x20005
  v_add_u32 v252, s3, v252
  v_mfma_f32_16x16x32_bf16 v[76:79], a[32:35], a[68:71], v[76:79]
  s_xor_b32 s60, s25, 2
  s_lshl_b32 s60, s60, 5
  s_add_u32 s60, s60, s44
  s_lshl_b32 s60, s60, 5
  s_add_u32 s60, s60, 0x60000
  v_and_b32 v252, 3, v252
  v_mfma_f32_16x16x32_bf16 v[76:79], a[36:39], a[88:91], v[76:79]
  ds_read_b64_tr_b16 a[32:33], v234 offset:8192
  buffer_load_dwordx4 a[176:179], v228, s[16:19], s60 offen sc1
  v_mfma_f32_16x16x32_bf16 v[92:95], a[44:47], a[88:91], v[92:95]
  v_lshlrev_b32 v252, 5, v252
  v_mfma_f32_16x16x32_bf16 v[92:95], a[40:43], a[68:71], v[92:95]
  ds_read_b64_tr_b16 a[34:35], v234 offset:8704
  s_and_b32 s3, s2, 0x1f
  s_mov_b64 exec, 0xffff
  v_add_u32 v231, s3, v252
  s_mov_b64 exec, -1
  v_mfma_f32_16x16x32_bf16 v[88:91], a[40:43], a[64:67], v[88:91]
  v_lshlrev_b32 v231, 9, v231
  v_mfma_f32_16x16x32_bf16 v[88:91], a[44:47], a[84:87], v[88:91]
  ds_read_b64_tr_b16 a[36:37], v234 offset:20480
  s_xor_b32 s60, s25, 3
  s_lshl_b32 s60, s60, 5
  s_add_u32 s60, s60, s44
  s_lshl_b32 s60, s60, 5
  s_add_u32 s60, s60, 0x60000
  v_mfma_f32_16x16x32_bf16 v[84:87], a[44:47], a[80:83], v[84:87]
  buffer_load_dwordx4 a[180:183], v228, s[16:19], s60 offen sc1
  s_add_u32 m0, s23, 0x16000
  v_mfma_f32_16x16x32_bf16 v[84:87], a[40:43], a[60:63], v[84:87]
  ds_read_b64_tr_b16 a[38:39], v234 offset:20992
  buffer_load_dwordx4 v224, s[36:39], s21 offen lds
  v_mfma_f32_16x16x32_bf16 v[80:83], a[40:43], a[56:59], v[80:83]
  s_lshl_b32 s3, s25, 7
  s_add_u32 s3, s3, 0xa8000
  v_add_u32 v231, s3, v231
  v_mfma_f32_16x16x32_bf16 v[80:83], a[44:47], a[76:79], v[80:83]
  ds_read_b64_tr_b16 a[40:41], v235 offset:8192
  s_waitcnt vmcnt(13)
  ds_bpermute_b32 v212, v245, v205 offset:0
  v_mfma_f32_16x16x32_bf16 v[96:99], a[4:7], a[76:79], v[96:99]
  ds_read_b64_tr_b16 a[42:43], v235 offset:8704
  ds_bpermute_b32 v216, v246, v204 offset:0
  v_mfma_f32_16x16x32_bf16 v[96:99], a[0:3], a[56:59], v[96:99]
  ds_read_b64_tr_b16 a[44:45], v235 offset:20480
  s_add_u32 m0, s23, 0x16400
  v_mfma_f32_16x16x32_bf16 v[100:103], a[0:3], a[60:63], v[100:103]
  ds_read_b64_tr_b16 a[46:47], v235 offset:20992
  buffer_load_dwordx4 v225, s[36:39], s21 offen lds
  v_mfma_f32_16x16x32_bf16 v[100:103], a[4:7], a[80:83], v[100:103]
  ds_bpermute_b32 v217, v247, v204 offset:0
  v_mfma_f32_16x16x32_bf16 v[104:107], a[4:7], a[84:87], v[104:107]
  ds_bpermute_b32 v213, v245, v205 offset:64
  v_mfma_f32_16x16x32_bf16 v[104:107], a[0:3], a[64:67], v[104:107]
  ds_bpermute_b32 v218, v246, v204 offset:64
  v_mfma_f32_16x16x32_bf16 v[108:111], a[0:3], a[68:71], v[108:111]
  ds_bpermute_b32 v219, v247, v204 offset:64
  v_mfma_f32_16x16x32_bf16 v[108:111], a[4:7], a[88:91], v[108:111]
  ds_read_b64_tr_b16 a[0:1], v232 offset:9216
  s_add_u32 m0, s23, 0x18000
  v_mfma_f32_16x16x32_bf16 v[124:127], a[12:15], a[88:91], v[124:127]
  buffer_load_dwordx4 v229, s[36:39], s21 offen lds
  ds_bpermute_b32 v214, v245, v205 offset:128
  v_mfma_f32_16x16x32_bf16 v[124:127], a[8:11], a[68:71], v[124:127]
  ds_read_b64_tr_b16 a[2:3], v232 offset:9728
  ds_bpermute_b32 v220, v246, v204 offset:128
  v_mfma_f32_16x16x32_bf16 v[120:123], a[8:11], a[64:67], v[120:123]
  ds_bpermute_b32 v221, v247, v204 offset:128
  v_mfma_f32_16x16x32_bf16 v[120:123], a[12:15], a[84:87], v[120:123]
  ds_read_b64_tr_b16 a[4:5], v232 offset:21504
  ds_bpermute_b32 v215, v245, v205 offset:192
  v_mfma_f32_16x16x32_bf16 v[116:119], a[12:15], a[80:83], v[116:119]
  ds_bpermute_b32 v222, v246, v205 offset:128
  v_mfma_f32_16x16x32_bf16 v[116:119], a[8:11], a[60:63], v[116:119]
  ds_read_b64_tr_b16 a[6:7], v232 offset:22016
  s_add_u32 m0, s23, 0x18400
  v_mfma_f32_16x16x32_bf16 v[112:115], a[8:11], a[56:59], v[112:115]
  buffer_load_dwordx4 v230, s[36:39], s21 offen lds
  s_bfe_u32 s21, s40, 0x40004
  s_lshl_b32 s21, s21, 17
  s_add_u32 s21, s21, s20
  ds_bpermute_b32 v223, v247, v205 offset:128
  v_mfma_f32_16x16x32_bf16 v[112:115], a[12:15], a[76:79], v[112:115]
  ds_read_b64_tr_b16 a[8:9], v233 offset:9216
  v_lshrrev_b32 v252, 1, v228
  s_waitcnt lgkmcnt(8)
  v_mfma_f32_16x16x32_bf16 v[0:3], a[20:23], a[116:119], v[0:3]
  s_xor_b32 s3, s25, 0
  s_lshl_b32 s3, s3, 9
  v_add_u32 v244, s3, v252
  s_waitcnt vmcnt(15)
  v_mfma_f32_16x16x32_bf16 v[0:3], a[136:139], a[200:203], v[0:3]
  ds_read_b64_tr_b16 a[10:11], v233 offset:9728
  s_lshl_b32 s3, s25, 11
  v_add_u32 v244, s3, v244
  v_mfma_f32_16x16x32_bf16 v[0:3], a[16:19], a[96:99], v[0:3]
  s_add_u32 m0, s23, 0x1a000
  s_mov_b32 s3, 2048
  s_cmp_eq_u32 s25, 3
  s_cselect_b32 s3, 75776, s3
  v_add_u32 v248, s3, v244
  v_mfma_f32_16x16x32_bf16 v[4:7], a[16:19], a[100:103], v[4:7]
  ds_read_b64_tr_b16 a[12:13], v233 offset:21504
  buffer_load_dwordx4 v224, s[36:39], s21 offen lds
  v_mfma_f32_16x16x32_bf16 v[4:7], a[136:139], a[204:207], v[4:7]
  s_xor_b32 s3, s25, 1
  s_lshl_b32 s3, s3, 9
  v_add_u32 v245, s3, v252
  v_mfma_f32_16x16x32_bf16 v[4:7], a[20:23], a[120:123], v[4:7]
  ds_read_b64_tr_b16 a[14:15], v233 offset:22016
  s_lshl_b32 s3, s25, 11
  v_add_u32 v245, s3, v245
  v_mfma_f32_16x16x32_bf16 v[8:11], a[20:23], a[124:127], v[8:11]
  s_mov_b32 s3, 2048
  s_cmp_eq_u32 s25, 3
  s_cselect_b32 s3, 75776, s3
  v_add_u32 v249, s3, v245
  v_mfma_f32_16x16x32_bf16 v[8:11], a[136:139], a[208:211], v[8:11]
  s_xor_b32 s3, s25, 2
  s_lshl_b32 s3, s3, 9
  v_add_u32 v246, s3, v252
  v_mfma_f32_16x16x32_bf16 v[8:11], a[16:19], a[104:107], v[8:11]
  s_add_u32 m0, s23, 0x1a400
  s_lshl_b32 s3, s25, 11
  v_add_u32 v246, s3, v246
  v_mfma_f32_16x16x32_bf16 v[12:15], a[16:19], a[108:111], v[12:15]
  buffer_load_dwordx4 v225, s[36:39], s21 offen lds
  s_mov_b32 s3, 2048
  s_cmp_eq_u32 s25, 3
  s_cselect_b32 s3, 75776, s3
  v_add_u32 v250, s3, v246
  v_mfma_f32_16x16x32_bf16 v[12:15], a[136:139], a[212:215], v[12:15]
  s_xor_b32 s3, s25, 3
  s_lshl_b32 s3, s3, 9
  v_add_u32 v247, s3, v252
  v_cvt_pk_bf16_f32 v0, v0, v1
  v_cvt_pk_bf16_f32 v1, v2, v3
  v_mfma_f32_16x16x32_bf16 v[12:15], a[20:23], a[128:131], v[12:15]
  ds_read_b64_tr_b16 a[16:17], v234 offset:9216
  s_lshl_b32 s3, s25, 11
  v_add_u32 v247, s3, v247
  v_mfma_f32_16x16x32_bf16 v[28:31], a[28:31], a[128:131], v[28:31]
  s_mov_b32 s3, 2048
  s_cmp_eq_u32 s25, 3
  s_cselect_b32 s3, 75776, s3
  v_add_u32 v251, s3, v247
  s_waitcnt vmcnt(16)
  v_mfma_f32_16x16x32_bf16 v[28:31], a[140:143], a[212:215], v[28:31]
  ds_read_b64_tr_b16 a[18:19], v234 offset:9728
  s_lshl_b32 s3, s25, 9
  v_add_u32 v252, s3, v252
  v_cvt_pk_bf16_f32 v4, v4, v5
  v_cvt_pk_bf16_f32 v5, v6, v7
  v_mfma_f32_16x16x32_bf16 v[28:31], a[24:27], a[108:111], v[28:31]
  s_add_u32 m0, s23, 0x1c000
  v_and_b32 v253, 16, v228
  v_mfma_f32_16x16x32_bf16 v[24:27], a[24:27], a[104:107], v[24:27]
  ds_read_b64_tr_b16 a[20:21], v234 offset:21504
  buffer_load_dwordx4 v229, s[36:39], s21 offen lds
  v_mfma_f32_16x16x32_bf16 v[24:27], a[140:143], a[208:211], v[24:27]
  v_cmp_eq_u32 s[46:47], 16, v253
  v_cvt_pk_bf16_f32 v8, v8, v9
  v_cvt_pk_bf16_f32 v9, v10, v11
  v_mfma_f32_16x16x32_bf16 v[24:27], a[28:31], a[124:127], v[24:27]
  ds_read_b64_tr_b16 a[22:23], v234 offset:22016
  s_or_b32 s3, s26, s25
  s_cmp_eq_u32 s3, 0
  s_cselect_b64 s[52:53], s[48:49], -1
  s_cselect_b64 s[54:55], s[50:51], -1
  v_mfma_f32_16x16x32_bf16 v[20:23], a[28:31], a[120:123], v[20:23]
  s_waitcnt lgkmcnt(8)
  v_cndmask_b32 v216, 0, v216, s[52:53]
  v_mfma_f32_16x16x32_bf16 v[20:23], a[140:143], a[204:207], v[20:23]
  s_add_u32 m0, s23, 0x1c400
  v_cndmask_b32 v217, 0, v217, s[54:55]
  v_cvt_pk_bf16_f32 v12, v12, v13
  v_cvt_pk_bf16_f32 v13, v14, v15
  v_mfma_f32_16x16x32_bf16 v[20:23], a[24:27], a[100:103], v[20:23]
  buffer_load_dwordx4 v230, s[36:39], s21 offen lds
  s_bfe_u32 s21, s40, 0x40008
  s_lshl_b32 s21, s21, 17
  s_add_u32 s21, s21, s20
  v_mul_f32 v254, v212, v212
  v_mfma_f32_16x16x32_bf16 v[16:19], a[24:27], a[96:99], v[16:19]
  v_rcp_f32 v254, v254
  v_mfma_f32_16x16x32_bf16 v[16:19], a[140:143], a[200:203], v[16:19]
  v_mul_f32 v212, 0x3e8293ee, v212
  v_cvt_pk_bf16_f32 v14, v28, v29
  v_cvt_pk_bf16_f32 v15, v30, v31
  v_mfma_f32_16x16x32_bf16 v[16:19], a[28:31], a[116:119], v[16:19]
  ds_read_b64_tr_b16 a[24:25], v235 offset:9216
  v_mul_f32 v240, v212, v217
  v_mfma_f32_16x16x32_bf16 v[32:35], a[36:39], a[116:119], v[32:35]
  v_mul_f32 v212, v212, v216
  s_waitcnt vmcnt(17)
  v_mfma_f32_16x16x32_bf16 v[32:35], a[144:147], a[200:203], v[32:35]
  ds_read_b64_tr_b16 a[26:27], v235 offset:9728
  s_add_u32 m0, s23, 0x1e000
  v_cvt_pk_bf16_f32 v10, v24, v25
  v_cvt_pk_bf16_f32 v11, v26, v27
  v_mfma_f32_16x16x32_bf16 v[32:35], a[32:35], a[96:99], v[32:35]
  buffer_load_dwordx4 v224, s[36:39], s21 offen lds
  v_mul_f32 v216, v216, v254
  v_mfma_f32_16x16x32_bf16 v[36:39], a[32:35], a[100:103], v[36:39]
  ds_read_b64_tr_b16 a[28:29], v235 offset:21504
  v_mul_f32 v217, v217, v254
  v_mfma_f32_16x16x32_bf16 v[36:39], a[144:147], a[204:207], v[36:39]
  v_mul_f32 v254, v213, v213
  v_cvt_pk_bf16_f32 v6, v20, v21
  v_cvt_pk_bf16_f32 v7, v22, v23
  v_mfma_f32_16x16x32_bf16 v[36:39], a[36:39], a[120:123], v[36:39]
  ds_read_b64_tr_b16 a[30:31], v235 offset:22016
  v_rcp_f32 v254, v254
  v_mfma_f32_16x16x32_bf16 v[40:43], a[36:39], a[124:127], v[40:43]
  v_mul_f32 v213, 0x3e8293ee, v213
  v_mfma_f32_16x16x32_bf16 v[40:43], a[144:147], a[208:211], v[40:43]
  s_add_u32 m0, s23, 0x1e400
  v_mul_f32 v241, v213, v219
  v_cvt_pk_bf16_f32 v2, v16, v17
  v_cvt_pk_bf16_f32 v3, v18, v19
  v_mfma_f32_16x16x32_bf16 v[40:43], a[32:35], a[104:107], v[40:43]
  buffer_load_dwordx4 v225, s[36:39], s21 offen lds
  v_mul_f32 v213, v213, v218
  v_mfma_f32_16x16x32_bf16 v[44:47], a[32:35], a[108:111], v[44:47]
  v_mul_f32 v218, v218, v254
  v_mfma_f32_16x16x32_bf16 v[44:47], a[144:147], a[212:215], v[44:47]
  v_mul_f32 v219, v219, v254
  v_cvt_pk_bf16_f32 v32, v32, v33
  v_cvt_pk_bf16_f32 v33, v34, v35
  v_mfma_f32_16x16x32_bf16 v[44:47], a[36:39], a[128:131], v[44:47]
  ds_read_b64_tr_b16 a[32:33], v236 offset:10240
  v_mul_f32 v254, v214, v214
  v_mfma_f32_16x16x32_bf16 v[60:63], a[44:47], a[128:131], v[60:63]
  s_add_u32 m0, s23, 0x20000
  v_rcp_f32 v254, v254
  s_waitcnt vmcnt(18)
  v_mfma_f32_16x16x32_bf16 v[60:63], a[148:151], a[212:215], v[60:63]
  ds_read_b64_tr_b16 a[34:35], v236 offset:10752
  buffer_load_dwordx4 v229, s[36:39], s21 offen lds
  v_cvt_pk_bf16_f32 v36, v36, v37
  v_cvt_pk_bf16_f32 v37, v38, v39
  v_mfma_f32_16x16x32_bf16 v[60:63], a[40:43], a[108:111], v[60:63]
  v_mul_f32 v214, 0x3e8293ee, v214
  v_mfma_f32_16x16x32_bf16 v[56:59], a[40:43], a[104:107], v[56:59]
  ds_read_b64_tr_b16 a[36:37], v236 offset:22528
  v_mul_f32 v242, v214, v221
  v_mfma_f32_16x16x32_bf16 v[56:59], a[148:151], a[208:211], v[56:59]
  v_mul_f32 v214, v214, v220
  v_cvt_pk_bf16_f32 v40, v40, v41
  v_cvt_pk_bf16_f32 v41, v42, v43
  v_mfma_f32_16x16x32_bf16 v[56:59], a[44:47], a[124:127], v[56:59]
  ds_read_b64_tr_b16 a[38:39], v236 offset:23040
  v_mul_f32 v220, v220, v254
  v_mfma_f32_16x16x32_bf16 v[52:55], a[44:47], a[120:123], v[52:55]
  s_add_u32 m0, s23, 0x20400
  v_mul_f32 v221, v221, v254
  v_mfma_f32_16x16x32_bf16 v[52:55], a[148:151], a[204:207], v[52:55]
  buffer_load_dwordx4 v230, s[36:39], s21 offen lds
  s_bfe_u32 s21, s40, 0x4000c
  s_lshl_b32 s21, s21, 17
  s_add_u32 s21, s21, s20
  v_mul_f32 v254, v215, v215
  v_cvt_pk_bf16_f32 v44, v44, v45
  v_cvt_pk_bf16_f32 v45, v46, v47
  v_mfma_f32_16x16x32_bf16 v[52:55], a[40:43], a[100:103], v[52:55]
  v_rcp_f32 v254, v254
  v_mfma_f32_16x16x32_bf16 v[48:51], a[40:43], a[96:99], v[48:51]
  v_mul_f32 v215, 0x3e8293ee, v215
  v_mfma_f32_16x16x32_bf16 v[48:51], a[148:151], a[200:203], v[48:51]
  v_mul_f32 v243, v215, v223
  v_cvt_pk_bf16_f32 v46, v60, v61
  v_cvt_pk_bf16_f32 v47, v62, v63
  v_mfma_f32_16x16x32_bf16 v[48:51], a[44:47], a[116:119], v[48:51]
  ds_read_b64_tr_b16 a[40:41], v237 offset:10240
  v_mul_f32 v215, v215, v222
  v_mfma_f32_16x16x32_bf16 v[192:195], a[4:7], a[132:135], v[192:195]
  v_mul_f32 v222, v222, v254
  s_waitcnt vmcnt(19)
  v_mfma_f32_16x16x32_bf16 v[192:195], a[152:155], a[216:219], v[192:195]
  ds_read_b64_tr_b16 a[42:43], v237 offset:10752
  v_mul_f32 v223, v223, v254
  v_cvt_pk_bf16_f32 v42, v56, v57
  v_cvt_pk_bf16_f32 v43, v58, v59
  v_mfma_f32_16x16x32_bf16 v[192:195], a[0:3], a[112:115], v[192:195]
  v_mov_b32 v254, 0x0c0c0100
  v_mfma_f32_16x16x32_bf16 v[64:67], a[0:3], a[96:99], v[64:67]
  ds_read_b64_tr_b16 a[44:45], v237 offset:22528
  v_mov_b32 v255, 0x01000c0c
  v_mfma_f32_16x16x32_bf16 v[64:67], a[152:155], a[200:203], v[64:67]
  v_cndmask_b32 v210, v254, v255, s[46:47]
  v_cvt_pk_bf16_f32 v38, v52, v53
  v_cvt_pk_bf16_f32 v39, v54, v55
  v_mfma_f32_16x16x32_bf16 v[64:67], a[4:7], a[116:119], v[64:67]
  ds_read_b64_tr_b16 a[46:47], v237 offset:23040
  v_mov_b32 v254, 0x0c0c0302
  v_mfma_f32_16x16x32_bf16 v[68:71], a[4:7], a[120:123], v[68:71]
  v_mov_b32 v255, 0x03020c0c
  v_mfma_f32_16x16x32_bf16 v[68:71], a[152:155], a[204:207], v[68:71]
  v_cndmask_b32 v211, v254, v255, s[46:47]
  v_cvt_pk_bf16_f32 v34, v48, v49
  v_cvt_pk_bf16_f32 v35, v50, v51
  v_mfma_f32_16x16x32_bf16 v[68:71], a[0:3], a[100:103], v[68:71]
  v_mov_b32 v254, 0x0c0c0c0c
  v_mfma_f32_16x16x32_bf16 v[72:75], a[0:3], a[104:107], v[72:75]
  v_cndmask_b32 v208, v210, v254, s[48:49]
  v_mfma_f32_16x16x32_bf16 v[72:75], a[152:155], a[208:211], v[72:75]
  v_cndmask_b32 v209, v211, v254, s[50:51]
  v_cvt_pk_bf16_f32 v192, v192, v193
  v_cvt_pk_bf16_f32 v193, v194, v195
  v_mfma_f32_16x16x32_bf16 v[72:75], a[4:7], a[124:127], v[72:75]
  v_cndmask_b32 v210, v254, v210, s[48:49]
  v_mfma_f32_16x16x32_bf16 v[76:79], a[4:7], a[128:131], v[76:79]
  v_cndmask_b32 v211, v254, v211, s[50:51]
  v_mfma_f32_16x16x32_bf16 v[76:79], a[152:155], a[212:215], v[76:79]
  v_mov_b32 v253, 0xce6e6b28
  v_cvt_pk_bf16_f32 v64, v64, v65
  v_cvt_pk_bf16_f32 v65, v66, v67
  v_mfma_f32_16x16x32_bf16 v[76:79], a[0:3], a[108:111], v[76:79]
  ds_read_b64_tr_b16 a[0:1], v238 offset:10240
  s_waitcnt lgkmcnt(8)
  v_mfma_f32_16x16x32_bf16 v[92:95], a[8:11], a[108:111], v[92:95]
  s_waitcnt vmcnt(18)
  v_mfma_f32_16x16x32_bf16 v[92:95], a[156:159], a[212:215], v[92:95]
  ds_read_b64_tr_b16 a[2:3], v238 offset:10752
  v_cvt_pk_bf16_f32 v68, v68, v69
  v_cvt_pk_bf16_f32 v69, v70, v71
  v_mfma_f32_16x16x32_bf16 v[92:95], a[12:15], a[128:131], v[92:95]
  v_mfma_f32_16x16x32_bf16 v[88:91], a[12:15], a[124:127], v[88:91]
  ds_read_b64_tr_b16 a[4:5], v238 offset:22528
  v_mfma_f32_16x16x32_bf16 v[88:91], a[156:159], a[208:211], v[88:91]
  v_cvt_pk_bf16_f32 v72, v72, v73
  v_cvt_pk_bf16_f32 v73, v74, v75
  v_mfma_f32_16x16x32_bf16 v[88:91], a[8:11], a[104:107], v[88:91]
  ds_read_b64_tr_b16 a[6:7], v238 offset:23040
  v_mfma_f32_16x16x32_bf16 v[84:87], a[8:11], a[100:103], v[84:87]
  v_mfma_f32_16x16x32_bf16 v[84:87], a[156:159], a[204:207], v[84:87]
  v_cvt_pk_bf16_f32 v76, v76, v77
  v_cvt_pk_bf16_f32 v77, v78, v79
  v_mfma_f32_16x16x32_bf16 v[84:87], a[12:15], a[120:123], v[84:87]
  v_mfma_f32_16x16x32_bf16 v[80:83], a[12:15], a[116:119], v[80:83]
  v_mfma_f32_16x16x32_bf16 v[80:83], a[156:159], a[200:203], v[80:83]
  v_cvt_pk_bf16_f32 v78, v92, v93
  v_cvt_pk_bf16_f32 v79, v94, v95
  v_mfma_f32_16x16x32_bf16 v[80:83], a[8:11], a[96:99], v[80:83]
  ds_read_b64_tr_b16 a[8:9], v239 offset:10240
  v_mfma_f32_16x16x32_bf16 v[96:99], a[16:19], a[96:99], v[96:99]
  ds_read_b64_tr_b16 a[10:11], v239 offset:10752
  s_waitcnt vmcnt(17)
  v_mfma_f32_16x16x32_bf16 v[96:99], a[160:163], a[200:203], v[96:99]
  ds_read_b64_tr_b16 a[12:13], v239 offset:22528
  v_cvt_pk_bf16_f32 v74, v88, v89
  v_cvt_pk_bf16_f32 v75, v90, v91
  v_mfma_f32_16x16x32_bf16 v[96:99], a[20:23], a[116:119], v[96:99]
  ds_read_b64_tr_b16 a[14:15], v239 offset:23040
  v_mfma_f32_16x16x32_bf16 v[100:103], a[20:23], a[120:123], v[100:103]
  v_mfma_f32_16x16x32_bf16 v[100:103], a[160:163], a[204:207], v[100:103]
  v_cvt_pk_bf16_f32 v70, v84, v85
  v_cvt_pk_bf16_f32 v71, v86, v87
  v_mfma_f32_16x16x32_bf16 v[100:103], a[16:19], a[100:103], v[100:103]
  v_mfma_f32_16x16x32_bf16 v[104:107], a[16:19], a[104:107], v[104:107]
  v_mfma_f32_16x16x32_bf16 v[104:107], a[160:163], a[208:211], v[104:107]
  v_cvt_pk_bf16_f32 v66, v80, v81
  v_cvt_pk_bf16_f32 v67, v82, v83
  v_mfma_f32_16x16x32_bf16 v[104:107], a[20:23], a[124:127], v[104:107]
  v_mfma_f32_16x16x32_bf16 v[108:111], a[20:23], a[128:131], v[108:111]
  v_mfma_f32_16x16x32_bf16 v[108:111], a[160:163], a[212:215], v[108:111]
  v_cvt_pk_bf16_f32 v96, v96, v97
  v_cvt_pk_bf16_f32 v97, v98, v99
  v_mfma_f32_16x16x32_bf16 v[108:111], a[16:19], a[108:111], v[108:111]
  ds_read_b64_tr_b16 a[16:17], v232 offset:10240
  v_mfma_f32_16x16x32_bf16 v[124:127], a[24:27], a[108:111], v[124:127]
  s_waitcnt vmcnt(16)
  v_mfma_f32_16x16x32_bf16 v[124:127], a[164:167], a[212:215], v[124:127]
  ds_read_b64_tr_b16 a[18:19], v232 offset:10752
  v_cvt_pk_bf16_f32 v100, v100, v101
  v_cvt_pk_bf16_f32 v101, v102, v103
  v_mfma_f32_16x16x32_bf16 v[124:127], a[28:31], a[128:131], v[124:127]
  v_mfma_f32_16x16x32_bf16 v[120:123], a[28:31], a[124:127], v[120:123]
  ds_read_b64_tr_b16 a[20:21], v232 offset:22528
  v_mfma_f32_16x16x32_bf16 v[120:123], a[164:167], a[208:211], v[120:123]
  v_cvt_pk_bf16_f32 v104, v104, v105
  v_cvt_pk_bf16_f32 v105, v106, v107
  v_mfma_f32_16x16x32_bf16 v[120:123], a[24:27], a[104:107], v[120:123]
  ds_read_b64_tr_b16 a[22:23], v232 offset:23040
  v_mfma_f32_16x16x32_bf16 v[116:119], a[24:27], a[100:103], v[116:119]
  v_mfma_f32_16x16x32_bf16 v[116:119], a[164:167], a[204:207], v[116:119]
  v_cvt_pk_bf16_f32 v108, v108, v109
  v_cvt_pk_bf16_f32 v109, v110, v111
  v_mfma_f32_16x16x32_bf16 v[116:119], a[28:31], a[120:123], v[116:119]
  v_mfma_f32_16x16x32_bf16 v[112:115], a[28:31], a[116:119], v[112:115]
  v_mfma_f32_16x16x32_bf16 v[112:115], a[164:167], a[200:203], v[112:115]
  v_cvt_pk_bf16_f32 v110, v124, v125
  v_cvt_pk_bf16_f32 v111, v126, v127
  v_mfma_f32_16x16x32_bf16 v[112:115], a[24:27], a[96:99], v[112:115]
  ds_read_b64_tr_b16 a[24:25], v233 offset:10240
  s_waitcnt lgkmcnt(8)
  v_mfma_f32_16x16x32_bf16 v[196:199], a[72:75], a[32:35], v[196:199]
  v_mfma_f32_16x16x32_bf16 v[196:199], a[92:95], a[36:39], v[196:199]
  ds_read_b64_tr_b16 a[26:27], v233 offset:10752
  v_cvt_pk_bf16_f32 v106, v120, v121
  v_cvt_pk_bf16_f32 v107, v122, v123
  v_mfma_f32_16x16x32_bf16 v[128:131], a[76:79], a[36:39], v[128:131]
  v_mfma_f32_16x16x32_bf16 v[128:131], a[56:59], a[32:35], v[128:131]
  ds_read_b64_tr_b16 a[28:29], v233 offset:22528
  v_mfma_f32_16x16x32_bf16 v[132:135], a[60:63], a[32:35], v[132:135]
  v_cvt_pk_bf16_f32 v102, v116, v117
  v_cvt_pk_bf16_f32 v103, v118, v119
  v_mfma_f32_16x16x32_bf16 v[132:135], a[80:83], a[36:39], v[132:135]
  ds_read_b64_tr_b16 a[30:31], v233 offset:23040
  v_mfma_f32_16x16x32_bf16 v[136:139], a[84:87], a[36:39], v[136:139]
  v_mfma_f32_16x16x32_bf16 v[136:139], a[64:67], a[32:35], v[136:139]
  v_cvt_pk_bf16_f32 v98, v112, v113
  v_cvt_pk_bf16_f32 v99, v114, v115
  ds_write_b64 v248, v[76:77] offset:0
  ds_write_b64 v249, v[78:79] offset:0
  ds_write_b64 v250, v[108:109] offset:0
  v_mfma_f32_16x16x32_bf16 v[140:143], a[68:71], a[32:35], v[140:143]
  ds_write_b64 v251, v[110:111] offset:0
  ds_write_b64 v252, v[192:193] offset:0
  v_mfma_f32_16x16x32_bf16 v[20:23], v[68:71], v[4:7], 0
  v_mfma_f32_16x16x32_bf16 v[84:87], v[64:67], v[4:7], 0
  v_mfma_f32_16x16x32_bf16 v[52:55], v[100:103], v[36:39], 0
  v_mfma_f32_16x16x32_bf16 v[140:143], a[88:91], a[36:39], v[140:143]
  ds_read_b64_tr_b16 a[32:33], v234 offset:10240
  v_mfma_f32_16x16x32_bf16 v[116:119], v[96:99], v[36:39], 0
  v_mfma_f32_16x16x32_bf16 v[24:27], v[72:75], v[8:11], 0
  v_mfma_f32_16x16x32_bf16 v[88:91], v[68:71], v[8:11], 0
  s_waitcnt lgkmcnt(0)
  s_barrier
  v_mfma_f32_16x16x32_bf16 v[156:159], a[88:91], a[44:47], v[156:159]
  ds_read_b64 v[200:201], v244 offset:0
  ds_read_b64 v[202:203], v245 offset:0
  ds_read_b64 v[204:205], v246 offset:0
  ds_read_b64 v[206:207], v247 offset:0
  v_mfma_f32_16x16x32_bf16 v[56:59], v[104:107], v[40:43], 0
  v_mfma_f32_16x16x32_bf16 v[156:159], a[68:71], a[40:43], v[156:159]
  ds_read_b64_tr_b16 a[34:35], v234 offset:10752
  v_mfma_f32_16x16x32_bf16 v[120:123], v[100:103], v[40:43], 0
  v_mfma_f32_16x16x32_bf16 v[28:31], v[76:79], v[12:15], 0
  v_mfma_f32_16x16x32_bf16 v[92:95], v[72:75], v[12:15], 0
  v_mfma_f32_16x16x32_bf16 v[60:63], v[108:111], v[44:47], 0
  v_mfma_f32_16x16x32_bf16 v[152:155], a[64:67], a[40:43], v[152:155]
  v_mfma_f32_16x16x32_bf16 v[124:127], v[104:107], v[44:47], 0
  v_mfma_f32_16x16x32_bf16 v[16:19], v[64:67], v[0:3], 0
  s_waitcnt lgkmcnt(1)
  v_mfma_f32_16x16x32_bf16 v[80:83], v[200:203], v[0:3], 0
  v_mfma_f32_16x16x32_bf16 v[48:51], v[96:99], v[32:35], 0
  v_mfma_f32_16x16x32_bf16 v[112:115], v[204:207], v[32:35], 0
  v_mfma_f32_16x16x32_bf16 v[152:155], a[84:87], a[44:47], v[152:155]
  ds_read_b64_tr_b16 a[36:37], v234 offset:22528
  s_nop 1
  v_cndmask_b32 v20, v20, v21, s[46:47]
  v_cndmask_b32 v52, v52, v53, s[46:47]
  v_cndmask_b32 v24, v24, v25, s[46:47]
  v_mfma_f32_16x16x32_bf16 v[148:151], a[80:83], a[44:47], v[148:151]
  v_cndmask_b32 v56, v56, v57, s[46:47]
  v_cndmask_b32 v28, v28, v29, s[46:47]
  v_cndmask_b32 v60, v60, v61, s[46:47]
  v_cndmask_b32 v16, v16, v17, s[46:47]
  v_cndmask_b32 v48, v48, v49, s[46:47]
  v_mfma_f32_16x16x32_bf16 v[148:151], a[60:63], a[40:43], v[148:151]
  ds_read_b64_tr_b16 a[38:39], v234 offset:23040
  s_mov_b64 exec, 7
  buffer_load_dwordx2 v[254:255], v231, s[16:19], 0 offen sc1
  s_mov_b64 exec, -1
  v_cndmask_b32 v21, v22, v23, s[46:47]
  v_cndmask_b32 v53, v54, v55, s[46:47]
  v_cndmask_b32 v25, v26, v27, s[46:47]
  v_mfma_f32_16x16x32_bf16 v[144:147], a[56:59], a[40:43], v[144:147]
  v_cndmask_b32 v57, v58, v59, s[46:47]
  v_cndmask_b32 v29, v30, v31, s[46:47]
  v_cndmask_b32 v61, v62, v63, s[46:47]
  v_cndmask_b32 v17, v18, v19, s[46:47]
  v_cndmask_b32 v49, v50, v51, s[46:47]
  v_mfma_f32_16x16x32_bf16 v[144:147], a[76:79], a[44:47], v[144:147]
  ds_read_b64_tr_b16 a[40:41], v235 offset:10240
  v_cndmask_b32 v84, v84, v85, s[46:47]
  v_cndmask_b32 v116, v116, v117, s[46:47]
  v_cndmask_b32 v88, v88, v89, s[46:47]
  v_cndmask_b32 v120, v120, v121, s[46:47]
  v_mfma_f32_16x16x32_bf16 v[160:163], a[76:79], a[4:7], v[160:163]
  v_cndmask_b32 v92, v92, v93, s[46:47]
  v_cndmask_b32 v124, v124, v125, s[46:47]
  v_cndmask_b32 v80, v80, v81, s[46:47]
  v_cndmask_b32 v112, v112, v113, s[46:47]
  v_cndmask_b32 v85, v86, v87, s[46:47]
  v_mfma_f32_16x16x32_bf16 v[160:163], a[56:59], a[0:3], v[160:163]
  ds_read_b64_tr_b16 a[42:43], v235 offset:10752
  v_cndmask_b32 v117, v118, v119, s[46:47]
  v_cndmask_b32 v89, v90, v91, s[46:47]
  v_cndmask_b32 v121, v122, v123, s[46:47]
  v_cndmask_b32 v93, v94, v95, s[46:47]
  v_mfma_f32_16x16x32_bf16 v[164:167], a[60:63], a[0:3], v[164:167]
  v_cndmask_b32 v125, v126, v127, s[46:47]
  v_cndmask_b32 v81, v82, v83, s[46:47]
  v_cndmask_b32 v113, v114, v115, s[46:47]
  v_cndmask_b32 v20, v84, v20, s[48:49]
  v_cndmask_b32 v52, v116, v52, s[48:49]
  v_mfma_f32_16x16x32_bf16 v[164:167], a[80:83], a[4:7], v[164:167]
  ds_read_b64_tr_b16 a[44:45], v235 offset:22528
  v_cndmask_b32 v24, v88, v24, s[48:49]
  v_cndmask_b32 v56, v120, v56, s[48:49]
  v_cndmask_b32 v28, v92, v28, s[48:49]
  v_cndmask_b32 v60, v124, v60, s[48:49]
  v_mfma_f32_16x16x32_bf16 v[168:171], a[84:87], a[4:7], v[168:171]
  v_cndmask_b32 v16, v80, v16, s[48:49]
  v_cndmask_b32 v48, v112, v48, s[48:49]
  v_cndmask_b32 v21, v85, v21, s[50:51]
  v_cndmask_b32 v53, v117, v53, s[50:51]
  v_cndmask_b32 v25, v89, v25, s[50:51]
  v_mfma_f32_16x16x32_bf16 v[168:171], a[64:67], a[0:3], v[168:171]
  ds_read_b64_tr_b16 a[46:47], v235 offset:23040
  v_cndmask_b32 v57, v121, v57, s[50:51]
  v_cndmask_b32 v29, v93, v29, s[50:51]
  v_cndmask_b32 v61, v125, v61, s[50:51]
  v_cndmask_b32 v17, v81, v17, s[50:51]
  v_mfma_f32_16x16x32_bf16 v[172:175], a[68:71], a[0:3], v[172:175]
  v_cndmask_b32 v49, v113, v49, s[50:51]
  v_mul_f32 v20, v20, v213
  v_mul_f32 v52, v52, v213
  v_mul_f32 v24, v24, v214
  v_mul_f32 v56, v56, v214
  v_mfma_f32_16x16x32_bf16 v[172:175], a[88:91], a[4:7], v[172:175]
  v_mul_f32 v28, v28, v215
  v_mul_f32 v60, v60, v215
  v_mul_f32 v16, v16, v212
  v_mul_f32 v48, v48, v212
  v_mul_f32 v21, v21, v241
  v_mfma_f32_16x16x32_bf16 v[188:191], a[88:91], a[12:15], v[188:191]
  v_mul_f32 v53, v53, v241
  v_mul_f32 v25, v25, v242
  v_mul_f32 v57, v57, v242
  v_mul_f32 v29, v29, v243
  v_mul_f32 v61, v61, v243
  v_mfma_f32_16x16x32_bf16 v[188:191], a[68:71], a[8:11], v[188:191]
  v_mul_f32 v17, v17, v240
  v_mul_f32 v49, v49, v240
  v_cndmask_b32 v16, v253, v16, s[52:53]
  v_cndmask_b32 v17, v253, v17, s[54:55]
  v_cndmask_b32 v48, v253, v48, s[52:53]
  v_mfma_f32_16x16x32_bf16 v[184:187], a[64:67], a[8:11], v[184:187]
  v_cndmask_b32 v49, v253, v49, s[54:55]
  v_max_f32 v84, v20, v21
  v_max_f32 v116, v52, v53
  v_max_f32 v88, v24, v25
  v_max_f32 v120, v56, v57
  v_mfma_f32_16x16x32_bf16 v[184:187], a[84:87], a[12:15], v[184:187]
  v_max_f32 v92, v28, v29
  v_max_f32 v124, v60, v61
  v_max_f32 v80, v16, v17
  v_max_f32 v112, v48, v49
  v_permlane16_swap_b32 v84, v116
  v_mfma_f32_16x16x32_bf16 v[180:183], a[80:83], a[12:15], v[180:183]
  v_permlane16_swap_b32 v88, v120
  v_permlane16_swap_b32 v92, v124
  v_permlane16_swap_b32 v80, v112
  v_max_f32 v84, v84, v116
  v_max_f32 v88, v88, v120
  v_mfma_f32_16x16x32_bf16 v[180:183], a[60:63], a[8:11], v[180:183]
  v_max_f32 v92, v92, v124
  v_max_f32 v80, v80, v112
  s_nop 0
  v_permlane32_swap_b32 v84, v88
  v_permlane32_swap_b32 v92, v80
  v_mfma_f32_16x16x32_bf16 v[176:179], a[56:59], a[8:11], v[176:179]
  v_max_f32 v84, v84, v88
  v_max_f32 v92, v92, v80
  v_mov_b32 v88, v84
  v_mov_b32 v80, v92
  s_nop 0
  v_mfma_f32_16x16x32_bf16 v[176:179], a[76:79], a[12:15], v[176:179]
  v_permlane32_swap_b32 v84, v88
  v_permlane32_swap_b32 v92, v80
  v_mov_b32 v116, v84
  v_mov_b32 v120, v88
  v_mov_b32 v124, v92
  v_mfma_f32_16x16x32_bf16 v[196:199], a[132:135], a[20:23], v[196:199]
  v_mov_b32 v112, v80
  v_permlane16_swap_b32 v84, v116
  v_permlane16_swap_b32 v88, v120
  v_permlane16_swap_b32 v92, v124
  v_permlane16_swap_b32 v80, v112
  s_waitcnt vmcnt(16)
  v_mfma_f32_16x16x32_bf16 v[196:199], a[216:219], a[168:171], v[196:199]
  v_sub_f32 v20, v20, v84
  v_sub_f32 v52, v52, v116
  v_sub_f32 v24, v24, v88
  v_sub_f32 v56, v56, v120
  v_sub_f32 v28, v28, v92
  v_mfma_f32_16x16x32_bf16 v[196:199], a[112:115], a[16:19], v[196:199]
  v_sub_f32 v60, v60, v124
  v_sub_f32 v16, v16, v80
  v_sub_f32 v48, v48, v112
  v_sub_f32 v21, v21, v84
  v_sub_f32 v53, v53, v116
  v_mfma_f32_16x16x32_bf16 v[128:131], a[96:99], a[16:19], v[128:131]
  v_sub_f32 v25, v25, v88
  v_sub_f32 v57, v57, v120
  v_sub_f32 v29, v29, v92
  v_sub_f32 v61, v61, v124
  v_sub_f32 v17, v17, v80
  v_mfma_f32_16x16x32_bf16 v[128:131], a[200:203], a[168:171], v[128:131]
  v_sub_f32 v49, v49, v112
  v_exp_f32 v20, v20
  v_exp_f32 v52, v52
  v_exp_f32 v24, v24
  v_exp_f32 v56, v56
  v_mfma_f32_16x16x32_bf16 v[128:131], a[116:119], a[20:23], v[128:131]
  v_exp_f32 v28, v28
  v_exp_f32 v60, v60
  v_exp_f32 v16, v16
  v_exp_f32 v48, v48
  v_exp_f32 v21, v21
  v_mfma_f32_16x16x32_bf16 v[132:135], a[120:123], a[20:23], v[132:135]
  v_exp_f32 v53, v53
  v_exp_f32 v25, v25
  v_exp_f32 v57, v57
  v_exp_f32 v29, v29
  v_exp_f32 v61, v61
  v_mfma_f32_16x16x32_bf16 v[132:135], a[204:207], a[168:171], v[132:135]
  v_exp_f32 v17, v17
  v_exp_f32 v49, v49
  s_waitcnt vmcnt(0)
  v_cmp_ne_u64 vcc, s[56:57], v[254:255]
  s_nop 1
  s_and_b32 s3, vcc_lo, 7
  s_cselect_b32 s67, 0, 128
  s_bitcmp1_b32 s67, 7
  s_cbranch_scc0 L_k1_nf0
  s_bfe_u32 s60, s40, 0x40000
  s_lshl_b32 s60, s60, 12
  s_add_u32 s60, s60, s42
  buffer_load_dwordx4 v[0:3], v226, s[12:15], s60 offen offset:0 sc1
  buffer_load_dwordx4 v[4:7], v226, s[12:15], s60 offen offset:1024 sc1
  buffer_load_dwordx4 v[8:11], v227, s[12:15], s60 offen offset:0 sc1
  buffer_load_dwordx4 v[12:15], v227, s[12:15], s60 offen offset:1024 sc1
  s_bitset1_b32 s67, 0
L_k1_nf0:
  v_add_f32 v84, v20, v21
  v_mfma_f32_16x16x32_bf16 v[132:135], a[100:103], a[16:19], v[132:135]
  v_add_f32 v116, v52, v53
  v_add_f32 v88, v24, v25
  v_add_f32 v120, v56, v57
  v_add_f32 v92, v28, v29
  v_add_f32 v124, v60, v61
  v_mfma_f32_16x16x32_bf16 v[136:139], a[104:107], a[16:19], v[136:139]
  v_add_f32 v80, v16, v17
  v_add_f32 v112, v48, v49
  v_permlane16_swap_b32 v84, v116
  v_permlane16_swap_b32 v88, v120
  v_permlane16_swap_b32 v92, v124
  v_mfma_f32_16x16x32_bf16 v[136:139], a[208:211], a[168:171], v[136:139]
  v_permlane16_swap_b32 v80, v112
  v_add_f32 v84, v84, v116
  v_add_f32 v88, v88, v120
  v_add_f32 v92, v92, v124
  v_add_f32 v80, v80, v112
  v_mfma_f32_16x16x32_bf16 v[136:139], a[124:127], a[20:23], v[136:139]
  v_mul_f32 v20, v20, v218
  v_permlane32_swap_b32 v84, v88
  v_permlane32_swap_b32 v92, v80
  v_add_f32 v84, v84, v88
  v_add_f32 v92, v92, v80
  v_mfma_f32_16x16x32_bf16 v[140:143], a[128:131], a[20:23], v[140:143]
  s_bitcmp1_b32 s67, 7
  s_cbranch_scc0 L_k1_nf1
  s_bfe_u32 s60, s40, 0x40000
  s_lshl_b32 s60, s60, 12
  s_add_u32 s60, s60, s42
  buffer_load_dwordx4 v[32:35], v226, s[12:15], s60 offen offset:2048 sc1
  buffer_load_dwordx4 v[36:39], v226, s[12:15], s60 offen offset:3072 sc1
  buffer_load_dwordx4 v[40:43], v227, s[12:15], s60 offen offset:2048 sc1
  buffer_load_dwordx4 v[44:47], v227, s[12:15], s60 offen offset:3072 sc1
  s_bitset1_b32 s67, 1
L_k1_nf1:
  v_rcp_f32 v84, v84
  v_rcp_f32 v92, v92
  v_mul_f32 v21, v21, v219
  v_mov_b32 v88, v84
  v_mfma_f32_16x16x32_bf16 v[140:143], a[212:215], a[168:171], v[140:143]
  v_mov_b32 v80, v92
  v_mul_f32 v52, v52, v218
  v_permlane32_swap_b32 v84, v88
  v_permlane32_swap_b32 v92, v80
  v_mov_b32 v116, v84
  v_mfma_f32_16x16x32_bf16 v[140:143], a[108:111], a[16:19], v[140:143]
  v_mov_b32 v120, v88
  v_mov_b32 v124, v92
  v_mov_b32 v112, v80
  v_permlane16_swap_b32 v84, v116
  v_permlane16_swap_b32 v88, v120
  v_mfma_f32_16x16x32_bf16 v[156:159], a[108:111], a[24:27], v[156:159]
  v_permlane16_swap_b32 v92, v124
  v_permlane16_swap_b32 v80, v112
  v_mul_f32 v53, v53, v219
  v_mul_f32 v24, v24, v220
  v_mul_f32 v25, v25, v221
  v_mfma_f32_16x16x32_bf16 v[156:159], a[212:215], a[172:175], v[156:159]
  v_mul_f32 v56, v56, v220
  v_mul_f32 v57, v57, v221
  v_mul_f32 v28, v28, v222
  v_mul_f32 v29, v29, v223
  v_mul_f32 v60, v60, v222
  v_mfma_f32_16x16x32_bf16 v[156:159], a[128:131], a[28:31], v[156:159]
  v_mul_f32 v61, v61, v223
  v_mul_f32 v16, v16, v216
  v_mul_f32 v17, v17, v217
  v_mul_f32 v48, v48, v216
  v_mul_f32 v49, v49, v217
  v_mfma_f32_16x16x32_bf16 v[152:155], a[124:127], a[28:31], v[152:155]
  v_mul_f32 v20, v20, v84
  v_mul_f32 v52, v52, v116
  v_mul_f32 v24, v24, v88
  v_mul_f32 v56, v56, v120
  v_mul_f32 v28, v28, v92
  v_mfma_f32_16x16x32_bf16 v[152:155], a[208:211], a[172:175], v[152:155]
  v_mul_f32 v60, v60, v124
  v_mul_f32 v16, v16, v80
  v_mul_f32 v48, v48, v112
  s_bitcmp1_b32 s67, 7
  s_cbranch_scc0 L_k1_nf2
  s_bfe_u32 s60, s40, 0x40004
  s_lshl_b32 s60, s60, 12
  s_add_u32 s60, s60, s42
  buffer_load_dwordx4 v[64:67], v226, s[12:15], s60 offen offset:0 sc1
  buffer_load_dwordx4 v[68:71], v226, s[12:15], s60 offen offset:1024 sc1
  buffer_load_dwordx4 v[72:75], v227, s[12:15], s60 offen offset:0 sc1
  buffer_load_dwordx4 v[76:79], v227, s[12:15], s60 offen offset:1024 sc1
  s_bitset1_b32 s67, 2
L_k1_nf2:
  v_mul_f32 v21, v21, v84
  v_mfma_f32_16x16x32_bf16 v[152:155], a[104:107], a[24:27], v[152:155]
  v_mul_f32 v53, v53, v116
  v_mul_f32 v25, v25, v88
  v_mul_f32 v57, v57, v120
  v_mul_f32 v29, v29, v92
  v_mul_f32 v61, v61, v124
  v_mfma_f32_16x16x32_bf16 v[148:151], a[100:103], a[24:27], v[148:151]
  v_mul_f32 v17, v17, v80
  v_mul_f32 v49, v49, v112
  v_cvt_pk_bf16_f32 v20, v20, v21
  v_cvt_pk_bf16_f32 v52, v52, v53
  v_cvt_pk_bf16_f32 v24, v24, v25
  v_mfma_f32_16x16x32_bf16 v[148:151], a[204:207], a[172:175], v[148:151]
  v_cvt_pk_bf16_f32 v196, v196, v197
  v_cvt_pk_bf16_f32 v197, v198, v199
  v_cvt_pk_bf16_f32 v131, v130, v131
  v_cvt_pk_bf16_f32 v130, v128, v129
  v_cvt_pk_bf16_f32 v132, v132, v133
  v_mfma_f32_16x16x32_bf16 v[148:151], a[120:123], a[28:31], v[148:151]
  v_cvt_pk_bf16_f32 v133, v134, v135
  v_cvt_pk_bf16_f32 v134, v136, v137
  v_cvt_pk_bf16_f32 v135, v138, v139
  v_cvt_pk_bf16_f32 v136, v140, v141
  v_cvt_pk_bf16_f32 v137, v142, v143
  v_mfma_f32_16x16x32_bf16 v[144:147], a[116:119], a[28:31], v[144:147]
  v_cvt_pk_bf16_f32 v56, v56, v57
  v_cvt_pk_bf16_f32 v28, v28, v29
  v_cvt_pk_bf16_f32 v60, v60, v61
  v_cvt_pk_bf16_f32 v16, v16, v17
  v_cvt_pk_bf16_f32 v48, v48, v49
  v_mfma_f32_16x16x32_bf16 v[144:147], a[200:203], a[172:175], v[144:147]
  s_bitcmp1_b32 s67, 7
  s_cbranch_scc0 L_k1_nf3
  s_bfe_u32 s60, s40, 0x40004
  s_lshl_b32 s60, s60, 12
  s_add_u32 s60, s60, s42
  buffer_load_dwordx4 v[96:99], v226, s[12:15], s60 offen offset:2048 sc1
  buffer_load_dwordx4 v[100:103], v226, s[12:15], s60 offen offset:3072 sc1
  buffer_load_dwordx4 v[104:107], v227, s[12:15], s60 offen offset:2048 sc1
  buffer_load_dwordx4 v[108:111], v227, s[12:15], s60 offen offset:3072 sc1
  s_bitset1_b32 s67, 3
  s_branch L_k1_nf3b
L_k1_nf3:
  s_mov_b64 exec, 7
  buffer_load_dwordx2 v[254:255], v231, s[16:19], 0 offen sc1
  s_mov_b64 exec, -1
L_k1_nf3b:
  v_perm_b32 v84, v20, v20, v208
  v_perm_b32 v116, v52, v52, v208
  v_perm_b32 v88, v24, v24, v208
  v_perm_b32 v120, v56, v56, v208
  v_mfma_f32_16x16x32_bf16 v[144:147], a[96:99], a[24:27], v[144:147]
  v_perm_b32 v92, v28, v28, v208
  v_perm_b32 v124, v60, v60, v208
  v_perm_b32 v80, v16, v16, v208
  v_perm_b32 v112, v48, v48, v208
  v_perm_b32 v85, v20, v20, v209
  s_waitcnt lgkmcnt(4)
  v_mfma_f32_16x16x32_bf16 v[160:163], a[96:99], a[32:35], v[160:163]
  v_perm_b32 v117, v52, v52, v209
  v_perm_b32 v89, v24, v24, v209
  v_perm_b32 v121, v56, v56, v209
  v_perm_b32 v93, v28, v28, v209
  v_perm_b32 v125, v60, v60, v209
  v_mfma_f32_16x16x32_bf16 v[160:163], a[200:203], a[176:179], v[160:163]
  v_perm_b32 v81, v16, v16, v209
  v_perm_b32 v113, v48, v48, v209
  v_perm_b32 v86, v20, v20, v210
  v_perm_b32 v118, v52, v52, v210
  v_perm_b32 v90, v24, v24, v210
  v_mfma_f32_16x16x32_bf16 v[160:163], a[116:119], a[36:39], v[160:163]
  v_perm_b32 v122, v56, v56, v210
  v_perm_b32 v94, v28, v28, v210
  v_perm_b32 v126, v60, v60, v210
  v_perm_b32 v82, v16, v16, v210
  v_perm_b32 v114, v48, v48, v210
  v_mfma_f32_16x16x32_bf16 v[164:167], a[120:123], a[36:39], v[164:167]
  v_perm_b32 v87, v20, v20, v211
  v_perm_b32 v119, v52, v52, v211
  v_perm_b32 v91, v24, v24, v211
  v_perm_b32 v123, v56, v56, v211
  v_perm_b32 v95, v28, v28, v211
  v_mfma_f32_16x16x32_bf16 v[164:167], a[204:207], a[176:179], v[164:167]
  v_perm_b32 v127, v60, v60, v211
  v_perm_b32 v83, v16, v16, v211
  v_perm_b32 v115, v48, v48, v211
  s_lshl_b32 s62, s26, 3
  s_lshl_b32 s3, s25, 1
  s_add_u32 s62, s62, s3
  s_mul_i32 s62, s62, 144
  s_lshl_b32 s3, s27, 1
  s_add_u32 s62, s62, s3
  s_lshr_b32 s3, s25, 1
  s_xor_b32 s63, s3, 1
  s_add_u32 s63, s63, s62
  s_add_u32 s62, s62, s3
  s_lshl_b32 s62, s62, 11
  s_lshl_b32 s63, s63, 11
  v_mfma_f32_16x16x32_bf16 v[164:167], a[100:103], a[32:35], v[164:167]
  s_mov_b32 s3, 83968
  s_cmp_eq_u32 s25, 3
  s_cselect_b32 s3, 0, s3
  v_add_u32 v248, s3, v244
  v_add_u32 v244, 81920, v244
  s_mov_b32 s3, 83968
  s_cmp_eq_u32 s25, 3
  s_cselect_b32 s3, 0, s3
  v_add_u32 v249, s3, v245
  v_add_u32 v245, 81920, v245
  s_mov_b32 s3, 83968
  s_cmp_eq_u32 s25, 3
  s_cselect_b32 s3, 0, s3
  v_add_u32 v250, s3, v246
  v_mfma_f32_16x16x32_bf16 v[168:171], a[104:107], a[32:35], v[168:171]
  v_add_u32 v246, 81920, v246
  s_mov_b32 s3, 83968
  s_cmp_eq_u32 s25, 3
  s_cselect_b32 s3, 0, s3
  v_add_u32 v251, s3, v247
  v_add_u32 v247, 81920, v247
  v_add_u32 v252, 81920, v252
  v_mfma_f32_16x16x32_bf16 v[168:171], a[208:211], a[176:179], v[168:171]
  v_cvt_pk_bf16_f32 v147, v146, v147
  v_cvt_pk_bf16_f32 v146, v144, v145
  v_cvt_pk_bf16_f32 v148, v148, v149
  v_cvt_pk_bf16_f32 v149, v150, v151
  v_cvt_pk_bf16_f32 v150, v152, v153
  v_mfma_f32_16x16x32_bf16 v[168:171], a[124:127], a[36:39], v[168:171]
  v_cvt_pk_bf16_f32 v151, v154, v155
  v_cvt_pk_bf16_f32 v152, v156, v157
  v_cvt_pk_bf16_f32 v153, v158, v159
  v_mfma_f32_16x16x32_bf16 v[172:175], a[128:131], a[36:39], v[172:175]
  v_mfma_f32_16x16x32_bf16 v[172:175], a[212:215], a[176:179], v[172:175]
  v_mfma_f32_16x16x32_bf16 v[172:175], a[108:111], a[32:35], v[172:175]
  s_waitcnt lgkmcnt(0)
  v_mfma_f32_16x16x32_bf16 v[188:191], a[108:111], a[40:43], v[188:191]
  v_mfma_f32_16x16x32_bf16 v[188:191], a[212:215], a[180:183], v[188:191]
  v_mfma_f32_16x16x32_bf16 v[188:191], a[128:131], a[44:47], v[188:191]
  v_mfma_f32_16x16x32_bf16 v[184:187], a[124:127], a[44:47], v[184:187]
  v_mfma_f32_16x16x32_bf16 v[184:187], a[208:211], a[180:183], v[184:187]
  v_mfma_f32_16x16x32_bf16 v[184:187], a[104:107], a[40:43], v[184:187]
  v_mfma_f32_16x16x32_bf16 v[180:183], a[100:103], a[40:43], v[180:183]
  v_mfma_f32_16x16x32_bf16 v[180:183], a[204:207], a[180:183], v[180:183]
  v_cvt_pk_bf16_f32 v163, v162, v163
  v_cvt_pk_bf16_f32 v162, v160, v161
  v_cvt_pk_bf16_f32 v164, v164, v165
  v_cvt_pk_bf16_f32 v165, v166, v167
  v_cvt_pk_bf16_f32 v166, v168, v169
  v_mfma_f32_16x16x32_bf16 v[180:183], a[120:123], a[44:47], v[180:183]
  v_cvt_pk_bf16_f32 v167, v170, v171
  v_cvt_pk_bf16_f32 v168, v172, v173
  v_cvt_pk_bf16_f32 v169, v174, v175
  v_mfma_f32_16x16x32_bf16 v[176:179], a[116:119], a[44:47], v[176:179]
  v_mfma_f32_16x16x32_bf16 v[176:179], a[200:203], a[180:183], v[176:179]
  v_mfma_f32_16x16x32_bf16 v[176:179], a[96:99], a[40:43], v[176:179]
  s_nop 7
  v_cvt_pk_bf16_f32 v179, v178, v179
  v_cvt_pk_bf16_f32 v178, v176, v177
  v_cvt_pk_bf16_f32 v180, v180, v181
  v_cvt_pk_bf16_f32 v181, v182, v183
  v_cvt_pk_bf16_f32 v182, v184, v185
  v_cvt_pk_bf16_f32 v183, v186, v187
  v_cvt_pk_bf16_f32 v184, v188, v189
  v_cvt_pk_bf16_f32 v185, v190, v191
  ds_write_b64 v248, v[136:137]
  ds_write_b64 v249, v[152:153]
  ds_write_b64 v250, v[168:169]
  ds_write_b64 v251, v[184:185]
  ds_write_b64 v252, v[196:197]
  v_mfma_f32_16x16x32_bf16 v[140:143], v[130:133], v[84:87], 0
  v_mfma_f32_16x16x32_bf16 v[20:23], v[146:149], v[84:87], 0
  v_mfma_f32_16x16x32_bf16 v[156:159], v[162:165], v[116:119], 0
  v_mfma_f32_16x16x32_bf16 v[52:55], v[178:181], v[116:119], 0
  s_waitcnt lgkmcnt(0)
  s_barrier
  ds_read_b64 v[128:129], v244
  ds_read_b64 v[144:145], v245
  ds_read_b64 v[160:161], v246
  ds_read_b64 v[176:177], v247
  v_mfma_f32_16x16x32_bf16 v[172:175], v[132:135], v[88:91], 0
  v_mfma_f32_16x16x32_bf16 v[24:27], v[148:151], v[88:91], 0
  v_mfma_f32_16x16x32_bf16 v[188:191], v[164:167], v[120:123], 0
  v_mfma_f32_16x16x32_bf16 v[56:59], v[180:183], v[120:123], 0
  v_mfma_f32_16x16x32_bf16 v[200:203], v[134:137], v[92:95], 0
  v_mfma_f32_16x16x32_bf16 v[28:31], v[150:153], v[92:95], 0
  v_mfma_f32_16x16x32_bf16 v[204:207], v[166:169], v[124:127], 0
  v_mfma_f32_16x16x32_bf16 v[60:63], v[182:185], v[124:127], 0
  s_waitcnt lgkmcnt(0)
  v_mfma_f32_16x16x32_bf16 v[192:195], v[128:131], v[80:83], 0
  v_mfma_f32_16x16x32_bf16 v[16:19], v[144:147], v[80:83], 0
  v_mfma_f32_16x16x32_bf16 v[196:199], v[160:163], v[112:115], 0
  v_mfma_f32_16x16x32_bf16 v[48:51], v[176:179], v[112:115], 0
  v_cvt_pk_bf16_f32 v23, v22, v23
  v_cvt_pk_bf16_f32 v22, v20, v21
  v_cvt_pk_bf16_f32 v20, v140, v141
  v_cvt_pk_bf16_f32 v21, v142, v143
  v_cvt_pk_bf16_f32 v55, v54, v55
  v_cvt_pk_bf16_f32 v54, v52, v53
  v_cvt_pk_bf16_f32 v52, v156, v157
  v_cvt_pk_bf16_f32 v53, v158, v159
  v_cvt_pk_bf16_f32 v27, v26, v27
  v_cvt_pk_bf16_f32 v26, v24, v25
  v_cvt_pk_bf16_f32 v24, v172, v173
  v_cvt_pk_bf16_f32 v25, v174, v175
  v_cvt_pk_bf16_f32 v59, v58, v59
  v_cvt_pk_bf16_f32 v58, v56, v57
  v_cvt_pk_bf16_f32 v56, v188, v189
  v_cvt_pk_bf16_f32 v57, v190, v191
  v_cvt_pk_bf16_f32 v31, v30, v31
  v_cvt_pk_bf16_f32 v30, v28, v29
  v_cvt_pk_bf16_f32 v28, v200, v201
  v_cvt_pk_bf16_f32 v29, v202, v203
  v_cvt_pk_bf16_f32 v63, v62, v63
  v_cvt_pk_bf16_f32 v62, v60, v61
  v_cvt_pk_bf16_f32 v60, v204, v205
  v_cvt_pk_bf16_f32 v61, v206, v207
  v_cvt_pk_bf16_f32 v19, v18, v19
  v_cvt_pk_bf16_f32 v18, v16, v17
  v_cvt_pk_bf16_f32 v16, v192, v193
  v_cvt_pk_bf16_f32 v17, v194, v195
  v_cvt_pk_bf16_f32 v51, v50, v51
  v_cvt_pk_bf16_f32 v50, v48, v49
  v_cvt_pk_bf16_f32 v48, v196, v197
  v_cvt_pk_bf16_f32 v49, v198, v199
  s_bitcmp1_b32 s67, 7
  s_cbranch_scc1 L_k1_noearly
  s_waitcnt vmcnt(0)
  v_cmp_ne_u64 vcc, s[56:57], v[254:255]
  s_nop 1
  s_and_b32 s3, vcc_lo, 7
  s_cselect_b32 s67, 0, 128
  s_cbranch_scc1 L_k1_noearly
  s_bfe_u32 s60, s40, 0x40000
  s_lshl_b32 s60, s60, 12
  s_add_u32 s60, s60, s42
  buffer_load_dwordx4 v[0:3], v226, s[12:15], s60 offen offset:0 sc1
  buffer_load_dwordx4 v[4:7], v226, s[12:15], s60 offen offset:1024 sc1
  buffer_load_dwordx4 v[8:11], v227, s[12:15], s60 offen offset:0 sc1
  buffer_load_dwordx4 v[12:15], v227, s[12:15], s60 offen offset:1024 sc1
  s_bfe_u32 s60, s40, 0x40000
  s_lshl_b32 s60, s60, 12
  s_add_u32 s60, s60, s42
  buffer_load_dwordx4 v[32:35], v226, s[12:15], s60 offen offset:2048 sc1
  buffer_load_dwordx4 v[36:39], v226, s[12:15], s60 offen offset:3072 sc1
  buffer_load_dwordx4 v[40:43], v227, s[12:15], s60 offen offset:2048 sc1
  buffer_load_dwordx4 v[44:47], v227, s[12:15], s60 offen offset:3072 sc1
  s_bfe_u32 s60, s40, 0x40004
  s_lshl_b32 s60, s60, 12
  s_add_u32 s60, s60, s42
  buffer_load_dwordx4 v[64:67], v226, s[12:15], s60 offen offset:0 sc1
  buffer_load_dwordx4 v[68:71], v226, s[12:15], s60 offen offset:1024 sc1
  buffer_load_dwordx4 v[72:75], v227, s[12:15], s60 offen offset:0 sc1
  buffer_load_dwordx4 v[76:79], v227, s[12:15], s60 offen offset:1024 sc1
  s_bfe_u32 s60, s40, 0x40004
  s_lshl_b32 s60, s60, 12
  s_add_u32 s60, s60, s42
  buffer_load_dwordx4 v[96:99], v226, s[12:15], s60 offen offset:2048 sc1
  buffer_load_dwordx4 v[100:103], v226, s[12:15], s60 offen offset:3072 sc1
  buffer_load_dwordx4 v[104:107], v227, s[12:15], s60 offen offset:2048 sc1
  buffer_load_dwordx4 v[108:111], v227, s[12:15], s60 offen offset:3072 sc1
L_k1_noearly:
  s_bitcmp1_b32 s25, 0
  s_cbranch_scc0 L_k1_noswap
  v_swap_b32 v20, v22
  v_swap_b32 v21, v23
  v_swap_b32 v52, v54
  v_swap_b32 v53, v55
  v_swap_b32 v24, v26
  v_swap_b32 v25, v27
  v_swap_b32 v56, v58
  v_swap_b32 v57, v59
  v_swap_b32 v28, v30
  v_swap_b32 v29, v31
  v_swap_b32 v60, v62
  v_swap_b32 v61, v63
  v_swap_b32 v16, v18
  v_swap_b32 v17, v19
  v_swap_b32 v48, v50
  v_swap_b32 v49, v51
L_k1_noswap:
  s_add_u32 s64, s62, 0x0
  buffer_store_dwordx4 v[20:23], v228, s[12:15], s64 offen offset:1024 sc1
  s_add_u32 s64, s63, 0x0
  buffer_store_dwordx4 v[52:55], v228, s[12:15], s64 offen offset:1024 sc1
  s_add_u32 s64, s62, 0x48000
  buffer_store_dwordx4 v[24:27], v228, s[12:15], s64 offen offset:0 sc1
  s_add_u32 s64, s63, 0x48000
  buffer_store_dwordx4 v[56:59], v228, s[12:15], s64 offen offset:0 sc1
  s_add_u32 s64, s62, 0x48000
  buffer_store_dwordx4 v[28:31], v228, s[12:15], s64 offen offset:1024 sc1
  s_add_u32 s64, s63, 0x48000
  buffer_store_dwordx4 v[60:63], v228, s[12:15], s64 offen offset:1024 sc1
  s_add_u32 s64, s62, 0x0
  buffer_store_dwordx4 v[16:19], v228, s[12:15], s64 offen offset:0 sc1
  s_add_u32 s64, s63, 0x0
  buffer_store_dwordx4 v[48:51], v228, s[12:15], s64 offen offset:0 sc1
  s_bitcmp1_b32 s67, 7
  s_cbranch_scc0 L_k1_no45
  s_bfe_u32 s60, s40, 0x40008
  s_lshl_b32 s60, s60, 12
  s_add_u32 s60, s60, s42
  buffer_load_dwordx4 v[128:131], v226, s[12:15], s60 offen offset:0 sc1
  buffer_load_dwordx4 v[132:135], v226, s[12:15], s60 offen offset:1024 sc1
  buffer_load_dwordx4 v[136:139], v227, s[12:15], s60 offen offset:0 sc1
  buffer_load_dwordx4 v[140:143], v227, s[12:15], s60 offen offset:1024 sc1
  s_bfe_u32 s60, s40, 0x40008
  s_lshl_b32 s60, s60, 12
  s_add_u32 s60, s60, s42
  buffer_load_dwordx4 v[160:163], v226, s[12:15], s60 offen offset:2048 sc1
  buffer_load_dwordx4 v[164:167], v226, s[12:15], s60 offen offset:3072 sc1
  buffer_load_dwordx4 v[168:171], v227, s[12:15], s60 offen offset:2048 sc1
  buffer_load_dwordx4 v[172:175], v227, s[12:15], s60 offen offset:3072 sc1
L_k1_no45:
  s_branch L_k2_start
L_k1_spin_qkv:
  s_mov_b32 s61, 0
L_k1_spin1_qkv:
  s_sleep 8
  buffer_load_dwordx2 v[252:253], v254, s[16:19], 0 offen sc1
  s_waitcnt vmcnt(0)
  s_add_u32 s61, s61, 1
  s_cmp_gt_u32 s61, 0x10000
  s_cbranch_scc1 L_k1_back_qkv
  v_cmp_ne_u64 vcc, s[56:57], v[252:253]
  s_cbranch_vccnz L_k1_spin1_qkv
  s_branch L_k1_back_qkv
L_k1_tspin_qkv:
  s_mov_b32 s61, 0
L_k1_tspin1_qkv:
  s_sleep 8
  buffer_load_dwordx2 a[226:227], off, s[32:35], 0 sc1
  s_waitcnt vmcnt(0)
  s_add_u32 s61, s61, 1
  s_cmp_gt_u32 s61, 0x10000
  s_cbranch_scc1 L_k1_tback_qkv
  v_accvgpr_read_b32 v252, a226
  v_accvgpr_read_b32 v253, a227
  s_nop 0
  v_readfirstlane_b32 s56, v252
  v_readfirstlane_b32 s57, v253
  s_nop 3
  s_cmp_lg_u32 s56, 0
  s_cbranch_scc0 L_k1_tspin1_qkv
  s_branch L_k1_tback_qkv
L_k1_w1:
  s_lshr_b32 s46, s27, 2
  s_mul_i32 s46, s46, 1792
  s_and_b32 s47, s27, 3
  s_mul_i32 s48, s47, 384
  s_add_u32 s44, s46, s48
  s_lshl_b32 s48, s47, 6
  s_add_u32 s45, s46, s48
  s_add_u32 s45, s45, 1536
  v_lshrrev_b32 v104, 3, v100
  v_bfe_u32 v106, v100, 1, 2
  v_bfe_u32 v107, v100, 4, 1
  v_xor_b32 v106, v106, v107
  v_and_b32 v105, 1, v100
  v_mul_u32_u24 v104, 7168, v104
  v_lshl_add_u32 v107, v105, 4, v104
  s_mul_i32 s49, s25, 114688
  s_add_u32 s50, s49, s44
  v_lshl_add_u32 v229, v106, 5, v107
  v_add_u32 v229, s50, v229
  v_xor_b32 v106, 2, v106
  v_lshl_add_u32 v230, v106, 5, v107
  s_add_u32 s50, s50, 57344
  v_add_u32 v230, s50, v230
  v_lshrrev_b32 v108, 2, v100
  v_mul_u32_u24 v108, 7168, v108
  v_bfe_u32 v109, v100, 1, 1
  v_bfe_u32 v110, v100, 5, 1
  v_xor_b32 v109, v109, v110
  v_lshl_add_u32 v108, v109, 5, v108
  v_lshl_add_u32 v108, v105, 4, v108
  s_add_u32 s50, s49, s45
  v_add_u32 v231, s50, v108
  s_mul_i32 s23, s25, 7168
  s_add_u32 m0, s23, 0x800
  s_nop 0
  buffer_load_dwordx4 v229, s[8:11], s21 offen offset:0 lds
  s_add_u32 m0, s23, 0xb80
  s_nop 0
  buffer_load_dwordx4 v229, s[8:11], s21 offen offset:128 lds
  s_add_u32 m0, s23, 0xf00
  s_nop 0
  buffer_load_dwordx4 v229, s[8:11], s21 offen offset:256 lds
  s_add_u32 m0, s23, 0x1400
  s_nop 0
  buffer_load_dwordx4 v230, s[8:11], s21 offen offset:0 lds
  s_add_u32 m0, s23, 0x1780
  s_nop 0
  buffer_load_dwordx4 v230, s[8:11], s21 offen offset:128 lds
  s_add_u32 m0, s23, 0x1b00
  s_nop 0
  buffer_load_dwordx4 v230, s[8:11], s21 offen offset:256 lds
  s_add_u32 m0, s23, 0x2000
  s_nop 0
  buffer_load_dwordx4 v231, s[8:11], s21 offen lds
  s_add_u32 s21, s21, 0x70000
  s_mov_b32 s100, s14
  s_mov_b32 s101, s15
  s_mov_b32 s32, s12
  s_mov_b32 s33, s13
  s_mov_b32 s34, 0x8
  s_mov_b32 s35, 0x20000
  s_add_u32 s40, s100, 0x3000000
  s_addc_u32 s41, s101, 0
  s_mov_b32 s43, 0x20000
  s_cmp_eq_u32 s25, 0
  s_cselect_b32 s42, 0x8000, 0
  s_add_u32 s16, s100, 0x3000000
  s_addc_u32 s17, s101, 0
  s_mov_b32 s18, 0xc8000
  s_mov_b32 s19, 0x20000
  s_add_u32 s12, s100, 0x400000
  s_addc_u32 s13, s101, 0
  s_mov_b32 s14, 0x1200000
  s_mov_b32 s15, 0x20000
  s_mov_b32 s28, s58
  s_mov_b32 s29, s59
  s_mov_b32 s31, 0x20000
  s_cmp_eq_u32 s26, 0
  s_cselect_b32 s30, 7168, 0
  s_mov_b32 s58, s100
  s_mov_b32 s59, s101
  s_mov_b32 s101, s36
  s_mov_b32 s20, s37
  s_mov_b32 s36, s38
  s_mov_b32 s37, s39
  s_mov_b32 s38, 0x200000
  s_mov_b32 s39, 0x20000
  s_lshl_b32 s100, s2, 2
  s_add_u32 s100, s100, s25
  v_and_b32 v108, 7, v100
  v_lshl_add_u32 v244, v108, 4, v104
  s_lshl_b32 s51, s25, 7
  s_add_u32 s51, s51, s44
  s_cmp_eq_u32 s25, 3
  s_cselect_b32 s51, s45, s51
  v_lshlrev_b32 v246, 4, v108
  v_lshl_add_u32 v246, v102, 3, v246
  v_add_u32 v246, s51, v246
  s_lshr_b32 s52, s51, 5
  s_add_u32 s52, s52, 192
  s_and_b32 s53, s26, 3
  s_lshl_b32 s53, s53, 1
  s_lshr_b32 s3, s26, 2
  s_add_u32 s53, s53, s3
  s_mul_i32 s53, s53, 0xe0000
  s_add_u32 s53, s53, s51
  s_lshl_b32 s52, s52, 10
  s_lshr_b32 s51, s26, 1
  s_lshl_b32 s51, s51, 8
  s_add_u32 s52, s52, s51
  s_and_b32 s51, s26, 1
  s_lshl_b32 s51, s51, 3
  s_add_u32 s52, s52, s51
  s_add_u32 s52, s52, 0x40000
  v_lshrrev_b32 v109, 1, v108
  v_lshlrev_b32 v245, 10, v109
  v_lshl_add_u32 v245, v105, 7, v245
  v_lshl_add_u32 v245, v102, 6, v245
  s_cmp_eq_u32 s25, 3
  s_cselect_b32 s51, 0x2c, 0x28
  v_and_b32 v109, s51, v100
  v_lshl_add_u32 v245, v109, 24, v245
  v_lshlrev_b32 v109, 4, v105
  v_mov_b32 v110, 0x3f80
  v_lshlrev_b32 v110, v109, v110
  v_lshrrev_b32 v109, 1, v101
  v_cmp_eq_u32 vcc, 0, v109
  s_nop 1
  v_cndmask_b32 v111, 0, v110, vcc
  v_accvgpr_write_b32 a220, v111
  v_cmp_eq_u32 vcc, 1, v109
  s_nop 1
  v_cndmask_b32 v111, 0, v110, vcc
  v_accvgpr_write_b32 a221, v111
  v_cmp_eq_u32 vcc, 2, v109
  s_nop 1
  v_cndmask_b32 v111, 0, v110, vcc
  v_accvgpr_write_b32 a222, v111
  v_cmp_eq_u32 vcc, 3, v109
  s_nop 1
  v_cndmask_b32 v111, 0, v110, vcc
  v_accvgpr_write_b32 a223, v111
  v_xor_b32 v108, v109, v102
  v_lshlrev_b32 v109, 7, v101
  v_add_u32 v109, s24, v109
  v_add_u32 v109, 2048, v109
  v_lshl_add_u32 v226, v108, 4, v109
  v_xor_b32 v108, 4, v108
  v_lshl_add_u32 v227, v108, 4, v109
  v_bfe_u32 v108, v100, 2, 2
  v_and_b32 v109, 3, v100
  v_bfe_u32 v110, v100, 3, 2
  v_lshrrev_b32 v111, 5, v100
  v_mul_u32_u24 v111, 7168, v111
  v_lshl_add_u32 v111, v109, 3, v111
  v_bfe_u32 v112, v100, 4, 1
  v_mul_u32_u24 v113, 3072, v112
  v_lshl_add_u32 v113, v108, 7, v113
  v_add_u32 v113, v113, v111
  v_xor_b32 v114, 0, v110
  v_lshl_add_u32 v232, v114, 5, v113
  v_add_u32 v236, 57344, v232
  v_xor_b32 v114, 1, v110
  v_lshl_add_u32 v233, v114, 5, v113
  v_add_u32 v237, 57344, v233
  v_xor_b32 v114, 2, v110
  v_lshl_add_u32 v234, v114, 5, v113
  v_add_u32 v238, 57344, v234
  v_xor_b32 v114, 3, v110
  v_lshl_add_u32 v235, v114, 5, v113
  v_add_u32 v239, 57344, v235
  v_lshl_add_u32 v113, v112, 3, v108
  v_lshl_add_u32 v113, v113, 6, v111
  v_add_u32 v113, 6144, v113
  v_xor_b32 v114, 0, v112
  v_lshl_add_u32 v240, v114, 5, v113
  v_add_u32 v242, 57344, v240
  v_xor_b32 v114, 1, v112
  v_lshl_add_u32 v241, v114, 5, v113
  v_add_u32 v243, 57344, v241
  s_mov_b32 s54, 0xffff0000
  v_mov_b32 v108, 0x3f803f80
  v_accvgpr_write_b32 a244, v108
  v_accvgpr_write_b32 a245, v108
  v_accvgpr_write_b32 a246, v108
  v_accvgpr_write_b32 a247, v108
  v_cmp_eq_u32 vcc, 1, v105
  s_add_u32 m0, s23, 0x7800
  s_nop 0
  buffer_load_dwordx4 v229, s[8:11], s21 offen offset:0 lds
  s_add_u32 m0, s23, 0x7b80
  s_nop 0
  buffer_load_dwordx4 v229, s[8:11], s21 offen offset:128 lds
  s_add_u32 m0, s23, 0x7f00
  s_nop 0
  buffer_load_dwordx4 v229, s[8:11], s21 offen offset:256 lds
  s_add_u32 m0, s23, 0x8400
  s_nop 0
  buffer_load_dwordx4 v230, s[8:11], s21 offen offset:0 lds
  s_add_u32 m0, s23, 0x8780
  s_nop 0
  buffer_load_dwordx4 v230, s[8:11], s21 offen offset:128 lds
  s_add_u32 m0, s23, 0x8b00
  s_nop 0
  buffer_load_dwordx4 v230, s[8:11], s21 offen offset:256 lds
  s_add_u32 m0, s23, 0x9000
  s_nop 0
  buffer_load_dwordx4 v231, s[8:11], s21 offen lds
  s_add_u32 s21, s21, 0x70000
  s_add_u32 m0, s24, 0x2780
  s_nop 0
  buffer_load_dwordx4 v224, s[4:7], s62 offen offset:128 lds
  s_add_u32 m0, s24, 0x2b80
  s_nop 0
  buffer_load_dwordx4 v225, s[4:7], s62 offen offset:128 lds
  s_add_u32 m0, s24, 0x2f80
  s_nop 0
  buffer_load_dwordx4 v224, s[4:7], s63 offen offset:128 lds
  s_add_u32 m0, s24, 0x3380
  s_nop 0
  buffer_load_dwordx4 v225, s[4:7], s63 offen offset:128 lds
  s_add_u32 m0, s24, 0x3780
  s_nop 0
  buffer_load_dwordx4 v224, s[4:7], s64 offen offset:128 lds
  s_add_u32 m0, s24, 0x3b80
  s_nop 0
  buffer_load_dwordx4 v225, s[4:7], s64 offen offset:128 lds
  s_add_u32 m0, s24, 0x3f80
  s_nop 0
  buffer_load_dwordx4 v224, s[4:7], s65 offen offset:128 lds
  s_add_u32 m0, s24, 0x4380
  s_nop 0
  buffer_load_dwordx4 v225, s[4:7], s65 offen offset:128 lds
  s_waitcnt vmcnt(15)
  s_barrier
  ds_read_b128 a[56:59], v226 offset:0
  ds_read_b128 a[72:75], v227 offset:0
  ds_read_b64_tr_b16 a[0:1], v232 offset:2048
  ds_read_b64_tr_b16 a[2:3], v232 offset:2560
  ds_read_b64_tr_b16 a[4:5], v232 offset:16384
  ds_read_b64_tr_b16 a[6:7], v232 offset:16896
  ds_read_b128 a[60:63], v226 offset:2048
  ds_read_b128 a[76:79], v227 offset:2048
  ds_read_b128 a[64:67], v226 offset:4096
  ds_read_b128 a[80:83], v227 offset:4096
  ds_read_b128 a[68:71], v226 offset:6144
  ds_read_b128 a[84:87], v227 offset:6144
  s_waitcnt lgkmcnt(6)
  v_mfma_f32_16x16x32_bf16 v[0:3], a[0:3], a[56:59], 0
  ds_read_b64_tr_b16 a[8:9], v233 offset:2048
  v_mfma_f32_16x16x32_bf16 v[0:3], a[4:7], a[72:75], v[0:3]
  ds_read_b64_tr_b16 a[10:11], v233 offset:2560
  s_getpc_b64 s[48:49]
L_k1_pc_w1:
  s_mov_b32 s50, L_k1_spin_w1-L_k1_pc_w1
  s_mov_b32 s51, 0x20000
  s_bfe_u32 s60, s2, 0x20003
  s_lshl_b32 s60, s60, 2
  s_add_u32 s60, s60, s25
  s_mul_i32 s60, s60, 2560
  v_lshlrev_b32 v252, 3, v228
  s_mov_b64 exec, 0xfffff
  buffer_load_dword a224, v252, s[48:51], s60 offen
  s_mov_b64 exec, -1
  s_add_u32 m0, s23, 0xe800
  s_waitcnt lgkmcnt(6)
  v_mfma_f32_16x16x32_bf16 v[4:7], a[4:7], a[76:79], 0
  ds_read_b64_tr_b16 a[12:13], v233 offset:16384
  buffer_load_dwordx4 v229, s[8:11], s21 offen offset:0 lds
  v_mfma_f32_16x16x32_bf16 v[4:7], a[0:3], a[60:63], v[4:7]
  ds_read_b64_tr_b16 a[14:15], v233 offset:16896
  s_waitcnt lgkmcnt(6)
  v_mfma_f32_16x16x32_bf16 v[8:11], a[0:3], a[64:67], 0
  ds_read_b64_tr_b16 a[16:17], v234 offset:2048
  v_mfma_f32_16x16x32_bf16 v[8:11], a[4:7], a[80:83], v[8:11]
  ds_read_b64_tr_b16 a[18:19], v234 offset:2560
  s_add_u32 m0, s23, 0xeb80
  s_waitcnt lgkmcnt(6)
  v_mfma_f32_16x16x32_bf16 v[12:15], a[4:7], a[84:87], 0
  ds_read_b64_tr_b16 a[20:21], v234 offset:16384
  buffer_load_dwordx4 v229, s[8:11], s21 offen offset:128 lds
  v_mfma_f32_16x16x32_bf16 v[12:15], a[0:3], a[68:71], v[12:15]
  ds_read_b64_tr_b16 a[22:23], v234 offset:16896
  s_waitcnt lgkmcnt(4)
  v_mfma_f32_16x16x32_bf16 v[28:31], a[8:11], a[68:71], 0
  ds_read_b64_tr_b16 a[24:25], v235 offset:2048
  v_mfma_f32_16x16x32_bf16 v[28:31], a[12:15], a[84:87], v[28:31]
  ds_read_b64_tr_b16 a[26:27], v235 offset:2560
  s_add_u32 m0, s23, 0xef00
  v_mfma_f32_16x16x32_bf16 v[24:27], a[12:15], a[80:83], 0
  ds_read_b64_tr_b16 a[28:29], v235 offset:16384
  buffer_load_dwordx4 v229, s[8:11], s21 offen offset:256 lds
  v_mfma_f32_16x16x32_bf16 v[24:27], a[8:11], a[64:67], v[24:27]
  ds_read_b64_tr_b16 a[30:31], v235 offset:16896
  v_mfma_f32_16x16x32_bf16 v[20:23], a[8:11], a[60:63], 0
  ds_read_b64_tr_b16 a[32:33], v232 offset:3072
  v_mfma_f32_16x16x32_bf16 v[20:23], a[12:15], a[76:79], v[20:23]
  ds_read_b64_tr_b16 a[34:35], v232 offset:3584
  s_add_u32 m0, s23, 0xf400
  v_mfma_f32_16x16x32_bf16 v[16:19], a[12:15], a[72:75], 0
  ds_read_b64_tr_b16 a[36:37], v232 offset:17408
  buffer_load_dwordx4 v230, s[8:11], s21 offen offset:0 lds
  v_mfma_f32_16x16x32_bf16 v[16:19], a[8:11], a[56:59], v[16:19]
  ds_read_b64_tr_b16 a[38:39], v232 offset:17920
  s_waitcnt lgkmcnt(8)
  v_mfma_f32_16x16x32_bf16 v[32:35], a[16:19], a[56:59], 0
  ds_read_b64_tr_b16 a[40:41], v233 offset:3072
  v_mfma_f32_16x16x32_bf16 v[32:35], a[20:23], a[72:75], v[32:35]
  ds_read_b64_tr_b16 a[42:43], v233 offset:3584
  s_add_u32 m0, s23, 0xf780
  v_mfma_f32_16x16x32_bf16 v[36:39], a[20:23], a[76:79], 0
  ds_read_b64_tr_b16 a[44:45], v233 offset:17408
  buffer_load_dwordx4 v230, s[8:11], s21 offen offset:128 lds
  v_mfma_f32_16x16x32_bf16 v[36:39], a[16:19], a[60:63], v[36:39]
  ds_read_b64_tr_b16 a[46:47], v233 offset:17920
  v_mfma_f32_16x16x32_bf16 v[40:43], a[16:19], a[64:67], 0
  ds_read_b64_tr_b16 a[48:49], v234 offset:3072
  v_mfma_f32_16x16x32_bf16 v[40:43], a[20:23], a[80:83], v[40:43]
  ds_read_b64_tr_b16 a[50:51], v234 offset:3584
  s_add_u32 m0, s23, 0xfb00
  v_mfma_f32_16x16x32_bf16 v[44:47], a[20:23], a[84:87], 0
  ds_read_b64_tr_b16 a[52:53], v234 offset:17408
  buffer_load_dwordx4 v230, s[8:11], s21 offen offset:256 lds
  v_mfma_f32_16x16x32_bf16 v[44:47], a[16:19], a[68:71], v[44:47]
  ds_read_b64_tr_b16 a[54:55], v234 offset:17920
  s_waitcnt lgkmcnt(8)
  v_mfma_f32_16x16x32_bf16 v[60:63], a[24:27], a[68:71], 0
  ds_read_b64_tr_b16 a[0:1], v235 offset:3072
  v_mfma_f32_16x16x32_bf16 v[60:63], a[28:31], a[84:87], v[60:63]
  ds_read_b64_tr_b16 a[2:3], v235 offset:3584
  s_add_u32 m0, s23, 0x10000
  v_mfma_f32_16x16x32_bf16 v[56:59], a[28:31], a[80:83], 0
  ds_read_b64_tr_b16 a[4:5], v235 offset:17408
  buffer_load_dwordx4 v231, s[8:11], s21 offen lds
  v_mfma_f32_16x16x32_bf16 v[56:59], a[24:27], a[64:67], v[56:59]
  ds_read_b64_tr_b16 a[6:7], v235 offset:17920
  v_mfma_f32_16x16x32_bf16 v[52:55], a[24:27], a[60:63], 0
  ds_read_b64_tr_b16 a[8:9], v232 offset:4096
  v_mfma_f32_16x16x32_bf16 v[52:55], a[28:31], a[76:79], v[52:55]
  ds_read_b64_tr_b16 a[10:11], v232 offset:4608
  s_add_u32 m0, s24, 0x700
  v_mfma_f32_16x16x32_bf16 v[48:51], a[28:31], a[72:75], 0
  ds_read_b64_tr_b16 a[12:13], v232 offset:18432
  buffer_load_dwordx4 v224, s[4:7], s62 offen offset:256 lds
  v_mfma_f32_16x16x32_bf16 v[48:51], a[24:27], a[56:59], v[48:51]
  ds_read_b64_tr_b16 a[14:15], v232 offset:18944
  v_mfma_f32_16x16x32_bf16 v[64:67], a[32:35], a[56:59], 0
  ds_read_b64_tr_b16 a[16:17], v233 offset:4096
  v_mfma_f32_16x16x32_bf16 v[64:67], a[36:39], a[72:75], v[64:67]
  ds_read_b64_tr_b16 a[18:19], v233 offset:4608
  v_mfma_f32_16x16x32_bf16 v[68:71], a[36:39], a[76:79], 0
  ds_read_b64_tr_b16 a[20:21], v233 offset:18432
  s_add_u32 m0, s24, 0xb00
  v_mfma_f32_16x16x32_bf16 v[68:71], a[32:35], a[60:63], v[68:71]
  ds_read_b64_tr_b16 a[22:23], v233 offset:18944
  buffer_load_dwordx4 v225, s[4:7], s62 offen offset:256 lds
  v_mfma_f32_16x16x32_bf16 v[72:75], a[32:35], a[64:67], 0
  ds_read_b64_tr_b16 a[24:25], v234 offset:4096
  v_mfma_f32_16x16x32_bf16 v[72:75], a[36:39], a[80:83], v[72:75]
  ds_read_b64_tr_b16 a[26:27], v234 offset:4608
  v_mfma_f32_16x16x32_bf16 v[76:79], a[36:39], a[84:87], 0
  ds_read_b64_tr_b16 a[28:29], v234 offset:18432
  s_add_u32 m0, s24, 0xf00
  v_mfma_f32_16x16x32_bf16 v[76:79], a[32:35], a[68:71], v[76:79]
  ds_read_b64_tr_b16 a[30:31], v234 offset:18944
  buffer_load_dwordx4 v224, s[4:7], s63 offen offset:256 lds
  s_waitcnt lgkmcnt(8)
  v_mfma_f32_16x16x32_bf16 v[92:95], a[40:43], a[68:71], 0
  ds_read_b64_tr_b16 a[32:33], v235 offset:4096
  v_mfma_f32_16x16x32_bf16 v[92:95], a[44:47], a[84:87], v[92:95]
  ds_read_b64_tr_b16 a[34:35], v235 offset:4608
  v_mfma_f32_16x16x32_bf16 v[88:91], a[44:47], a[80:83], 0
  ds_read_b64_tr_b16 a[36:37], v235 offset:18432
  s_add_u32 m0, s24, 0x1300
  v_mfma_f32_16x16x32_bf16 v[88:91], a[40:43], a[64:67], v[88:91]
  ds_read_b64_tr_b16 a[38:39], v235 offset:18944
  buffer_load_dwordx4 v225, s[4:7], s63 offen offset:256 lds
  v_mfma_f32_16x16x32_bf16 v[84:87], a[40:43], a[60:63], 0
  v_mfma_f32_16x16x32_bf16 v[84:87], a[44:47], a[76:79], v[84:87]
  v_mfma_f32_16x16x32_bf16 v[80:83], a[44:47], a[72:75], 0
  s_add_u32 m0, s24, 0x1700
  v_mfma_f32_16x16x32_bf16 v[80:83], a[40:43], a[56:59], v[80:83]
  ds_read_b64_tr_b16 a[40:41], v240 offset:2048
  buffer_load_dwordx4 v224, s[4:7], s64 offen offset:256 lds
  v_mfma_f32_16x16x32_bf16 v[96:99], a[48:51], a[56:59], 0
  ds_read_b64_tr_b16 a[42:43], v240 offset:2304
  v_mfma_f32_16x16x32_bf16 v[96:99], a[52:55], a[72:75], v[96:99]
  ds_read_b64_tr_b16 a[44:45], v240 offset:16384
  v_mfma_f32_16x16x32_bf16 v[100:103], a[52:55], a[76:79], 0
  ds_read_b64_tr_b16 a[46:47], v240 offset:16640
  s_add_u32 m0, s24, 0x1b00
  v_mfma_f32_16x16x32_bf16 v[100:103], a[48:51], a[60:63], v[100:103]
  buffer_load_dwordx4 v225, s[4:7], s64 offen offset:256 lds
  v_mfma_f32_16x16x32_bf16 v[104:107], a[48:51], a[64:67], 0
  v_mfma_f32_16x16x32_bf16 v[104:107], a[52:55], a[80:83], v[104:107]
  v_mfma_f32_16x16x32_bf16 v[108:111], a[52:55], a[84:87], 0
  s_add_u32 m0, s24, 0x1f00
  v_mfma_f32_16x16x32_bf16 v[108:111], a[48:51], a[68:71], v[108:111]
  ds_read_b64_tr_b16 a[48:49], v241 offset:2048
  buffer_load_dwordx4 v224, s[4:7], s65 offen offset:256 lds
  v_mfma_f32_16x16x32_bf16 v[124:127], a[0:3], a[68:71], 0
  ds_read_b64_tr_b16 a[50:51], v241 offset:2304
  v_mfma_f32_16x16x32_bf16 v[124:127], a[4:7], a[84:87], v[124:127]
  ds_read_b64_tr_b16 a[52:53], v241 offset:16384
  v_mfma_f32_16x16x32_bf16 v[120:123], a[4:7], a[80:83], 0
  ds_read_b64_tr_b16 a[54:55], v241 offset:16640
  s_add_u32 m0, s24, 0x2300
  v_mfma_f32_16x16x32_bf16 v[120:123], a[0:3], a[64:67], v[120:123]
  buffer_load_dwordx4 v225, s[4:7], s65 offen offset:256 lds
  s_add_u32 s21, s21, 0x70000
  v_mfma_f32_16x16x32_bf16 v[116:119], a[0:3], a[60:63], 0
  v_mfma_f32_16x16x32_bf16 v[116:119], a[4:7], a[76:79], v[116:119]
  v_mfma_f32_16x16x32_bf16 v[112:115], a[4:7], a[72:75], 0
  v_mfma_f32_16x16x32_bf16 v[112:115], a[0:3], a[56:59], v[112:115]
  s_waitcnt lgkmcnt(0) vmcnt(24)
  s_barrier
  ds_read_b64_tr_b16 a[0:1], v232 offset:30720
  v_mfma_f32_16x16x32_bf16 v[128:131], a[8:11], a[56:59], 0
  s_nop 0
  v_mfma_f32_16x16x32_bf16 v[128:131], a[12:15], a[72:75], v[128:131]
  ds_read_b64_tr_b16 a[2:3], v232 offset:31232
  v_mfma_f32_16x16x32_bf16 v[132:135], a[12:15], a[76:79], 0
  buffer_load_dwordx4 a[228:231], v228, s[4:7], s67 offen offset:0
  v_mfma_f32_16x16x32_bf16 v[132:135], a[8:11], a[60:63], v[132:135]
  ds_read_b64_tr_b16 a[4:5], v232 offset:45056
  v_mfma_f32_16x16x32_bf16 v[136:139], a[8:11], a[64:67], 0
  s_nop 0
  v_mfma_f32_16x16x32_bf16 v[136:139], a[12:15], a[80:83], v[136:139]
  ds_read_b64_tr_b16 a[6:7], v232 offset:45568
  v_mfma_f32_16x16x32_bf16 v[140:143], a[12:15], a[84:87], 0
  buffer_load_dwordx4 a[232:235], v228, s[4:7], s67 offen offset:1024
  v_mfma_f32_16x16x32_bf16 v[140:143], a[8:11], a[68:71], v[140:143]
  ds_read_b64_tr_b16 a[8:9], v233 offset:30720
  v_mfma_f32_16x16x32_bf16 v[156:159], a[16:19], a[68:71], 0
  s_nop 0
  v_mfma_f32_16x16x32_bf16 v[156:159], a[20:23], a[84:87], v[156:159]
  ds_read_b64_tr_b16 a[10:11], v233 offset:31232
  v_mfma_f32_16x16x32_bf16 v[152:155], a[20:23], a[80:83], 0
  buffer_load_dwordx4 a[236:239], v228, s[4:7], s67 offen offset:2048
  v_mfma_f32_16x16x32_bf16 v[152:155], a[16:19], a[64:67], v[152:155]
  ds_read_b64_tr_b16 a[12:13], v233 offset:45056
  v_mfma_f32_16x16x32_bf16 v[148:151], a[16:19], a[60:63], 0
  v_mfma_f32_16x16x32_bf16 v[148:151], a[20:23], a[76:79], v[148:151]
  ds_read_b64_tr_b16 a[14:15], v233 offset:45568
  s_nop 0
  v_mfma_f32_16x16x32_bf16 v[144:147], a[20:23], a[72:75], 0
  buffer_load_dwordx4 a[240:243], v228, s[4:7], s67 offen offset:3072
  v_mfma_f32_16x16x32_bf16 v[144:147], a[16:19], a[56:59], v[144:147]
  ds_read_b64_tr_b16 a[16:17], v234 offset:30720
  v_mfma_f32_16x16x32_bf16 v[160:163], a[24:27], a[56:59], 0
  v_mfma_f32_16x16x32_bf16 v[160:163], a[28:31], a[72:75], v[160:163]
  ds_read_b64_tr_b16 a[18:19], v234 offset:31232
  s_add_u32 m0, s23, 0x800
  v_mfma_f32_16x16x32_bf16 v[164:167], a[28:31], a[76:79], 0
  buffer_load_dwordx4 v229, s[8:11], s21 offen offset:0 lds
  v_mfma_f32_16x16x32_bf16 v[164:167], a[24:27], a[60:63], v[164:167]
  ds_read_b64_tr_b16 a[20:21], v234 offset:45056
  v_mfma_f32_16x16x32_bf16 v[168:171], a[24:27], a[64:67], 0
  s_waitcnt vmcnt(27)
  ds_read_b128 a[88:91], v226 offset:8192
  v_mfma_f32_16x16x32_bf16 v[168:171], a[28:31], a[80:83], v[168:171]
  ds_read_b64_tr_b16 a[22:23], v234 offset:45568
  s_add_u32 m0, s23, 0xb80
  v_mfma_f32_16x16x32_bf16 v[172:175], a[28:31], a[84:87], 0
  ds_read_b128 a[104:107], v227 offset:8192
  v_mfma_f32_16x16x32_bf16 v[172:175], a[24:27], a[68:71], v[172:175]
  ds_read_b64_tr_b16 a[24:25], v235 offset:30720
  v_mfma_f32_16x16x32_bf16 v[188:191], a[32:35], a[68:71], 0
  buffer_load_dwordx4 v229, s[8:11], s21 offen offset:128 lds
  v_mfma_f32_16x16x32_bf16 v[188:191], a[36:39], a[84:87], v[188:191]
  ds_read_b64_tr_b16 a[26:27], v235 offset:31232
  v_mfma_f32_16x16x32_bf16 v[184:187], a[36:39], a[80:83], 0
  s_waitcnt vmcnt(26)
  ds_read_b128 a[92:95], v226 offset:10240
  s_add_u32 m0, s23, 0xf00
  v_mfma_f32_16x16x32_bf16 v[184:187], a[32:35], a[64:67], v[184:187]
  ds_read_b64_tr_b16 a[28:29], v235 offset:45056
  v_mfma_f32_16x16x32_bf16 v[180:183], a[32:35], a[60:63], 0
  ds_read_b128 a[108:111], v227 offset:10240
  v_mfma_f32_16x16x32_bf16 v[180:183], a[36:39], a[76:79], v[180:183]
  ds_read_b64_tr_b16 a[30:31], v235 offset:45568
  v_mfma_f32_16x16x32_bf16 v[176:179], a[36:39], a[72:75], 0
  s_waitcnt vmcnt(24)
  ds_read_b128 a[96:99], v226 offset:12288
  v_mfma_f32_16x16x32_bf16 v[176:179], a[32:35], a[56:59], v[176:179]
  ds_read_b64_tr_b16 a[32:33], v232 offset:31744
  v_mfma_f32_16x16x32_bf16 v[192:195], a[40:43], a[56:59], 0
  ds_read_b128 a[112:115], v227 offset:12288
  v_mfma_f32_16x16x32_bf16 v[192:195], a[44:47], a[72:75], v[192:195]
  ds_read_b64_tr_b16 a[34:35], v232 offset:32256
  v_mfma_f32_16x16x32_bf16 v[196:199], a[44:47], a[76:79], 0
  buffer_load_dwordx4 v229, s[8:11], s21 offen offset:256 lds
  s_add_u32 m0, s23, 0x1400
  v_mfma_f32_16x16x32_bf16 v[196:199], a[40:43], a[60:63], v[196:199]
  ds_read_b64_tr_b16 a[36:37], v232 offset:46080
  v_mfma_f32_16x16x32_bf16 v[200:203], a[40:43], a[64:67], 0
  s_waitcnt vmcnt(23)
  ds_read_b128 a[100:103], v226 offset:14336
  v_mfma_f32_16x16x32_bf16 v[200:203], a[44:47], a[80:83], v[200:203]
  ds_read_b64_tr_b16 a[38:39], v232 offset:46592
  v_mfma_f32_16x16x32_bf16 v[204:207], a[44:47], a[84:87], 0
  ds_read_b128 a[116:119], v227 offset:14336
  v_mfma_f32_16x16x32_bf16 v[204:207], a[40:43], a[68:71], v[204:207]
  ds_read_b64_tr_b16 a[40:41], v233 offset:31744
  v_mfma_f32_16x16x32_bf16 v[220:223], a[48:51], a[68:71], 0
  buffer_load_dwordx4 v230, s[8:11], s21 offen offset:0 lds
  s_add_u32 m0, s23, 0x1780
  v_mfma_f32_16x16x32_bf16 v[220:223], a[52:55], a[84:87], v[220:223]
  ds_read_b64_tr_b16 a[42:43], v233 offset:32256
  v_mfma_f32_16x16x32_bf16 v[216:219], a[52:55], a[80:83], 0
  buffer_load_dwordx4 v230, s[8:11], s21 offen offset:128 lds
  s_add_u32 m0, s23, 0x1b00
  v_mfma_f32_16x16x32_bf16 v[216:219], a[48:51], a[64:67], v[216:219]
  ds_read_b64_tr_b16 a[44:45], v233 offset:46080
  v_mfma_f32_16x16x32_bf16 v[212:215], a[48:51], a[60:63], 0
  buffer_load_dwordx4 v230, s[8:11], s21 offen offset:256 lds
  s_add_u32 m0, s23, 0x2000
  v_mfma_f32_16x16x32_bf16 v[212:215], a[52:55], a[76:79], v[212:215]
  ds_read_b64_tr_b16 a[46:47], v233 offset:46592
  v_mfma_f32_16x16x32_bf16 v[208:211], a[52:55], a[72:75], 0
  buffer_load_dwordx4 v231, s[8:11], s21 offen lds
  s_add_u32 s21, s21, 0x70000
  v_mfma_f32_16x16x32_bf16 v[208:211], a[48:51], a[56:59], v[208:211]
  ds_read_b64_tr_b16 a[48:49], v234 offset:31744
  s_waitcnt lgkmcnt(8)
  v_mfma_f32_16x16x32_bf16 v[0:3], a[0:3], a[88:91], v[0:3]
  s_add_u32 m0, s24, 0x2680
  v_mfma_f32_16x16x32_bf16 v[0:3], a[4:7], a[104:107], v[0:3]
  ds_read_b64_tr_b16 a[50:51], v234 offset:32256
  v_mfma_f32_16x16x32_bf16 v[4:7], a[4:7], a[108:111], v[4:7]
  buffer_load_dwordx4 v224, s[4:7], s62 offen offset:384 lds
  v_mfma_f32_16x16x32_bf16 v[4:7], a[0:3], a[92:95], v[4:7]
  ds_read_b64_tr_b16 a[52:53], v234 offset:46080
  v_mfma_f32_16x16x32_bf16 v[8:11], a[0:3], a[96:99], v[8:11]
  v_mfma_f32_16x16x32_bf16 v[8:11], a[4:7], a[112:115], v[8:11]
  ds_read_b64_tr_b16 a[54:55], v234 offset:46592
  s_waitcnt lgkmcnt(8)
  v_mfma_f32_16x16x32_bf16 v[12:15], a[4:7], a[116:119], v[12:15]
  v_mfma_f32_16x16x32_bf16 v[12:15], a[0:3], a[100:103], v[12:15]
  ds_read_b64_tr_b16 a[0:1], v235 offset:31744
  s_add_u32 m0, s24, 0x2a80
  v_mfma_f32_16x16x32_bf16 v[28:31], a[8:11], a[100:103], v[28:31]
  buffer_load_dwordx4 v225, s[4:7], s62 offen offset:384 lds
  v_mfma_f32_16x16x32_bf16 v[28:31], a[12:15], a[116:119], v[28:31]
  ds_read_b64_tr_b16 a[2:3], v235 offset:32256
  v_mfma_f32_16x16x32_bf16 v[24:27], a[12:15], a[112:115], v[24:27]
  v_mfma_f32_16x16x32_bf16 v[24:27], a[8:11], a[96:99], v[24:27]
  ds_read_b64_tr_b16 a[4:5], v235 offset:46080
  v_mfma_f32_16x16x32_bf16 v[20:23], a[8:11], a[92:95], v[20:23]
  v_mfma_f32_16x16x32_bf16 v[20:23], a[12:15], a[108:111], v[20:23]
  ds_read_b64_tr_b16 a[6:7], v235 offset:46592
  v_mfma_f32_16x16x32_bf16 v[16:19], a[12:15], a[104:107], v[16:19]
  v_mfma_f32_16x16x32_bf16 v[16:19], a[8:11], a[88:91], v[16:19]
  ds_read_b64_tr_b16 a[8:9], v232 offset:32768
  s_add_u32 m0, s24, 0x2e80
  v_mfma_f32_16x16x32_bf16 v[32:35], a[16:19], a[88:91], v[32:35]
  buffer_load_dwordx4 v224, s[4:7], s63 offen offset:384 lds
  v_mfma_f32_16x16x32_bf16 v[32:35], a[20:23], a[104:107], v[32:35]
  ds_read_b64_tr_b16 a[10:11], v232 offset:33280
  v_mfma_f32_16x16x32_bf16 v[36:39], a[20:23], a[108:111], v[36:39]
  v_mfma_f32_16x16x32_bf16 v[36:39], a[16:19], a[92:95], v[36:39]
  ds_read_b64_tr_b16 a[12:13], v232 offset:47104
  v_mfma_f32_16x16x32_bf16 v[40:43], a[16:19], a[96:99], v[40:43]
  v_mfma_f32_16x16x32_bf16 v[40:43], a[20:23], a[112:115], v[40:43]
  ds_read_b64_tr_b16 a[14:15], v232 offset:47616
  v_mfma_f32_16x16x32_bf16 v[44:47], a[20:23], a[116:119], v[44:47]
  v_mfma_f32_16x16x32_bf16 v[44:47], a[16:19], a[100:103], v[44:47]
  ds_read_b64_tr_b16 a[16:17], v233 offset:32768
  s_add_u32 m0, s24, 0x3280
  v_mfma_f32_16x16x32_bf16 v[60:63], a[24:27], a[100:103], v[60:63]
  buffer_load_dwordx4 v225, s[4:7], s63 offen offset:384 lds
  v_mfma_f32_16x16x32_bf16 v[60:63], a[28:31], a[116:119], v[60:63]
  ds_read_b64_tr_b16 a[18:19], v233 offset:33280
  v_mfma_f32_16x16x32_bf16 v[56:59], a[28:31], a[112:115], v[56:59]
  v_mfma_f32_16x16x32_bf16 v[56:59], a[24:27], a[96:99], v[56:59]
  ds_read_b64_tr_b16 a[20:21], v233 offset:47104
  v_mfma_f32_16x16x32_bf16 v[52:55], a[24:27], a[92:95], v[52:55]
  v_mfma_f32_16x16x32_bf16 v[52:55], a[28:31], a[108:111], v[52:55]
  ds_read_b64_tr_b16 a[22:23], v233 offset:47616
  v_mfma_f32_16x16x32_bf16 v[48:51], a[28:31], a[104:107], v[48:51]
  v_mfma_f32_16x16x32_bf16 v[48:51], a[24:27], a[88:91], v[48:51]
  ds_read_b64_tr_b16 a[24:25], v234 offset:32768
  s_add_u32 m0, s24, 0x3680
  v_mfma_f32_16x16x32_bf16 v[64:67], a[32:35], a[88:91], v[64:67]
  buffer_load_dwordx4 v224, s[4:7], s64 offen offset:384 lds
  v_mfma_f32_16x16x32_bf16 v[64:67], a[36:39], a[104:107], v[64:67]
  ds_read_b64_tr_b16 a[26:27], v234 offset:33280
  v_mfma_f32_16x16x32_bf16 v[68:71], a[36:39], a[108:111], v[68:71]
  v_mfma_f32_16x16x32_bf16 v[68:71], a[32:35], a[92:95], v[68:71]
  ds_read_b64_tr_b16 a[28:29], v234 offset:47104
  v_mfma_f32_16x16x32_bf16 v[72:75], a[32:35], a[96:99], v[72:75]
  v_mfma_f32_16x16x32_bf16 v[72:75], a[36:39], a[112:115], v[72:75]
  ds_read_b64_tr_b16 a[30:31], v234 offset:47616
  v_mfma_f32_16x16x32_bf16 v[76:79], a[36:39], a[116:119], v[76:79]
  v_mfma_f32_16x16x32_bf16 v[76:79], a[32:35], a[100:103], v[76:79]
  ds_read_b64_tr_b16 a[32:33], v235 offset:32768
  s_add_u32 m0, s24, 0x3a80
  s_waitcnt lgkmcnt(8)
  v_mfma_f32_16x16x32_bf16 v[92:95], a[40:43], a[100:103], v[92:95]
  buffer_load_dwordx4 v225, s[4:7], s64 offen offset:384 lds
  v_mfma_f32_16x16x32_bf16 v[92:95], a[44:47], a[116:119], v[92:95]
  ds_read_b64_tr_b16 a[34:35], v235 offset:33280
  v_mfma_f32_16x16x32_bf16 v[88:91], a[44:47], a[112:115], v[88:91]
  v_mfma_f32_16x16x32_bf16 v[88:91], a[40:43], a[96:99], v[88:91]
  ds_read_b64_tr_b16 a[36:37], v235 offset:47104
  v_mfma_f32_16x16x32_bf16 v[84:87], a[40:43], a[92:95], v[84:87]
  v_mfma_f32_16x16x32_bf16 v[84:87], a[44:47], a[108:111], v[84:87]
  ds_read_b64_tr_b16 a[38:39], v235 offset:47616
  v_mfma_f32_16x16x32_bf16 v[80:83], a[44:47], a[104:107], v[80:83]
  v_mfma_f32_16x16x32_bf16 v[80:83], a[40:43], a[88:91], v[80:83]
  ds_read_b64_tr_b16 a[40:41], v240 offset:30720
  s_add_u32 m0, s24, 0x3e80
  v_mfma_f32_16x16x32_bf16 v[96:99], a[48:51], a[88:91], v[96:99]
  buffer_load_dwordx4 v224, s[4:7], s65 offen offset:384 lds
  v_mfma_f32_16x16x32_bf16 v[96:99], a[52:55], a[104:107], v[96:99]
  ds_read_b64_tr_b16 a[42:43], v240 offset:30976
  v_mfma_f32_16x16x32_bf16 v[100:103], a[52:55], a[108:111], v[100:103]
  v_mfma_f32_16x16x32_bf16 v[100:103], a[48:51], a[92:95], v[100:103]
  ds_read_b64_tr_b16 a[44:45], v240 offset:45056
  v_mfma_f32_16x16x32_bf16 v[104:107], a[48:51], a[96:99], v[104:107]
  v_mfma_f32_16x16x32_bf16 v[104:107], a[52:55], a[112:115], v[104:107]
  ds_read_b64_tr_b16 a[46:47], v240 offset:45312
  v_mfma_f32_16x16x32_bf16 v[108:111], a[52:55], a[116:119], v[108:111]
  v_mfma_f32_16x16x32_bf16 v[108:111], a[48:51], a[100:103], v[108:111]
  ds_read_b64_tr_b16 a[48:49], v241 offset:30720
  s_add_u32 m0, s24, 0x4280
  v_mfma_f32_16x16x32_bf16 v[124:127], a[0:3], a[100:103], v[124:127]
  ds_read_b64_tr_b16 a[50:51], v241 offset:30976
  v_mfma_f32_16x16x32_bf16 v[124:127], a[4:7], a[116:119], v[124:127]
  ds_read_b64_tr_b16 a[52:53], v241 offset:45056
  v_mfma_f32_16x16x32_bf16 v[120:123], a[4:7], a[112:115], v[120:123]
  ds_read_b64_tr_b16 a[54:55], v241 offset:45312
  v_mfma_f32_16x16x32_bf16 v[120:123], a[0:3], a[96:99], v[120:123]
  s_waitcnt vmcnt(24)
  ds_read_b128 a[56:59], v226 offset:0
  v_mfma_f32_16x16x32_bf16 v[116:119], a[0:3], a[92:95], v[116:119]
  ds_read_b128 a[72:75], v227 offset:0
  v_mfma_f32_16x16x32_bf16 v[116:119], a[4:7], a[108:111], v[116:119]
  buffer_load_dwordx4 v225, s[4:7], s65 offen offset:384 lds
  v_mfma_f32_16x16x32_bf16 v[112:115], a[4:7], a[104:107], v[112:115]
  s_waitcnt vmcnt(23)
  ds_read_b128 a[60:63], v226 offset:2048
  v_mfma_f32_16x16x32_bf16 v[112:115], a[0:3], a[88:91], v[112:115]
  s_waitcnt lgkmcnt(0)
  s_barrier
  ds_read_b64_tr_b16 a[0:1], v236 offset:2048
  v_mfma_f32_16x16x32_bf16 v[128:131], a[8:11], a[88:91], v[128:131]
  ds_read_b128 a[76:79], v227 offset:2048
  s_add_u32 m0, s23, 0x7800
  v_mfma_f32_16x16x32_bf16 v[128:131], a[12:15], a[104:107], v[128:131]
  ds_read_b64_tr_b16 a[2:3], v236 offset:2560
  v_mfma_f32_16x16x32_bf16 v[132:135], a[12:15], a[108:111], v[132:135]
  buffer_load_dwordx4 v229, s[8:11], s21 offen offset:0 lds
  v_mfma_f32_16x16x32_bf16 v[132:135], a[8:11], a[92:95], v[132:135]
  ds_read_b64_tr_b16 a[4:5], v236 offset:16384
  s_add_u32 m0, s23, 0x7b80
  v_mfma_f32_16x16x32_bf16 v[136:139], a[8:11], a[96:99], v[136:139]
  buffer_load_dwordx4 v229, s[8:11], s21 offen offset:128 lds
  v_mfma_f32_16x16x32_bf16 v[136:139], a[12:15], a[112:115], v[136:139]
  ds_read_b64_tr_b16 a[6:7], v236 offset:16896
  v_mfma_f32_16x16x32_bf16 v[140:143], a[12:15], a[116:119], v[140:143]
  s_waitcnt vmcnt(23)
  ds_read_b128 a[64:67], v226 offset:4096
  s_add_u32 m0, s23, 0x7f00
  v_mfma_f32_16x16x32_bf16 v[140:143], a[8:11], a[100:103], v[140:143]
  ds_read_b64_tr_b16 a[8:9], v237 offset:2048
  v_mfma_f32_16x16x32_bf16 v[156:159], a[16:19], a[100:103], v[156:159]
  ds_read_b128 a[80:83], v227 offset:4096
  v_mfma_f32_16x16x32_bf16 v[156:159], a[20:23], a[116:119], v[156:159]
  ds_read_b64_tr_b16 a[10:11], v237 offset:2560
  v_mfma_f32_16x16x32_bf16 v[152:155], a[20:23], a[112:115], v[152:155]
  buffer_load_dwordx4 v229, s[8:11], s21 offen offset:256 lds
  s_add_u32 m0, s23, 0x8400
  v_mfma_f32_16x16x32_bf16 v[152:155], a[16:19], a[96:99], v[152:155]
  ds_read_b64_tr_b16 a[12:13], v237 offset:16384
  v_mfma_f32_16x16x32_bf16 v[148:151], a[16:19], a[92:95], v[148:151]
  s_waitcnt vmcnt(22)
  ds_read_b128 a[68:71], v226 offset:6144
  v_mfma_f32_16x16x32_bf16 v[148:151], a[20:23], a[108:111], v[148:151]
  ds_read_b64_tr_b16 a[14:15], v237 offset:16896
  v_mfma_f32_16x16x32_bf16 v[144:147], a[20:23], a[104:107], v[144:147]
  ds_read_b128 a[84:87], v227 offset:6144
  v_mfma_f32_16x16x32_bf16 v[144:147], a[16:19], a[88:91], v[144:147]
  ds_read_b64_tr_b16 a[16:17], v238 offset:2048
  v_mfma_f32_16x16x32_bf16 v[160:163], a[24:27], a[88:91], v[160:163]
  buffer_load_dwordx4 v230, s[8:11], s21 offen offset:0 lds
  s_add_u32 m0, s23, 0x8780
  v_mfma_f32_16x16x32_bf16 v[160:163], a[28:31], a[104:107], v[160:163]
  ds_read_b64_tr_b16 a[18:19], v238 offset:2560
  v_mfma_f32_16x16x32_bf16 v[164:167], a[28:31], a[108:111], v[164:167]
  buffer_load_dwordx4 v230, s[8:11], s21 offen offset:128 lds
  s_add_u32 m0, s23, 0x8b00
  v_mfma_f32_16x16x32_bf16 v[164:167], a[24:27], a[92:95], v[164:167]
  ds_read_b64_tr_b16 a[20:21], v238 offset:16384
  v_mfma_f32_16x16x32_bf16 v[168:171], a[24:27], a[96:99], v[168:171]
  buffer_load_dwordx4 v230, s[8:11], s21 offen offset:256 lds
  s_add_u32 m0, s23, 0x9000
  v_mfma_f32_16x16x32_bf16 v[168:171], a[28:31], a[112:115], v[168:171]
  ds_read_b64_tr_b16 a[22:23], v238 offset:16896
  v_mfma_f32_16x16x32_bf16 v[172:175], a[28:31], a[116:119], v[172:175]
  buffer_load_dwordx4 v231, s[8:11], s21 offen lds
  v_mfma_f32_16x16x32_bf16 v[172:175], a[24:27], a[100:103], v[172:175]
  ds_read_b64_tr_b16 a[24:25], v239 offset:2048
  v_mfma_f32_16x16x32_bf16 v[188:191], a[32:35], a[100:103], v[188:191]
  s_add_u32 m0, s24, 0x600
  v_mfma_f32_16x16x32_bf16 v[188:191], a[36:39], a[116:119], v[188:191]
  ds_read_b64_tr_b16 a[26:27], v239 offset:2560
  v_mfma_f32_16x16x32_bf16 v[184:187], a[36:39], a[112:115], v[184:187]
  buffer_load_dwordx4 v224, s[4:7], s62 offen offset:512 lds
  v_mfma_f32_16x16x32_bf16 v[184:187], a[32:35], a[96:99], v[184:187]
  ds_read_b64_tr_b16 a[28:29], v239 offset:16384
  s_add_u32 m0, s24, 0xa00
  v_mfma_f32_16x16x32_bf16 v[180:183], a[32:35], a[92:95], v[180:183]
  buffer_load_dwordx4 v225, s[4:7], s62 offen offset:512 lds
  v_mfma_f32_16x16x32_bf16 v[180:183], a[36:39], a[108:111], v[180:183]
  ds_read_b64_tr_b16 a[30:31], v239 offset:16896
  v_mfma_f32_16x16x32_bf16 v[176:179], a[36:39], a[104:107], v[176:179]
  v_mfma_f32_16x16x32_bf16 v[176:179], a[32:35], a[88:91], v[176:179]
  ds_read_b64_tr_b16 a[32:33], v236 offset:3072
  s_add_u32 m0, s24, 0xe00
  v_mfma_f32_16x16x32_bf16 v[192:195], a[40:43], a[88:91], v[192:195]
  s_waitcnt lgkmcnt(8)
  buffer_load_dwordx4 v224, s[4:7], s63 offen offset:512 lds
  v_mfma_f32_16x16x32_bf16 v[192:195], a[44:47], a[104:107], v[192:195]
  ds_read_b64_tr_b16 a[34:35], v236 offset:3584
  v_mfma_f32_16x16x32_bf16 v[196:199], a[44:47], a[108:111], v[196:199]
  s_add_u32 m0, s24, 0x1200
  v_mfma_f32_16x16x32_bf16 v[196:199], a[40:43], a[92:95], v[196:199]
  ds_read_b64_tr_b16 a[36:37], v236 offset:17408
  v_mfma_f32_16x16x32_bf16 v[200:203], a[40:43], a[96:99], v[200:203]
  buffer_load_dwordx4 v225, s[4:7], s63 offen offset:512 lds
  v_mfma_f32_16x16x32_bf16 v[200:203], a[44:47], a[112:115], v[200:203]
  ds_read_b64_tr_b16 a[38:39], v236 offset:17920
  v_mfma_f32_16x16x32_bf16 v[204:207], a[44:47], a[116:119], v[204:207]
  s_add_u32 m0, s24, 0x1600
  v_mfma_f32_16x16x32_bf16 v[204:207], a[40:43], a[100:103], v[204:207]
  ds_read_b64_tr_b16 a[40:41], v237 offset:3072
  v_mfma_f32_16x16x32_bf16 v[220:223], a[48:51], a[100:103], v[220:223]
  buffer_load_dwordx4 v224, s[4:7], s64 offen offset:512 lds
  v_mfma_f32_16x16x32_bf16 v[220:223], a[52:55], a[116:119], v[220:223]
  ds_read_b64_tr_b16 a[42:43], v237 offset:3584
  s_add_u32 m0, s24, 0x1a00
  v_mfma_f32_16x16x32_bf16 v[216:219], a[52:55], a[112:115], v[216:219]
  buffer_load_dwordx4 v225, s[4:7], s64 offen offset:512 lds
  v_mfma_f32_16x16x32_bf16 v[216:219], a[48:51], a[96:99], v[216:219]
  ds_read_b64_tr_b16 a[44:45], v237 offset:17408
  v_mfma_f32_16x16x32_bf16 v[212:215], a[48:51], a[92:95], v[212:215]
  v_mfma_f32_16x16x32_bf16 v[212:215], a[52:55], a[108:111], v[212:215]
  ds_read_b64_tr_b16 a[46:47], v237 offset:17920
  s_add_u32 m0, s24, 0x1e00
  v_mfma_f32_16x16x32_bf16 v[208:211], a[52:55], a[104:107], v[208:211]
  buffer_load_dwordx4 v224, s[4:7], s65 offen offset:512 lds
  v_mfma_f32_16x16x32_bf16 v[208:211], a[48:51], a[88:91], v[208:211]
  ds_read_b64_tr_b16 a[48:49], v238 offset:3072
  v_mfma_f32_16x16x32_bf16 v[0:3], a[0:3], a[56:59], v[0:3]
  s_add_u32 m0, s24, 0x2200
  s_waitcnt vmcnt(29)
  v_mfma_f32_16x16x32_bf16 v[248:251], a[244:247], a[228:231], 0
  v_mfma_f32_16x16x32_bf16 v[0:3], a[4:7], a[72:75], v[0:3]
  ds_read_b64_tr_b16 a[50:51], v238 offset:3584
  v_mfma_f32_16x16x32_bf16 v[248:251], a[244:247], a[232:235], v[248:251]
  v_mfma_f32_16x16x32_bf16 v[4:7], a[4:7], a[76:79], v[4:7]
  buffer_load_dwordx4 v225, s[4:7], s65 offen offset:512 lds
  s_add_u32 s21, s21, 0x70000
  v_mfma_f32_16x16x32_bf16 v[4:7], a[0:3], a[60:63], v[4:7]
  ds_read_b64_tr_b16 a[52:53], v238 offset:17408
  v_mfma_f32_16x16x32_bf16 v[252:255], a[244:247], a[236:239], 0
  v_mfma_f32_16x16x32_bf16 v[8:11], a[0:3], a[64:67], v[8:11]
  v_mfma_f32_16x16x32_bf16 v[252:255], a[244:247], a[240:243], v[252:255]
  v_mfma_f32_16x16x32_bf16 v[8:11], a[4:7], a[80:83], v[8:11]
  ds_read_b64_tr_b16 a[54:55], v238 offset:17920
  v_mfma_f32_16x16x32_bf16 v[12:15], a[4:7], a[84:87], v[12:15]
  v_mfma_f32_16x16x32_bf16 v[12:15], a[0:3], a[68:71], v[12:15]
  ds_read_b64_tr_b16 a[0:1], v239 offset:3072
  v_mfma_f32_16x16x32_bf16 v[28:31], a[8:11], a[68:71], v[28:31]
  v_mfma_f32_16x16x32_bf16 v[28:31], a[12:15], a[84:87], v[28:31]
  ds_read_b64_tr_b16 a[2:3], v239 offset:3584
  v_mfma_f32_16x16x32_bf16 v[24:27], a[12:15], a[80:83], v[24:27]
  v_mfma_f32_16x16x32_bf16 v[24:27], a[8:11], a[64:67], v[24:27]
  ds_read_b64_tr_b16 a[4:5], v239 offset:17408
  v_mfma_f32_16x16x32_bf16 v[20:23], a[8:11], a[60:63], v[20:23]
  v_mfma_f32_16x16x32_bf16 v[20:23], a[12:15], a[76:79], v[20:23]
  ds_read_b64_tr_b16 a[6:7], v239 offset:17920
  v_add_f32_dpp v248, v248, v248 row_ror:8 row_mask:0xf bank_mask:0xf
  v_mfma_f32_16x16x32_bf16 v[16:19], a[12:15], a[72:75], v[16:19]
  v_add_f32_dpp v252, v252, v252 row_ror:8 row_mask:0xf bank_mask:0xf
  v_mfma_f32_16x16x32_bf16 v[16:19], a[8:11], a[56:59], v[16:19]
  ds_read_b64_tr_b16 a[8:9], v236 offset:4096
  v_add_f32_dpp v248, v248, v248 row_ror:4 row_mask:0xf bank_mask:0xf
  s_waitcnt lgkmcnt(8)
  v_mfma_f32_16x16x32_bf16 v[32:35], a[16:19], a[56:59], v[32:35]
  v_add_f32_dpp v252, v252, v252 row_ror:4 row_mask:0xf bank_mask:0xf
  v_mfma_f32_16x16x32_bf16 v[32:35], a[20:23], a[72:75], v[32:35]
  ds_read_b64_tr_b16 a[10:11], v236 offset:4608
  v_add_f32_dpp v248, v248, v248 row_ror:2 row_mask:0xf bank_mask:0xf
  v_mfma_f32_16x16x32_bf16 v[36:39], a[20:23], a[76:79], v[36:39]
  v_add_f32_dpp v252, v252, v252 row_ror:2 row_mask:0xf bank_mask:0xf
  v_mfma_f32_16x16x32_bf16 v[36:39], a[16:19], a[60:63], v[36:39]
  ds_read_b64_tr_b16 a[12:13], v236 offset:18432
  v_add_f32_dpp v248, v248, v248 row_ror:1 row_mask:0xf bank_mask:0xf
  v_mfma_f32_16x16x32_bf16 v[40:43], a[16:19], a[64:67], v[40:43]
  v_add_f32_dpp v252, v252, v252 row_ror:1 row_mask:0xf bank_mask:0xf
  v_mfma_f32_16x16x32_bf16 v[40:43], a[20:23], a[80:83], v[40:43]
  ds_read_b64_tr_b16 a[14:15], v236 offset:18944
  v_mul_f32 v248, 0x3a800000, v248
  v_mfma_f32_16x16x32_bf16 v[44:47], a[20:23], a[84:87], v[44:47]
  v_mul_f32 v252, 0x3a800000, v252
  v_mov_b32 v249, 0
  v_mfma_f32_16x16x32_bf16 v[44:47], a[16:19], a[68:71], v[44:47]
  ds_read_b64_tr_b16 a[16:17], v237 offset:4096
  v_mov_b32 v253, 0
  v_mfma_f32_16x16x32_bf16 v[60:63], a[24:27], a[68:71], v[60:63]
  s_waitcnt vmcnt(21)
  ds_read_b128 a[88:91], v226 offset:8192
  v_accvgpr_read_b32 v250, a228
  v_mfma_f32_16x16x32_bf16 v[60:63], a[28:31], a[84:87], v[60:63]
  ds_read_b64_tr_b16 a[18:19], v237 offset:4608
  v_and_b32 v251, s54, v250
  v_mfma_f32_16x16x32_bf16 v[56:59], a[28:31], a[80:83], v[56:59]
  ds_read_b128 a[104:107], v227 offset:8192
  v_lshlrev_b32 v250, 16, v250
  v_mfma_f32_16x16x32_bf16 v[56:59], a[24:27], a[64:67], v[56:59]
  ds_read_b64_tr_b16 a[20:21], v237 offset:18432
  v_sub_f32 v251, v251, v248
  v_mfma_f32_16x16x32_bf16 v[52:55], a[24:27], a[60:63], v[52:55]
  v_sub_f32 v250, v250, v248
  v_fmac_f32 v249, v251, v251
  v_mfma_f32_16x16x32_bf16 v[52:55], a[28:31], a[76:79], v[52:55]
  ds_read_b64_tr_b16 a[22:23], v237 offset:18944
  v_fmac_f32 v249, v250, v250
  v_mfma_f32_16x16x32_bf16 v[48:51], a[28:31], a[72:75], v[48:51]
  v_accvgpr_read_b32 v254, a236
  v_and_b32 v255, s54, v254
  v_mfma_f32_16x16x32_bf16 v[48:51], a[24:27], a[56:59], v[48:51]
  ds_read_b64_tr_b16 a[24:25], v238 offset:4096
  v_lshlrev_b32 v254, 16, v254
  v_mfma_f32_16x16x32_bf16 v[64:67], a[32:35], a[56:59], v[64:67]
  s_waitcnt vmcnt(19)
  ds_read_b128 a[92:95], v226 offset:10240
  s_add_u32 m0, s24, 0x2580
  v_mfma_f32_16x16x32_bf16 v[64:67], a[36:39], a[72:75], v[64:67]
  ds_read_b64_tr_b16 a[26:27], v238 offset:4608
  v_sub_f32 v255, v255, v252
  v_mfma_f32_16x16x32_bf16 v[68:71], a[36:39], a[76:79], v[68:71]
  ds_read_b128 a[108:111], v227 offset:10240
  v_sub_f32 v254, v254, v252
  v_mfma_f32_16x16x32_bf16 v[68:71], a[32:35], a[60:63], v[68:71]
  ds_read_b64_tr_b16 a[28:29], v238 offset:18432
  v_fmac_f32 v253, v255, v255
  v_mfma_f32_16x16x32_bf16 v[72:75], a[32:35], a[64:67], v[72:75]
  s_waitcnt lgkmcnt(7)
  buffer_load_dwordx4 v224, s[4:7], s62 offen offset:640 lds
  s_add_u32 m0, s24, 0x2980
  v_mfma_f32_16x16x32_bf16 v[72:75], a[36:39], a[80:83], v[72:75]
  ds_read_b64_tr_b16 a[30:31], v238 offset:18944
  v_fmac_f32 v253, v254, v254
  v_mfma_f32_16x16x32_bf16 v[76:79], a[36:39], a[84:87], v[76:79]
  buffer_load_dwordx4 v225, s[4:7], s62 offen offset:640 lds
  s_add_u32 m0, s24, 0x2d80
  v_mfma_f32_16x16x32_bf16 v[76:79], a[32:35], a[68:71], v[76:79]
  ds_read_b64_tr_b16 a[32:33], v239 offset:4096
  v_accvgpr_read_b32 v250, a229
  v_mfma_f32_16x16x32_bf16 v[92:95], a[40:43], a[68:71], v[92:95]
  s_waitcnt vmcnt(19)
  ds_read_b128 a[96:99], v226 offset:12288
  v_and_b32 v251, s54, v250
  v_mfma_f32_16x16x32_bf16 v[92:95], a[44:47], a[84:87], v[92:95]
  ds_read_b64_tr_b16 a[34:35], v239 offset:4608
  v_lshlrev_b32 v250, 16, v250
  v_mfma_f32_16x16x32_bf16 v[88:91], a[44:47], a[80:83], v[88:91]
  ds_read_b128 a[112:115], v227 offset:12288
  v_sub_f32 v251, v251, v248
  v_mfma_f32_16x16x32_bf16 v[88:91], a[40:43], a[64:67], v[88:91]
  ds_read_b64_tr_b16 a[36:37], v239 offset:18432
  v_sub_f32 v250, v250, v248
  v_mfma_f32_16x16x32_bf16 v[84:87], a[40:43], a[60:63], v[84:87]
  s_waitcnt lgkmcnt(7)
  buffer_load_dwordx4 v224, s[4:7], s63 offen offset:640 lds
  s_add_u32 m0, s24, 0x3180
  v_mfma_f32_16x16x32_bf16 v[84:87], a[44:47], a[76:79], v[84:87]
  ds_read_b64_tr_b16 a[38:39], v239 offset:18944
  v_fmac_f32 v249, v251, v251
  v_mfma_f32_16x16x32_bf16 v[80:83], a[44:47], a[72:75], v[80:83]
  buffer_load_dwordx4 v225, s[4:7], s63 offen offset:640 lds
  s_add_u32 s60, s53, 0x0
  v_mfma_f32_16x16x32_bf16 v[80:83], a[40:43], a[56:59], v[80:83]
  ds_read_b64_tr_b16 a[40:41], v242 offset:2048
  v_fmac_f32 v249, v250, v250
  v_mfma_f32_16x16x32_bf16 v[96:99], a[48:51], a[56:59], v[96:99]
  s_waitcnt vmcnt(19)
  ds_read_b128 a[100:103], v226 offset:14336
  v_accvgpr_read_b32 v254, a237
  v_mfma_f32_16x16x32_bf16 v[96:99], a[52:55], a[72:75], v[96:99]
  ds_read_b64_tr_b16 a[42:43], v242 offset:2304
  v_and_b32 v255, s54, v254
  v_mfma_f32_16x16x32_bf16 v[100:103], a[52:55], a[76:79], v[100:103]
  ds_read_b128 a[116:119], v227 offset:14336
  v_lshlrev_b32 v254, 16, v254
  v_mfma_f32_16x16x32_bf16 v[100:103], a[48:51], a[60:63], v[100:103]
  ds_read_b64_tr_b16 a[44:45], v242 offset:16384
  v_sub_f32 v255, v255, v252
  v_mfma_f32_16x16x32_bf16 v[104:107], a[48:51], a[64:67], v[104:107]
  buffer_load_dwordx4 a[136:139], v244, s[8:11], s60 offen
  s_add_u32 m0, s24, 0x3580
  v_mfma_f32_16x16x32_bf16 v[104:107], a[52:55], a[80:83], v[104:107]
  ds_read_b64_tr_b16 a[46:47], v242 offset:16640
  v_sub_f32 v254, v254, v252
  v_mfma_f32_16x16x32_bf16 v[108:111], a[52:55], a[84:87], v[108:111]
  s_waitcnt lgkmcnt(8)
  buffer_load_dwordx4 v224, s[4:7], s64 offen offset:640 lds
  s_add_u32 m0, s24, 0x3980
  v_mfma_f32_16x16x32_bf16 v[108:111], a[48:51], a[68:71], v[108:111]
  ds_read_b64_tr_b16 a[48:49], v243 offset:2048
  v_fmac_f32 v253, v255, v255
  v_mfma_f32_16x16x32_bf16 v[124:127], a[0:3], a[68:71], v[124:127]
  ds_read_b64_tr_b16 a[50:51], v243 offset:2304
  v_fmac_f32 v253, v254, v254
  v_mfma_f32_16x16x32_bf16 v[124:127], a[4:7], a[84:87], v[124:127]
  ds_read_b64_tr_b16 a[52:53], v243 offset:16384
  v_accvgpr_read_b32 v250, a230
  v_mfma_f32_16x16x32_bf16 v[120:123], a[4:7], a[80:83], v[120:123]
  ds_read_b64_tr_b16 a[54:55], v243 offset:16640
  v_and_b32 v251, s54, v250
  v_mfma_f32_16x16x32_bf16 v[120:123], a[0:3], a[64:67], v[120:123]
  buffer_load_dwordx4 v225, s[4:7], s64 offen offset:640 lds
  s_add_u32 m0, s24, 0x3d80
  v_mfma_f32_16x16x32_bf16 v[116:119], a[0:3], a[60:63], v[116:119]
  s_waitcnt lgkmcnt(6)
  buffer_load_dwordx4 v224, s[4:7], s65 offen offset:640 lds
  s_add_u32 m0, s24, 0x4180
  v_mfma_f32_16x16x32_bf16 v[116:119], a[4:7], a[76:79], v[116:119]
  buffer_load_dwordx4 v225, s[4:7], s65 offen offset:640 lds
  s_add_u32 s60, s53, 0xe000
  v_mfma_f32_16x16x32_bf16 v[112:115], a[4:7], a[72:75], v[112:115]
  buffer_load_dwordx4 a[140:143], v244, s[8:11], s60 offen
  v_lshlrev_b32 v250, 16, v250
  v_mfma_f32_16x16x32_bf16 v[112:115], a[0:3], a[56:59], v[112:115]
  s_waitcnt lgkmcnt(0)
  s_barrier
  ds_read_b64_tr_b16 a[0:1], v232 offset:2048
  v_sub_f32 v251, v251, v248
  v_mfma_f32_16x16x32_bf16 v[128:131], a[8:11], a[56:59], v[128:131]
  s_add_u32 m0, s23, 0xe800
  v_sub_f32 v250, v250, v248
  v_mfma_f32_16x16x32_bf16 v[128:131], a[12:15], a[72:75], v[128:131]
  ds_read_b64_tr_b16 a[2:3], v232 offset:2560
  v_fmac_f32 v249, v251, v251
  v_mfma_f32_16x16x32_bf16 v[132:135], a[12:15], a[76:79], v[132:135]
  buffer_load_dwordx4 v229, s[8:11], s21 offen offset:0 lds
  v_fmac_f32 v249, v250, v250
  v_mfma_f32_16x16x32_bf16 v[132:135], a[8:11], a[60:63], v[132:135]
  ds_read_b64_tr_b16 a[4:5], v232 offset:16384
  v_accvgpr_read_b32 v254, a238
  v_mfma_f32_16x16x32_bf16 v[136:139], a[8:11], a[64:67], v[136:139]
  v_and_b32 v255, s54, v254
  v_lshlrev_b32 v254, 16, v254
  v_mfma_f32_16x16x32_bf16 v[136:139], a[12:15], a[80:83], v[136:139]
  ds_read_b64_tr_b16 a[6:7], v232 offset:16896
  s_add_u32 m0, s23, 0xeb80
  v_mfma_f32_16x16x32_bf16 v[140:143], a[12:15], a[84:87], v[140:143]
  buffer_load_dwordx4 v229, s[8:11], s21 offen offset:128 lds
  v_sub_f32 v255, v255, v252
  v_mfma_f32_16x16x32_bf16 v[140:143], a[8:11], a[68:71], v[140:143]
  ds_read_b64_tr_b16 a[8:9], v233 offset:2048
  v_sub_f32 v254, v254, v252
  v_mfma_f32_16x16x32_bf16 v[156:159], a[16:19], a[68:71], v[156:159]
  v_fmac_f32 v253, v255, v255
  v_fmac_f32 v253, v254, v254
  v_mfma_f32_16x16x32_bf16 v[156:159], a[20:23], a[84:87], v[156:159]
  ds_read_b64_tr_b16 a[10:11], v233 offset:2560
  v_accvgpr_read_b32 v250, a231
  v_mfma_f32_16x16x32_bf16 v[152:155], a[20:23], a[80:83], v[152:155]
  s_add_u32 m0, s23, 0xef00
  v_and_b32 v251, s54, v250
  v_mfma_f32_16x16x32_bf16 v[152:155], a[16:19], a[64:67], v[152:155]
  ds_read_b64_tr_b16 a[12:13], v233 offset:16384
  v_lshlrev_b32 v250, 16, v250
  v_mfma_f32_16x16x32_bf16 v[148:151], a[16:19], a[60:63], v[148:151]
  buffer_load_dwordx4 v229, s[8:11], s21 offen offset:256 lds
  v_sub_f32 v251, v251, v248
  v_mfma_f32_16x16x32_bf16 v[148:151], a[20:23], a[76:79], v[148:151]
  ds_read_b64_tr_b16 a[14:15], v233 offset:16896
  v_sub_f32 v250, v250, v248
  v_mfma_f32_16x16x32_bf16 v[144:147], a[20:23], a[72:75], v[144:147]
  v_fmac_f32 v249, v251, v251
  v_fmac_f32 v249, v250, v250
  v_mfma_f32_16x16x32_bf16 v[144:147], a[16:19], a[56:59], v[144:147]
  ds_read_b64_tr_b16 a[16:17], v234 offset:2048
  s_add_u32 s60, s53, 0x1c000
  v_mfma_f32_16x16x32_bf16 v[160:163], a[24:27], a[56:59], v[160:163]
  buffer_load_dwordx4 a[144:147], v244, s[8:11], s60 offen
  v_accvgpr_read_b32 v254, a239
  v_mfma_f32_16x16x32_bf16 v[160:163], a[28:31], a[72:75], v[160:163]
  ds_read_b64_tr_b16 a[18:19], v234 offset:2560
  v_and_b32 v255, s54, v254
  v_mfma_f32_16x16x32_bf16 v[164:167], a[28:31], a[76:79], v[164:167]
  v_lshlrev_b32 v254, 16, v254
  v_sub_f32 v255, v255, v252
  v_mfma_f32_16x16x32_bf16 v[164:167], a[24:27], a[60:63], v[164:167]
  ds_read_b64_tr_b16 a[20:21], v234 offset:16384
  v_sub_f32 v254, v254, v252
  v_mfma_f32_16x16x32_bf16 v[168:171], a[24:27], a[64:67], v[168:171]
  s_add_u32 m0, s23, 0xf400
  v_fmac_f32 v253, v255, v255
  v_mfma_f32_16x16x32_bf16 v[168:171], a[28:31], a[80:83], v[168:171]
  ds_read_b64_tr_b16 a[22:23], v234 offset:16896
  v_fmac_f32 v253, v254, v254
  v_mfma_f32_16x16x32_bf16 v[172:175], a[28:31], a[84:87], v[172:175]
  buffer_load_dwordx4 v230, s[8:11], s21 offen offset:0 lds
  v_accvgpr_read_b32 v250, a232
  v_mfma_f32_16x16x32_bf16 v[172:175], a[24:27], a[68:71], v[172:175]
  ds_read_b64_tr_b16 a[24:25], v235 offset:2048
  v_and_b32 v251, s54, v250
  v_mfma_f32_16x16x32_bf16 v[188:191], a[32:35], a[68:71], v[188:191]
  v_lshlrev_b32 v250, 16, v250
  v_sub_f32 v251, v251, v248
  v_mfma_f32_16x16x32_bf16 v[188:191], a[36:39], a[84:87], v[188:191]
  ds_read_b64_tr_b16 a[26:27], v235 offset:2560
  v_sub_f32 v250, v250, v248
  v_mfma_f32_16x16x32_bf16 v[184:187], a[36:39], a[80:83], v[184:187]
  s_add_u32 m0, s23, 0xf780
  v_fmac_f32 v249, v251, v251
  v_mfma_f32_16x16x32_bf16 v[184:187], a[32:35], a[64:67], v[184:187]
  ds_read_b64_tr_b16 a[28:29], v235 offset:16384
  v_fmac_f32 v249, v250, v250
  v_mfma_f32_16x16x32_bf16 v[180:183], a[32:35], a[60:63], v[180:183]
  buffer_load_dwordx4 v230, s[8:11], s21 offen offset:128 lds
  v_accvgpr_read_b32 v254, a240
  v_mfma_f32_16x16x32_bf16 v[180:183], a[36:39], a[76:79], v[180:183]
  ds_read_b64_tr_b16 a[30:31], v235 offset:16896
  v_and_b32 v255, s54, v254
  v_mfma_f32_16x16x32_bf16 v[176:179], a[36:39], a[72:75], v[176:179]
  v_lshlrev_b32 v254, 16, v254
  v_sub_f32 v255, v255, v252
  v_mfma_f32_16x16x32_bf16 v[176:179], a[32:35], a[56:59], v[176:179]
  ds_read_b64_tr_b16 a[32:33], v232 offset:3072
  s_add_u32 s60, s53, 0x2a000
  v_mfma_f32_16x16x32_bf16 v[192:195], a[40:43], a[56:59], v[192:195]
  buffer_load_dwordx4 a[148:151], v244, s[8:11], s60 offen
  v_sub_f32 v254, v254, v252
  v_mfma_f32_16x16x32_bf16 v[192:195], a[44:47], a[72:75], v[192:195]
  ds_read_b64_tr_b16 a[34:35], v232 offset:3584
  v_fmac_f32 v253, v255, v255
  v_mfma_f32_16x16x32_bf16 v[196:199], a[44:47], a[76:79], v[196:199]
  v_fmac_f32 v253, v254, v254
  v_accvgpr_read_b32 v250, a233
  v_mfma_f32_16x16x32_bf16 v[196:199], a[40:43], a[60:63], v[196:199]
  ds_read_b64_tr_b16 a[36:37], v232 offset:17408
  v_and_b32 v251, s54, v250
  v_mfma_f32_16x16x32_bf16 v[200:203], a[40:43], a[64:67], v[200:203]
  s_add_u32 m0, s23, 0xfb00
  v_lshlrev_b32 v250, 16, v250
  v_mfma_f32_16x16x32_bf16 v[200:203], a[44:47], a[80:83], v[200:203]
  ds_read_b64_tr_b16 a[38:39], v232 offset:17920
  v_sub_f32 v251, v251, v248
  v_mfma_f32_16x16x32_bf16 v[204:207], a[44:47], a[84:87], v[204:207]
  buffer_load_dwordx4 v230, s[8:11], s21 offen offset:256 lds
  v_sub_f32 v250, v250, v248
  v_mfma_f32_16x16x32_bf16 v[204:207], a[40:43], a[68:71], v[204:207]
  ds_read_b64_tr_b16 a[40:41], v233 offset:3072
  v_fmac_f32 v249, v251, v251
  v_mfma_f32_16x16x32_bf16 v[220:223], a[48:51], a[68:71], v[220:223]
  v_fmac_f32 v249, v250, v250
  v_accvgpr_read_b32 v254, a241
  v_mfma_f32_16x16x32_bf16 v[220:223], a[52:55], a[84:87], v[220:223]
  ds_read_b64_tr_b16 a[42:43], v233 offset:3584
  s_add_u32 m0, s23, 0x10000
  v_mfma_f32_16x16x32_bf16 v[216:219], a[52:55], a[80:83], v[216:219]
  buffer_load_dwordx4 v231, s[8:11], s21 offen lds
  v_and_b32 v255, s54, v254
  v_mfma_f32_16x16x32_bf16 v[216:219], a[48:51], a[64:67], v[216:219]
  ds_read_b64_tr_b16 a[44:45], v233 offset:17408
  v_lshlrev_b32 v254, 16, v254
  v_mfma_f32_16x16x32_bf16 v[212:215], a[48:51], a[60:63], v[212:215]
  v_sub_f32 v255, v255, v252
  v_sub_f32 v254, v254, v252
  v_mfma_f32_16x16x32_bf16 v[212:215], a[52:55], a[76:79], v[212:215]
  ds_read_b64_tr_b16 a[46:47], v233 offset:17920
  v_fmac_f32 v253, v255, v255
  v_mfma_f32_16x16x32_bf16 v[208:211], a[52:55], a[72:75], v[208:211]
  s_nop 0
  v_fmac_f32 v253, v254, v254
  v_mfma_f32_16x16x32_bf16 v[208:211], a[48:51], a[56:59], v[208:211]
  ds_read_b64_tr_b16 a[48:49], v234 offset:3072
  v_accvgpr_read_b32 v250, a234
  s_waitcnt lgkmcnt(8)
  v_mfma_f32_16x16x32_bf16 v[0:3], a[0:3], a[88:91], v[0:3]
  buffer_load_dwordx2 a[226:227], off, s[32:35], 0 sc1
  s_add_u32 s21, s21, 0x70000
  v_mfma_f32_16x16x32_bf16 v[0:3], a[4:7], a[104:107], v[0:3]
  ds_read_b64_tr_b16 a[50:51], v234 offset:3584
  v_and_b32 v251, s54, v250
  v_mfma_f32_16x16x32_bf16 v[4:7], a[4:7], a[108:111], v[4:7]
  s_waitcnt vmcnt(26)
  ds_read_b128 a[56:59], v226 offset:0
  v_lshlrev_b32 v250, 16, v250
  v_mfma_f32_16x16x32_bf16 v[4:7], a[0:3], a[92:95], v[4:7]
  ds_read_b64_tr_b16 a[52:53], v234 offset:17408
  v_sub_f32 v251, v251, v248
  v_mfma_f32_16x16x32_bf16 v[8:11], a[0:3], a[96:99], v[8:11]
  ds_read_b128 a[72:75], v227 offset:0
  v_sub_f32 v250, v250, v248
  v_mfma_f32_16x16x32_bf16 v[8:11], a[4:7], a[112:115], v[8:11]
  ds_read_b64_tr_b16 a[54:55], v234 offset:17920
  v_fmac_f32 v249, v251, v251
  v_mfma_f32_16x16x32_bf16 v[12:15], a[4:7], a[116:119], v[12:15]
  v_fmac_f32 v249, v250, v250
  v_accvgpr_read_b32 v254, a242
  v_mfma_f32_16x16x32_bf16 v[12:15], a[0:3], a[100:103], v[12:15]
  ds_read_b64_tr_b16 a[0:1], v235 offset:3072
  v_and_b32 v255, s54, v254
  v_mfma_f32_16x16x32_bf16 v[28:31], a[8:11], a[100:103], v[28:31]
  s_add_u32 m0, s24, 0x500
  v_lshlrev_b32 v254, 16, v254
  v_mfma_f32_16x16x32_bf16 v[28:31], a[12:15], a[116:119], v[28:31]
  ds_read_b64_tr_b16 a[2:3], v235 offset:3584
  v_sub_f32 v255, v255, v252
  v_mfma_f32_16x16x32_bf16 v[24:27], a[12:15], a[112:115], v[24:27]
  s_waitcnt lgkmcnt(3)
  buffer_load_dwordx4 v224, s[4:7], s62 offen offset:768 lds
  v_sub_f32 v254, v254, v252
  v_mfma_f32_16x16x32_bf16 v[24:27], a[8:11], a[96:99], v[24:27]
  ds_read_b64_tr_b16 a[4:5], v235 offset:17408
  v_fmac_f32 v253, v255, v255
  v_mfma_f32_16x16x32_bf16 v[20:23], a[8:11], a[92:95], v[20:23]
  v_fmac_f32 v253, v254, v254
  v_accvgpr_read_b32 v250, a235
  v_mfma_f32_16x16x32_bf16 v[20:23], a[12:15], a[108:111], v[20:23]
  ds_read_b64_tr_b16 a[6:7], v235 offset:17920
  s_add_u32 m0, s24, 0x900
  v_mfma_f32_16x16x32_bf16 v[16:19], a[12:15], a[104:107], v[16:19]
  s_waitcnt vmcnt(25)
  ds_read_b128 a[60:63], v226 offset:2048
  v_and_b32 v251, s54, v250
  v_mfma_f32_16x16x32_bf16 v[16:19], a[8:11], a[88:91], v[16:19]
  ds_read_b64_tr_b16 a[8:9], v232 offset:4096
  v_lshlrev_b32 v250, 16, v250
  v_mfma_f32_16x16x32_bf16 v[32:35], a[16:19], a[88:91], v[32:35]
  ds_read_b128 a[76:79], v227 offset:2048
  v_sub_f32 v251, v251, v248
  v_mfma_f32_16x16x32_bf16 v[32:35], a[20:23], a[104:107], v[32:35]
  ds_read_b64_tr_b16 a[10:11], v232 offset:4608
  v_sub_f32 v250, v250, v248
  v_mfma_f32_16x16x32_bf16 v[36:39], a[20:23], a[108:111], v[36:39]
  buffer_load_dwordx4 v225, s[4:7], s62 offen offset:768 lds
  s_add_u32 m0, s24, 0xd00
  v_mfma_f32_16x16x32_bf16 v[36:39], a[16:19], a[92:95], v[36:39]
  ds_read_b64_tr_b16 a[12:13], v232 offset:18432
  v_fmac_f32 v249, v251, v251
  v_mfma_f32_16x16x32_bf16 v[40:43], a[16:19], a[96:99], v[40:43]
  s_waitcnt lgkmcnt(2)
  buffer_load_dwordx4 v224, s[4:7], s63 offen offset:768 lds
  v_fmac_f32 v249, v250, v250
  v_mfma_f32_16x16x32_bf16 v[40:43], a[20:23], a[112:115], v[40:43]
  ds_read_b64_tr_b16 a[14:15], v232 offset:18944
  v_accvgpr_read_b32 v254, a243
  v_mfma_f32_16x16x32_bf16 v[44:47], a[20:23], a[116:119], v[44:47]
  v_and_b32 v255, s54, v254
  v_lshlrev_b32 v254, 16, v254
  v_mfma_f32_16x16x32_bf16 v[44:47], a[16:19], a[100:103], v[44:47]
  ds_read_b64_tr_b16 a[16:17], v233 offset:4096
  s_add_u32 s60, s53, 0x38000
  v_mfma_f32_16x16x32_bf16 v[60:63], a[24:27], a[100:103], v[60:63]
  buffer_load_dwordx4 a[152:155], v244, s[8:11], s60 offen
  v_sub_f32 v255, v255, v252
  v_mfma_f32_16x16x32_bf16 v[60:63], a[28:31], a[116:119], v[60:63]
  ds_read_b64_tr_b16 a[18:19], v233 offset:4608
  v_sub_f32 v254, v254, v252
  v_mfma_f32_16x16x32_bf16 v[56:59], a[28:31], a[112:115], v[56:59]
  v_fmac_f32 v253, v255, v255
  v_fmac_f32 v253, v254, v254
  v_mfma_f32_16x16x32_bf16 v[56:59], a[24:27], a[96:99], v[56:59]
  ds_read_b64_tr_b16 a[20:21], v233 offset:18432
  v_mfma_f32_16x16x32_bf16 v[52:55], a[24:27], a[92:95], v[52:55]
  s_waitcnt vmcnt(26)
  ds_read_b128 a[64:67], v226 offset:4096
  s_add_u32 m0, s24, 0x1100
  v_mfma_f32_16x16x32_bf16 v[52:55], a[28:31], a[108:111], v[52:55]
  ds_read_b64_tr_b16 a[22:23], v233 offset:18944
  v_add_f32_dpp v249, v249, v249 row_ror:8 row_mask:0xf bank_mask:0xf
  v_mfma_f32_16x16x32_bf16 v[48:51], a[28:31], a[104:107], v[48:51]
  ds_read_b128 a[80:83], v227 offset:4096
  v_add_f32_dpp v253, v253, v253 row_ror:8 row_mask:0xf bank_mask:0xf
  v_mfma_f32_16x16x32_bf16 v[48:51], a[24:27], a[88:91], v[48:51]
  ds_read_b64_tr_b16 a[24:25], v234 offset:4096
  v_add_f32_dpp v249, v249, v249 row_ror:4 row_mask:0xf bank_mask:0xf
  v_mfma_f32_16x16x32_bf16 v[64:67], a[32:35], a[88:91], v[64:67]
  buffer_load_dwordx4 v225, s[4:7], s63 offen offset:768 lds
  v_add_f32_dpp v253, v253, v253 row_ror:4 row_mask:0xf bank_mask:0xf
  v_mfma_f32_16x16x32_bf16 v[64:67], a[36:39], a[104:107], v[64:67]
  ds_read_b64_tr_b16 a[26:27], v234 offset:4608
  s_add_u32 m0, s24, 0x1500
  v_mfma_f32_16x16x32_bf16 v[68:71], a[36:39], a[108:111], v[68:71]
  s_waitcnt lgkmcnt(2)
  buffer_load_dwordx4 v224, s[4:7], s64 offen offset:768 lds
  v_add_f32_dpp v249, v249, v249 row_ror:2 row_mask:0xf bank_mask:0xf
  v_mfma_f32_16x16x32_bf16 v[68:71], a[32:35], a[92:95], v[68:71]
  ds_read_b64_tr_b16 a[28:29], v234 offset:18432
  v_add_f32_dpp v253, v253, v253 row_ror:2 row_mask:0xf bank_mask:0xf
  v_mfma_f32_16x16x32_bf16 v[72:75], a[32:35], a[96:99], v[72:75]
  v_add_f32_dpp v249, v249, v249 row_ror:1 row_mask:0xf bank_mask:0xf
  v_mfma_f32_16x16x32_bf16 v[72:75], a[36:39], a[112:115], v[72:75]
  ds_read_b64_tr_b16 a[30:31], v234 offset:18944
  v_add_f32_dpp v253, v253, v253 row_ror:1 row_mask:0xf bank_mask:0xf
  v_mfma_f32_16x16x32_bf16 v[76:79], a[36:39], a[116:119], v[76:79]
  s_add_u32 m0, s24, 0x1900
  v_mov_b32 v250, v249
  v_mfma_f32_16x16x32_bf16 v[76:79], a[32:35], a[100:103], v[76:79]
  ds_read_b64_tr_b16 a[32:33], v235 offset:4096
  v_mov_b32 v254, v253
  v_mfma_f32_16x16x32_bf16 v[92:95], a[40:43], a[100:103], v[92:95]
  buffer_load_dwordx4 v225, s[4:7], s64 offen offset:768 lds
  v_mfma_f32_16x16x32_bf16 v[92:95], a[44:47], a[116:119], v[92:95]
  ds_read_b64_tr_b16 a[34:35], v235 offset:4608
  v_permlane16_swap_b32 v249, v250
  v_mfma_f32_16x16x32_bf16 v[88:91], a[44:47], a[112:115], v[88:91]
  s_waitcnt vmcnt(27)
  ds_read_b128 a[68:71], v226 offset:6144
  v_permlane16_swap_b32 v253, v254
  v_mfma_f32_16x16x32_bf16 v[88:91], a[40:43], a[96:99], v[88:91]
  ds_read_b64_tr_b16 a[36:37], v235 offset:18432
  s_add_u32 s60, s53, 0x46000
  v_mfma_f32_16x16x32_bf16 v[84:87], a[40:43], a[92:95], v[84:87]
  ds_read_b128 a[84:87], v227 offset:6144
  v_add_f32 v249, v249, v250
  v_mfma_f32_16x16x32_bf16 v[84:87], a[44:47], a[108:111], v[84:87]
  ds_read_b64_tr_b16 a[38:39], v235 offset:18944
  v_add_f32 v253, v253, v254
  v_mfma_f32_16x16x32_bf16 v[80:83], a[44:47], a[104:107], v[80:83]
  buffer_load_dwordx4 a[156:159], v244, s[8:11], s60 offen
  v_mov_b32 v250, v249
  v_mfma_f32_16x16x32_bf16 v[80:83], a[40:43], a[88:91], v[80:83]
  ds_read_b64_tr_b16 a[40:41], v240 offset:2048
  v_mov_b32 v254, v253
  v_mfma_f32_16x16x32_bf16 v[96:99], a[48:51], a[88:91], v[96:99]
  s_add_u32 m0, s24, 0x1d00
  v_mfma_f32_16x16x32_bf16 v[96:99], a[52:55], a[104:107], v[96:99]
  ds_read_b64_tr_b16 a[42:43], v240 offset:2304
  v_permlane32_swap_b32 v249, v250
  v_mfma_f32_16x16x32_bf16 v[100:103], a[52:55], a[108:111], v[100:103]
  s_waitcnt lgkmcnt(3)
  buffer_load_dwordx4 v224, s[4:7], s65 offen offset:768 lds
  v_permlane32_swap_b32 v253, v254
  v_mfma_f32_16x16x32_bf16 v[100:103], a[48:51], a[92:95], v[100:103]
  ds_read_b64_tr_b16 a[44:45], v240 offset:16384
  v_add_f32 v249, v249, v250
  v_mfma_f32_16x16x32_bf16 v[104:107], a[48:51], a[96:99], v[104:107]
  v_add_f32 v253, v253, v254
  v_mfma_f32_16x16x32_bf16 v[104:107], a[52:55], a[112:115], v[104:107]
  ds_read_b64_tr_b16 a[46:47], v240 offset:16640
  s_add_u32 m0, s24, 0x2100
  v_mfma_f32_16x16x32_bf16 v[108:111], a[52:55], a[116:119], v[108:111]
  buffer_load_dwordx4 v225, s[4:7], s65 offen offset:768 lds
  v_cndmask_b32 v248, v248, v252, vcc
  v_mfma_f32_16x16x32_bf16 v[108:111], a[48:51], a[100:103], v[108:111]
  ds_read_b64_tr_b16 a[48:49], v241 offset:2048
  v_cndmask_b32 v249, v249, v253, vcc
  v_mfma_f32_16x16x32_bf16 v[124:127], a[0:3], a[100:103], v[124:127]
  ds_read_b64_tr_b16 a[50:51], v241 offset:2304
  v_mul_f32 v249, 0x3a800000, v249
  v_mfma_f32_16x16x32_bf16 v[124:127], a[4:7], a[116:119], v[124:127]
  ds_read_b64_tr_b16 a[52:53], v241 offset:16384
  v_cvt_pk_bf16_f32 v252, -v248, -v248
  v_mfma_f32_16x16x32_bf16 v[120:123], a[4:7], a[112:115], v[120:123]
  ds_read_b64_tr_b16 a[54:55], v241 offset:16640
  s_nop 0
  v_mfma_f32_16x16x32_bf16 v[120:123], a[0:3], a[96:99], v[120:123]
  buffer_load_dwordx2 v[246:247], v246, s[28:31], 0 offen
  v_cvt_pk_bf16_f32 v249, v249, v249
  v_mfma_f32_16x16x32_bf16 v[116:119], a[0:3], a[92:95], v[116:119]
  v_and_b32 v249, s54, v249
  v_mfma_f32_16x16x32_bf16 v[116:119], a[4:7], a[108:111], v[116:119]
  v_add_f32 v249, 0x3727c5ac, v249
  v_mfma_f32_16x16x32_bf16 v[112:115], a[4:7], a[104:107], v[112:115]
  v_cvt_pk_bf16_f32 v249, v249, v249
  v_mfma_f32_16x16x32_bf16 v[112:115], a[0:3], a[88:91], v[112:115]
  s_waitcnt lgkmcnt(0)
  s_barrier
  ds_read_b64_tr_b16 a[0:1], v232 offset:30720
  v_and_b32 v249, s54, v249
  v_mfma_f32_16x16x32_bf16 v[128:131], a[8:11], a[88:91], v[128:131]
  s_add_u32 m0, s23, 0x800
  v_sqrt_f32 v249, v249
  v_mfma_f32_16x16x32_bf16 v[128:131], a[12:15], a[104:107], v[128:131]
  ds_read_b64_tr_b16 a[2:3], v232 offset:31232
  v_mov_b32 v254, v252
  v_mfma_f32_16x16x32_bf16 v[132:135], a[12:15], a[108:111], v[132:135]
  buffer_load_dwordx4 v229, s[8:11], s21 offen offset:0 lds
  v_cvt_pk_bf16_f32 v253, -v248, v249
  v_mfma_f32_16x16x32_bf16 v[132:135], a[8:11], a[92:95], v[132:135]
  ds_read_b64_tr_b16 a[4:5], v232 offset:45056
  v_and_b32 v249, s54, v253
  v_mfma_f32_16x16x32_bf16 v[136:139], a[8:11], a[96:99], v[136:139]
  v_rcp_f32 v249, v249
  v_mfma_f32_16x16x32_bf16 v[136:139], a[12:15], a[112:115], v[136:139]
  ds_read_b64_tr_b16 a[6:7], v232 offset:45568
  s_add_u32 m0, s23, 0xb80
  v_mfma_f32_16x16x32_bf16 v[140:143], a[12:15], a[116:119], v[140:143]
  buffer_load_dwordx4 v229, s[8:11], s21 offen offset:128 lds
  v_mov_b32 v255, v253
  v_mfma_f32_16x16x32_bf16 v[140:143], a[8:11], a[100:103], v[140:143]
  ds_read_b64_tr_b16 a[8:9], v233 offset:30720
  v_lshrrev_b32 v250, 2, v228
  v_mfma_f32_16x16x32_bf16 v[156:159], a[16:19], a[100:103], v[156:159]
  s_lshr_b32 s61, s67, 7
  s_add_u32 s61, s61, 0x10000
  s_mov_b64 exec, 3
  buffer_store_dwordx4 v[252:255], v228, s[16:19], s61 offen sc1
  s_mov_b64 exec, -1
  v_mfma_f32_16x16x32_bf16 v[156:159], a[20:23], a[116:119], v[156:159]
  ds_read_b64_tr_b16 a[10:11], v233 offset:31232
  s_lshr_b32 s61, s67, 9
  s_add_u32 s61, s61, 0x20000
  s_mov_b64 exec, 3
  buffer_store_dword v249, v250, s[16:19], s61 offen sc1
  s_mov_b64 exec, -1
  v_mfma_f32_16x16x32_bf16 v[152:155], a[20:23], a[112:115], v[152:155]
  v_mfma_f32_16x16x32_bf16 v[152:155], a[16:19], a[96:99], v[152:155]
  ds_read_b64_tr_b16 a[12:13], v233 offset:45056
  s_add_u32 m0, s23, 0xf00
  v_mfma_f32_16x16x32_bf16 v[148:151], a[16:19], a[92:95], v[148:151]
  buffer_load_dwordx4 v229, s[8:11], s21 offen offset:256 lds
  v_mfma_f32_16x16x32_bf16 v[148:151], a[20:23], a[108:111], v[148:151]
  ds_read_b64_tr_b16 a[14:15], v233 offset:45568
  v_mfma_f32_16x16x32_bf16 v[144:147], a[20:23], a[104:107], v[144:147]
  v_mfma_f32_16x16x32_bf16 v[144:147], a[16:19], a[88:91], v[144:147]
  ds_read_b64_tr_b16 a[16:17], v234 offset:30720
  v_mfma_f32_16x16x32_bf16 v[160:163], a[24:27], a[88:91], v[160:163]
  v_mfma_f32_16x16x32_bf16 v[160:163], a[28:31], a[104:107], v[160:163]
  ds_read_b64_tr_b16 a[18:19], v234 offset:31232
  s_add_u32 m0, s23, 0x1400
  v_mfma_f32_16x16x32_bf16 v[164:167], a[28:31], a[108:111], v[164:167]
  buffer_load_dwordx4 v230, s[8:11], s21 offen offset:0 lds
  v_mfma_f32_16x16x32_bf16 v[164:167], a[24:27], a[92:95], v[164:167]
  ds_read_b64_tr_b16 a[20:21], v234 offset:45056
  v_mfma_f32_16x16x32_bf16 v[168:171], a[24:27], a[96:99], v[168:171]
  v_mfma_f32_16x16x32_bf16 v[168:171], a[28:31], a[112:115], v[168:171]
  ds_read_b64_tr_b16 a[22:23], v234 offset:45568
  v_mfma_f32_16x16x32_bf16 v[172:175], a[28:31], a[116:119], v[172:175]
  v_mfma_f32_16x16x32_bf16 v[172:175], a[24:27], a[100:103], v[172:175]
  ds_read_b64_tr_b16 a[24:25], v235 offset:30720
  s_add_u32 s60, s53, 0x54000
  v_mfma_f32_16x16x32_bf16 v[188:191], a[32:35], a[100:103], v[188:191]
  buffer_load_dwordx4 a[160:163], v244, s[8:11], s60 offen
  v_mfma_f32_16x16x32_bf16 v[188:191], a[36:39], a[116:119], v[188:191]
  ds_read_b64_tr_b16 a[26:27], v235 offset:31232
  v_mfma_f32_16x16x32_bf16 v[184:187], a[36:39], a[112:115], v[184:187]
  v_mfma_f32_16x16x32_bf16 v[184:187], a[32:35], a[96:99], v[184:187]
  ds_read_b64_tr_b16 a[28:29], v235 offset:45056
  v_mfma_f32_16x16x32_bf16 v[180:183], a[32:35], a[92:95], v[180:183]
  s_add_u32 m0, s23, 0x1780
  v_mfma_f32_16x16x32_bf16 v[180:183], a[36:39], a[108:111], v[180:183]
  ds_read_b64_tr_b16 a[30:31], v235 offset:45568
  v_mfma_f32_16x16x32_bf16 v[176:179], a[36:39], a[104:107], v[176:179]
  buffer_load_dwordx4 v230, s[8:11], s21 offen offset:128 lds
  v_mfma_f32_16x16x32_bf16 v[176:179], a[32:35], a[88:91], v[176:179]
  ds_read_b64_tr_b16 a[32:33], v232 offset:31744
  v_mfma_f32_16x16x32_bf16 v[192:195], a[40:43], a[88:91], v[192:195]
  v_mfma_f32_16x16x32_bf16 v[192:195], a[44:47], a[104:107], v[192:195]
  ds_read_b64_tr_b16 a[34:35], v232 offset:32256
  v_mfma_f32_16x16x32_bf16 v[196:199], a[44:47], a[108:111], v[196:199]
  s_add_u32 m0, s23, 0x1b00
  v_mfma_f32_16x16x32_bf16 v[196:199], a[40:43], a[92:95], v[196:199]
  ds_read_b64_tr_b16 a[36:37], v232 offset:46080
  v_mfma_f32_16x16x32_bf16 v[200:203], a[40:43], a[96:99], v[200:203]
  buffer_load_dwordx4 v230, s[8:11], s21 offen offset:256 lds
  v_mfma_f32_16x16x32_bf16 v[200:203], a[44:47], a[112:115], v[200:203]
  ds_read_b64_tr_b16 a[38:39], v232 offset:46592
  v_mfma_f32_16x16x32_bf16 v[204:207], a[44:47], a[116:119], v[204:207]
  v_mfma_f32_16x16x32_bf16 v[204:207], a[40:43], a[100:103], v[204:207]
  ds_read_b64_tr_b16 a[40:41], v233 offset:31744
  v_mfma_f32_16x16x32_bf16 v[220:223], a[48:51], a[100:103], v[220:223]
  s_add_u32 m0, s23, 0x2000
  v_mfma_f32_16x16x32_bf16 v[220:223], a[52:55], a[116:119], v[220:223]
  ds_read_b64_tr_b16 a[42:43], v233 offset:32256
  v_mfma_f32_16x16x32_bf16 v[216:219], a[52:55], a[112:115], v[216:219]
  buffer_load_dwordx4 v231, s[8:11], s21 offen lds
  v_mfma_f32_16x16x32_bf16 v[216:219], a[48:51], a[96:99], v[216:219]
  ds_read_b64_tr_b16 a[44:45], v233 offset:46080
  v_mfma_f32_16x16x32_bf16 v[212:215], a[48:51], a[92:95], v[212:215]
  v_mfma_f32_16x16x32_bf16 v[212:215], a[52:55], a[108:111], v[212:215]
  ds_read_b64_tr_b16 a[46:47], v233 offset:46592
  v_mfma_f32_16x16x32_bf16 v[208:211], a[52:55], a[104:107], v[208:211]
  s_add_u32 s60, s53, 0x62000
  v_mfma_f32_16x16x32_bf16 v[208:211], a[48:51], a[88:91], v[208:211]
  ds_read_b64_tr_b16 a[48:49], v234 offset:31744
  s_waitcnt lgkmcnt(8)
  v_mfma_f32_16x16x32_bf16 v[0:3], a[0:3], a[56:59], v[0:3]
  buffer_load_dwordx4 a[164:167], v244, s[8:11], s60 offen
  s_add_u32 s21, s21, 0x70000
  v_mfma_f32_16x16x32_bf16 v[0:3], a[4:7], a[72:75], v[0:3]
  ds_read_b64_tr_b16 a[50:51], v234 offset:32256
  s_waitcnt vmcnt(37)
  v_mfma_f32_16x16x32_bf16 v[248:251], a[220:223], a[136:139], 0
  v_mfma_f32_16x16x32_bf16 v[4:7], a[4:7], a[76:79], v[4:7]
  ds_read_b128 a[88:91], v226 offset:8192
  v_mfma_f32_16x16x32_bf16 v[4:7], a[0:3], a[60:63], v[4:7]
  ds_read_b64_tr_b16 a[52:53], v234 offset:46080
  v_mfma_f32_16x16x32_bf16 v[8:11], a[0:3], a[64:67], v[8:11]
  ds_read_b128 a[104:107], v227 offset:8192
  v_mfma_f32_16x16x32_bf16 v[8:11], a[4:7], a[80:83], v[8:11]
  ds_read_b64_tr_b16 a[54:55], v234 offset:46592
  s_waitcnt vmcnt(32)
  v_mfma_f32_16x16x32_bf16 v[248:251], a[220:223], a[140:143], v[248:251]
  v_mfma_f32_16x16x32_bf16 v[12:15], a[4:7], a[84:87], v[12:15]
  v_mfma_f32_16x16x32_bf16 v[12:15], a[0:3], a[68:71], v[12:15]
  ds_read_b64_tr_b16 a[0:1], v235 offset:31744
  v_mfma_f32_16x16x32_bf16 v[28:31], a[8:11], a[68:71], v[28:31]
  s_add_u32 m0, s24, 0x2480
  v_mfma_f32_16x16x32_bf16 v[28:31], a[12:15], a[84:87], v[28:31]
  ds_read_b64_tr_b16 a[2:3], v235 offset:32256
  v_mfma_f32_16x16x32_bf16 v[24:27], a[12:15], a[80:83], v[24:27]
  s_waitcnt lgkmcnt(3)
  buffer_load_dwordx4 v224, s[4:7], s62 offen offset:896 lds
  v_mfma_f32_16x16x32_bf16 v[24:27], a[8:11], a[64:67], v[24:27]
  ds_read_b64_tr_b16 a[4:5], v235 offset:46080
  v_mfma_f32_16x16x32_bf16 v[20:23], a[8:11], a[60:63], v[20:23]
  v_mfma_f32_16x16x32_bf16 v[20:23], a[12:15], a[76:79], v[20:23]
  ds_read_b64_tr_b16 a[6:7], v235 offset:46592
  s_add_u32 m0, s24, 0x2880
  v_mfma_f32_16x16x32_bf16 v[16:19], a[12:15], a[72:75], v[16:19]
  ds_read_b128 a[92:95], v226 offset:10240
  v_mfma_f32_16x16x32_bf16 v[16:19], a[8:11], a[56:59], v[16:19]
  ds_read_b64_tr_b16 a[8:9], v232 offset:32768
  v_mfma_f32_16x16x32_bf16 v[32:35], a[16:19], a[56:59], v[32:35]
  ds_read_b128 a[108:111], v227 offset:10240
  v_mfma_f32_16x16x32_bf16 v[32:35], a[20:23], a[72:75], v[32:35]
  ds_read_b64_tr_b16 a[10:11], v232 offset:33280
  v_mfma_f32_16x16x32_bf16 v[36:39], a[20:23], a[76:79], v[36:39]
  buffer_load_dwordx4 v225, s[4:7], s62 offen offset:896 lds
  v_mfma_f32_16x16x32_bf16 v[36:39], a[16:19], a[60:63], v[36:39]
  ds_read_b64_tr_b16 a[12:13], v232 offset:47104
  s_add_u32 m0, s24, 0x2c80
  v_mfma_f32_16x16x32_bf16 v[40:43], a[16:19], a[64:67], v[40:43]
  s_waitcnt lgkmcnt(2)
  buffer_load_dwordx4 v224, s[4:7], s63 offen offset:896 lds
  v_mfma_f32_16x16x32_bf16 v[40:43], a[20:23], a[80:83], v[40:43]
  ds_read_b64_tr_b16 a[14:15], v232 offset:47616
  v_mfma_f32_16x16x32_bf16 v[44:47], a[20:23], a[84:87], v[44:47]
  v_mfma_f32_16x16x32_bf16 v[44:47], a[16:19], a[68:71], v[44:47]
  ds_read_b64_tr_b16 a[16:17], v233 offset:32768
  v_mfma_f32_16x16x32_bf16 v[60:63], a[24:27], a[68:71], v[60:63]
  s_add_u32 m0, s24, 0x3080
  v_mfma_f32_16x16x32_bf16 v[60:63], a[28:31], a[84:87], v[60:63]
  ds_read_b64_tr_b16 a[18:19], v233 offset:33280
  v_mfma_f32_16x16x32_bf16 v[56:59], a[28:31], a[80:83], v[56:59]
  buffer_load_dwordx4 v225, s[4:7], s63 offen offset:896 lds
  v_mfma_f32_16x16x32_bf16 v[56:59], a[24:27], a[64:67], v[56:59]
  ds_read_b64_tr_b16 a[20:21], v233 offset:47104
  v_mfma_f32_16x16x32_bf16 v[52:55], a[24:27], a[60:63], v[52:55]
  ds_read_b128 a[96:99], v226 offset:12288
  v_mfma_f32_16x16x32_bf16 v[52:55], a[28:31], a[76:79], v[52:55]
  ds_read_b64_tr_b16 a[22:23], v233 offset:47616
  v_mfma_f32_16x16x32_bf16 v[48:51], a[28:31], a[72:75], v[48:51]
  ds_read_b128 a[112:115], v227 offset:12288
  s_add_u32 s60, s53, 0x70000
  v_mfma_f32_16x16x32_bf16 v[48:51], a[24:27], a[56:59], v[48:51]
  ds_read_b64_tr_b16 a[24:25], v234 offset:32768
  v_mfma_f32_16x16x32_bf16 v[64:67], a[32:35], a[56:59], v[64:67]
  buffer_load_dwordx4 a[168:171], v244, s[8:11], s60 offen
  v_mfma_f32_16x16x32_bf16 v[64:67], a[36:39], a[72:75], v[64:67]
  ds_read_b64_tr_b16 a[26:27], v234 offset:33280
  v_mfma_f32_16x16x32_bf16 v[68:71], a[36:39], a[76:79], v[68:71]
  v_mfma_f32_16x16x32_bf16 v[68:71], a[32:35], a[60:63], v[68:71]
  ds_read_b64_tr_b16 a[28:29], v234 offset:47104
  s_add_u32 m0, s24, 0x3480
  v_mfma_f32_16x16x32_bf16 v[72:75], a[32:35], a[64:67], v[72:75]
  s_waitcnt lgkmcnt(3)
  buffer_load_dwordx4 v224, s[4:7], s64 offen offset:896 lds
  v_mfma_f32_16x16x32_bf16 v[72:75], a[36:39], a[80:83], v[72:75]
  ds_read_b64_tr_b16 a[30:31], v234 offset:47616
  v_mfma_f32_16x16x32_bf16 v[76:79], a[36:39], a[84:87], v[76:79]
  v_mfma_f32_16x16x32_bf16 v[76:79], a[32:35], a[68:71], v[76:79]
  ds_read_b64_tr_b16 a[32:33], v235 offset:32768
  v_mfma_f32_16x16x32_bf16 v[92:95], a[40:43], a[68:71], v[92:95]
  v_mfma_f32_16x16x32_bf16 v[92:95], a[44:47], a[84:87], v[92:95]
  ds_read_b64_tr_b16 a[34:35], v235 offset:33280
  s_add_u32 m0, s24, 0x3880
  v_mfma_f32_16x16x32_bf16 v[88:91], a[44:47], a[80:83], v[88:91]
  ds_read_b128 a[100:103], v226 offset:14336
  v_mfma_f32_16x16x32_bf16 v[88:91], a[40:43], a[64:67], v[88:91]
  ds_read_b64_tr_b16 a[36:37], v235 offset:47104
  v_mfma_f32_16x16x32_bf16 v[84:87], a[40:43], a[60:63], v[84:87]
  ds_read_b128 a[116:119], v227 offset:14336
  v_mfma_f32_16x16x32_bf16 v[84:87], a[44:47], a[76:79], v[84:87]
  ds_read_b64_tr_b16 a[38:39], v235 offset:47616
  v_mfma_f32_16x16x32_bf16 v[80:83], a[44:47], a[72:75], v[80:83]
  buffer_load_dwordx4 v225, s[4:7], s64 offen offset:896 lds
  s_add_u32 m0, s24, 0x3c80
  v_mfma_f32_16x16x32_bf16 v[80:83], a[40:43], a[56:59], v[80:83]
  ds_read_b64_tr_b16 a[40:41], v240 offset:30720
  v_mfma_f32_16x16x32_bf16 v[96:99], a[48:51], a[56:59], v[96:99]
  s_waitcnt lgkmcnt(2)
  buffer_load_dwordx4 v224, s[4:7], s65 offen offset:896 lds
  v_mfma_f32_16x16x32_bf16 v[96:99], a[52:55], a[72:75], v[96:99]
  ds_read_b64_tr_b16 a[42:43], v240 offset:30976
  v_mfma_f32_16x16x32_bf16 v[100:103], a[52:55], a[76:79], v[100:103]
  v_mfma_f32_16x16x32_bf16 v[100:103], a[48:51], a[60:63], v[100:103]
  ds_read_b64_tr_b16 a[44:45], v240 offset:45056
  v_mfma_f32_16x16x32_bf16 v[104:107], a[48:51], a[64:67], v[104:107]
  s_add_u32 m0, s24, 0x4080
  v_mfma_f32_16x16x32_bf16 v[104:107], a[52:55], a[80:83], v[104:107]
  ds_read_b64_tr_b16 a[46:47], v240 offset:45312
  v_mfma_f32_16x16x32_bf16 v[108:111], a[52:55], a[84:87], v[108:111]
  buffer_load_dwordx4 v225, s[4:7], s65 offen offset:896 lds
  v_mfma_f32_16x16x32_bf16 v[108:111], a[48:51], a[68:71], v[108:111]
  ds_read_b64_tr_b16 a[48:49], v241 offset:30720
  v_mfma_f32_16x16x32_bf16 v[124:127], a[0:3], a[68:71], v[124:127]
  ds_read_b64_tr_b16 a[50:51], v241 offset:30976
  s_waitcnt vmcnt(37)
  v_mfma_f32_16x16x32_bf16 v[248:251], a[220:223], a[144:147], v[248:251]
  v_mfma_f32_16x16x32_bf16 v[124:127], a[4:7], a[84:87], v[124:127]
  ds_read_b64_tr_b16 a[52:53], v241 offset:45056
  s_add_u32 s60, s53, 0x7e000
  v_mfma_f32_16x16x32_bf16 v[120:123], a[4:7], a[80:83], v[120:123]
  ds_read_b64_tr_b16 a[54:55], v241 offset:45312
  v_mfma_f32_16x16x32_bf16 v[120:123], a[0:3], a[64:67], v[120:123]
  buffer_load_dwordx4 a[172:175], v244, s[8:11], s60 offen
  v_mfma_f32_16x16x32_bf16 v[116:119], a[0:3], a[60:63], v[116:119]
  s_waitcnt vmcnt(35)
  v_mfma_f32_16x16x32_bf16 v[248:251], a[220:223], a[148:151], v[248:251]
  v_mfma_f32_16x16x32_bf16 v[116:119], a[4:7], a[76:79], v[116:119]
  v_mfma_f32_16x16x32_bf16 v[112:115], a[4:7], a[72:75], v[112:115]
  v_mfma_f32_16x16x32_bf16 v[112:115], a[0:3], a[56:59], v[112:115]
  s_waitcnt lgkmcnt(0) vmcnt(33)
  s_barrier
  ds_read_b64_tr_b16 a[0:1], v236 offset:2048
  v_mfma_f32_16x16x32_bf16 v[128:131], a[8:11], a[56:59], v[128:131]
  s_add_u32 m0, s23, 0x7800
  v_mfma_f32_16x16x32_bf16 v[128:131], a[12:15], a[72:75], v[128:131]
  ds_read_b64_tr_b16 a[2:3], v236 offset:2560
  v_mfma_f32_16x16x32_bf16 v[132:135], a[12:15], a[76:79], v[132:135]
  buffer_load_dwordx4 v229, s[8:11], s21 offen offset:0 lds
  v_mfma_f32_16x16x32_bf16 v[132:135], a[8:11], a[60:63], v[132:135]
  ds_read_b64_tr_b16 a[4:5], v236 offset:16384
  v_mfma_f32_16x16x32_bf16 v[136:139], a[8:11], a[64:67], v[136:139]
  v_mfma_f32_16x16x32_bf16 v[136:139], a[12:15], a[80:83], v[136:139]
  ds_read_b64_tr_b16 a[6:7], v236 offset:16896
  s_add_u32 m0, s23, 0x7b80
  v_mfma_f32_16x16x32_bf16 v[140:143], a[12:15], a[84:87], v[140:143]
  buffer_load_dwordx4 v229, s[8:11], s21 offen offset:128 lds
  v_mfma_f32_16x16x32_bf16 v[140:143], a[8:11], a[68:71], v[140:143]
  ds_read_b64_tr_b16 a[8:9], v237 offset:2048
  v_mfma_f32_16x16x32_bf16 v[156:159], a[16:19], a[68:71], v[156:159]
  v_mfma_f32_16x16x32_bf16 v[156:159], a[20:23], a[84:87], v[156:159]
  ds_read_b64_tr_b16 a[10:11], v237 offset:2560
  v_mfma_f32_16x16x32_bf16 v[152:155], a[20:23], a[80:83], v[152:155]
  v_mfma_f32_16x16x32_bf16 v[152:155], a[16:19], a[64:67], v[152:155]
  ds_read_b64_tr_b16 a[12:13], v237 offset:16384
  s_add_u32 m0, s23, 0x7f00
  v_mfma_f32_16x16x32_bf16 v[148:151], a[16:19], a[60:63], v[148:151]
  buffer_load_dwordx4 v229, s[8:11], s21 offen offset:256 lds
  v_mfma_f32_16x16x32_bf16 v[148:151], a[20:23], a[76:79], v[148:151]
  ds_read_b64_tr_b16 a[14:15], v237 offset:16896
  v_mfma_f32_16x16x32_bf16 v[144:147], a[20:23], a[72:75], v[144:147]
  v_mfma_f32_16x16x32_bf16 v[144:147], a[16:19], a[56:59], v[144:147]
  ds_read_b64_tr_b16 a[16:17], v238 offset:2048
  v_mfma_f32_16x16x32_bf16 v[160:163], a[24:27], a[56:59], v[160:163]
  v_mfma_f32_16x16x32_bf16 v[160:163], a[28:31], a[72:75], v[160:163]
  ds_read_b64_tr_b16 a[18:19], v238 offset:2560
  s_add_u32 m0, s23, 0x8400
  v_mfma_f32_16x16x32_bf16 v[164:167], a[28:31], a[76:79], v[164:167]
  buffer_load_dwordx4 v230, s[8:11], s21 offen offset:0 lds
  v_mfma_f32_16x16x32_bf16 v[164:167], a[24:27], a[60:63], v[164:167]
  ds_read_b64_tr_b16 a[20:21], v238 offset:16384
  v_mfma_f32_16x16x32_bf16 v[168:171], a[24:27], a[64:67], v[168:171]
  v_mfma_f32_16x16x32_bf16 v[168:171], a[28:31], a[80:83], v[168:171]
  ds_read_b64_tr_b16 a[22:23], v238 offset:16896
  v_mfma_f32_16x16x32_bf16 v[172:175], a[28:31], a[84:87], v[172:175]
  v_mfma_f32_16x16x32_bf16 v[172:175], a[24:27], a[68:71], v[172:175]
  ds_read_b64_tr_b16 a[24:25], v239 offset:2048
  s_add_u32 s60, s53, 0x8c000
  v_mfma_f32_16x16x32_bf16 v[188:191], a[32:35], a[68:71], v[188:191]
  buffer_load_dwordx4 a[176:179], v244, s[8:11], s60 offen
  v_mfma_f32_16x16x32_bf16 v[188:191], a[36:39], a[84:87], v[188:191]
  ds_read_b64_tr_b16 a[26:27], v239 offset:2560
  v_mfma_f32_16x16x32_bf16 v[184:187], a[36:39], a[80:83], v[184:187]
  v_mfma_f32_16x16x32_bf16 v[184:187], a[32:35], a[64:67], v[184:187]
  ds_read_b64_tr_b16 a[28:29], v239 offset:16384
  v_mfma_f32_16x16x32_bf16 v[180:183], a[32:35], a[60:63], v[180:183]
  s_add_u32 m0, s23, 0x8780
  v_mfma_f32_16x16x32_bf16 v[180:183], a[36:39], a[76:79], v[180:183]
  ds_read_b64_tr_b16 a[30:31], v239 offset:16896
  v_mfma_f32_16x16x32_bf16 v[176:179], a[36:39], a[72:75], v[176:179]
  buffer_load_dwordx4 v230, s[8:11], s21 offen offset:128 lds
  v_mfma_f32_16x16x32_bf16 v[176:179], a[32:35], a[56:59], v[176:179]
  ds_read_b64_tr_b16 a[32:33], v236 offset:3072
  v_mfma_f32_16x16x32_bf16 v[192:195], a[40:43], a[56:59], v[192:195]
  v_mfma_f32_16x16x32_bf16 v[192:195], a[44:47], a[72:75], v[192:195]
  ds_read_b64_tr_b16 a[34:35], v236 offset:3584
  v_mfma_f32_16x16x32_bf16 v[196:199], a[44:47], a[76:79], v[196:199]
  s_add_u32 m0, s23, 0x8b00
  v_mfma_f32_16x16x32_bf16 v[196:199], a[40:43], a[60:63], v[196:199]
  ds_read_b64_tr_b16 a[36:37], v236 offset:17408
  v_mfma_f32_16x16x32_bf16 v[200:203], a[40:43], a[64:67], v[200:203]
  buffer_load_dwordx4 v230, s[8:11], s21 offen offset:256 lds
  v_mfma_f32_16x16x32_bf16 v[200:203], a[44:47], a[80:83], v[200:203]
  ds_read_b64_tr_b16 a[38:39], v236 offset:17920
  v_mfma_f32_16x16x32_bf16 v[204:207], a[44:47], a[84:87], v[204:207]
  v_mfma_f32_16x16x32_bf16 v[204:207], a[40:43], a[68:71], v[204:207]
  ds_read_b64_tr_b16 a[40:41], v237 offset:3072
  v_mfma_f32_16x16x32_bf16 v[220:223], a[48:51], a[68:71], v[220:223]
  s_add_u32 m0, s23, 0x9000
  v_mfma_f32_16x16x32_bf16 v[220:223], a[52:55], a[84:87], v[220:223]
  ds_read_b64_tr_b16 a[42:43], v237 offset:3584
  v_mfma_f32_16x16x32_bf16 v[216:219], a[52:55], a[80:83], v[216:219]
  buffer_load_dwordx4 v231, s[8:11], s21 offen lds
  v_mfma_f32_16x16x32_bf16 v[216:219], a[48:51], a[64:67], v[216:219]
  ds_read_b64_tr_b16 a[44:45], v237 offset:17408
  v_mfma_f32_16x16x32_bf16 v[212:215], a[48:51], a[60:63], v[212:215]
  v_mfma_f32_16x16x32_bf16 v[212:215], a[52:55], a[76:79], v[212:215]
  ds_read_b64_tr_b16 a[46:47], v237 offset:17920
  v_mfma_f32_16x16x32_bf16 v[208:211], a[52:55], a[72:75], v[208:211]
  s_add_u32 s60, s53, 0x9a000
  v_mfma_f32_16x16x32_bf16 v[208:211], a[48:51], a[56:59], v[208:211]
  ds_read_b64_tr_b16 a[48:49], v238 offset:3072
  s_waitcnt lgkmcnt(8)
  v_mfma_f32_16x16x32_bf16 v[0:3], a[0:3], a[88:91], v[0:3]
  buffer_load_dwordx4 a[180:183], v244, s[8:11], s60 offen
  s_add_u32 s21, s21, 0x70000
  v_mfma_f32_16x16x32_bf16 v[0:3], a[4:7], a[104:107], v[0:3]
  ds_read_b64_tr_b16 a[50:51], v238 offset:3584
  s_waitcnt vmcnt(37)
  v_mfma_f32_16x16x32_bf16 v[248:251], a[220:223], a[152:155], v[248:251]
  v_mfma_f32_16x16x32_bf16 v[4:7], a[4:7], a[108:111], v[4:7]
  ds_read_b128 a[56:59], v226 offset:0
  v_mfma_f32_16x16x32_bf16 v[4:7], a[0:3], a[92:95], v[4:7]
  ds_read_b64_tr_b16 a[52:53], v238 offset:17408
  v_mfma_f32_16x16x32_bf16 v[8:11], a[0:3], a[96:99], v[8:11]
  ds_read_b128 a[72:75], v227 offset:0
  v_mfma_f32_16x16x32_bf16 v[8:11], a[4:7], a[112:115], v[8:11]
  ds_read_b64_tr_b16 a[54:55], v238 offset:17920
  s_waitcnt vmcnt(33)
  v_mfma_f32_16x16x32_bf16 v[248:251], a[220:223], a[156:159], v[248:251]
  v_mfma_f32_16x16x32_bf16 v[12:15], a[4:7], a[116:119], v[12:15]
  v_mfma_f32_16x16x32_bf16 v[12:15], a[0:3], a[100:103], v[12:15]
  ds_read_b64_tr_b16 a[0:1], v239 offset:3072
  v_mfma_f32_16x16x32_bf16 v[28:31], a[8:11], a[100:103], v[28:31]
  s_add_u32 m0, s24, 0x400
  v_mfma_f32_16x16x32_bf16 v[28:31], a[12:15], a[116:119], v[28:31]
  ds_read_b64_tr_b16 a[2:3], v239 offset:3584
  v_mfma_f32_16x16x32_bf16 v[24:27], a[12:15], a[112:115], v[24:27]
  s_waitcnt lgkmcnt(3)
  buffer_load_dwordx4 v224, s[4:7], s62 offen offset:1024 lds
  v_mfma_f32_16x16x32_bf16 v[24:27], a[8:11], a[96:99], v[24:27]
  ds_read_b64_tr_b16 a[4:5], v239 offset:17408
  v_mfma_f32_16x16x32_bf16 v[20:23], a[8:11], a[92:95], v[20:23]
  v_mfma_f32_16x16x32_bf16 v[20:23], a[12:15], a[108:111], v[20:23]
  ds_read_b64_tr_b16 a[6:7], v239 offset:17920
  s_add_u32 m0, s24, 0x800
  v_mfma_f32_16x16x32_bf16 v[16:19], a[12:15], a[104:107], v[16:19]
  ds_read_b128 a[60:63], v226 offset:2048
  v_mfma_f32_16x16x32_bf16 v[16:19], a[8:11], a[88:91], v[16:19]
  ds_read_b64_tr_b16 a[8:9], v236 offset:4096
  v_mfma_f32_16x16x32_bf16 v[32:35], a[16:19], a[88:91], v[32:35]
  ds_read_b128 a[76:79], v227 offset:2048
  v_mfma_f32_16x16x32_bf16 v[32:35], a[20:23], a[104:107], v[32:35]
  ds_read_b64_tr_b16 a[10:11], v236 offset:4608
  v_mfma_f32_16x16x32_bf16 v[36:39], a[20:23], a[108:111], v[36:39]
  buffer_load_dwordx4 v225, s[4:7], s62 offen offset:1024 lds
  v_mfma_f32_16x16x32_bf16 v[36:39], a[16:19], a[92:95], v[36:39]
  ds_read_b64_tr_b16 a[12:13], v236 offset:18432
  s_add_u32 m0, s24, 0xc00
  v_mfma_f32_16x16x32_bf16 v[40:43], a[16:19], a[96:99], v[40:43]
  s_waitcnt lgkmcnt(2)
  buffer_load_dwordx4 v224, s[4:7], s63 offen offset:1024 lds
  v_mfma_f32_16x16x32_bf16 v[40:43], a[20:23], a[112:115], v[40:43]
  ds_read_b64_tr_b16 a[14:15], v236 offset:18944
  v_mfma_f32_16x16x32_bf16 v[44:47], a[20:23], a[116:119], v[44:47]
  v_mfma_f32_16x16x32_bf16 v[44:47], a[16:19], a[100:103], v[44:47]
  ds_read_b64_tr_b16 a[16:17], v237 offset:4096
  v_mfma_f32_16x16x32_bf16 v[60:63], a[24:27], a[100:103], v[60:63]
  s_add_u32 m0, s24, 0x1000
  v_mfma_f32_16x16x32_bf16 v[60:63], a[28:31], a[116:119], v[60:63]
  ds_read_b64_tr_b16 a[18:19], v237 offset:4608
  v_mfma_f32_16x16x32_bf16 v[56:59], a[28:31], a[112:115], v[56:59]
  buffer_load_dwordx4 v225, s[4:7], s63 offen offset:1024 lds
  v_mfma_f32_16x16x32_bf16 v[56:59], a[24:27], a[96:99], v[56:59]
  ds_read_b64_tr_b16 a[20:21], v237 offset:18432
  v_mfma_f32_16x16x32_bf16 v[52:55], a[24:27], a[92:95], v[52:55]
  ds_read_b128 a[64:67], v226 offset:4096
  v_mfma_f32_16x16x32_bf16 v[52:55], a[28:31], a[108:111], v[52:55]
  ds_read_b64_tr_b16 a[22:23], v237 offset:18944
  v_mfma_f32_16x16x32_bf16 v[48:51], a[28:31], a[104:107], v[48:51]
  ds_read_b128 a[80:83], v227 offset:4096
  s_add_u32 s60, s53, 0xa8000
  v_mfma_f32_16x16x32_bf16 v[48:51], a[24:27], a[88:91], v[48:51]
  ds_read_b64_tr_b16 a[24:25], v238 offset:4096
  v_mfma_f32_16x16x32_bf16 v[64:67], a[32:35], a[88:91], v[64:67]
  buffer_load_dwordx4 a[184:187], v244, s[8:11], s60 offen
  v_mfma_f32_16x16x32_bf16 v[64:67], a[36:39], a[104:107], v[64:67]
  ds_read_b64_tr_b16 a[26:27], v238 offset:4608
  v_mfma_f32_16x16x32_bf16 v[68:71], a[36:39], a[108:111], v[68:71]
  v_mfma_f32_16x16x32_bf16 v[68:71], a[32:35], a[92:95], v[68:71]
  ds_read_b64_tr_b16 a[28:29], v238 offset:18432
  s_add_u32 m0, s24, 0x1400
  v_mfma_f32_16x16x32_bf16 v[72:75], a[32:35], a[96:99], v[72:75]
  s_waitcnt lgkmcnt(3)
  buffer_load_dwordx4 v224, s[4:7], s64 offen offset:1024 lds
  v_mfma_f32_16x16x32_bf16 v[72:75], a[36:39], a[112:115], v[72:75]
  ds_read_b64_tr_b16 a[30:31], v238 offset:18944
  v_mfma_f32_16x16x32_bf16 v[76:79], a[36:39], a[116:119], v[76:79]
  v_mfma_f32_16x16x32_bf16 v[76:79], a[32:35], a[100:103], v[76:79]
  ds_read_b64_tr_b16 a[32:33], v239 offset:4096
  v_mfma_f32_16x16x32_bf16 v[92:95], a[40:43], a[100:103], v[92:95]
  v_mfma_f32_16x16x32_bf16 v[92:95], a[44:47], a[116:119], v[92:95]
  ds_read_b64_tr_b16 a[34:35], v239 offset:4608
  s_add_u32 m0, s24, 0x1800
  v_mfma_f32_16x16x32_bf16 v[88:91], a[44:47], a[112:115], v[88:91]
  s_waitcnt vmcnt(37)
  ds_read_b128 a[68:71], v226 offset:6144
  v_mfma_f32_16x16x32_bf16 v[88:91], a[40:43], a[96:99], v[88:91]
  ds_read_b64_tr_b16 a[36:37], v239 offset:18432
  v_mfma_f32_16x16x32_bf16 v[84:87], a[40:43], a[92:95], v[84:87]
  ds_read_b128 a[84:87], v227 offset:6144
  v_mfma_f32_16x16x32_bf16 v[84:87], a[44:47], a[108:111], v[84:87]
  ds_read_b64_tr_b16 a[38:39], v239 offset:18944
  v_mfma_f32_16x16x32_bf16 v[80:83], a[44:47], a[104:107], v[80:83]
  buffer_load_dwordx4 v225, s[4:7], s64 offen offset:1024 lds
  s_add_u32 m0, s24, 0x1c00
  v_mfma_f32_16x16x32_bf16 v[80:83], a[40:43], a[88:91], v[80:83]
  ds_read_b64_tr_b16 a[40:41], v242 offset:2048
  v_mfma_f32_16x16x32_bf16 v[96:99], a[48:51], a[88:91], v[96:99]
  s_waitcnt lgkmcnt(2)
  buffer_load_dwordx4 v224, s[4:7], s65 offen offset:1024 lds
  v_mfma_f32_16x16x32_bf16 v[96:99], a[52:55], a[104:107], v[96:99]
  ds_read_b64_tr_b16 a[42:43], v242 offset:2304
  v_mfma_f32_16x16x32_bf16 v[100:103], a[52:55], a[108:111], v[100:103]
  v_mfma_f32_16x16x32_bf16 v[100:103], a[48:51], a[92:95], v[100:103]
  ds_read_b64_tr_b16 a[44:45], v242 offset:16384
  v_mfma_f32_16x16x32_bf16 v[104:107], a[48:51], a[96:99], v[104:107]
  s_add_u32 m0, s24, 0x2000
  v_mfma_f32_16x16x32_bf16 v[104:107], a[52:55], a[112:115], v[104:107]
  ds_read_b64_tr_b16 a[46:47], v242 offset:16640
  v_mfma_f32_16x16x32_bf16 v[108:111], a[52:55], a[116:119], v[108:111]
  buffer_load_dwordx4 v225, s[4:7], s65 offen offset:1024 lds
  v_mfma_f32_16x16x32_bf16 v[108:111], a[48:51], a[100:103], v[108:111]
  ds_read_b64_tr_b16 a[48:49], v243 offset:2048
  v_mfma_f32_16x16x32_bf16 v[124:127], a[0:3], a[100:103], v[124:127]
  ds_read_b64_tr_b16 a[50:51], v243 offset:2304
  s_waitcnt vmcnt(32)
  v_mfma_f32_16x16x32_bf16 v[248:251], a[220:223], a[160:163], v[248:251]
  v_mfma_f32_16x16x32_bf16 v[124:127], a[4:7], a[116:119], v[124:127]
  ds_read_b64_tr_b16 a[52:53], v243 offset:16384
  s_add_u32 s60, s53, 0xb6000
  v_mfma_f32_16x16x32_bf16 v[120:123], a[4:7], a[112:115], v[120:123]
  ds_read_b64_tr_b16 a[54:55], v243 offset:16640
  v_mfma_f32_16x16x32_bf16 v[120:123], a[0:3], a[96:99], v[120:123]
  buffer_load_dwordx4 a[188:191], v244, s[8:11], s60 offen
  v_mfma_f32_16x16x32_bf16 v[116:119], a[0:3], a[92:95], v[116:119]
  s_waitcnt vmcnt(29)
  v_mfma_f32_16x16x32_bf16 v[248:251], a[220:223], a[164:167], v[248:251]
  v_mfma_f32_16x16x32_bf16 v[116:119], a[4:7], a[108:111], v[116:119]
  v_mfma_f32_16x16x32_bf16 v[112:115], a[4:7], a[104:107], v[112:115]
  v_mfma_f32_16x16x32_bf16 v[112:115], a[0:3], a[88:91], v[112:115]
  s_waitcnt lgkmcnt(0)
  s_barrier
  ds_read_b64_tr_b16 a[0:1], v232 offset:2048
  v_mfma_f32_16x16x32_bf16 v[128:131], a[8:11], a[88:91], v[128:131]
  v_accvgpr_read_b32 v252, a226
  v_accvgpr_read_b32 v253, a227
  s_nop 0
  v_readfirstlane_b32 s56, v252
  v_readfirstlane_b32 s57, v253
  s_nop 3
  s_cmp_lg_u32 s56, 0
  s_cbranch_scc0 L_k1_tspin_w1
L_k1_tback_w1:
  s_add_u32 m0, s23, 0xe800
  v_mfma_f32_16x16x32_bf16 v[128:131], a[12:15], a[104:107], v[128:131]
  ds_read_b64_tr_b16 a[2:3], v232 offset:2560
  v_mfma_f32_16x16x32_bf16 v[132:135], a[12:15], a[108:111], v[132:135]
  buffer_load_dwordx4 v229, s[8:11], s21 offen offset:0 lds
  v_mfma_f32_16x16x32_bf16 v[132:135], a[8:11], a[92:95], v[132:135]
  ds_read_b64_tr_b16 a[4:5], v232 offset:16384
  v_mfma_f32_16x16x32_bf16 v[136:139], a[8:11], a[96:99], v[136:139]
  v_mfma_f32_16x16x32_bf16 v[136:139], a[12:15], a[112:115], v[136:139]
  ds_read_b64_tr_b16 a[6:7], v232 offset:16896
  s_add_u32 m0, s23, 0xeb80
  v_mfma_f32_16x16x32_bf16 v[140:143], a[12:15], a[116:119], v[140:143]
  buffer_load_dwordx4 v229, s[8:11], s21 offen offset:128 lds
  v_mfma_f32_16x16x32_bf16 v[140:143], a[8:11], a[100:103], v[140:143]
  ds_read_b64_tr_b16 a[8:9], v233 offset:2048
  v_mfma_f32_16x16x32_bf16 v[156:159], a[16:19], a[100:103], v[156:159]
  v_mfma_f32_16x16x32_bf16 v[156:159], a[20:23], a[116:119], v[156:159]
  ds_read_b64_tr_b16 a[10:11], v233 offset:2560
  v_mfma_f32_16x16x32_bf16 v[152:155], a[20:23], a[112:115], v[152:155]
  s_add_u32 m0, s23, 0xef00
  v_mfma_f32_16x16x32_bf16 v[152:155], a[16:19], a[96:99], v[152:155]
  ds_read_b64_tr_b16 a[12:13], v233 offset:16384
  v_mfma_f32_16x16x32_bf16 v[148:151], a[16:19], a[92:95], v[148:151]
  buffer_load_dwordx4 v229, s[8:11], s21 offen offset:256 lds
  v_mfma_f32_16x16x32_bf16 v[148:151], a[20:23], a[108:111], v[148:151]
  ds_read_b64_tr_b16 a[14:15], v233 offset:16896
  v_mfma_f32_16x16x32_bf16 v[144:147], a[20:23], a[104:107], v[144:147]
  v_mfma_f32_16x16x32_bf16 v[144:147], a[16:19], a[88:91], v[144:147]
  ds_read_b64_tr_b16 a[16:17], v234 offset:2048
  s_add_u32 s60, s53, 0xc4000
  v_mfma_f32_16x16x32_bf16 v[160:163], a[24:27], a[88:91], v[160:163]
  buffer_load_dwordx4 a[192:195], v244, s[8:11], s60 offen
  v_mfma_f32_16x16x32_bf16 v[160:163], a[28:31], a[104:107], v[160:163]
  ds_read_b64_tr_b16 a[18:19], v234 offset:2560
  v_mfma_f32_16x16x32_bf16 v[164:167], a[28:31], a[108:111], v[164:167]
  v_mfma_f32_16x16x32_bf16 v[164:167], a[24:27], a[92:95], v[164:167]
  ds_read_b64_tr_b16 a[20:21], v234 offset:16384
  v_mfma_f32_16x16x32_bf16 v[168:171], a[24:27], a[96:99], v[168:171]
  s_add_u32 m0, s23, 0xf400
  v_mfma_f32_16x16x32_bf16 v[168:171], a[28:31], a[112:115], v[168:171]
  ds_read_b64_tr_b16 a[22:23], v234 offset:16896
  v_mfma_f32_16x16x32_bf16 v[172:175], a[28:31], a[116:119], v[172:175]
  buffer_load_dwordx4 v230, s[8:11], s21 offen offset:0 lds
  v_mfma_f32_16x16x32_bf16 v[172:175], a[24:27], a[100:103], v[172:175]
  ds_read_b64_tr_b16 a[24:25], v235 offset:2048
  v_mfma_f32_16x16x32_bf16 v[188:191], a[32:35], a[100:103], v[188:191]
  v_mfma_f32_16x16x32_bf16 v[188:191], a[36:39], a[116:119], v[188:191]
  ds_read_b64_tr_b16 a[26:27], v235 offset:2560
  v_mfma_f32_16x16x32_bf16 v[184:187], a[36:39], a[112:115], v[184:187]
  s_add_u32 m0, s23, 0xf780
  v_mfma_f32_16x16x32_bf16 v[184:187], a[32:35], a[96:99], v[184:187]
  ds_read_b64_tr_b16 a[28:29], v235 offset:16384
  v_mfma_f32_16x16x32_bf16 v[180:183], a[32:35], a[92:95], v[180:183]
  buffer_load_dwordx4 v230, s[8:11], s21 offen offset:128 lds
  v_mfma_f32_16x16x32_bf16 v[180:183], a[36:39], a[108:111], v[180:183]
  ds_read_b64_tr_b16 a[30:31], v235 offset:16896
  v_mfma_f32_16x16x32_bf16 v[176:179], a[36:39], a[104:107], v[176:179]
  v_mfma_f32_16x16x32_bf16 v[176:179], a[32:35], a[88:91], v[176:179]
  ds_read_b64_tr_b16 a[32:33], v232 offset:3072
  s_add_u32 s60, s53, 0xd2000
  v_mfma_f32_16x16x32_bf16 v[192:195], a[40:43], a[88:91], v[192:195]
  buffer_load_dwordx4 a[196:199], v244, s[8:11], s60 offen
  v_mfma_f32_16x16x32_bf16 v[192:195], a[44:47], a[104:107], v[192:195]
  ds_read_b64_tr_b16 a[34:35], v232 offset:3584
  v_mfma_f32_16x16x32_bf16 v[196:199], a[44:47], a[108:111], v[196:199]
  v_mfma_f32_16x16x32_bf16 v[196:199], a[40:43], a[92:95], v[196:199]
  ds_read_b64_tr_b16 a[36:37], v232 offset:17408
  v_mfma_f32_16x16x32_bf16 v[200:203], a[40:43], a[96:99], v[200:203]
  s_add_u32 m0, s23, 0xfb00
  v_mfma_f32_16x16x32_bf16 v[200:203], a[44:47], a[112:115], v[200:203]
  ds_read_b64_tr_b16 a[38:39], v232 offset:17920
  v_mfma_f32_16x16x32_bf16 v[204:207], a[44:47], a[116:119], v[204:207]
  buffer_load_dwordx4 v230, s[8:11], s21 offen offset:256 lds
  v_mfma_f32_16x16x32_bf16 v[204:207], a[40:43], a[100:103], v[204:207]
  ds_read_b64_tr_b16 a[40:41], v233 offset:3072
  v_mfma_f32_16x16x32_bf16 v[220:223], a[48:51], a[100:103], v[220:223]
  v_mfma_f32_16x16x32_bf16 v[220:223], a[52:55], a[116:119], v[220:223]
  ds_read_b64_tr_b16 a[42:43], v233 offset:3584
  s_add_u32 m0, s23, 0x10000
  v_mfma_f32_16x16x32_bf16 v[216:219], a[52:55], a[112:115], v[216:219]
  buffer_load_dwordx4 v231, s[8:11], s21 offen lds
  v_mfma_f32_16x16x32_bf16 v[216:219], a[48:51], a[96:99], v[216:219]
  ds_read_b64_tr_b16 a[44:45], v233 offset:17408
  v_mfma_f32_16x16x32_bf16 v[212:215], a[48:51], a[92:95], v[212:215]
  v_mfma_f32_16x16x32_bf16 v[212:215], a[52:55], a[108:111], v[212:215]
  ds_read_b64_tr_b16 a[46:47], v233 offset:17920
  v_mfma_f32_16x16x32_bf16 v[208:211], a[52:55], a[104:107], v[208:211]
  s_lshl_b32 s60, s2, 7
  v_mfma_f32_16x16x32_bf16 v[208:211], a[48:51], a[88:91], v[208:211]
  ds_read_b64_tr_b16 a[48:49], v234 offset:3072
  s_waitcnt lgkmcnt(8)
  v_mfma_f32_16x16x32_bf16 v[0:3], a[0:3], a[56:59], v[0:3]
  s_mov_b64 exec, 1
  buffer_store_dwordx2 a[226:227], off, s[40:43], s60 offset:0 sc1
  s_mov_b64 exec, -1
  s_add_u32 s21, s21, 0x70000
  v_lshlrev_b32 v244, 3, v228
  v_mfma_f32_16x16x32_bf16 v[0:3], a[4:7], a[72:75], v[0:3]
  ds_read_b64_tr_b16 a[50:51], v234 offset:3584
  s_add_u32 s28, s58, 0x2000000
  s_addc_u32 s29, s59, 0
  s_mov_b32 s30, 0xc00000
  s_mov_b32 s31, 0x20000
  s_mov_b32 s36, s101
  s_mov_b32 s37, s20
  s_mov_b32 s38, 0x700000
  v_mfma_f32_16x16x32_bf16 v[4:7], a[4:7], a[76:79], v[4:7]
  s_bfe_u32 s55, s2, 0x40003
  s_lshl_b32 s55, s55, 2
  s_add_u32 s55, s55, s25
  s_waitcnt vmcnt(34)
  v_mfma_f32_16x16x32_bf16 v[248:251], a[220:223], a[168:171], v[248:251]
  v_mfma_f32_16x16x32_bf16 v[4:7], a[0:3], a[60:63], v[4:7]
  ds_read_b64_tr_b16 a[52:53], v234 offset:17408
  v_mfma_f32_16x16x32_bf16 v[8:11], a[0:3], a[64:67], v[8:11]
  ds_read_b128 a[88:91], v226 offset:8192
  v_mfma_f32_16x16x32_bf16 v[8:11], a[4:7], a[80:83], v[8:11]
  ds_read_b64_tr_b16 a[54:55], v234 offset:17920
  v_mfma_f32_16x16x32_bf16 v[12:15], a[4:7], a[84:87], v[12:15]
  ds_read_b128 a[104:107], v227 offset:8192
  s_waitcnt vmcnt(29)
  v_mfma_f32_16x16x32_bf16 v[248:251], a[220:223], a[172:175], v[248:251]
  v_mfma_f32_16x16x32_bf16 v[12:15], a[0:3], a[68:71], v[12:15]
  ds_read_b64_tr_b16 a[0:1], v235 offset:3072
  v_mfma_f32_16x16x32_bf16 v[28:31], a[8:11], a[68:71], v[28:31]
  s_add_u32 m0, s24, 0x2380
  v_mfma_f32_16x16x32_bf16 v[28:31], a[12:15], a[84:87], v[28:31]
  ds_read_b64_tr_b16 a[2:3], v235 offset:3584
  v_mfma_f32_16x16x32_bf16 v[24:27], a[12:15], a[80:83], v[24:27]
  s_waitcnt lgkmcnt(2)
  buffer_load_dwordx4 v224, s[4:7], s62 offen offset:1152 lds
  v_mfma_f32_16x16x32_bf16 v[24:27], a[8:11], a[64:67], v[24:27]
  ds_read_b64_tr_b16 a[4:5], v235 offset:17408
  v_mfma_f32_16x16x32_bf16 v[20:23], a[8:11], a[60:63], v[20:23]
  v_mfma_f32_16x16x32_bf16 v[20:23], a[12:15], a[76:79], v[20:23]
  ds_read_b64_tr_b16 a[6:7], v235 offset:17920
  v_mfma_f32_16x16x32_bf16 v[16:19], a[12:15], a[72:75], v[16:19]
  ds_read_b128 a[92:95], v226 offset:10240
  s_add_u32 m0, s24, 0x2780
  v_mfma_f32_16x16x32_bf16 v[16:19], a[8:11], a[56:59], v[16:19]
  ds_read_b64_tr_b16 a[8:9], v232 offset:4096
  v_mfma_f32_16x16x32_bf16 v[32:35], a[16:19], a[56:59], v[32:35]
  ds_read_b128 a[108:111], v227 offset:10240
  v_mfma_f32_16x16x32_bf16 v[32:35], a[20:23], a[72:75], v[32:35]
  ds_read_b64_tr_b16 a[10:11], v232 offset:4608
  v_mfma_f32_16x16x32_bf16 v[36:39], a[20:23], a[76:79], v[36:39]
  buffer_load_dwordx4 v225, s[4:7], s62 offen offset:1152 lds
  v_mfma_f32_16x16x32_bf16 v[36:39], a[16:19], a[60:63], v[36:39]
  ds_read_b64_tr_b16 a[12:13], v232 offset:18432
  v_mfma_f32_16x16x32_bf16 v[40:43], a[16:19], a[64:67], v[40:43]
  v_mfma_f32_16x16x32_bf16 v[40:43], a[20:23], a[80:83], v[40:43]
  ds_read_b64_tr_b16 a[14:15], v232 offset:18944
  s_add_u32 m0, s24, 0x2b80
  v_mfma_f32_16x16x32_bf16 v[44:47], a[20:23], a[84:87], v[44:47]
  s_waitcnt lgkmcnt(3)
  buffer_load_dwordx4 v224, s[4:7], s63 offen offset:1152 lds
  v_mfma_f32_16x16x32_bf16 v[44:47], a[16:19], a[68:71], v[44:47]
  ds_read_b64_tr_b16 a[16:17], v233 offset:4096
  v_mfma_f32_16x16x32_bf16 v[60:63], a[24:27], a[68:71], v[60:63]
  v_mfma_f32_16x16x32_bf16 v[60:63], a[28:31], a[84:87], v[60:63]
  ds_read_b64_tr_b16 a[18:19], v233 offset:4608
  v_mfma_f32_16x16x32_bf16 v[56:59], a[28:31], a[80:83], v[56:59]
  v_mfma_f32_16x16x32_bf16 v[56:59], a[24:27], a[64:67], v[56:59]
  ds_read_b64_tr_b16 a[20:21], v233 offset:18432
  v_mfma_f32_16x16x32_bf16 v[52:55], a[24:27], a[60:63], v[52:55]
  ds_read_b128 a[96:99], v226 offset:12288
  s_add_u32 m0, s24, 0x2f80
  v_mfma_f32_16x16x32_bf16 v[52:55], a[28:31], a[76:79], v[52:55]
  ds_read_b64_tr_b16 a[22:23], v233 offset:18944
  v_mfma_f32_16x16x32_bf16 v[48:51], a[28:31], a[72:75], v[48:51]
  ds_read_b128 a[112:115], v227 offset:12288
  v_mfma_f32_16x16x32_bf16 v[48:51], a[24:27], a[56:59], v[48:51]
  ds_read_b64_tr_b16 a[24:25], v234 offset:4096
  v_mfma_f32_16x16x32_bf16 v[64:67], a[32:35], a[56:59], v[64:67]
  buffer_load_dwordx4 v225, s[4:7], s63 offen offset:1152 lds
  v_mfma_f32_16x16x32_bf16 v[64:67], a[36:39], a[72:75], v[64:67]
  ds_read_b64_tr_b16 a[26:27], v234 offset:4608
  v_mfma_f32_16x16x32_bf16 v[68:71], a[36:39], a[76:79], v[68:71]
  v_mfma_f32_16x16x32_bf16 v[68:71], a[32:35], a[60:63], v[68:71]
  ds_read_b64_tr_b16 a[28:29], v234 offset:18432
  s_add_u32 m0, s24, 0x3380
  v_mfma_f32_16x16x32_bf16 v[72:75], a[32:35], a[64:67], v[72:75]
  s_waitcnt lgkmcnt(3)
  buffer_load_dwordx4 v224, s[4:7], s64 offen offset:1152 lds
  v_mfma_f32_16x16x32_bf16 v[72:75], a[36:39], a[80:83], v[72:75]
  ds_read_b64_tr_b16 a[30:31], v234 offset:18944
  v_mfma_f32_16x16x32_bf16 v[76:79], a[36:39], a[84:87], v[76:79]
  v_mfma_f32_16x16x32_bf16 v[76:79], a[32:35], a[68:71], v[76:79]
  ds_read_b64_tr_b16 a[32:33], v235 offset:4096
  v_mfma_f32_16x16x32_bf16 v[92:95], a[40:43], a[68:71], v[92:95]
  v_mfma_f32_16x16x32_bf16 v[92:95], a[44:47], a[84:87], v[92:95]
  ds_read_b64_tr_b16 a[34:35], v235 offset:4608
  v_mfma_f32_16x16x32_bf16 v[88:91], a[44:47], a[80:83], v[88:91]
  ds_read_b128 a[100:103], v226 offset:14336
  s_add_u32 m0, s24, 0x3780
  v_mfma_f32_16x16x32_bf16 v[88:91], a[40:43], a[64:67], v[88:91]
  ds_read_b64_tr_b16 a[36:37], v235 offset:18432
  v_mfma_f32_16x16x32_bf16 v[84:87], a[40:43], a[60:63], v[84:87]
  ds_read_b128 a[116:119], v227 offset:14336
  v_mfma_f32_16x16x32_bf16 v[84:87], a[44:47], a[76:79], v[84:87]
  ds_read_b64_tr_b16 a[38:39], v235 offset:18944
  v_mfma_f32_16x16x32_bf16 v[80:83], a[44:47], a[72:75], v[80:83]
  buffer_load_dwordx4 v225, s[4:7], s64 offen offset:1152 lds
  v_mfma_f32_16x16x32_bf16 v[80:83], a[40:43], a[56:59], v[80:83]
  ds_read_b64_tr_b16 a[40:41], v240 offset:2048
  v_mfma_f32_16x16x32_bf16 v[96:99], a[48:51], a[56:59], v[96:99]
  v_mfma_f32_16x16x32_bf16 v[96:99], a[52:55], a[72:75], v[96:99]
  ds_read_b64_tr_b16 a[42:43], v240 offset:2304
  s_add_u32 m0, s24, 0x3b80
  v_mfma_f32_16x16x32_bf16 v[100:103], a[52:55], a[76:79], v[100:103]
  s_waitcnt lgkmcnt(3)
  buffer_load_dwordx4 v224, s[4:7], s65 offen offset:1152 lds
  v_mfma_f32_16x16x32_bf16 v[100:103], a[48:51], a[60:63], v[100:103]
  ds_read_b64_tr_b16 a[44:45], v240 offset:16384
  v_mfma_f32_16x16x32_bf16 v[104:107], a[48:51], a[64:67], v[104:107]
  v_mfma_f32_16x16x32_bf16 v[104:107], a[52:55], a[80:83], v[104:107]
  ds_read_b64_tr_b16 a[46:47], v240 offset:16640
  v_mfma_f32_16x16x32_bf16 v[108:111], a[52:55], a[84:87], v[108:111]
  v_mfma_f32_16x16x32_bf16 v[108:111], a[48:51], a[68:71], v[108:111]
  ds_read_b64_tr_b16 a[48:49], v241 offset:2048
  v_mfma_f32_16x16x32_bf16 v[124:127], a[0:3], a[68:71], v[124:127]
  ds_read_b64_tr_b16 a[50:51], v241 offset:2304
  s_add_u32 m0, s24, 0x3f80
  v_mfma_f32_16x16x32_bf16 v[124:127], a[4:7], a[84:87], v[124:127]
  ds_read_b64_tr_b16 a[52:53], v241 offset:16384
  s_waitcnt vmcnt(31)
  v_mfma_f32_16x16x32_bf16 v[248:251], a[220:223], a[176:179], v[248:251]
  v_mfma_f32_16x16x32_bf16 v[120:123], a[4:7], a[80:83], v[120:123]
  ds_read_b64_tr_b16 a[54:55], v241 offset:16640
  v_mfma_f32_16x16x32_bf16 v[120:123], a[0:3], a[64:67], v[120:123]
  buffer_load_dwordx4 v225, s[4:7], s65 offen offset:1152 lds
  v_mfma_f32_16x16x32_bf16 v[116:119], a[0:3], a[60:63], v[116:119]
  v_mfma_f32_16x16x32_bf16 v[116:119], a[4:7], a[76:79], v[116:119]
  s_waitcnt vmcnt(28)
  v_mfma_f32_16x16x32_bf16 v[248:251], a[220:223], a[180:183], v[248:251]
  v_mfma_f32_16x16x32_bf16 v[112:115], a[4:7], a[72:75], v[112:115]
  v_mfma_f32_16x16x32_bf16 v[112:115], a[0:3], a[56:59], v[112:115]
  s_waitcnt lgkmcnt(0)
  s_barrier
  ds_read_b64_tr_b16 a[0:1], v232 offset:30720
  v_mfma_f32_16x16x32_bf16 v[128:131], a[8:11], a[56:59], v[128:131]
  s_add_u32 m0, s23, 0x800
  v_mfma_f32_16x16x32_bf16 v[128:131], a[12:15], a[72:75], v[128:131]
  ds_read_b64_tr_b16 a[2:3], v232 offset:31232
  v_mfma_f32_16x16x32_bf16 v[132:135], a[12:15], a[76:79], v[132:135]
  buffer_load_dwordx4 v229, s[8:11], s21 offen offset:0 lds
  v_mfma_f32_16x16x32_bf16 v[132:135], a[8:11], a[60:63], v[132:135]
  ds_read_b64_tr_b16 a[4:5], v232 offset:45056
  v_mfma_f32_16x16x32_bf16 v[136:139], a[8:11], a[64:67], v[136:139]
  v_mfma_f32_16x16x32_bf16 v[136:139], a[12:15], a[80:83], v[136:139]
  ds_read_b64_tr_b16 a[6:7], v232 offset:45568
  v_mfma_f32_16x16x32_bf16 v[140:143], a[12:15], a[84:87], v[140:143]
  s_add_u32 m0, s23, 0xb80
  v_mfma_f32_16x16x32_bf16 v[140:143], a[8:11], a[68:71], v[140:143]
  ds_read_b64_tr_b16 a[8:9], v233 offset:30720
  v_mfma_f32_16x16x32_bf16 v[156:159], a[16:19], a[68:71], v[156:159]
  buffer_load_dwordx4 v229, s[8:11], s21 offen offset:128 lds
  v_mfma_f32_16x16x32_bf16 v[156:159], a[20:23], a[84:87], v[156:159]
  ds_read_b64_tr_b16 a[10:11], v233 offset:31232
  v_mfma_f32_16x16x32_bf16 v[152:155], a[20:23], a[80:83], v[152:155]
  v_mfma_f32_16x16x32_bf16 v[152:155], a[16:19], a[64:67], v[152:155]
  ds_read_b64_tr_b16 a[12:13], v233 offset:45056
  v_mfma_f32_16x16x32_bf16 v[148:151], a[16:19], a[60:63], v[148:151]
  v_mfma_f32_16x16x32_bf16 v[148:151], a[20:23], a[76:79], v[148:151]
  ds_read_b64_tr_b16 a[14:15], v233 offset:45568
  s_add_u32 m0, s23, 0xf00
  v_mfma_f32_16x16x32_bf16 v[144:147], a[20:23], a[72:75], v[144:147]
  buffer_load_dwordx4 v229, s[8:11], s21 offen offset:256 lds
  v_mfma_f32_16x16x32_bf16 v[144:147], a[16:19], a[56:59], v[144:147]
  ds_read_b64_tr_b16 a[16:17], v234 offset:30720
  v_mfma_f32_16x16x32_bf16 v[160:163], a[24:27], a[56:59], v[160:163]
  v_mfma_f32_16x16x32_bf16 v[160:163], a[28:31], a[72:75], v[160:163]
  ds_read_b64_tr_b16 a[18:19], v234 offset:31232
  v_mfma_f32_16x16x32_bf16 v[164:167], a[28:31], a[76:79], v[164:167]
  v_mfma_f32_16x16x32_bf16 v[164:167], a[24:27], a[60:63], v[164:167]
  ds_read_b64_tr_b16 a[20:21], v234 offset:45056
  s_add_u32 m0, s23, 0x1400
  v_mfma_f32_16x16x32_bf16 v[168:171], a[24:27], a[64:67], v[168:171]
  buffer_load_dwordx4 v230, s[8:11], s21 offen offset:0 lds
  v_mfma_f32_16x16x32_bf16 v[168:171], a[28:31], a[80:83], v[168:171]
  ds_read_b64_tr_b16 a[22:23], v234 offset:45568
  v_mfma_f32_16x16x32_bf16 v[172:175], a[28:31], a[84:87], v[172:175]
  v_mfma_f32_16x16x32_bf16 v[172:175], a[24:27], a[68:71], v[172:175]
  ds_read_b64_tr_b16 a[24:25], v235 offset:30720
  v_mfma_f32_16x16x32_bf16 v[188:191], a[32:35], a[68:71], v[188:191]
  v_mfma_f32_16x16x32_bf16 v[188:191], a[36:39], a[84:87], v[188:191]
  ds_read_b64_tr_b16 a[26:27], v235 offset:31232
  v_mfma_f32_16x16x32_bf16 v[184:187], a[36:39], a[80:83], v[184:187]
  s_add_u32 m0, s23, 0x1780
  v_mfma_f32_16x16x32_bf16 v[184:187], a[32:35], a[64:67], v[184:187]
  ds_read_b64_tr_b16 a[28:29], v235 offset:45056
  v_mfma_f32_16x16x32_bf16 v[180:183], a[32:35], a[60:63], v[180:183]
  buffer_load_dwordx4 v230, s[8:11], s21 offen offset:128 lds
  v_mfma_f32_16x16x32_bf16 v[180:183], a[36:39], a[76:79], v[180:183]
  ds_read_b64_tr_b16 a[30:31], v235 offset:45568
  v_mfma_f32_16x16x32_bf16 v[176:179], a[36:39], a[72:75], v[176:179]
  v_mfma_f32_16x16x32_bf16 v[176:179], a[32:35], a[56:59], v[176:179]
  ds_read_b64_tr_b16 a[32:33], v232 offset:31744
  v_mfma_f32_16x16x32_bf16 v[192:195], a[40:43], a[56:59], v[192:195]
  s_add_u32 m0, s23, 0x1b00
  v_mfma_f32_16x16x32_bf16 v[192:195], a[44:47], a[72:75], v[192:195]
  ds_read_b64_tr_b16 a[34:35], v232 offset:32256
  v_mfma_f32_16x16x32_bf16 v[196:199], a[44:47], a[76:79], v[196:199]
  buffer_load_dwordx4 v230, s[8:11], s21 offen offset:256 lds
  v_mfma_f32_16x16x32_bf16 v[196:199], a[40:43], a[60:63], v[196:199]
  ds_read_b64_tr_b16 a[36:37], v232 offset:46080
  v_mfma_f32_16x16x32_bf16 v[200:203], a[40:43], a[64:67], v[200:203]
  v_mfma_f32_16x16x32_bf16 v[200:203], a[44:47], a[80:83], v[200:203]
  ds_read_b64_tr_b16 a[38:39], v232 offset:46592
  v_mfma_f32_16x16x32_bf16 v[204:207], a[44:47], a[84:87], v[204:207]
  v_mfma_f32_16x16x32_bf16 v[204:207], a[40:43], a[68:71], v[204:207]
  ds_read_b64_tr_b16 a[40:41], v233 offset:31744
  s_add_u32 m0, s23, 0x2000
  v_mfma_f32_16x16x32_bf16 v[220:223], a[48:51], a[68:71], v[220:223]
  buffer_load_dwordx4 v231, s[8:11], s21 offen lds
  v_mfma_f32_16x16x32_bf16 v[220:223], a[52:55], a[84:87], v[220:223]
  ds_read_b64_tr_b16 a[42:43], v233 offset:32256
  v_mfma_f32_16x16x32_bf16 v[216:219], a[52:55], a[80:83], v[216:219]
  v_mfma_f32_16x16x32_bf16 v[216:219], a[48:51], a[64:67], v[216:219]
  ds_read_b64_tr_b16 a[44:45], v233 offset:46080
  v_mfma_f32_16x16x32_bf16 v[212:215], a[48:51], a[60:63], v[212:215]
  v_mfma_f32_16x16x32_bf16 v[212:215], a[52:55], a[76:79], v[212:215]
  ds_read_b64_tr_b16 a[46:47], v233 offset:46592
  s_lshl_b32 s60, s100, 7
  s_add_u32 s60, s60, 0xa8000
  v_mfma_f32_16x16x32_bf16 v[208:211], a[52:55], a[72:75], v[208:211]
  buffer_load_dword a224, off, s[16:19], s60
  s_add_u32 s21, s21, 0x70000
  v_mfma_f32_16x16x32_bf16 v[208:211], a[48:51], a[56:59], v[208:211]
  ds_read_b64_tr_b16 a[48:49], v234 offset:31744
  s_waitcnt lgkmcnt(8)
  v_mfma_f32_16x16x32_bf16 v[0:3], a[0:3], a[88:91], v[0:3]
  s_waitcnt vmcnt(34)
  ds_read_b128 a[56:59], v226 offset:0
  s_waitcnt vmcnt(31)
  v_mfma_f32_16x16x32_bf16 v[248:251], a[220:223], a[184:187], v[248:251]
  v_mfma_f32_16x16x32_bf16 v[0:3], a[4:7], a[104:107], v[0:3]
  ds_read_b64_tr_b16 a[50:51], v234 offset:32256
  v_mfma_f32_16x16x32_bf16 v[4:7], a[4:7], a[108:111], v[4:7]
  ds_read_b128 a[72:75], v227 offset:0
  v_mfma_f32_16x16x32_bf16 v[4:7], a[0:3], a[92:95], v[4:7]
  ds_read_b64_tr_b16 a[52:53], v234 offset:46080
  v_mfma_f32_16x16x32_bf16 v[8:11], a[0:3], a[96:99], v[8:11]
  s_waitcnt vmcnt(26)
  v_mfma_f32_16x16x32_bf16 v[248:251], a[220:223], a[188:191], v[248:251]
  v_mfma_f32_16x16x32_bf16 v[8:11], a[4:7], a[112:115], v[8:11]
  ds_read_b64_tr_b16 a[54:55], v234 offset:46592
  v_mfma_f32_16x16x32_bf16 v[12:15], a[4:7], a[116:119], v[12:15]
  v_mfma_f32_16x16x32_bf16 v[12:15], a[0:3], a[100:103], v[12:15]
  ds_read_b64_tr_b16 a[0:1], v235 offset:31744
  v_mfma_f32_16x16x32_bf16 v[28:31], a[8:11], a[100:103], v[28:31]
  s_add_u32 m0, s24, 0x300
  v_mfma_f32_16x16x32_bf16 v[28:31], a[12:15], a[116:119], v[28:31]
  ds_read_b64_tr_b16 a[2:3], v235 offset:32256
  v_mfma_f32_16x16x32_bf16 v[24:27], a[12:15], a[112:115], v[24:27]
  s_waitcnt lgkmcnt(4)
  buffer_load_dwordx4 v224, s[4:7], s62 offen offset:1280 lds
  v_mfma_f32_16x16x32_bf16 v[24:27], a[8:11], a[96:99], v[24:27]
  ds_read_b64_tr_b16 a[4:5], v235 offset:46080
  v_mfma_f32_16x16x32_bf16 v[20:23], a[8:11], a[92:95], v[20:23]
  v_mfma_f32_16x16x32_bf16 v[20:23], a[12:15], a[108:111], v[20:23]
  ds_read_b64_tr_b16 a[6:7], v235 offset:46592
  v_mfma_f32_16x16x32_bf16 v[16:19], a[12:15], a[104:107], v[16:19]
  ds_read_b128 a[60:63], v226 offset:2048
  s_add_u32 m0, s24, 0x700
  v_mfma_f32_16x16x32_bf16 v[16:19], a[8:11], a[88:91], v[16:19]
  ds_read_b64_tr_b16 a[8:9], v232 offset:32768
  v_mfma_f32_16x16x32_bf16 v[32:35], a[16:19], a[88:91], v[32:35]
  ds_read_b128 a[76:79], v227 offset:2048
  v_mfma_f32_16x16x32_bf16 v[32:35], a[20:23], a[104:107], v[32:35]
  ds_read_b64_tr_b16 a[10:11], v232 offset:33280
  v_mfma_f32_16x16x32_bf16 v[36:39], a[20:23], a[108:111], v[36:39]
  buffer_load_dwordx4 v225, s[4:7], s62 offen offset:1280 lds
  v_mfma_f32_16x16x32_bf16 v[36:39], a[16:19], a[92:95], v[36:39]
  ds_read_b64_tr_b16 a[12:13], v232 offset:47104
  v_mfma_f32_16x16x32_bf16 v[40:43], a[16:19], a[96:99], v[40:43]
  s_add_u32 m0, s24, 0xb00
  v_mfma_f32_16x16x32_bf16 v[40:43], a[20:23], a[112:115], v[40:43]
  ds_read_b64_tr_b16 a[14:15], v232 offset:47616
  v_mfma_f32_16x16x32_bf16 v[44:47], a[20:23], a[116:119], v[44:47]
  s_waitcnt lgkmcnt(3)
  buffer_load_dwordx4 v224, s[4:7], s63 offen offset:1280 lds
  v_mfma_f32_16x16x32_bf16 v[44:47], a[16:19], a[100:103], v[44:47]
  ds_read_b64_tr_b16 a[16:17], v233 offset:32768
  v_mfma_f32_16x16x32_bf16 v[60:63], a[24:27], a[100:103], v[60:63]
  v_mfma_f32_16x16x32_bf16 v[60:63], a[28:31], a[116:119], v[60:63]
  ds_read_b64_tr_b16 a[18:19], v233 offset:33280
  v_mfma_f32_16x16x32_bf16 v[56:59], a[28:31], a[112:115], v[56:59]
  s_add_u32 m0, s24, 0xf00
  v_mfma_f32_16x16x32_bf16 v[56:59], a[24:27], a[96:99], v[56:59]
  ds_read_b64_tr_b16 a[20:21], v233 offset:47104
  v_mfma_f32_16x16x32_bf16 v[52:55], a[24:27], a[92:95], v[52:55]
  ds_read_b128 a[64:67], v226 offset:4096
  v_mfma_f32_16x16x32_bf16 v[52:55], a[28:31], a[108:111], v[52:55]
  ds_read_b64_tr_b16 a[22:23], v233 offset:47616
  v_mfma_f32_16x16x32_bf16 v[48:51], a[28:31], a[104:107], v[48:51]
  ds_read_b128 a[80:83], v227 offset:4096
  v_mfma_f32_16x16x32_bf16 v[48:51], a[24:27], a[88:91], v[48:51]
  ds_read_b64_tr_b16 a[24:25], v234 offset:32768
  v_mfma_f32_16x16x32_bf16 v[64:67], a[32:35], a[88:91], v[64:67]
  buffer_load_dwordx4 v225, s[4:7], s63 offen offset:1280 lds
  s_add_u32 m0, s24, 0x1300
  v_mfma_f32_16x16x32_bf16 v[64:67], a[36:39], a[104:107], v[64:67]
  ds_read_b64_tr_b16 a[26:27], v234 offset:33280
  v_mfma_f32_16x16x32_bf16 v[68:71], a[36:39], a[108:111], v[68:71]
  s_waitcnt lgkmcnt(2)
  buffer_load_dwordx4 v224, s[4:7], s64 offen offset:1280 lds
  v_mfma_f32_16x16x32_bf16 v[68:71], a[32:35], a[92:95], v[68:71]
  ds_read_b64_tr_b16 a[28:29], v234 offset:47104
  v_mfma_f32_16x16x32_bf16 v[72:75], a[32:35], a[96:99], v[72:75]
  v_mfma_f32_16x16x32_bf16 v[72:75], a[36:39], a[112:115], v[72:75]
  ds_read_b64_tr_b16 a[30:31], v234 offset:47616
  v_mfma_f32_16x16x32_bf16 v[76:79], a[36:39], a[116:119], v[76:79]
  s_add_u32 m0, s24, 0x1700
  v_mfma_f32_16x16x32_bf16 v[76:79], a[32:35], a[100:103], v[76:79]
  ds_read_b64_tr_b16 a[32:33], v235 offset:32768
  v_mfma_f32_16x16x32_bf16 v[92:95], a[40:43], a[100:103], v[92:95]
  buffer_load_dwordx4 v225, s[4:7], s64 offen offset:1280 lds
  v_mfma_f32_16x16x32_bf16 v[92:95], a[44:47], a[116:119], v[92:95]
  ds_read_b64_tr_b16 a[34:35], v235 offset:33280
  v_mfma_f32_16x16x32_bf16 v[88:91], a[44:47], a[112:115], v[88:91]
  ds_read_b128 a[68:71], v226 offset:6144
  v_mfma_f32_16x16x32_bf16 v[88:91], a[40:43], a[96:99], v[88:91]
  ds_read_b64_tr_b16 a[36:37], v235 offset:47104
  v_mfma_f32_16x16x32_bf16 v[84:87], a[40:43], a[92:95], v[84:87]
  ds_read_b128 a[84:87], v227 offset:6144
  s_add_u32 m0, s24, 0x1b00
  v_mfma_f32_16x16x32_bf16 v[84:87], a[44:47], a[108:111], v[84:87]
  ds_read_b64_tr_b16 a[38:39], v235 offset:47616
  v_mfma_f32_16x16x32_bf16 v[80:83], a[44:47], a[104:107], v[80:83]
  s_waitcnt lgkmcnt(1)
  buffer_load_dwordx4 v224, s[4:7], s65 offen offset:1280 lds
  v_mfma_f32_16x16x32_bf16 v[80:83], a[40:43], a[88:91], v[80:83]
  ds_read_b64_tr_b16 a[40:41], v240 offset:30720
  v_mfma_f32_16x16x32_bf16 v[96:99], a[48:51], a[88:91], v[96:99]
  v_mfma_f32_16x16x32_bf16 v[96:99], a[52:55], a[104:107], v[96:99]
  ds_read_b64_tr_b16 a[42:43], v240 offset:30976
  v_mfma_f32_16x16x32_bf16 v[100:103], a[52:55], a[108:111], v[100:103]
  s_add_u32 m0, s24, 0x1f00
  v_mfma_f32_16x16x32_bf16 v[100:103], a[48:51], a[92:95], v[100:103]
  ds_read_b64_tr_b16 a[44:45], v240 offset:45056
  v_mfma_f32_16x16x32_bf16 v[104:107], a[48:51], a[96:99], v[104:107]
  buffer_load_dwordx4 v225, s[4:7], s65 offen offset:1280 lds
  v_mfma_f32_16x16x32_bf16 v[104:107], a[52:55], a[112:115], v[104:107]
  ds_read_b64_tr_b16 a[46:47], v240 offset:45312
  v_mfma_f32_16x16x32_bf16 v[108:111], a[52:55], a[116:119], v[108:111]
  v_mfma_f32_16x16x32_bf16 v[108:111], a[48:51], a[100:103], v[108:111]
  ds_read_b64_tr_b16 a[48:49], v241 offset:30720
  v_mfma_f32_16x16x32_bf16 v[124:127], a[0:3], a[100:103], v[124:127]
  ds_read_b64_tr_b16 a[50:51], v241 offset:30976
  s_getpc_b64 s[32:33]
L_k1_pc3_w1_0:
  s_mov_b32 s34, L_k1_spin_w1-L_k1_pc3_w1_0
  s_bfe_u32 s60, s2, 0x40003
  s_lshl_b32 s60, s60, 2
  s_add_u32 s60, s60, s25
  s_lshl_b32 s60, s60, 9
  v_mfma_f32_16x16x32_bf16 v[124:127], a[4:7], a[116:119], v[124:127]
  ds_read_b64_tr_b16 a[52:53], v241 offset:45056
  s_waitcnt vmcnt(30)
  v_mfma_f32_16x16x32_bf16 v[248:251], a[220:223], a[192:195], v[248:251]
  v_mfma_f32_16x16x32_bf16 v[120:123], a[4:7], a[112:115], v[120:123]
  ds_read_b64_tr_b16 a[54:55], v241 offset:45312
  v_mfma_f32_16x16x32_bf16 v[120:123], a[0:3], a[96:99], v[120:123]
  s_mov_b64 exec, 15
  buffer_load_dword a224, v244, s[32:35], s60 offen
  s_mov_b64 exec, -1
  v_mfma_f32_16x16x32_bf16 v[116:119], a[0:3], a[92:95], v[116:119]
  v_mfma_f32_16x16x32_bf16 v[116:119], a[4:7], a[108:111], v[116:119]
  s_waitcnt vmcnt(28)
  v_mfma_f32_16x16x32_bf16 v[248:251], a[220:223], a[196:199], v[248:251]
  v_mfma_f32_16x16x32_bf16 v[112:115], a[4:7], a[104:107], v[112:115]
  v_mfma_f32_16x16x32_bf16 v[112:115], a[0:3], a[88:91], v[112:115]
  s_waitcnt lgkmcnt(0) vmcnt(26)
  s_barrier
  ds_read_b64_tr_b16 a[0:1], v236 offset:2048
  v_mfma_f32_16x16x32_bf16 v[128:131], a[8:11], a[88:91], v[128:131]
  s_add_u32 m0, s23, 0x7800
  v_mfma_f32_16x16x32_bf16 v[128:131], a[12:15], a[104:107], v[128:131]
  ds_read_b64_tr_b16 a[2:3], v236 offset:2560
  v_mfma_f32_16x16x32_bf16 v[132:135], a[12:15], a[108:111], v[132:135]
  buffer_load_dwordx4 v229, s[8:11], s21 offen offset:0 lds
  v_mfma_f32_16x16x32_bf16 v[132:135], a[8:11], a[92:95], v[132:135]
  ds_read_b64_tr_b16 a[4:5], v236 offset:16384
  v_mfma_f32_16x16x32_bf16 v[136:139], a[8:11], a[96:99], v[136:139]
  v_mfma_f32_16x16x32_bf16 v[136:139], a[12:15], a[112:115], v[136:139]
  ds_read_b64_tr_b16 a[6:7], v236 offset:16896
  v_mfma_f32_16x16x32_bf16 v[140:143], a[12:15], a[116:119], v[140:143]
  v_mfma_f32_16x16x32_bf16 v[140:143], a[8:11], a[100:103], v[140:143]
  ds_read_b64_tr_b16 a[8:9], v237 offset:2048
  s_add_u32 m0, s23, 0x7b80
  v_mfma_f32_16x16x32_bf16 v[156:159], a[16:19], a[100:103], v[156:159]
  buffer_load_dwordx4 v229, s[8:11], s21 offen offset:128 lds
  v_mfma_f32_16x16x32_bf16 v[156:159], a[20:23], a[116:119], v[156:159]
  ds_read_b64_tr_b16 a[10:11], v237 offset:2560
  v_add_f32_dpp v248, v248, v248 row_ror:8 row_mask:0xf bank_mask:0xf
  v_mfma_f32_16x16x32_bf16 v[152:155], a[20:23], a[112:115], v[152:155]
  v_add_f32_dpp v249, v249, v249 row_ror:8 row_mask:0xf bank_mask:0xf
  v_mfma_f32_16x16x32_bf16 v[152:155], a[16:19], a[96:99], v[152:155]
  ds_read_b64_tr_b16 a[12:13], v237 offset:16384
  v_add_f32_dpp v250, v250, v250 row_ror:8 row_mask:0xf bank_mask:0xf
  v_mfma_f32_16x16x32_bf16 v[148:151], a[16:19], a[92:95], v[148:151]
  v_add_f32_dpp v251, v251, v251 row_ror:8 row_mask:0xf bank_mask:0xf
  v_mfma_f32_16x16x32_bf16 v[148:151], a[20:23], a[108:111], v[148:151]
  ds_read_b64_tr_b16 a[14:15], v237 offset:16896
  v_and_b32 v254, s54, v248
  v_mfma_f32_16x16x32_bf16 v[144:147], a[20:23], a[104:107], v[144:147]
  s_add_u32 m0, s23, 0x7f00
  v_sub_f32 v254, v248, v254
  v_mfma_f32_16x16x32_bf16 v[144:147], a[16:19], a[88:91], v[144:147]
  ds_read_b64_tr_b16 a[16:17], v238 offset:2048
  v_and_b32 v255, s54, v254
  v_mfma_f32_16x16x32_bf16 v[160:163], a[24:27], a[88:91], v[160:163]
  buffer_load_dwordx4 v229, s[8:11], s21 offen offset:256 lds
  v_sub_f32 v255, v254, v255
  v_mfma_f32_16x16x32_bf16 v[160:163], a[28:31], a[104:107], v[160:163]
  ds_read_b64_tr_b16 a[18:19], v238 offset:2560
  s_mov_b32 s61, 0x07060302
  v_perm_b32 v252, v254, v248, s61
  v_mfma_f32_16x16x32_bf16 v[164:167], a[28:31], a[108:111], v[164:167]
  s_mov_b32 s61, 0x05040302
  v_perm_b32 v253, v246, v255, s61
  v_mfma_f32_16x16x32_bf16 v[164:167], a[24:27], a[92:95], v[164:167]
  ds_read_b64_tr_b16 a[20:21], v238 offset:16384
  buffer_store_dwordx2 v[252:253], v245, s[16:19], s52 offen offset:0 sc1
  v_mfma_f32_16x16x32_bf16 v[168:171], a[24:27], a[96:99], v[168:171]
  v_mfma_f32_16x16x32_bf16 v[168:171], a[28:31], a[112:115], v[168:171]
  ds_read_b64_tr_b16 a[22:23], v238 offset:16896
  v_and_b32 v254, s54, v249
  v_mfma_f32_16x16x32_bf16 v[172:175], a[28:31], a[116:119], v[172:175]
  s_add_u32 m0, s23, 0x8400
  v_sub_f32 v254, v249, v254
  v_mfma_f32_16x16x32_bf16 v[172:175], a[24:27], a[100:103], v[172:175]
  ds_read_b64_tr_b16 a[24:25], v239 offset:2048
  v_and_b32 v255, s54, v254
  v_mfma_f32_16x16x32_bf16 v[188:191], a[32:35], a[100:103], v[188:191]
  buffer_load_dwordx4 v230, s[8:11], s21 offen offset:0 lds
  v_sub_f32 v255, v254, v255
  v_mfma_f32_16x16x32_bf16 v[188:191], a[36:39], a[116:119], v[188:191]
  ds_read_b64_tr_b16 a[26:27], v239 offset:2560
  s_mov_b32 s61, 0x07060302
  v_perm_b32 v252, v254, v249, s61
  v_mfma_f32_16x16x32_bf16 v[184:187], a[36:39], a[112:115], v[184:187]
  s_mov_b32 s61, 0x07060302
  v_perm_b32 v253, v246, v255, s61
  v_mfma_f32_16x16x32_bf16 v[184:187], a[32:35], a[96:99], v[184:187]
  ds_read_b64_tr_b16 a[28:29], v239 offset:16384
  buffer_store_dwordx2 v[252:253], v245, s[16:19], s52 offen offset:16 sc1
  v_mfma_f32_16x16x32_bf16 v[180:183], a[32:35], a[92:95], v[180:183]
  v_mfma_f32_16x16x32_bf16 v[180:183], a[36:39], a[108:111], v[180:183]
  ds_read_b64_tr_b16 a[30:31], v239 offset:16896
  s_add_u32 m0, s23, 0x8780
  v_mfma_f32_16x16x32_bf16 v[176:179], a[36:39], a[104:107], v[176:179]
  buffer_load_dwordx4 v230, s[8:11], s21 offen offset:128 lds
  v_and_b32 v254, s54, v250
  v_mfma_f32_16x16x32_bf16 v[176:179], a[32:35], a[88:91], v[176:179]
  ds_read_b64_tr_b16 a[32:33], v236 offset:3072
  v_sub_f32 v254, v250, v254
  v_mfma_f32_16x16x32_bf16 v[192:195], a[40:43], a[88:91], v[192:195]
  v_and_b32 v255, s54, v254
  v_mfma_f32_16x16x32_bf16 v[192:195], a[44:47], a[104:107], v[192:195]
  ds_read_b64_tr_b16 a[34:35], v236 offset:3584
  v_sub_f32 v255, v254, v255
  v_mfma_f32_16x16x32_bf16 v[196:199], a[44:47], a[108:111], v[196:199]
  s_mov_b32 s61, 0x07060302
  v_perm_b32 v252, v254, v250, s61
  v_mfma_f32_16x16x32_bf16 v[196:199], a[40:43], a[92:95], v[196:199]
  ds_read_b64_tr_b16 a[36:37], v236 offset:17408
  s_mov_b32 s61, 0x05040302
  v_perm_b32 v253, v247, v255, s61
  v_mfma_f32_16x16x32_bf16 v[200:203], a[40:43], a[96:99], v[200:203]
  buffer_store_dwordx2 v[252:253], v245, s[16:19], s52 offen offset:32 sc1
  v_mfma_f32_16x16x32_bf16 v[200:203], a[44:47], a[112:115], v[200:203]
  ds_read_b64_tr_b16 a[38:39], v236 offset:17920
  s_add_u32 m0, s23, 0x8b00
  v_mfma_f32_16x16x32_bf16 v[204:207], a[44:47], a[116:119], v[204:207]
  buffer_load_dwordx4 v230, s[8:11], s21 offen offset:256 lds
  v_and_b32 v254, s54, v251
  v_mfma_f32_16x16x32_bf16 v[204:207], a[40:43], a[100:103], v[204:207]
  ds_read_b64_tr_b16 a[40:41], v237 offset:3072
  v_sub_f32 v254, v251, v254
  v_mfma_f32_16x16x32_bf16 v[220:223], a[48:51], a[100:103], v[220:223]
  v_and_b32 v255, s54, v254
  v_mfma_f32_16x16x32_bf16 v[220:223], a[52:55], a[116:119], v[220:223]
  ds_read_b64_tr_b16 a[42:43], v237 offset:3584
  v_sub_f32 v255, v254, v255
  v_mfma_f32_16x16x32_bf16 v[216:219], a[52:55], a[112:115], v[216:219]
  s_mov_b32 s61, 0x07060302
  v_perm_b32 v252, v254, v251, s61
  v_mfma_f32_16x16x32_bf16 v[216:219], a[48:51], a[96:99], v[216:219]
  ds_read_b64_tr_b16 a[44:45], v237 offset:17408
  s_mov_b32 s61, 0x07060302
  v_perm_b32 v253, v247, v255, s61
  v_mfma_f32_16x16x32_bf16 v[212:215], a[48:51], a[92:95], v[212:215]
  s_add_u32 m0, s23, 0x9000
  buffer_store_dwordx2 v[252:253], v245, s[16:19], s52 offen offset:48 sc1
  v_mfma_f32_16x16x32_bf16 v[212:215], a[52:55], a[108:111], v[212:215]
  ds_read_b64_tr_b16 a[46:47], v237 offset:17920
  v_mfma_f32_16x16x32_bf16 v[208:211], a[52:55], a[104:107], v[208:211]
  buffer_load_dwordx4 v231, s[8:11], s21 offen lds
  s_add_u32 s21, s21, 0x70000
  v_mfma_f32_16x16x32_bf16 v[208:211], a[48:51], a[88:91], v[208:211]
  ds_read_b64_tr_b16 a[48:49], v238 offset:3072
  s_waitcnt lgkmcnt(8)
  v_mfma_f32_16x16x32_bf16 v[0:3], a[0:3], a[56:59], v[0:3]
  s_waitcnt vmcnt(34)
  ds_read_b128 a[88:91], v226 offset:8192
  v_mfma_f32_16x16x32_bf16 v[0:3], a[4:7], a[72:75], v[0:3]
  ds_read_b64_tr_b16 a[50:51], v238 offset:3584
  v_mfma_f32_16x16x32_bf16 v[4:7], a[4:7], a[76:79], v[4:7]
  ds_read_b128 a[104:107], v227 offset:8192
  v_mfma_f32_16x16x32_bf16 v[4:7], a[0:3], a[60:63], v[4:7]
  ds_read_b64_tr_b16 a[52:53], v238 offset:17408
  v_mfma_f32_16x16x32_bf16 v[8:11], a[0:3], a[64:67], v[8:11]
  v_mfma_f32_16x16x32_bf16 v[8:11], a[4:7], a[80:83], v[8:11]
  ds_read_b64_tr_b16 a[54:55], v238 offset:17920
  v_mfma_f32_16x16x32_bf16 v[12:15], a[4:7], a[84:87], v[12:15]
  v_mfma_f32_16x16x32_bf16 v[12:15], a[0:3], a[68:71], v[12:15]
  ds_read_b64_tr_b16 a[0:1], v239 offset:3072
  v_mfma_f32_16x16x32_bf16 v[28:31], a[8:11], a[68:71], v[28:31]
  s_add_u32 m0, s24, 0x2280
  v_mfma_f32_16x16x32_bf16 v[28:31], a[12:15], a[84:87], v[28:31]
  ds_read_b64_tr_b16 a[2:3], v239 offset:3584
  v_mfma_f32_16x16x32_bf16 v[24:27], a[12:15], a[80:83], v[24:27]
  s_waitcnt lgkmcnt(4)
  buffer_load_dwordx4 v224, s[4:7], s62 offen offset:1408 lds
  v_mfma_f32_16x16x32_bf16 v[24:27], a[8:11], a[64:67], v[24:27]
  ds_read_b64_tr_b16 a[4:5], v239 offset:17408
  v_mfma_f32_16x16x32_bf16 v[20:23], a[8:11], a[60:63], v[20:23]
  v_mfma_f32_16x16x32_bf16 v[20:23], a[12:15], a[76:79], v[20:23]
  ds_read_b64_tr_b16 a[6:7], v239 offset:17920
  v_mfma_f32_16x16x32_bf16 v[16:19], a[12:15], a[72:75], v[16:19]
  s_waitcnt vmcnt(33)
  ds_read_b128 a[92:95], v226 offset:10240
  s_add_u32 m0, s24, 0x2680
  v_mfma_f32_16x16x32_bf16 v[16:19], a[8:11], a[56:59], v[16:19]
  ds_read_b64_tr_b16 a[8:9], v236 offset:4096
  v_mfma_f32_16x16x32_bf16 v[32:35], a[16:19], a[56:59], v[32:35]
  ds_read_b128 a[108:111], v227 offset:10240
  v_mfma_f32_16x16x32_bf16 v[32:35], a[20:23], a[72:75], v[32:35]
  ds_read_b64_tr_b16 a[10:11], v236 offset:4608
  v_mfma_f32_16x16x32_bf16 v[36:39], a[20:23], a[76:79], v[36:39]
  buffer_load_dwordx4 v225, s[4:7], s62 offen offset:1408 lds
  v_mfma_f32_16x16x32_bf16 v[36:39], a[16:19], a[60:63], v[36:39]
  ds_read_b64_tr_b16 a[12:13], v236 offset:18432
  v_mfma_f32_16x16x32_bf16 v[40:43], a[16:19], a[64:67], v[40:43]
  v_mfma_f32_16x16x32_bf16 v[40:43], a[20:23], a[80:83], v[40:43]
  ds_read_b64_tr_b16 a[14:15], v236 offset:18944
  s_add_u32 m0, s24, 0x2a80
  v_mfma_f32_16x16x32_bf16 v[44:47], a[20:23], a[84:87], v[44:47]
  s_waitcnt lgkmcnt(3)
  buffer_load_dwordx4 v224, s[4:7], s63 offen offset:1408 lds
  v_mfma_f32_16x16x32_bf16 v[44:47], a[16:19], a[68:71], v[44:47]
  ds_read_b64_tr_b16 a[16:17], v237 offset:4096
  v_mfma_f32_16x16x32_bf16 v[60:63], a[24:27], a[68:71], v[60:63]
  v_mfma_f32_16x16x32_bf16 v[60:63], a[28:31], a[84:87], v[60:63]
  ds_read_b64_tr_b16 a[18:19], v237 offset:4608
  v_mfma_f32_16x16x32_bf16 v[56:59], a[28:31], a[80:83], v[56:59]
  v_mfma_f32_16x16x32_bf16 v[56:59], a[24:27], a[64:67], v[56:59]
  ds_read_b64_tr_b16 a[20:21], v237 offset:18432
  v_mfma_f32_16x16x32_bf16 v[52:55], a[24:27], a[60:63], v[52:55]
  s_waitcnt vmcnt(33)
  ds_read_b128 a[96:99], v226 offset:12288
  s_add_u32 m0, s24, 0x2e80
  v_mfma_f32_16x16x32_bf16 v[52:55], a[28:31], a[76:79], v[52:55]
  ds_read_b64_tr_b16 a[22:23], v237 offset:18944
  v_mfma_f32_16x16x32_bf16 v[48:51], a[28:31], a[72:75], v[48:51]
  ds_read_b128 a[112:115], v227 offset:12288
  v_mfma_f32_16x16x32_bf16 v[48:51], a[24:27], a[56:59], v[48:51]
  ds_read_b64_tr_b16 a[24:25], v238 offset:4096
  v_mfma_f32_16x16x32_bf16 v[64:67], a[32:35], a[56:59], v[64:67]
  buffer_load_dwordx4 v225, s[4:7], s63 offen offset:1408 lds
  v_mfma_f32_16x16x32_bf16 v[64:67], a[36:39], a[72:75], v[64:67]
  ds_read_b64_tr_b16 a[26:27], v238 offset:4608
  v_mfma_f32_16x16x32_bf16 v[68:71], a[36:39], a[76:79], v[68:71]
  v_mfma_f32_16x16x32_bf16 v[68:71], a[32:35], a[60:63], v[68:71]
  ds_read_b64_tr_b16 a[28:29], v238 offset:18432
  s_add_u32 m0, s24, 0x3280
  v_mfma_f32_16x16x32_bf16 v[72:75], a[32:35], a[64:67], v[72:75]
  s_waitcnt lgkmcnt(3)
  buffer_load_dwordx4 v224, s[4:7], s64 offen offset:1408 lds
  v_mfma_f32_16x16x32_bf16 v[72:75], a[36:39], a[80:83], v[72:75]
  ds_read_b64_tr_b16 a[30:31], v238 offset:18944
  v_mfma_f32_16x16x32_bf16 v[76:79], a[36:39], a[84:87], v[76:79]
  v_mfma_f32_16x16x32_bf16 v[76:79], a[32:35], a[68:71], v[76:79]
  ds_read_b64_tr_b16 a[32:33], v239 offset:4096
  v_mfma_f32_16x16x32_bf16 v[92:95], a[40:43], a[68:71], v[92:95]
  v_mfma_f32_16x16x32_bf16 v[92:95], a[44:47], a[84:87], v[92:95]
  ds_read_b64_tr_b16 a[34:35], v239 offset:4608
  v_mfma_f32_16x16x32_bf16 v[88:91], a[44:47], a[80:83], v[88:91]
  s_waitcnt vmcnt(33)
  ds_read_b128 a[100:103], v226 offset:14336
  s_add_u32 m0, s24, 0x3680
  v_mfma_f32_16x16x32_bf16 v[88:91], a[40:43], a[64:67], v[88:91]
  ds_read_b64_tr_b16 a[36:37], v239 offset:18432
  v_mfma_f32_16x16x32_bf16 v[84:87], a[40:43], a[60:63], v[84:87]
  ds_read_b128 a[116:119], v227 offset:14336
  v_mfma_f32_16x16x32_bf16 v[84:87], a[44:47], a[76:79], v[84:87]
  ds_read_b64_tr_b16 a[38:39], v239 offset:18944
  v_mfma_f32_16x16x32_bf16 v[80:83], a[44:47], a[72:75], v[80:83]
  buffer_load_dwordx4 v225, s[4:7], s64 offen offset:1408 lds
  v_mfma_f32_16x16x32_bf16 v[80:83], a[40:43], a[56:59], v[80:83]
  ds_read_b64_tr_b16 a[40:41], v242 offset:2048
  v_mfma_f32_16x16x32_bf16 v[96:99], a[48:51], a[56:59], v[96:99]
  v_mfma_f32_16x16x32_bf16 v[96:99], a[52:55], a[72:75], v[96:99]
  ds_read_b64_tr_b16 a[42:43], v242 offset:2304
  s_add_u32 m0, s24, 0x3a80
  v_mfma_f32_16x16x32_bf16 v[100:103], a[52:55], a[76:79], v[100:103]
  s_waitcnt lgkmcnt(3)
  buffer_load_dwordx4 v224, s[4:7], s65 offen offset:1408 lds
  v_mfma_f32_16x16x32_bf16 v[100:103], a[48:51], a[60:63], v[100:103]
  ds_read_b64_tr_b16 a[44:45], v242 offset:16384
  v_mfma_f32_16x16x32_bf16 v[104:107], a[48:51], a[64:67], v[104:107]
  v_mfma_f32_16x16x32_bf16 v[104:107], a[52:55], a[80:83], v[104:107]
  ds_read_b64_tr_b16 a[46:47], v242 offset:16640
  v_mfma_f32_16x16x32_bf16 v[108:111], a[52:55], a[84:87], v[108:111]
  v_mfma_f32_16x16x32_bf16 v[108:111], a[48:51], a[68:71], v[108:111]
  ds_read_b64_tr_b16 a[48:49], v243 offset:2048
  v_mfma_f32_16x16x32_bf16 v[124:127], a[0:3], a[68:71], v[124:127]
  ds_read_b64_tr_b16 a[50:51], v243 offset:2304
  s_add_u32 m0, s24, 0x3e80
  v_mfma_f32_16x16x32_bf16 v[124:127], a[4:7], a[84:87], v[124:127]
  ds_read_b64_tr_b16 a[52:53], v243 offset:16384
  v_mfma_f32_16x16x32_bf16 v[120:123], a[4:7], a[80:83], v[120:123]
  ds_read_b64_tr_b16 a[54:55], v243 offset:16640
  v_mfma_f32_16x16x32_bf16 v[120:123], a[0:3], a[64:67], v[120:123]
  buffer_load_dwordx4 v225, s[4:7], s65 offen offset:1408 lds
  v_mfma_f32_16x16x32_bf16 v[116:119], a[0:3], a[60:63], v[116:119]
  v_mfma_f32_16x16x32_bf16 v[116:119], a[4:7], a[76:79], v[116:119]
  v_mfma_f32_16x16x32_bf16 v[112:115], a[4:7], a[72:75], v[112:115]
  v_mfma_f32_16x16x32_bf16 v[112:115], a[0:3], a[56:59], v[112:115]
  s_waitcnt lgkmcnt(0) vmcnt(29)
  s_barrier
  ds_read_b64_tr_b16 a[0:1], v232 offset:2048
  v_mfma_f32_16x16x32_bf16 v[128:131], a[8:11], a[56:59], v[128:131]
  s_add_u32 m0, s23, 0xe800
  v_mfma_f32_16x16x32_bf16 v[128:131], a[12:15], a[72:75], v[128:131]
  ds_read_b64_tr_b16 a[2:3], v232 offset:2560
  v_mfma_f32_16x16x32_bf16 v[132:135], a[12:15], a[76:79], v[132:135]
  buffer_load_dwordx4 v229, s[8:11], s21 offen offset:0 lds
  v_mfma_f32_16x16x32_bf16 v[132:135], a[8:11], a[60:63], v[132:135]
  ds_read_b64_tr_b16 a[4:5], v232 offset:16384
  v_mfma_f32_16x16x32_bf16 v[136:139], a[8:11], a[64:67], v[136:139]
  v_mfma_f32_16x16x32_bf16 v[136:139], a[12:15], a[80:83], v[136:139]
  ds_read_b64_tr_b16 a[6:7], v232 offset:16896
  v_mfma_f32_16x16x32_bf16 v[140:143], a[12:15], a[84:87], v[140:143]
  v_mfma_f32_16x16x32_bf16 v[140:143], a[8:11], a[68:71], v[140:143]
  ds_read_b64_tr_b16 a[8:9], v233 offset:2048
  s_add_u32 m0, s23, 0xeb80
  v_mfma_f32_16x16x32_bf16 v[156:159], a[16:19], a[68:71], v[156:159]
  buffer_load_dwordx4 v229, s[8:11], s21 offen offset:128 lds
  v_mfma_f32_16x16x32_bf16 v[156:159], a[20:23], a[84:87], v[156:159]
  ds_read_b64_tr_b16 a[10:11], v233 offset:2560
  v_mfma_f32_16x16x32_bf16 v[152:155], a[20:23], a[80:83], v[152:155]
  v_mfma_f32_16x16x32_bf16 v[152:155], a[16:19], a[64:67], v[152:155]
  ds_read_b64_tr_b16 a[12:13], v233 offset:16384
  v_mfma_f32_16x16x32_bf16 v[148:151], a[16:19], a[60:63], v[148:151]
  v_mfma_f32_16x16x32_bf16 v[148:151], a[20:23], a[76:79], v[148:151]
  ds_read_b64_tr_b16 a[14:15], v233 offset:16896
  v_mfma_f32_16x16x32_bf16 v[144:147], a[20:23], a[72:75], v[144:147]
  s_add_u32 m0, s23, 0xef00
  v_mfma_f32_16x16x32_bf16 v[144:147], a[16:19], a[56:59], v[144:147]
  ds_read_b64_tr_b16 a[16:17], v234 offset:2048
  v_mfma_f32_16x16x32_bf16 v[160:163], a[24:27], a[56:59], v[160:163]
  buffer_load_dwordx4 v229, s[8:11], s21 offen offset:256 lds
  v_mfma_f32_16x16x32_bf16 v[160:163], a[28:31], a[72:75], v[160:163]
  ds_read_b64_tr_b16 a[18:19], v234 offset:2560
  v_mfma_f32_16x16x32_bf16 v[164:167], a[28:31], a[76:79], v[164:167]
  v_mfma_f32_16x16x32_bf16 v[164:167], a[24:27], a[60:63], v[164:167]
  ds_read_b64_tr_b16 a[20:21], v234 offset:16384
  v_mfma_f32_16x16x32_bf16 v[168:171], a[24:27], a[64:67], v[168:171]
  v_mfma_f32_16x16x32_bf16 v[168:171], a[28:31], a[80:83], v[168:171]
  ds_read_b64_tr_b16 a[22:23], v234 offset:16896
  v_mfma_f32_16x16x32_bf16 v[172:175], a[28:31], a[84:87], v[172:175]
  s_add_u32 m0, s23, 0xf400
  v_mfma_f32_16x16x32_bf16 v[172:175], a[24:27], a[68:71], v[172:175]
  ds_read_b64_tr_b16 a[24:25], v235 offset:2048
  v_mfma_f32_16x16x32_bf16 v[188:191], a[32:35], a[68:71], v[188:191]
  buffer_load_dwordx4 v230, s[8:11], s21 offen offset:0 lds
  v_mfma_f32_16x16x32_bf16 v[188:191], a[36:39], a[84:87], v[188:191]
  ds_read_b64_tr_b16 a[26:27], v235 offset:2560
  v_mfma_f32_16x16x32_bf16 v[184:187], a[36:39], a[80:83], v[184:187]
  v_mfma_f32_16x16x32_bf16 v[184:187], a[32:35], a[64:67], v[184:187]
  ds_read_b64_tr_b16 a[28:29], v235 offset:16384
  v_mfma_f32_16x16x32_bf16 v[180:183], a[32:35], a[60:63], v[180:183]
  v_mfma_f32_16x16x32_bf16 v[180:183], a[36:39], a[76:79], v[180:183]
  ds_read_b64_tr_b16 a[30:31], v235 offset:16896
  s_add_u32 m0, s23, 0xf780
  v_mfma_f32_16x16x32_bf16 v[176:179], a[36:39], a[72:75], v[176:179]
  buffer_load_dwordx4 v230, s[8:11], s21 offen offset:128 lds
  v_mfma_f32_16x16x32_bf16 v[176:179], a[32:35], a[56:59], v[176:179]
  ds_read_b64_tr_b16 a[32:33], v232 offset:3072
  v_mfma_f32_16x16x32_bf16 v[192:195], a[40:43], a[56:59], v[192:195]
  v_mfma_f32_16x16x32_bf16 v[192:195], a[44:47], a[72:75], v[192:195]
  ds_read_b64_tr_b16 a[34:35], v232 offset:3584
  v_mfma_f32_16x16x32_bf16 v[196:199], a[44:47], a[76:79], v[196:199]
  v_mfma_f32_16x16x32_bf16 v[196:199], a[40:43], a[60:63], v[196:199]
  ds_read_b64_tr_b16 a[36:37], v232 offset:17408
  v_mfma_f32_16x16x32_bf16 v[200:203], a[40:43], a[64:67], v[200:203]
  v_mfma_f32_16x16x32_bf16 v[200:203], a[44:47], a[80:83], v[200:203]
  ds_read_b64_tr_b16 a[38:39], v232 offset:17920
  s_add_u32 m0, s23, 0xfb00
  v_mfma_f32_16x16x32_bf16 v[204:207], a[44:47], a[84:87], v[204:207]
  buffer_load_dwordx4 v230, s[8:11], s21 offen offset:256 lds
  v_mfma_f32_16x16x32_bf16 v[204:207], a[40:43], a[68:71], v[204:207]
  ds_read_b64_tr_b16 a[40:41], v233 offset:3072
  v_mfma_f32_16x16x32_bf16 v[220:223], a[48:51], a[68:71], v[220:223]
  v_mfma_f32_16x16x32_bf16 v[220:223], a[52:55], a[84:87], v[220:223]
  ds_read_b64_tr_b16 a[42:43], v233 offset:3584
  v_mfma_f32_16x16x32_bf16 v[216:219], a[52:55], a[80:83], v[216:219]
  v_mfma_f32_16x16x32_bf16 v[216:219], a[48:51], a[64:67], v[216:219]
  ds_read_b64_tr_b16 a[44:45], v233 offset:17408
  v_mfma_f32_16x16x32_bf16 v[212:215], a[48:51], a[60:63], v[212:215]
  s_add_u32 m0, s23, 0x10000
  v_mfma_f32_16x16x32_bf16 v[212:215], a[52:55], a[76:79], v[212:215]
  ds_read_b64_tr_b16 a[46:47], v233 offset:17920
  v_mfma_f32_16x16x32_bf16 v[208:211], a[52:55], a[72:75], v[208:211]
  buffer_load_dwordx4 v231, s[8:11], s21 offen lds
  s_add_u32 s21, s21, 0x70000
  v_mfma_f32_16x16x32_bf16 v[208:211], a[48:51], a[56:59], v[208:211]
  ds_read_b64_tr_b16 a[48:49], v234 offset:3072
  s_waitcnt lgkmcnt(8)
  v_mfma_f32_16x16x32_bf16 v[0:3], a[0:3], a[88:91], v[0:3]
  s_waitcnt vmcnt(33)
  ds_read_b128 a[56:59], v226 offset:0
  v_mfma_f32_16x16x32_bf16 v[0:3], a[4:7], a[104:107], v[0:3]
  ds_read_b64_tr_b16 a[50:51], v234 offset:3584
  v_mfma_f32_16x16x32_bf16 v[4:7], a[4:7], a[108:111], v[4:7]
  ds_read_b128 a[72:75], v227 offset:0
  v_mfma_f32_16x16x32_bf16 v[4:7], a[0:3], a[92:95], v[4:7]
  ds_read_b64_tr_b16 a[52:53], v234 offset:17408
  v_mfma_f32_16x16x32_bf16 v[8:11], a[0:3], a[96:99], v[8:11]
  v_mfma_f32_16x16x32_bf16 v[8:11], a[4:7], a[112:115], v[8:11]
  ds_read_b64_tr_b16 a[54:55], v234 offset:17920
  v_mfma_f32_16x16x32_bf16 v[12:15], a[4:7], a[116:119], v[12:15]
  v_mfma_f32_16x16x32_bf16 v[12:15], a[0:3], a[100:103], v[12:15]
  ds_read_b64_tr_b16 a[0:1], v235 offset:3072
  v_mfma_f32_16x16x32_bf16 v[28:31], a[8:11], a[100:103], v[28:31]
  s_add_u32 m0, s24, 0x200
  v_mfma_f32_16x16x32_bf16 v[28:31], a[12:15], a[116:119], v[28:31]
  ds_read_b64_tr_b16 a[2:3], v235 offset:3584
  v_mfma_f32_16x16x32_bf16 v[24:27], a[12:15], a[112:115], v[24:27]
  s_waitcnt lgkmcnt(4)
  buffer_load_dwordx4 v224, s[4:7], s62 offen offset:1536 lds
  v_mfma_f32_16x16x32_bf16 v[24:27], a[8:11], a[96:99], v[24:27]
  ds_read_b64_tr_b16 a[4:5], v235 offset:17408
  v_mfma_f32_16x16x32_bf16 v[20:23], a[8:11], a[92:95], v[20:23]
  v_mfma_f32_16x16x32_bf16 v[20:23], a[12:15], a[108:111], v[20:23]
  ds_read_b64_tr_b16 a[6:7], v235 offset:17920
  v_mfma_f32_16x16x32_bf16 v[16:19], a[12:15], a[104:107], v[16:19]
  s_waitcnt vmcnt(32)
  ds_read_b128 a[60:63], v226 offset:2048
  s_add_u32 m0, s24, 0x600
  v_mfma_f32_16x16x32_bf16 v[16:19], a[8:11], a[88:91], v[16:19]
  ds_read_b64_tr_b16 a[8:9], v232 offset:4096
  v_mfma_f32_16x16x32_bf16 v[32:35], a[16:19], a[88:91], v[32:35]
  ds_read_b128 a[76:79], v227 offset:2048
  v_mfma_f32_16x16x32_bf16 v[32:35], a[20:23], a[104:107], v[32:35]
  ds_read_b64_tr_b16 a[10:11], v232 offset:4608
  v_mfma_f32_16x16x32_bf16 v[36:39], a[20:23], a[108:111], v[36:39]
  buffer_load_dwordx4 v225, s[4:7], s62 offen offset:1536 lds
  v_mfma_f32_16x16x32_bf16 v[36:39], a[16:19], a[92:95], v[36:39]
  ds_read_b64_tr_b16 a[12:13], v232 offset:18432
  v_mfma_f32_16x16x32_bf16 v[40:43], a[16:19], a[96:99], v[40:43]
  v_mfma_f32_16x16x32_bf16 v[40:43], a[20:23], a[112:115], v[40:43]
  ds_read_b64_tr_b16 a[14:15], v232 offset:18944
  s_add_u32 m0, s24, 0xa00
  v_mfma_f32_16x16x32_bf16 v[44:47], a[20:23], a[116:119], v[44:47]
  s_waitcnt lgkmcnt(3)
  buffer_load_dwordx4 v224, s[4:7], s63 offen offset:1536 lds
  v_mfma_f32_16x16x32_bf16 v[44:47], a[16:19], a[100:103], v[44:47]
  ds_read_b64_tr_b16 a[16:17], v233 offset:4096
  v_mfma_f32_16x16x32_bf16 v[60:63], a[24:27], a[100:103], v[60:63]
  v_mfma_f32_16x16x32_bf16 v[60:63], a[28:31], a[116:119], v[60:63]
  ds_read_b64_tr_b16 a[18:19], v233 offset:4608
  v_mfma_f32_16x16x32_bf16 v[56:59], a[28:31], a[112:115], v[56:59]
  v_mfma_f32_16x16x32_bf16 v[56:59], a[24:27], a[96:99], v[56:59]
  ds_read_b64_tr_b16 a[20:21], v233 offset:18432
  v_mfma_f32_16x16x32_bf16 v[52:55], a[24:27], a[92:95], v[52:55]
  s_waitcnt vmcnt(32)
  ds_read_b128 a[64:67], v226 offset:4096
  s_add_u32 m0, s24, 0xe00
  v_mfma_f32_16x16x32_bf16 v[52:55], a[28:31], a[108:111], v[52:55]
  ds_read_b64_tr_b16 a[22:23], v233 offset:18944
  v_mfma_f32_16x16x32_bf16 v[48:51], a[28:31], a[104:107], v[48:51]
  ds_read_b128 a[80:83], v227 offset:4096
  v_mfma_f32_16x16x32_bf16 v[48:51], a[24:27], a[88:91], v[48:51]
  ds_read_b64_tr_b16 a[24:25], v234 offset:4096
  v_mfma_f32_16x16x32_bf16 v[64:67], a[32:35], a[88:91], v[64:67]
  buffer_load_dwordx4 v225, s[4:7], s63 offen offset:1536 lds
  v_mfma_f32_16x16x32_bf16 v[64:67], a[36:39], a[104:107], v[64:67]
  ds_read_b64_tr_b16 a[26:27], v234 offset:4608
  v_mfma_f32_16x16x32_bf16 v[68:71], a[36:39], a[108:111], v[68:71]
  v_mfma_f32_16x16x32_bf16 v[68:71], a[32:35], a[92:95], v[68:71]
  ds_read_b64_tr_b16 a[28:29], v234 offset:18432
  s_add_u32 m0, s24, 0x1200
  v_mfma_f32_16x16x32_bf16 v[72:75], a[32:35], a[96:99], v[72:75]
  s_waitcnt lgkmcnt(3)
  buffer_load_dwordx4 v224, s[4:7], s64 offen offset:1536 lds
  v_mfma_f32_16x16x32_bf16 v[72:75], a[36:39], a[112:115], v[72:75]
  ds_read_b64_tr_b16 a[30:31], v234 offset:18944
  v_mfma_f32_16x16x32_bf16 v[76:79], a[36:39], a[116:119], v[76:79]
  v_mfma_f32_16x16x32_bf16 v[76:79], a[32:35], a[100:103], v[76:79]
  ds_read_b64_tr_b16 a[32:33], v235 offset:4096
  v_mfma_f32_16x16x32_bf16 v[92:95], a[40:43], a[100:103], v[92:95]
  v_mfma_f32_16x16x32_bf16 v[92:95], a[44:47], a[116:119], v[92:95]
  ds_read_b64_tr_b16 a[34:35], v235 offset:4608
  v_mfma_f32_16x16x32_bf16 v[88:91], a[44:47], a[112:115], v[88:91]
  s_waitcnt vmcnt(32)
  ds_read_b128 a[68:71], v226 offset:6144
  s_add_u32 m0, s24, 0x1600
  v_mfma_f32_16x16x32_bf16 v[88:91], a[40:43], a[96:99], v[88:91]
  ds_read_b64_tr_b16 a[36:37], v235 offset:18432
  v_mfma_f32_16x16x32_bf16 v[84:87], a[40:43], a[92:95], v[84:87]
  ds_read_b128 a[84:87], v227 offset:6144
  v_mfma_f32_16x16x32_bf16 v[84:87], a[44:47], a[108:111], v[84:87]
  ds_read_b64_tr_b16 a[38:39], v235 offset:18944
  v_mfma_f32_16x16x32_bf16 v[80:83], a[44:47], a[104:107], v[80:83]
  buffer_load_dwordx4 v225, s[4:7], s64 offen offset:1536 lds
  v_mfma_f32_16x16x32_bf16 v[80:83], a[40:43], a[88:91], v[80:83]
  ds_read_b64_tr_b16 a[40:41], v240 offset:2048
  v_mfma_f32_16x16x32_bf16 v[96:99], a[48:51], a[88:91], v[96:99]
  v_mfma_f32_16x16x32_bf16 v[96:99], a[52:55], a[104:107], v[96:99]
  ds_read_b64_tr_b16 a[42:43], v240 offset:2304
  s_add_u32 m0, s24, 0x1a00
  v_mfma_f32_16x16x32_bf16 v[100:103], a[52:55], a[108:111], v[100:103]
  s_waitcnt lgkmcnt(3)
  buffer_load_dwordx4 v224, s[4:7], s65 offen offset:1536 lds
  v_mfma_f32_16x16x32_bf16 v[100:103], a[48:51], a[92:95], v[100:103]
  ds_read_b64_tr_b16 a[44:45], v240 offset:16384
  v_mfma_f32_16x16x32_bf16 v[104:107], a[48:51], a[96:99], v[104:107]
  v_mfma_f32_16x16x32_bf16 v[104:107], a[52:55], a[112:115], v[104:107]
  ds_read_b64_tr_b16 a[46:47], v240 offset:16640
  v_mfma_f32_16x16x32_bf16 v[108:111], a[52:55], a[116:119], v[108:111]
  v_mfma_f32_16x16x32_bf16 v[108:111], a[48:51], a[100:103], v[108:111]
  ds_read_b64_tr_b16 a[48:49], v241 offset:2048
  v_mfma_f32_16x16x32_bf16 v[124:127], a[0:3], a[100:103], v[124:127]
  ds_read_b64_tr_b16 a[50:51], v241 offset:2304
  s_add_u32 m0, s24, 0x1e00
  v_mfma_f32_16x16x32_bf16 v[124:127], a[4:7], a[116:119], v[124:127]
  ds_read_b64_tr_b16 a[52:53], v241 offset:16384
  v_mfma_f32_16x16x32_bf16 v[120:123], a[4:7], a[112:115], v[120:123]
  ds_read_b64_tr_b16 a[54:55], v241 offset:16640
  v_mfma_f32_16x16x32_bf16 v[120:123], a[0:3], a[96:99], v[120:123]
  buffer_load_dwordx4 v225, s[4:7], s65 offen offset:1536 lds
  v_mfma_f32_16x16x32_bf16 v[116:119], a[0:3], a[92:95], v[116:119]
  v_mfma_f32_16x16x32_bf16 v[116:119], a[4:7], a[108:111], v[116:119]
  v_mfma_f32_16x16x32_bf16 v[112:115], a[4:7], a[104:107], v[112:115]
  v_mfma_f32_16x16x32_bf16 v[112:115], a[0:3], a[88:91], v[112:115]
  s_waitcnt lgkmcnt(0) vmcnt(23)
  s_barrier
  ds_read_b64_tr_b16 a[0:1], v232 offset:30720
  v_mfma_f32_16x16x32_bf16 v[128:131], a[8:11], a[88:91], v[128:131]
  s_add_u32 m0, s23, 0x800
  v_mfma_f32_16x16x32_bf16 v[128:131], a[12:15], a[104:107], v[128:131]
  ds_read_b64_tr_b16 a[2:3], v232 offset:31232
  v_mfma_f32_16x16x32_bf16 v[132:135], a[12:15], a[108:111], v[132:135]
  buffer_load_dwordx4 v229, s[8:11], s21 offen offset:0 lds
  v_mfma_f32_16x16x32_bf16 v[132:135], a[8:11], a[92:95], v[132:135]
  ds_read_b64_tr_b16 a[4:5], v232 offset:45056
  v_mfma_f32_16x16x32_bf16 v[136:139], a[8:11], a[96:99], v[136:139]
  v_mfma_f32_16x16x32_bf16 v[136:139], a[12:15], a[112:115], v[136:139]
  ds_read_b64_tr_b16 a[6:7], v232 offset:45568
  v_mfma_f32_16x16x32_bf16 v[140:143], a[12:15], a[116:119], v[140:143]
  s_add_u32 m0, s23, 0xb80
  v_mfma_f32_16x16x32_bf16 v[140:143], a[8:11], a[100:103], v[140:143]
  ds_read_b64_tr_b16 a[8:9], v233 offset:30720
  v_mfma_f32_16x16x32_bf16 v[156:159], a[16:19], a[100:103], v[156:159]
  buffer_load_dwordx4 v229, s[8:11], s21 offen offset:128 lds
  v_mfma_f32_16x16x32_bf16 v[156:159], a[20:23], a[116:119], v[156:159]
  ds_read_b64_tr_b16 a[10:11], v233 offset:31232
  v_mfma_f32_16x16x32_bf16 v[152:155], a[20:23], a[112:115], v[152:155]
  v_mfma_f32_16x16x32_bf16 v[152:155], a[16:19], a[96:99], v[152:155]
  ds_read_b64_tr_b16 a[12:13], v233 offset:45056
  v_mfma_f32_16x16x32_bf16 v[148:151], a[16:19], a[92:95], v[148:151]
  v_mfma_f32_16x16x32_bf16 v[148:151], a[20:23], a[108:111], v[148:151]
  ds_read_b64_tr_b16 a[14:15], v233 offset:45568
  s_add_u32 m0, s23, 0xf00
  v_mfma_f32_16x16x32_bf16 v[144:147], a[20:23], a[104:107], v[144:147]
  buffer_load_dwordx4 v229, s[8:11], s21 offen offset:256 lds
  v_mfma_f32_16x16x32_bf16 v[144:147], a[16:19], a[88:91], v[144:147]
  ds_read_b64_tr_b16 a[16:17], v234 offset:30720
  v_mfma_f32_16x16x32_bf16 v[160:163], a[24:27], a[88:91], v[160:163]
  v_mfma_f32_16x16x32_bf16 v[160:163], a[28:31], a[104:107], v[160:163]
  ds_read_b64_tr_b16 a[18:19], v234 offset:31232
  v_mfma_f32_16x16x32_bf16 v[164:167], a[28:31], a[108:111], v[164:167]
  v_mfma_f32_16x16x32_bf16 v[164:167], a[24:27], a[92:95], v[164:167]
  ds_read_b64_tr_b16 a[20:21], v234 offset:45056
  s_add_u32 m0, s23, 0x1400
  v_mfma_f32_16x16x32_bf16 v[168:171], a[24:27], a[96:99], v[168:171]
  buffer_load_dwordx4 v230, s[8:11], s21 offen offset:0 lds
  v_mfma_f32_16x16x32_bf16 v[168:171], a[28:31], a[112:115], v[168:171]
  ds_read_b64_tr_b16 a[22:23], v234 offset:45568
  v_mfma_f32_16x16x32_bf16 v[172:175], a[28:31], a[116:119], v[172:175]
  v_mfma_f32_16x16x32_bf16 v[172:175], a[24:27], a[100:103], v[172:175]
  ds_read_b64_tr_b16 a[24:25], v235 offset:30720
  v_mfma_f32_16x16x32_bf16 v[188:191], a[32:35], a[100:103], v[188:191]
  v_mfma_f32_16x16x32_bf16 v[188:191], a[36:39], a[116:119], v[188:191]
  ds_read_b64_tr_b16 a[26:27], v235 offset:31232
  v_mfma_f32_16x16x32_bf16 v[184:187], a[36:39], a[112:115], v[184:187]
  s_add_u32 m0, s23, 0x1780
  v_mfma_f32_16x16x32_bf16 v[184:187], a[32:35], a[96:99], v[184:187]
  ds_read_b64_tr_b16 a[28:29], v235 offset:45056
  v_mfma_f32_16x16x32_bf16 v[180:183], a[32:35], a[92:95], v[180:183]
  buffer_load_dwordx4 v230, s[8:11], s21 offen offset:128 lds
  v_mfma_f32_16x16x32_bf16 v[180:183], a[36:39], a[108:111], v[180:183]
  ds_read_b64_tr_b16 a[30:31], v235 offset:45568
  v_mfma_f32_16x16x32_bf16 v[176:179], a[36:39], a[104:107], v[176:179]
  v_mfma_f32_16x16x32_bf16 v[176:179], a[32:35], a[88:91], v[176:179]
  ds_read_b64_tr_b16 a[32:33], v232 offset:31744
  v_mfma_f32_16x16x32_bf16 v[192:195], a[40:43], a[88:91], v[192:195]
  s_add_u32 m0, s23, 0x1b00
  v_mfma_f32_16x16x32_bf16 v[192:195], a[44:47], a[104:107], v[192:195]
  ds_read_b64_tr_b16 a[34:35], v232 offset:32256
  v_mfma_f32_16x16x32_bf16 v[196:199], a[44:47], a[108:111], v[196:199]
  buffer_load_dwordx4 v230, s[8:11], s21 offen offset:256 lds
  v_mfma_f32_16x16x32_bf16 v[196:199], a[40:43], a[92:95], v[196:199]
  ds_read_b64_tr_b16 a[36:37], v232 offset:46080
  v_mfma_f32_16x16x32_bf16 v[200:203], a[40:43], a[96:99], v[200:203]
  v_mfma_f32_16x16x32_bf16 v[200:203], a[44:47], a[112:115], v[200:203]
  ds_read_b64_tr_b16 a[38:39], v232 offset:46592
  v_mfma_f32_16x16x32_bf16 v[204:207], a[44:47], a[116:119], v[204:207]
  v_mfma_f32_16x16x32_bf16 v[204:207], a[40:43], a[100:103], v[204:207]
  ds_read_b64_tr_b16 a[40:41], v233 offset:31744
  s_add_u32 m0, s23, 0x2000
  v_mfma_f32_16x16x32_bf16 v[220:223], a[48:51], a[100:103], v[220:223]
  buffer_load_dwordx4 v231, s[8:11], s21 offen lds
  v_mfma_f32_16x16x32_bf16 v[220:223], a[52:55], a[116:119], v[220:223]
  ds_read_b64_tr_b16 a[42:43], v233 offset:32256
  v_mfma_f32_16x16x32_bf16 v[216:219], a[52:55], a[112:115], v[216:219]
  v_mfma_f32_16x16x32_bf16 v[216:219], a[48:51], a[96:99], v[216:219]
  ds_read_b64_tr_b16 a[44:45], v233 offset:46080
  v_mfma_f32_16x16x32_bf16 v[212:215], a[48:51], a[92:95], v[212:215]
  v_mfma_f32_16x16x32_bf16 v[212:215], a[52:55], a[108:111], v[212:215]
  ds_read_b64_tr_b16 a[46:47], v233 offset:46592
  s_lshl_b32 s60, s2, 7
  v_mfma_f32_16x16x32_bf16 v[208:211], a[52:55], a[104:107], v[208:211]
  s_mov_b64 exec, 1
  buffer_store_dwordx2 a[226:227], off, s[40:43], s60 offset:64 sc1
  s_mov_b64 exec, -1
  s_add_u32 s21, s21, 0x70000
  v_mfma_f32_16x16x32_bf16 v[208:211], a[48:51], a[88:91], v[208:211]
  ds_read_b64_tr_b16 a[48:49], v234 offset:31744
  s_waitcnt lgkmcnt(8)
  v_mfma_f32_16x16x32_bf16 v[0:3], a[0:3], a[56:59], v[0:3]
  s_waitcnt vmcnt(29)
  ds_read_b128 a[88:91], v226 offset:8192
  v_mfma_f32_16x16x32_bf16 v[0:3], a[4:7], a[72:75], v[0:3]
  ds_read_b64_tr_b16 a[50:51], v234 offset:32256
  v_mfma_f32_16x16x32_bf16 v[4:7], a[4:7], a[76:79], v[4:7]
  ds_read_b128 a[104:107], v227 offset:8192
  v_mfma_f32_16x16x32_bf16 v[4:7], a[0:3], a[60:63], v[4:7]
  ds_read_b64_tr_b16 a[52:53], v234 offset:46080
  v_mfma_f32_16x16x32_bf16 v[8:11], a[0:3], a[64:67], v[8:11]
  v_mfma_f32_16x16x32_bf16 v[8:11], a[4:7], a[80:83], v[8:11]
  ds_read_b64_tr_b16 a[54:55], v234 offset:46592
  v_mfma_f32_16x16x32_bf16 v[12:15], a[4:7], a[84:87], v[12:15]
  v_mfma_f32_16x16x32_bf16 v[12:15], a[0:3], a[68:71], v[12:15]
  ds_read_b64_tr_b16 a[0:1], v235 offset:31744
  v_mfma_f32_16x16x32_bf16 v[28:31], a[8:11], a[68:71], v[28:31]
  s_add_u32 m0, s24, 0x2180
  v_mfma_f32_16x16x32_bf16 v[28:31], a[12:15], a[84:87], v[28:31]
  ds_read_b64_tr_b16 a[2:3], v235 offset:32256
  v_mfma_f32_16x16x32_bf16 v[24:27], a[12:15], a[80:83], v[24:27]
  s_waitcnt lgkmcnt(4)
  buffer_load_dwordx4 v224, s[4:7], s62 offen offset:1664 lds
  v_mfma_f32_16x16x32_bf16 v[24:27], a[8:11], a[64:67], v[24:27]
  ds_read_b64_tr_b16 a[4:5], v235 offset:46080
  v_mfma_f32_16x16x32_bf16 v[20:23], a[8:11], a[60:63], v[20:23]
  v_mfma_f32_16x16x32_bf16 v[20:23], a[12:15], a[76:79], v[20:23]
  ds_read_b64_tr_b16 a[6:7], v235 offset:46592
  v_mfma_f32_16x16x32_bf16 v[16:19], a[12:15], a[72:75], v[16:19]
  s_waitcnt vmcnt(28)
  ds_read_b128 a[92:95], v226 offset:10240
  s_add_u32 m0, s24, 0x2580
  v_mfma_f32_16x16x32_bf16 v[16:19], a[8:11], a[56:59], v[16:19]
  ds_read_b64_tr_b16 a[8:9], v232 offset:32768
  v_mfma_f32_16x16x32_bf16 v[32:35], a[16:19], a[56:59], v[32:35]
  ds_read_b128 a[108:111], v227 offset:10240
  v_mfma_f32_16x16x32_bf16 v[32:35], a[20:23], a[72:75], v[32:35]
  ds_read_b64_tr_b16 a[10:11], v232 offset:33280
  v_mfma_f32_16x16x32_bf16 v[36:39], a[20:23], a[76:79], v[36:39]
  buffer_load_dwordx4 v225, s[4:7], s62 offen offset:1664 lds
  v_mfma_f32_16x16x32_bf16 v[36:39], a[16:19], a[60:63], v[36:39]
  ds_read_b64_tr_b16 a[12:13], v232 offset:47104
  v_mfma_f32_16x16x32_bf16 v[40:43], a[16:19], a[64:67], v[40:43]
  v_mfma_f32_16x16x32_bf16 v[40:43], a[20:23], a[80:83], v[40:43]
  ds_read_b64_tr_b16 a[14:15], v232 offset:47616
  s_add_u32 m0, s24, 0x2980
  v_mfma_f32_16x16x32_bf16 v[44:47], a[20:23], a[84:87], v[44:47]
  s_waitcnt lgkmcnt(3)
  buffer_load_dwordx4 v224, s[4:7], s63 offen offset:1664 lds
  v_mfma_f32_16x16x32_bf16 v[44:47], a[16:19], a[68:71], v[44:47]
  ds_read_b64_tr_b16 a[16:17], v233 offset:32768
  v_mfma_f32_16x16x32_bf16 v[60:63], a[24:27], a[68:71], v[60:63]
  v_mfma_f32_16x16x32_bf16 v[60:63], a[28:31], a[84:87], v[60:63]
  ds_read_b64_tr_b16 a[18:19], v233 offset:33280
  v_mfma_f32_16x16x32_bf16 v[56:59], a[28:31], a[80:83], v[56:59]
  v_mfma_f32_16x16x32_bf16 v[56:59], a[24:27], a[64:67], v[56:59]
  ds_read_b64_tr_b16 a[20:21], v233 offset:47104
  v_mfma_f32_16x16x32_bf16 v[52:55], a[24:27], a[60:63], v[52:55]
  s_waitcnt vmcnt(28)
  ds_read_b128 a[96:99], v226 offset:12288
  s_add_u32 m0, s24, 0x2d80
  v_mfma_f32_16x16x32_bf16 v[52:55], a[28:31], a[76:79], v[52:55]
  ds_read_b64_tr_b16 a[22:23], v233 offset:47616
  v_mfma_f32_16x16x32_bf16 v[48:51], a[28:31], a[72:75], v[48:51]
  ds_read_b128 a[112:115], v227 offset:12288
  v_mfma_f32_16x16x32_bf16 v[48:51], a[24:27], a[56:59], v[48:51]
  ds_read_b64_tr_b16 a[24:25], v234 offset:32768
  v_mfma_f32_16x16x32_bf16 v[64:67], a[32:35], a[56:59], v[64:67]
  buffer_load_dwordx4 v225, s[4:7], s63 offen offset:1664 lds
  v_mfma_f32_16x16x32_bf16 v[64:67], a[36:39], a[72:75], v[64:67]
  ds_read_b64_tr_b16 a[26:27], v234 offset:33280
  v_mfma_f32_16x16x32_bf16 v[68:71], a[36:39], a[76:79], v[68:71]
  v_mfma_f32_16x16x32_bf16 v[68:71], a[32:35], a[60:63], v[68:71]
  ds_read_b64_tr_b16 a[28:29], v234 offset:47104
  s_add_u32 m0, s24, 0x3180
  v_mfma_f32_16x16x32_bf16 v[72:75], a[32:35], a[64:67], v[72:75]
  s_waitcnt lgkmcnt(3)
  buffer_load_dwordx4 v224, s[4:7], s64 offen offset:1664 lds
  v_mfma_f32_16x16x32_bf16 v[72:75], a[36:39], a[80:83], v[72:75]
  ds_read_b64_tr_b16 a[30:31], v234 offset:47616
  v_mfma_f32_16x16x32_bf16 v[76:79], a[36:39], a[84:87], v[76:79]
  v_mfma_f32_16x16x32_bf16 v[76:79], a[32:35], a[68:71], v[76:79]
  ds_read_b64_tr_b16 a[32:33], v235 offset:32768
  v_mfma_f32_16x16x32_bf16 v[92:95], a[40:43], a[68:71], v[92:95]
  v_mfma_f32_16x16x32_bf16 v[92:95], a[44:47], a[84:87], v[92:95]
  ds_read_b64_tr_b16 a[34:35], v235 offset:33280
  v_mfma_f32_16x16x32_bf16 v[88:91], a[44:47], a[80:83], v[88:91]
  s_waitcnt vmcnt(28)
  ds_read_b128 a[100:103], v226 offset:14336
  s_add_u32 m0, s24, 0x3580
  v_mfma_f32_16x16x32_bf16 v[88:91], a[40:43], a[64:67], v[88:91]
  ds_read_b64_tr_b16 a[36:37], v235 offset:47104
  v_mfma_f32_16x16x32_bf16 v[84:87], a[40:43], a[60:63], v[84:87]
  ds_read_b128 a[116:119], v227 offset:14336
  v_mfma_f32_16x16x32_bf16 v[84:87], a[44:47], a[76:79], v[84:87]
  ds_read_b64_tr_b16 a[38:39], v235 offset:47616
  v_mfma_f32_16x16x32_bf16 v[80:83], a[44:47], a[72:75], v[80:83]
  buffer_load_dwordx4 v225, s[4:7], s64 offen offset:1664 lds
  v_mfma_f32_16x16x32_bf16 v[80:83], a[40:43], a[56:59], v[80:83]
  ds_read_b64_tr_b16 a[40:41], v240 offset:30720
  v_mfma_f32_16x16x32_bf16 v[96:99], a[48:51], a[56:59], v[96:99]
  v_mfma_f32_16x16x32_bf16 v[96:99], a[52:55], a[72:75], v[96:99]
  ds_read_b64_tr_b16 a[42:43], v240 offset:30976
  s_add_u32 m0, s24, 0x3980
  v_mfma_f32_16x16x32_bf16 v[100:103], a[52:55], a[76:79], v[100:103]
  s_waitcnt lgkmcnt(3)
  buffer_load_dwordx4 v224, s[4:7], s65 offen offset:1664 lds
  v_mfma_f32_16x16x32_bf16 v[100:103], a[48:51], a[60:63], v[100:103]
  ds_read_b64_tr_b16 a[44:45], v240 offset:45056
  v_mfma_f32_16x16x32_bf16 v[104:107], a[48:51], a[64:67], v[104:107]
  v_mfma_f32_16x16x32_bf16 v[104:107], a[52:55], a[80:83], v[104:107]
  ds_read_b64_tr_b16 a[46:47], v240 offset:45312
  v_mfma_f32_16x16x32_bf16 v[108:111], a[52:55], a[84:87], v[108:111]
  v_mfma_f32_16x16x32_bf16 v[108:111], a[48:51], a[68:71], v[108:111]
  ds_read_b64_tr_b16 a[48:49], v241 offset:30720
  v_mfma_f32_16x16x32_bf16 v[124:127], a[0:3], a[68:71], v[124:127]
  ds_read_b64_tr_b16 a[50:51], v241 offset:30976
  s_add_u32 m0, s24, 0x3d80
  v_mfma_f32_16x16x32_bf16 v[124:127], a[4:7], a[84:87], v[124:127]
  ds_read_b64_tr_b16 a[52:53], v241 offset:45056
  v_mfma_f32_16x16x32_bf16 v[120:123], a[4:7], a[80:83], v[120:123]
  ds_read_b64_tr_b16 a[54:55], v241 offset:45312
  v_mfma_f32_16x16x32_bf16 v[120:123], a[0:3], a[64:67], v[120:123]
  buffer_load_dwordx4 v225, s[4:7], s65 offen offset:1664 lds
  v_mfma_f32_16x16x32_bf16 v[116:119], a[0:3], a[60:63], v[116:119]
  v_mfma_f32_16x16x32_bf16 v[116:119], a[4:7], a[76:79], v[116:119]
  v_mfma_f32_16x16x32_bf16 v[112:115], a[4:7], a[72:75], v[112:115]
  v_mfma_f32_16x16x32_bf16 v[112:115], a[0:3], a[56:59], v[112:115]
  s_waitcnt lgkmcnt(0) vmcnt(24)
  s_barrier
  ds_read_b64_tr_b16 a[0:1], v236 offset:2048
  v_mfma_f32_16x16x32_bf16 v[128:131], a[8:11], a[56:59], v[128:131]
  s_add_u32 m0, s23, 0x7800
  v_mfma_f32_16x16x32_bf16 v[128:131], a[12:15], a[72:75], v[128:131]
  ds_read_b64_tr_b16 a[2:3], v236 offset:2560
  v_mfma_f32_16x16x32_bf16 v[132:135], a[12:15], a[76:79], v[132:135]
  buffer_load_dwordx4 v229, s[8:11], s21 offen offset:0 lds
  v_mfma_f32_16x16x32_bf16 v[132:135], a[8:11], a[60:63], v[132:135]
  ds_read_b64_tr_b16 a[4:5], v236 offset:16384
  v_mfma_f32_16x16x32_bf16 v[136:139], a[8:11], a[64:67], v[136:139]
  v_mfma_f32_16x16x32_bf16 v[136:139], a[12:15], a[80:83], v[136:139]
  ds_read_b64_tr_b16 a[6:7], v236 offset:16896
  v_mfma_f32_16x16x32_bf16 v[140:143], a[12:15], a[84:87], v[140:143]
  v_mfma_f32_16x16x32_bf16 v[140:143], a[8:11], a[68:71], v[140:143]
  ds_read_b64_tr_b16 a[8:9], v237 offset:2048
  s_add_u32 m0, s23, 0x7b80
  v_mfma_f32_16x16x32_bf16 v[156:159], a[16:19], a[68:71], v[156:159]
  buffer_load_dwordx4 v229, s[8:11], s21 offen offset:128 lds
  v_mfma_f32_16x16x32_bf16 v[156:159], a[20:23], a[84:87], v[156:159]
  ds_read_b64_tr_b16 a[10:11], v237 offset:2560
  v_mfma_f32_16x16x32_bf16 v[152:155], a[20:23], a[80:83], v[152:155]
  v_mfma_f32_16x16x32_bf16 v[152:155], a[16:19], a[64:67], v[152:155]
  ds_read_b64_tr_b16 a[12:13], v237 offset:16384
  v_mfma_f32_16x16x32_bf16 v[148:151], a[16:19], a[60:63], v[148:151]
  v_mfma_f32_16x16x32_bf16 v[148:151], a[20:23], a[76:79], v[148:151]
  ds_read_b64_tr_b16 a[14:15], v237 offset:16896
  v_mfma_f32_16x16x32_bf16 v[144:147], a[20:23], a[72:75], v[144:147]
  s_add_u32 m0, s23, 0x7f00
  v_mfma_f32_16x16x32_bf16 v[144:147], a[16:19], a[56:59], v[144:147]
  ds_read_b64_tr_b16 a[16:17], v238 offset:2048
  v_mfma_f32_16x16x32_bf16 v[160:163], a[24:27], a[56:59], v[160:163]
  buffer_load_dwordx4 v229, s[8:11], s21 offen offset:256 lds
  v_mfma_f32_16x16x32_bf16 v[160:163], a[28:31], a[72:75], v[160:163]
  ds_read_b64_tr_b16 a[18:19], v238 offset:2560
  v_mfma_f32_16x16x32_bf16 v[164:167], a[28:31], a[76:79], v[164:167]
  v_mfma_f32_16x16x32_bf16 v[164:167], a[24:27], a[60:63], v[164:167]
  ds_read_b64_tr_b16 a[20:21], v238 offset:16384
  v_mfma_f32_16x16x32_bf16 v[168:171], a[24:27], a[64:67], v[168:171]
  v_mfma_f32_16x16x32_bf16 v[168:171], a[28:31], a[80:83], v[168:171]
  ds_read_b64_tr_b16 a[22:23], v238 offset:16896
  v_mfma_f32_16x16x32_bf16 v[172:175], a[28:31], a[84:87], v[172:175]
  s_add_u32 m0, s23, 0x8400
  v_mfma_f32_16x16x32_bf16 v[172:175], a[24:27], a[68:71], v[172:175]
  ds_read_b64_tr_b16 a[24:25], v239 offset:2048
  v_mfma_f32_16x16x32_bf16 v[188:191], a[32:35], a[68:71], v[188:191]
  buffer_load_dwordx4 v230, s[8:11], s21 offen offset:0 lds
  v_mfma_f32_16x16x32_bf16 v[188:191], a[36:39], a[84:87], v[188:191]
  ds_read_b64_tr_b16 a[26:27], v239 offset:2560
  v_mfma_f32_16x16x32_bf16 v[184:187], a[36:39], a[80:83], v[184:187]
  v_mfma_f32_16x16x32_bf16 v[184:187], a[32:35], a[64:67], v[184:187]
  ds_read_b64_tr_b16 a[28:29], v239 offset:16384
  v_mfma_f32_16x16x32_bf16 v[180:183], a[32:35], a[60:63], v[180:183]
  v_mfma_f32_16x16x32_bf16 v[180:183], a[36:39], a[76:79], v[180:183]
  ds_read_b64_tr_b16 a[30:31], v239 offset:16896
  s_add_u32 m0, s23, 0x8780
  v_mfma_f32_16x16x32_bf16 v[176:179], a[36:39], a[72:75], v[176:179]
  buffer_load_dwordx4 v230, s[8:11], s21 offen offset:128 lds
  v_mfma_f32_16x16x32_bf16 v[176:179], a[32:35], a[56:59], v[176:179]
  ds_read_b64_tr_b16 a[32:33], v236 offset:3072
  v_mfma_f32_16x16x32_bf16 v[192:195], a[40:43], a[56:59], v[192:195]
  v_mfma_f32_16x16x32_bf16 v[192:195], a[44:47], a[72:75], v[192:195]
  ds_read_b64_tr_b16 a[34:35], v236 offset:3584
  v_mfma_f32_16x16x32_bf16 v[196:199], a[44:47], a[76:79], v[196:199]
  v_mfma_f32_16x16x32_bf16 v[196:199], a[40:43], a[60:63], v[196:199]
  ds_read_b64_tr_b16 a[36:37], v236 offset:17408
  v_mfma_f32_16x16x32_bf16 v[200:203], a[40:43], a[64:67], v[200:203]
  v_mfma_f32_16x16x32_bf16 v[200:203], a[44:47], a[80:83], v[200:203]
  ds_read_b64_tr_b16 a[38:39], v236 offset:17920
  s_add_u32 m0, s23, 0x8b00
  v_mfma_f32_16x16x32_bf16 v[204:207], a[44:47], a[84:87], v[204:207]
  buffer_load_dwordx4 v230, s[8:11], s21 offen offset:256 lds
  v_mfma_f32_16x16x32_bf16 v[204:207], a[40:43], a[68:71], v[204:207]
  ds_read_b64_tr_b16 a[40:41], v237 offset:3072
  v_mfma_f32_16x16x32_bf16 v[220:223], a[48:51], a[68:71], v[220:223]
  v_mfma_f32_16x16x32_bf16 v[220:223], a[52:55], a[84:87], v[220:223]
  ds_read_b64_tr_b16 a[42:43], v237 offset:3584
  v_mfma_f32_16x16x32_bf16 v[216:219], a[52:55], a[80:83], v[216:219]
  v_mfma_f32_16x16x32_bf16 v[216:219], a[48:51], a[64:67], v[216:219]
  ds_read_b64_tr_b16 a[44:45], v237 offset:17408
  v_mfma_f32_16x16x32_bf16 v[212:215], a[48:51], a[60:63], v[212:215]
  s_add_u32 m0, s23, 0x9000
  v_mfma_f32_16x16x32_bf16 v[212:215], a[52:55], a[76:79], v[212:215]
  ds_read_b64_tr_b16 a[46:47], v237 offset:17920
  v_mfma_f32_16x16x32_bf16 v[208:211], a[52:55], a[72:75], v[208:211]
  buffer_load_dwordx4 v231, s[8:11], s21 offen lds
  s_add_u32 s21, s21, 0x70000
  v_mfma_f32_16x16x32_bf16 v[208:211], a[48:51], a[56:59], v[208:211]
  ds_read_b64_tr_b16 a[48:49], v238 offset:3072
  s_waitcnt lgkmcnt(8)
  v_mfma_f32_16x16x32_bf16 v[0:3], a[0:3], a[88:91], v[0:3]
  s_waitcnt vmcnt(29)
  ds_read_b128 a[56:59], v226 offset:0
  v_mfma_f32_16x16x32_bf16 v[0:3], a[4:7], a[104:107], v[0:3]
  ds_read_b64_tr_b16 a[50:51], v238 offset:3584
  v_mfma_f32_16x16x32_bf16 v[4:7], a[4:7], a[108:111], v[4:7]
  ds_read_b128 a[72:75], v227 offset:0
  v_mfma_f32_16x16x32_bf16 v[4:7], a[0:3], a[92:95], v[4:7]
  ds_read_b64_tr_b16 a[52:53], v238 offset:17408
  v_mfma_f32_16x16x32_bf16 v[8:11], a[0:3], a[96:99], v[8:11]
  v_mfma_f32_16x16x32_bf16 v[8:11], a[4:7], a[112:115], v[8:11]
  ds_read_b64_tr_b16 a[54:55], v238 offset:17920
  v_mfma_f32_16x16x32_bf16 v[12:15], a[4:7], a[116:119], v[12:15]
  v_mfma_f32_16x16x32_bf16 v[12:15], a[0:3], a[100:103], v[12:15]
  ds_read_b64_tr_b16 a[0:1], v239 offset:3072
  v_mfma_f32_16x16x32_bf16 v[28:31], a[8:11], a[100:103], v[28:31]
  s_add_u32 m0, s24, 0x100
  v_mfma_f32_16x16x32_bf16 v[28:31], a[12:15], a[116:119], v[28:31]
  ds_read_b64_tr_b16 a[2:3], v239 offset:3584
  v_mfma_f32_16x16x32_bf16 v[24:27], a[12:15], a[112:115], v[24:27]
  s_waitcnt lgkmcnt(4)
  buffer_load_dwordx4 v224, s[4:7], s62 offen offset:1792 lds
  v_mfma_f32_16x16x32_bf16 v[24:27], a[8:11], a[96:99], v[24:27]
  ds_read_b64_tr_b16 a[4:5], v239 offset:17408
  v_mfma_f32_16x16x32_bf16 v[20:23], a[8:11], a[92:95], v[20:23]
  v_mfma_f32_16x16x32_bf16 v[20:23], a[12:15], a[108:111], v[20:23]
  ds_read_b64_tr_b16 a[6:7], v239 offset:17920
  v_mfma_f32_16x16x32_bf16 v[16:19], a[12:15], a[104:107], v[16:19]
  s_waitcnt vmcnt(28)
  ds_read_b128 a[60:63], v226 offset:2048
  s_add_u32 m0, s24, 0x500
  v_mfma_f32_16x16x32_bf16 v[16:19], a[8:11], a[88:91], v[16:19]
  ds_read_b64_tr_b16 a[8:9], v236 offset:4096
  v_mfma_f32_16x16x32_bf16 v[32:35], a[16:19], a[88:91], v[32:35]
  ds_read_b128 a[76:79], v227 offset:2048
  v_mfma_f32_16x16x32_bf16 v[32:35], a[20:23], a[104:107], v[32:35]
  ds_read_b64_tr_b16 a[10:11], v236 offset:4608
  v_mfma_f32_16x16x32_bf16 v[36:39], a[20:23], a[108:111], v[36:39]
  buffer_load_dwordx4 v225, s[4:7], s62 offen offset:1792 lds
  v_mfma_f32_16x16x32_bf16 v[36:39], a[16:19], a[92:95], v[36:39]
  ds_read_b64_tr_b16 a[12:13], v236 offset:18432
  v_mfma_f32_16x16x32_bf16 v[40:43], a[16:19], a[96:99], v[40:43]
  s_add_u32 m0, s24, 0x900
  v_mfma_f32_16x16x32_bf16 v[40:43], a[20:23], a[112:115], v[40:43]
  ds_read_b64_tr_b16 a[14:15], v236 offset:18944
  v_mfma_f32_16x16x32_bf16 v[44:47], a[20:23], a[116:119], v[44:47]
  s_waitcnt lgkmcnt(3)
  buffer_load_dwordx4 v224, s[4:7], s63 offen offset:1792 lds
  v_mfma_f32_16x16x32_bf16 v[44:47], a[16:19], a[100:103], v[44:47]
  ds_read_b64_tr_b16 a[16:17], v237 offset:4096
  v_mfma_f32_16x16x32_bf16 v[60:63], a[24:27], a[100:103], v[60:63]
  v_mfma_f32_16x16x32_bf16 v[60:63], a[28:31], a[116:119], v[60:63]
  ds_read_b64_tr_b16 a[18:19], v237 offset:4608
  v_mfma_f32_16x16x32_bf16 v[56:59], a[28:31], a[112:115], v[56:59]
  s_add_u32 m0, s24, 0xd00
  v_mfma_f32_16x16x32_bf16 v[56:59], a[24:27], a[96:99], v[56:59]
  ds_read_b64_tr_b16 a[20:21], v237 offset:18432
  v_mfma_f32_16x16x32_bf16 v[52:55], a[24:27], a[92:95], v[52:55]
  s_waitcnt vmcnt(28)
  ds_read_b128 a[64:67], v226 offset:4096
  v_mfma_f32_16x16x32_bf16 v[52:55], a[28:31], a[108:111], v[52:55]
  ds_read_b64_tr_b16 a[22:23], v237 offset:18944
  v_mfma_f32_16x16x32_bf16 v[48:51], a[28:31], a[104:107], v[48:51]
  ds_read_b128 a[80:83], v227 offset:4096
  v_mfma_f32_16x16x32_bf16 v[48:51], a[24:27], a[88:91], v[48:51]
  ds_read_b64_tr_b16 a[24:25], v238 offset:4096
  v_mfma_f32_16x16x32_bf16 v[64:67], a[32:35], a[88:91], v[64:67]
  buffer_load_dwordx4 v225, s[4:7], s63 offen offset:1792 lds
  s_add_u32 m0, s24, 0x1100
  v_mfma_f32_16x16x32_bf16 v[64:67], a[36:39], a[104:107], v[64:67]
  ds_read_b64_tr_b16 a[26:27], v238 offset:4608
  v_mfma_f32_16x16x32_bf16 v[68:71], a[36:39], a[108:111], v[68:71]
  s_waitcnt lgkmcnt(2)
  buffer_load_dwordx4 v224, s[4:7], s64 offen offset:1792 lds
  v_mfma_f32_16x16x32_bf16 v[68:71], a[32:35], a[92:95], v[68:71]
  ds_read_b64_tr_b16 a[28:29], v238 offset:18432
  v_mfma_f32_16x16x32_bf16 v[72:75], a[32:35], a[96:99], v[72:75]
  v_mfma_f32_16x16x32_bf16 v[72:75], a[36:39], a[112:115], v[72:75]
  ds_read_b64_tr_b16 a[30:31], v238 offset:18944
  v_mfma_f32_16x16x32_bf16 v[76:79], a[36:39], a[116:119], v[76:79]
  s_add_u32 m0, s24, 0x1500
  v_mfma_f32_16x16x32_bf16 v[76:79], a[32:35], a[100:103], v[76:79]
  ds_read_b64_tr_b16 a[32:33], v239 offset:4096
  v_mfma_f32_16x16x32_bf16 v[92:95], a[40:43], a[100:103], v[92:95]
  buffer_load_dwordx4 v225, s[4:7], s64 offen offset:1792 lds
  v_mfma_f32_16x16x32_bf16 v[92:95], a[44:47], a[116:119], v[92:95]
  ds_read_b64_tr_b16 a[34:35], v239 offset:4608
  v_mfma_f32_16x16x32_bf16 v[88:91], a[44:47], a[112:115], v[88:91]
  s_waitcnt vmcnt(29)
  ds_read_b128 a[68:71], v226 offset:6144
  v_mfma_f32_16x16x32_bf16 v[88:91], a[40:43], a[96:99], v[88:91]
  ds_read_b64_tr_b16 a[36:37], v239 offset:18432
  v_mfma_f32_16x16x32_bf16 v[84:87], a[40:43], a[92:95], v[84:87]
  ds_read_b128 a[84:87], v227 offset:6144
  s_add_u32 m0, s24, 0x1900
  v_mfma_f32_16x16x32_bf16 v[84:87], a[44:47], a[108:111], v[84:87]
  ds_read_b64_tr_b16 a[38:39], v239 offset:18944
  v_mfma_f32_16x16x32_bf16 v[80:83], a[44:47], a[104:107], v[80:83]
  s_waitcnt lgkmcnt(1)
  buffer_load_dwordx4 v224, s[4:7], s65 offen offset:1792 lds
  v_mfma_f32_16x16x32_bf16 v[80:83], a[40:43], a[88:91], v[80:83]
  ds_read_b64_tr_b16 a[40:41], v242 offset:2048
  v_mfma_f32_16x16x32_bf16 v[96:99], a[48:51], a[88:91], v[96:99]
  v_mfma_f32_16x16x32_bf16 v[96:99], a[52:55], a[104:107], v[96:99]
  ds_read_b64_tr_b16 a[42:43], v242 offset:2304
  v_mfma_f32_16x16x32_bf16 v[100:103], a[52:55], a[108:111], v[100:103]
  s_add_u32 m0, s24, 0x1d00
  v_mfma_f32_16x16x32_bf16 v[100:103], a[48:51], a[92:95], v[100:103]
  ds_read_b64_tr_b16 a[44:45], v242 offset:16384
  v_mfma_f32_16x16x32_bf16 v[104:107], a[48:51], a[96:99], v[104:107]
  buffer_load_dwordx4 v225, s[4:7], s65 offen offset:1792 lds
  v_mfma_f32_16x16x32_bf16 v[104:107], a[52:55], a[112:115], v[104:107]
  ds_read_b64_tr_b16 a[46:47], v242 offset:16640
  v_mfma_f32_16x16x32_bf16 v[108:111], a[52:55], a[116:119], v[108:111]
  v_mfma_f32_16x16x32_bf16 v[108:111], a[48:51], a[100:103], v[108:111]
  ds_read_b64_tr_b16 a[48:49], v243 offset:2048
  v_mfma_f32_16x16x32_bf16 v[124:127], a[0:3], a[100:103], v[124:127]
  ds_read_b64_tr_b16 a[50:51], v243 offset:2304
  s_getpc_b64 s[32:33]
L_k1_pc3_w1_1:
  s_mov_b32 s34, L_k1_spin_w1-L_k1_pc3_w1_1
  s_bfe_u32 s60, s2, 0x40003
  s_lshl_b32 s60, s60, 2
  s_add_u32 s60, s60, s25
  s_lshl_b32 s60, s60, 9
  v_mfma_f32_16x16x32_bf16 v[124:127], a[4:7], a[116:119], v[124:127]
  ds_read_b64_tr_b16 a[52:53], v243 offset:16384
  v_mfma_f32_16x16x32_bf16 v[120:123], a[4:7], a[112:115], v[120:123]
  ds_read_b64_tr_b16 a[54:55], v243 offset:16640
  v_mfma_f32_16x16x32_bf16 v[120:123], a[0:3], a[96:99], v[120:123]
  s_mov_b64 exec, 15
  buffer_load_dword a224, v244, s[32:35], s60 offen
  s_mov_b64 exec, -1
  v_mfma_f32_16x16x32_bf16 v[116:119], a[0:3], a[92:95], v[116:119]
  v_mfma_f32_16x16x32_bf16 v[116:119], a[4:7], a[108:111], v[116:119]
  v_mfma_f32_16x16x32_bf16 v[112:115], a[4:7], a[104:107], v[112:115]
  v_mfma_f32_16x16x32_bf16 v[112:115], a[0:3], a[88:91], v[112:115]
  s_waitcnt lgkmcnt(0) vmcnt(25)
  s_barrier
  ds_read_b64_tr_b16 a[0:1], v232 offset:2048
  v_mfma_f32_16x16x32_bf16 v[128:131], a[8:11], a[88:91], v[128:131]
  s_add_u32 m0, s23, 0xe800
  v_mfma_f32_16x16x32_bf16 v[128:131], a[12:15], a[104:107], v[128:131]
  ds_read_b64_tr_b16 a[2:3], v232 offset:2560
  v_mfma_f32_16x16x32_bf16 v[132:135], a[12:15], a[108:111], v[132:135]
  buffer_load_dwordx4 v229, s[8:11], s21 offen offset:0 lds
  v_mfma_f32_16x16x32_bf16 v[132:135], a[8:11], a[92:95], v[132:135]
  ds_read_b64_tr_b16 a[4:5], v232 offset:16384
  v_mfma_f32_16x16x32_bf16 v[136:139], a[8:11], a[96:99], v[136:139]
  v_mfma_f32_16x16x32_bf16 v[136:139], a[12:15], a[112:115], v[136:139]
  ds_read_b64_tr_b16 a[6:7], v232 offset:16896
  v_mfma_f32_16x16x32_bf16 v[140:143], a[12:15], a[116:119], v[140:143]
  s_add_u32 m0, s23, 0xeb80
  v_mfma_f32_16x16x32_bf16 v[140:143], a[8:11], a[100:103], v[140:143]
  ds_read_b64_tr_b16 a[8:9], v233 offset:2048
  v_mfma_f32_16x16x32_bf16 v[156:159], a[16:19], a[100:103], v[156:159]
  buffer_load_dwordx4 v229, s[8:11], s21 offen offset:128 lds
  v_mfma_f32_16x16x32_bf16 v[156:159], a[20:23], a[116:119], v[156:159]
  ds_read_b64_tr_b16 a[10:11], v233 offset:2560
  v_mfma_f32_16x16x32_bf16 v[152:155], a[20:23], a[112:115], v[152:155]
  v_mfma_f32_16x16x32_bf16 v[152:155], a[16:19], a[96:99], v[152:155]
  ds_read_b64_tr_b16 a[12:13], v233 offset:16384
  v_mfma_f32_16x16x32_bf16 v[148:151], a[16:19], a[92:95], v[148:151]
  v_mfma_f32_16x16x32_bf16 v[148:151], a[20:23], a[108:111], v[148:151]
  ds_read_b64_tr_b16 a[14:15], v233 offset:16896
  s_add_u32 m0, s23, 0xef00
  v_mfma_f32_16x16x32_bf16 v[144:147], a[20:23], a[104:107], v[144:147]
  buffer_load_dwordx4 v229, s[8:11], s21 offen offset:256 lds
  v_mfma_f32_16x16x32_bf16 v[144:147], a[16:19], a[88:91], v[144:147]
  ds_read_b64_tr_b16 a[16:17], v234 offset:2048
  v_mfma_f32_16x16x32_bf16 v[160:163], a[24:27], a[88:91], v[160:163]
  v_mfma_f32_16x16x32_bf16 v[160:163], a[28:31], a[104:107], v[160:163]
  ds_read_b64_tr_b16 a[18:19], v234 offset:2560
  v_mfma_f32_16x16x32_bf16 v[164:167], a[28:31], a[108:111], v[164:167]
  v_mfma_f32_16x16x32_bf16 v[164:167], a[24:27], a[92:95], v[164:167]
  ds_read_b64_tr_b16 a[20:21], v234 offset:16384
  s_add_u32 m0, s23, 0xf400
  v_mfma_f32_16x16x32_bf16 v[168:171], a[24:27], a[96:99], v[168:171]
  buffer_load_dwordx4 v230, s[8:11], s21 offen offset:0 lds
  v_mfma_f32_16x16x32_bf16 v[168:171], a[28:31], a[112:115], v[168:171]
  ds_read_b64_tr_b16 a[22:23], v234 offset:16896
  v_mfma_f32_16x16x32_bf16 v[172:175], a[28:31], a[116:119], v[172:175]
  v_mfma_f32_16x16x32_bf16 v[172:175], a[24:27], a[100:103], v[172:175]
  ds_read_b64_tr_b16 a[24:25], v235 offset:2048
  v_mfma_f32_16x16x32_bf16 v[188:191], a[32:35], a[100:103], v[188:191]
  v_mfma_f32_16x16x32_bf16 v[188:191], a[36:39], a[116:119], v[188:191]
  ds_read_b64_tr_b16 a[26:27], v235 offset:2560
  v_mfma_f32_16x16x32_bf16 v[184:187], a[36:39], a[112:115], v[184:187]
  s_add_u32 m0, s23, 0xf780
  v_mfma_f32_16x16x32_bf16 v[184:187], a[32:35], a[96:99], v[184:187]
  ds_read_b64_tr_b16 a[28:29], v235 offset:16384
  v_mfma_f32_16x16x32_bf16 v[180:183], a[32:35], a[92:95], v[180:183]
  buffer_load_dwordx4 v230, s[8:11], s21 offen offset:128 lds
  v_mfma_f32_16x16x32_bf16 v[180:183], a[36:39], a[108:111], v[180:183]
  ds_read_b64_tr_b16 a[30:31], v235 offset:16896
  v_mfma_f32_16x16x32_bf16 v[176:179], a[36:39], a[104:107], v[176:179]
  v_mfma_f32_16x16x32_bf16 v[176:179], a[32:35], a[88:91], v[176:179]
  ds_read_b64_tr_b16 a[32:33], v232 offset:3072
  v_mfma_f32_16x16x32_bf16 v[192:195], a[40:43], a[88:91], v[192:195]
  s_add_u32 m0, s23, 0xfb00
  v_mfma_f32_16x16x32_bf16 v[192:195], a[44:47], a[104:107], v[192:195]
  ds_read_b64_tr_b16 a[34:35], v232 offset:3584
  v_mfma_f32_16x16x32_bf16 v[196:199], a[44:47], a[108:111], v[196:199]
  buffer_load_dwordx4 v230, s[8:11], s21 offen offset:256 lds
  v_mfma_f32_16x16x32_bf16 v[196:199], a[40:43], a[92:95], v[196:199]
  ds_read_b64_tr_b16 a[36:37], v232 offset:17408
  v_mfma_f32_16x16x32_bf16 v[200:203], a[40:43], a[96:99], v[200:203]
  v_mfma_f32_16x16x32_bf16 v[200:203], a[44:47], a[112:115], v[200:203]
  ds_read_b64_tr_b16 a[38:39], v232 offset:17920
  v_mfma_f32_16x16x32_bf16 v[204:207], a[44:47], a[116:119], v[204:207]
  v_mfma_f32_16x16x32_bf16 v[204:207], a[40:43], a[100:103], v[204:207]
  ds_read_b64_tr_b16 a[40:41], v233 offset:3072
  s_add_u32 m0, s23, 0x10000
  v_mfma_f32_16x16x32_bf16 v[220:223], a[48:51], a[100:103], v[220:223]
  buffer_load_dwordx4 v231, s[8:11], s21 offen lds
  v_mfma_f32_16x16x32_bf16 v[220:223], a[52:55], a[116:119], v[220:223]
  ds_read_b64_tr_b16 a[42:43], v233 offset:3584
  v_mfma_f32_16x16x32_bf16 v[216:219], a[52:55], a[112:115], v[216:219]
  v_mfma_f32_16x16x32_bf16 v[216:219], a[48:51], a[96:99], v[216:219]
  ds_read_b64_tr_b16 a[44:45], v233 offset:17408
  v_mfma_f32_16x16x32_bf16 v[212:215], a[48:51], a[92:95], v[212:215]
  v_mfma_f32_16x16x32_bf16 v[212:215], a[52:55], a[108:111], v[212:215]
  ds_read_b64_tr_b16 a[46:47], v233 offset:17920
  v_and_b32 v254, 0x30, v228
  v_lshlrev_b32 v254, 4, v254
  v_and_b32 v255, 0x1c0, v228
  v_lshl_add_u32 v254, v255, 6, v254
  s_and_b32 s60, s2, 0x19
  s_lshl_b32 s60, s60, 7
  v_or_b32 v254, s60, v254
  s_mov_b32 exec_lo, 0
  v_and_b32 v254, 0x10, v228
  v_lshlrev_b32 v254, 3, v254
  v_and_b32 v255, 0x60, v228
  v_lshl_add_u32 v254, v255, 5, v254
  s_and_b32 s60, s2, 0xe6
  s_lshl_b32 s60, s60, 7
  s_add_u32 s60, s60, 64
  v_add_u32 v254, s60, v254
  s_mov_b64 exec, -1
  v_mfma_f32_16x16x32_bf16 v[208:211], a[52:55], a[104:107], v[208:211]
  buffer_load_dwordx2 v[252:253], v254, s[16:19], 0 offen sc1
  s_add_u32 s21, s21, 0x70000
  v_mfma_f32_16x16x32_bf16 v[208:211], a[48:51], a[88:91], v[208:211]
  ds_read_b64_tr_b16 a[48:49], v234 offset:3072
  s_waitcnt lgkmcnt(8)
  v_mfma_f32_16x16x32_bf16 v[0:3], a[0:3], a[56:59], v[0:3]
  s_waitcnt vmcnt(30)
  ds_read_b128 a[88:91], v226 offset:8192
  v_mfma_f32_16x16x32_bf16 v[0:3], a[4:7], a[72:75], v[0:3]
  ds_read_b64_tr_b16 a[50:51], v234 offset:3584
  v_mfma_f32_16x16x32_bf16 v[4:7], a[4:7], a[76:79], v[4:7]
  ds_read_b128 a[104:107], v227 offset:8192
  v_mfma_f32_16x16x32_bf16 v[4:7], a[0:3], a[60:63], v[4:7]
  ds_read_b64_tr_b16 a[52:53], v234 offset:17408
  v_mfma_f32_16x16x32_bf16 v[8:11], a[0:3], a[64:67], v[8:11]
  v_mfma_f32_16x16x32_bf16 v[8:11], a[4:7], a[80:83], v[8:11]
  ds_read_b64_tr_b16 a[54:55], v234 offset:17920
  v_mfma_f32_16x16x32_bf16 v[12:15], a[4:7], a[84:87], v[12:15]
  v_mfma_f32_16x16x32_bf16 v[12:15], a[0:3], a[68:71], v[12:15]
  ds_read_b64_tr_b16 a[0:1], v235 offset:3072
  v_mfma_f32_16x16x32_bf16 v[28:31], a[8:11], a[68:71], v[28:31]
  s_add_u32 m0, s24, 0x2080
  v_mfma_f32_16x16x32_bf16 v[28:31], a[12:15], a[84:87], v[28:31]
  ds_read_b64_tr_b16 a[2:3], v235 offset:3584
  v_mfma_f32_16x16x32_bf16 v[24:27], a[12:15], a[80:83], v[24:27]
  s_waitcnt lgkmcnt(4)
  buffer_load_dwordx4 v224, s[4:7], s62 offen offset:1920 lds
  v_mfma_f32_16x16x32_bf16 v[24:27], a[8:11], a[64:67], v[24:27]
  ds_read_b64_tr_b16 a[4:5], v235 offset:17408
  v_mfma_f32_16x16x32_bf16 v[20:23], a[8:11], a[60:63], v[20:23]
  v_mfma_f32_16x16x32_bf16 v[20:23], a[12:15], a[76:79], v[20:23]
  ds_read_b64_tr_b16 a[6:7], v235 offset:17920
  v_mfma_f32_16x16x32_bf16 v[16:19], a[12:15], a[72:75], v[16:19]
  s_waitcnt vmcnt(29)
  ds_read_b128 a[92:95], v226 offset:10240
  s_add_u32 m0, s24, 0x2480
  v_mfma_f32_16x16x32_bf16 v[16:19], a[8:11], a[56:59], v[16:19]
  ds_read_b64_tr_b16 a[8:9], v232 offset:4096
  v_mfma_f32_16x16x32_bf16 v[32:35], a[16:19], a[56:59], v[32:35]
  ds_read_b128 a[108:111], v227 offset:10240
  v_mfma_f32_16x16x32_bf16 v[32:35], a[20:23], a[72:75], v[32:35]
  ds_read_b64_tr_b16 a[10:11], v232 offset:4608
  v_mfma_f32_16x16x32_bf16 v[36:39], a[20:23], a[76:79], v[36:39]
  buffer_load_dwordx4 v225, s[4:7], s62 offen offset:1920 lds
  v_mfma_f32_16x16x32_bf16 v[36:39], a[16:19], a[60:63], v[36:39]
  ds_read_b64_tr_b16 a[12:13], v232 offset:18432
  v_mfma_f32_16x16x32_bf16 v[40:43], a[16:19], a[64:67], v[40:43]
  s_add_u32 m0, s24, 0x2880
  v_mfma_f32_16x16x32_bf16 v[40:43], a[20:23], a[80:83], v[40:43]
  ds_read_b64_tr_b16 a[14:15], v232 offset:18944
  v_mfma_f32_16x16x32_bf16 v[44:47], a[20:23], a[84:87], v[44:47]
  s_waitcnt lgkmcnt(3)
  buffer_load_dwordx4 v224, s[4:7], s63 offen offset:1920 lds
  v_mfma_f32_16x16x32_bf16 v[44:47], a[16:19], a[68:71], v[44:47]
  ds_read_b64_tr_b16 a[16:17], v233 offset:4096
  v_mfma_f32_16x16x32_bf16 v[60:63], a[24:27], a[68:71], v[60:63]
  v_mfma_f32_16x16x32_bf16 v[60:63], a[28:31], a[84:87], v[60:63]
  ds_read_b64_tr_b16 a[18:19], v233 offset:4608
  v_mfma_f32_16x16x32_bf16 v[56:59], a[28:31], a[80:83], v[56:59]
  s_add_u32 m0, s24, 0x2c80
  v_mfma_f32_16x16x32_bf16 v[56:59], a[24:27], a[64:67], v[56:59]
  ds_read_b64_tr_b16 a[20:21], v233 offset:18432
  v_mfma_f32_16x16x32_bf16 v[52:55], a[24:27], a[60:63], v[52:55]
  s_waitcnt vmcnt(29)
  ds_read_b128 a[96:99], v226 offset:12288
  v_mfma_f32_16x16x32_bf16 v[52:55], a[28:31], a[76:79], v[52:55]
  ds_read_b64_tr_b16 a[22:23], v233 offset:18944
  v_mfma_f32_16x16x32_bf16 v[48:51], a[28:31], a[72:75], v[48:51]
  ds_read_b128 a[112:115], v227 offset:12288
  v_mfma_f32_16x16x32_bf16 v[48:51], a[24:27], a[56:59], v[48:51]
  ds_read_b64_tr_b16 a[24:25], v234 offset:4096
  v_mfma_f32_16x16x32_bf16 v[64:67], a[32:35], a[56:59], v[64:67]
  buffer_load_dwordx4 v225, s[4:7], s63 offen offset:1920 lds
  s_add_u32 m0, s24, 0x3080
  v_mfma_f32_16x16x32_bf16 v[64:67], a[36:39], a[72:75], v[64:67]
  ds_read_b64_tr_b16 a[26:27], v234 offset:4608
  v_mfma_f32_16x16x32_bf16 v[68:71], a[36:39], a[76:79], v[68:71]
  s_waitcnt lgkmcnt(2)
  buffer_load_dwordx4 v224, s[4:7], s64 offen offset:1920 lds
  v_mfma_f32_16x16x32_bf16 v[68:71], a[32:35], a[60:63], v[68:71]
  ds_read_b64_tr_b16 a[28:29], v234 offset:18432
  v_mfma_f32_16x16x32_bf16 v[72:75], a[32:35], a[64:67], v[72:75]
  v_mfma_f32_16x16x32_bf16 v[72:75], a[36:39], a[80:83], v[72:75]
  ds_read_b64_tr_b16 a[30:31], v234 offset:18944
  v_mfma_f32_16x16x32_bf16 v[76:79], a[36:39], a[84:87], v[76:79]
  s_add_u32 m0, s24, 0x3480
  v_mfma_f32_16x16x32_bf16 v[76:79], a[32:35], a[68:71], v[76:79]
  ds_read_b64_tr_b16 a[32:33], v235 offset:4096
  v_mfma_f32_16x16x32_bf16 v[92:95], a[40:43], a[68:71], v[92:95]
  buffer_load_dwordx4 v225, s[4:7], s64 offen offset:1920 lds
  v_mfma_f32_16x16x32_bf16 v[92:95], a[44:47], a[84:87], v[92:95]
  ds_read_b64_tr_b16 a[34:35], v235 offset:4608
  v_mfma_f32_16x16x32_bf16 v[88:91], a[44:47], a[80:83], v[88:91]
  s_waitcnt vmcnt(30)
  ds_read_b128 a[100:103], v226 offset:14336
  v_mfma_f32_16x16x32_bf16 v[88:91], a[40:43], a[64:67], v[88:91]
  ds_read_b64_tr_b16 a[36:37], v235 offset:18432
  v_mfma_f32_16x16x32_bf16 v[84:87], a[40:43], a[60:63], v[84:87]
  ds_read_b128 a[116:119], v227 offset:14336
  s_add_u32 m0, s24, 0x3880
  v_mfma_f32_16x16x32_bf16 v[84:87], a[44:47], a[76:79], v[84:87]
  ds_read_b64_tr_b16 a[38:39], v235 offset:18944
  v_mfma_f32_16x16x32_bf16 v[80:83], a[44:47], a[72:75], v[80:83]
  s_waitcnt lgkmcnt(1)
  buffer_load_dwordx4 v224, s[4:7], s65 offen offset:1920 lds
  v_mfma_f32_16x16x32_bf16 v[80:83], a[40:43], a[56:59], v[80:83]
  ds_read_b64_tr_b16 a[40:41], v240 offset:2048
  v_mfma_f32_16x16x32_bf16 v[96:99], a[48:51], a[56:59], v[96:99]
  v_mfma_f32_16x16x32_bf16 v[96:99], a[52:55], a[72:75], v[96:99]
  ds_read_b64_tr_b16 a[42:43], v240 offset:2304
  v_mfma_f32_16x16x32_bf16 v[100:103], a[52:55], a[76:79], v[100:103]
  s_add_u32 m0, s24, 0x3c80
  v_mfma_f32_16x16x32_bf16 v[100:103], a[48:51], a[60:63], v[100:103]
  ds_read_b64_tr_b16 a[44:45], v240 offset:16384
  v_mfma_f32_16x16x32_bf16 v[104:107], a[48:51], a[64:67], v[104:107]
  buffer_load_dwordx4 v225, s[4:7], s65 offen offset:1920 lds
  v_mfma_f32_16x16x32_bf16 v[104:107], a[52:55], a[80:83], v[104:107]
  ds_read_b64_tr_b16 a[46:47], v240 offset:16640
  v_mfma_f32_16x16x32_bf16 v[108:111], a[52:55], a[84:87], v[108:111]
  v_mfma_f32_16x16x32_bf16 v[108:111], a[48:51], a[68:71], v[108:111]
  ds_read_b64_tr_b16 a[48:49], v241 offset:2048
  v_mfma_f32_16x16x32_bf16 v[124:127], a[0:3], a[68:71], v[124:127]
  ds_read_b64_tr_b16 a[50:51], v241 offset:2304
  s_getpc_b64 s[32:33]
L_k1_pc2_w1:
  s_add_u32 s32, s32, L_k2_start-L_k1_pc2_w1
  s_addc_u32 s33, s33, 0
  s_mov_b32 s34, L_k2_spin-L_k2_start
  s_lshr_b32 s60, s2, 3
  s_lshl_b32 s60, s60, 2
  s_add_u32 s60, s60, s25
  s_lshl_b32 s60, s60, 8
  v_mfma_f32_16x16x32_bf16 v[124:127], a[4:7], a[84:87], v[124:127]
  ds_read_b64_tr_b16 a[52:53], v241 offset:16384
  v_mfma_f32_16x16x32_bf16 v[120:123], a[4:7], a[80:83], v[120:123]
  ds_read_b64_tr_b16 a[54:55], v241 offset:16640
  v_mfma_f32_16x16x32_bf16 v[120:123], a[0:3], a[64:67], v[120:123]
  s_mov_b64 exec, 3
  buffer_load_dword a224, v244, s[32:35], s60 offen
  s_mov_b64 exec, -1
  v_mfma_f32_16x16x32_bf16 v[116:119], a[0:3], a[60:63], v[116:119]
  v_mfma_f32_16x16x32_bf16 v[116:119], a[4:7], a[76:79], v[116:119]
  v_mfma_f32_16x16x32_bf16 v[112:115], a[4:7], a[72:75], v[112:115]
  v_mfma_f32_16x16x32_bf16 v[112:115], a[0:3], a[56:59], v[112:115]
  s_waitcnt lgkmcnt(0) vmcnt(26)
  s_barrier
  ds_read_b64_tr_b16 a[0:1], v232 offset:30720
  v_mfma_f32_16x16x32_bf16 v[128:131], a[8:11], a[56:59], v[128:131]
  s_waitcnt vmcnt(9)
  v_cmp_ne_u64 vcc, s[56:57], v[252:253]
  s_cbranch_vccnz L_k1_spin_w1
L_k1_back_w1:
  s_add_u32 m0, s23, 0x800
  v_mfma_f32_16x16x32_bf16 v[128:131], a[12:15], a[72:75], v[128:131]
  ds_read_b64_tr_b16 a[2:3], v232 offset:31232
  v_mfma_f32_16x16x32_bf16 v[132:135], a[12:15], a[76:79], v[132:135]
  buffer_load_dwordx4 v229, s[8:11], s21 offen offset:0 lds
  v_mfma_f32_16x16x32_bf16 v[132:135], a[8:11], a[60:63], v[132:135]
  ds_read_b64_tr_b16 a[4:5], v232 offset:45056
  v_and_b32 v244, 0xff, v228
  s_lshr_b32 s60, s62, 7
  s_add_u32 s60, s60, 0x10000
  v_mfma_f32_16x16x32_bf16 v[136:139], a[8:11], a[64:67], v[136:139]
  buffer_load_dwordx4 a[200:203], v244, s[16:19], s60 offen sc1
  v_mfma_f32_16x16x32_bf16 v[136:139], a[12:15], a[80:83], v[136:139]
  ds_read_b64_tr_b16 a[6:7], v232 offset:45568
  v_mfma_f32_16x16x32_bf16 v[140:143], a[12:15], a[84:87], v[140:143]
  s_add_u32 m0, s23, 0xb80
  v_mfma_f32_16x16x32_bf16 v[140:143], a[8:11], a[68:71], v[140:143]
  ds_read_b64_tr_b16 a[8:9], v233 offset:30720
  v_mfma_f32_16x16x32_bf16 v[156:159], a[16:19], a[68:71], v[156:159]
  buffer_load_dwordx4 v229, s[8:11], s21 offen offset:128 lds
  v_mfma_f32_16x16x32_bf16 v[156:159], a[20:23], a[84:87], v[156:159]
  ds_read_b64_tr_b16 a[10:11], v233 offset:31232
  s_lshr_b32 s60, s63, 7
  s_add_u32 s60, s60, 0x10000
  v_mfma_f32_16x16x32_bf16 v[152:155], a[20:23], a[80:83], v[152:155]
  buffer_load_dwordx4 a[204:207], v244, s[16:19], s60 offen sc1
  v_mfma_f32_16x16x32_bf16 v[152:155], a[16:19], a[64:67], v[152:155]
  ds_read_b64_tr_b16 a[12:13], v233 offset:45056
  v_mfma_f32_16x16x32_bf16 v[148:151], a[16:19], a[60:63], v[148:151]
  v_mfma_f32_16x16x32_bf16 v[148:151], a[20:23], a[76:79], v[148:151]
  ds_read_b64_tr_b16 a[14:15], v233 offset:45568
  s_add_u32 m0, s23, 0xf00
  v_mfma_f32_16x16x32_bf16 v[144:147], a[20:23], a[72:75], v[144:147]
  buffer_load_dwordx4 v229, s[8:11], s21 offen offset:256 lds
  v_mfma_f32_16x16x32_bf16 v[144:147], a[16:19], a[56:59], v[144:147]
  ds_read_b64_tr_b16 a[16:17], v234 offset:30720
  v_mfma_f32_16x16x32_bf16 v[160:163], a[24:27], a[56:59], v[160:163]
  s_lshr_b32 s60, s64, 7
  s_add_u32 s60, s60, 0x10000
  v_mfma_f32_16x16x32_bf16 v[160:163], a[28:31], a[72:75], v[160:163]
  ds_read_b64_tr_b16 a[18:19], v234 offset:31232
  v_mfma_f32_16x16x32_bf16 v[164:167], a[28:31], a[76:79], v[164:167]
  buffer_load_dwordx4 a[208:211], v244, s[16:19], s60 offen sc1
  v_mfma_f32_16x16x32_bf16 v[164:167], a[24:27], a[60:63], v[164:167]
  ds_read_b64_tr_b16 a[20:21], v234 offset:45056
  s_add_u32 m0, s23, 0x1400
  v_mfma_f32_16x16x32_bf16 v[168:171], a[24:27], a[64:67], v[168:171]
  buffer_load_dwordx4 v230, s[8:11], s21 offen offset:0 lds
  v_mfma_f32_16x16x32_bf16 v[168:171], a[28:31], a[80:83], v[168:171]
  ds_read_b64_tr_b16 a[22:23], v234 offset:45568
  v_mfma_f32_16x16x32_bf16 v[172:175], a[28:31], a[84:87], v[172:175]
  s_lshr_b32 s60, s65, 7
  s_add_u32 s60, s60, 0x10000
  v_mfma_f32_16x16x32_bf16 v[172:175], a[24:27], a[68:71], v[172:175]
  ds_read_b64_tr_b16 a[24:25], v235 offset:30720
  v_mfma_f32_16x16x32_bf16 v[188:191], a[32:35], a[68:71], v[188:191]
  buffer_load_dwordx4 a[212:215], v244, s[16:19], s60 offen sc1
  v_mfma_f32_16x16x32_bf16 v[188:191], a[36:39], a[84:87], v[188:191]
  ds_read_b64_tr_b16 a[26:27], v235 offset:31232
  v_mfma_f32_16x16x32_bf16 v[184:187], a[36:39], a[80:83], v[184:187]
  s_lshl_b32 s60, s44, 5
  s_add_u32 s60, s60, 0x70000
  v_mfma_f32_16x16x32_bf16 v[184:187], a[32:35], a[64:67], v[184:187]
  ds_read_b64_tr_b16 a[28:29], v235 offset:45056
  v_mfma_f32_16x16x32_bf16 v[180:183], a[32:35], a[60:63], v[180:183]
  buffer_load_dwordx4 a[136:139], v228, s[16:19], s60 offen sc1
  v_mfma_f32_16x16x32_bf16 v[180:183], a[36:39], a[76:79], v[180:183]
  ds_read_b64_tr_b16 a[30:31], v235 offset:45568
  s_add_u32 m0, s23, 0x1780
  v_mfma_f32_16x16x32_bf16 v[176:179], a[36:39], a[72:75], v[176:179]
  buffer_load_dwordx4 v230, s[8:11], s21 offen offset:128 lds
  v_mfma_f32_16x16x32_bf16 v[176:179], a[32:35], a[56:59], v[176:179]
  ds_read_b64_tr_b16 a[32:33], v232 offset:31744
  v_mfma_f32_16x16x32_bf16 v[192:195], a[40:43], a[56:59], v[192:195]
  s_lshl_b32 s60, s44, 5
  s_add_u32 s60, s60, 0x70400
  v_mfma_f32_16x16x32_bf16 v[192:195], a[44:47], a[72:75], v[192:195]
  ds_read_b64_tr_b16 a[34:35], v232 offset:32256
  v_mfma_f32_16x16x32_bf16 v[196:199], a[44:47], a[76:79], v[196:199]
  buffer_load_dwordx4 a[140:143], v228, s[16:19], s60 offen sc1
  v_mfma_f32_16x16x32_bf16 v[196:199], a[40:43], a[60:63], v[196:199]
  ds_read_b64_tr_b16 a[36:37], v232 offset:46080
  s_add_u32 m0, s23, 0x1b00
  v_mfma_f32_16x16x32_bf16 v[200:203], a[40:43], a[64:67], v[200:203]
  buffer_load_dwordx4 v230, s[8:11], s21 offen offset:256 lds
  v_mfma_f32_16x16x32_bf16 v[200:203], a[44:47], a[80:83], v[200:203]
  ds_read_b64_tr_b16 a[38:39], v232 offset:46592
  v_mfma_f32_16x16x32_bf16 v[204:207], a[44:47], a[84:87], v[204:207]
  v_mfma_f32_16x16x32_bf16 v[204:207], a[40:43], a[68:71], v[204:207]
  ds_read_b64_tr_b16 a[40:41], v233 offset:31744
  s_lshl_b32 s60, s44, 5
  s_add_u32 s60, s60, 0x70800
  v_mfma_f32_16x16x32_bf16 v[220:223], a[48:51], a[68:71], v[220:223]
  buffer_load_dwordx4 a[144:147], v228, s[16:19], s60 offen sc1
  v_mfma_f32_16x16x32_bf16 v[220:223], a[52:55], a[84:87], v[220:223]
  ds_read_b64_tr_b16 a[42:43], v233 offset:32256
  v_mfma_f32_16x16x32_bf16 v[216:219], a[52:55], a[80:83], v[216:219]
  s_add_u32 m0, s23, 0x2000
  v_mfma_f32_16x16x32_bf16 v[216:219], a[48:51], a[64:67], v[216:219]
  ds_read_b64_tr_b16 a[44:45], v233 offset:46080
  v_mfma_f32_16x16x32_bf16 v[212:215], a[48:51], a[60:63], v[212:215]
  buffer_load_dwordx4 v231, s[8:11], s21 offen lds
  v_mfma_f32_16x16x32_bf16 v[212:215], a[52:55], a[76:79], v[212:215]
  ds_read_b64_tr_b16 a[46:47], v233 offset:46592
  s_lshl_b32 s60, s44, 5
  s_add_u32 s60, s60, 0x70c00
  v_mfma_f32_16x16x32_bf16 v[208:211], a[52:55], a[72:75], v[208:211]
  buffer_load_dwordx4 a[148:151], v228, s[16:19], s60 offen sc1
  v_mfma_f32_16x16x32_bf16 v[208:211], a[48:51], a[56:59], v[208:211]
  ds_read_b64_tr_b16 a[48:49], v234 offset:31744
  s_waitcnt lgkmcnt(8)
  v_mfma_f32_16x16x32_bf16 v[0:3], a[0:3], a[88:91], v[0:3]
  s_lshl_b32 s60, s44, 5
  s_add_u32 s60, s60, 0x71000
  v_mfma_f32_16x16x32_bf16 v[0:3], a[4:7], a[104:107], v[0:3]
  ds_read_b64_tr_b16 a[50:51], v234 offset:32256
  v_mfma_f32_16x16x32_bf16 v[4:7], a[4:7], a[108:111], v[4:7]
  buffer_load_dwordx4 a[152:155], v228, s[16:19], s60 offen sc1
  s_add_u32 s21, s21, 0x70000
  v_mfma_f32_16x16x32_bf16 v[4:7], a[0:3], a[92:95], v[4:7]
  ds_read_b64_tr_b16 a[52:53], v234 offset:46080
  v_mfma_f32_16x16x32_bf16 v[8:11], a[0:3], a[96:99], v[8:11]
  ds_read_b128 a[56:59], v226 offset:0
  v_mfma_f32_16x16x32_bf16 v[8:11], a[4:7], a[112:115], v[8:11]
  ds_read_b64_tr_b16 a[54:55], v234 offset:46592
  v_mfma_f32_16x16x32_bf16 v[12:15], a[4:7], a[116:119], v[12:15]
  ds_read_b128 a[72:75], v227 offset:0
  v_mfma_f32_16x16x32_bf16 v[12:15], a[0:3], a[100:103], v[12:15]
  ds_read_b64_tr_b16 a[0:1], v235 offset:31744
  v_mfma_f32_16x16x32_bf16 v[28:31], a[8:11], a[100:103], v[28:31]
  s_lshl_b32 s60, s44, 5
  s_add_u32 s60, s60, 0x71400
  v_mfma_f32_16x16x32_bf16 v[28:31], a[12:15], a[116:119], v[28:31]
  ds_read_b64_tr_b16 a[2:3], v235 offset:32256
  v_mfma_f32_16x16x32_bf16 v[24:27], a[12:15], a[112:115], v[24:27]
  buffer_load_dwordx4 a[156:159], v228, s[16:19], s60 offen sc1
  v_mfma_f32_16x16x32_bf16 v[24:27], a[8:11], a[96:99], v[24:27]
  ds_read_b64_tr_b16 a[4:5], v235 offset:46080
  v_mfma_f32_16x16x32_bf16 v[20:23], a[8:11], a[92:95], v[20:23]
  v_mfma_f32_16x16x32_bf16 v[20:23], a[12:15], a[108:111], v[20:23]
  ds_read_b64_tr_b16 a[6:7], v235 offset:46592
  v_mfma_f32_16x16x32_bf16 v[16:19], a[12:15], a[104:107], v[16:19]
  ds_read_b128 a[60:63], v226 offset:2048
  s_lshl_b32 s60, s44, 5
  s_add_u32 s60, s60, 0x71800
  v_mfma_f32_16x16x32_bf16 v[16:19], a[8:11], a[88:91], v[16:19]
  ds_read_b64_tr_b16 a[8:9], v232 offset:32768
  v_mfma_f32_16x16x32_bf16 v[32:35], a[16:19], a[88:91], v[32:35]
  ds_read_b128 a[76:79], v227 offset:2048
  v_mfma_f32_16x16x32_bf16 v[32:35], a[20:23], a[104:107], v[32:35]
  ds_read_b64_tr_b16 a[10:11], v232 offset:33280
  v_mfma_f32_16x16x32_bf16 v[36:39], a[20:23], a[108:111], v[36:39]
  buffer_load_dwordx4 a[160:163], v228, s[16:19], s60 offen sc1
  v_mfma_f32_16x16x32_bf16 v[36:39], a[16:19], a[92:95], v[36:39]
  ds_read_b64_tr_b16 a[12:13], v232 offset:47104
  v_mfma_f32_16x16x32_bf16 v[40:43], a[16:19], a[96:99], v[40:43]
  s_lshl_b32 s60, s44, 5
  s_add_u32 s60, s60, 0x71c00
  v_mfma_f32_16x16x32_bf16 v[40:43], a[20:23], a[112:115], v[40:43]
  ds_read_b64_tr_b16 a[14:15], v232 offset:47616
  v_mfma_f32_16x16x32_bf16 v[44:47], a[20:23], a[116:119], v[44:47]
  buffer_load_dwordx4 a[164:167], v228, s[16:19], s60 offen sc1
  v_mfma_f32_16x16x32_bf16 v[44:47], a[16:19], a[100:103], v[44:47]
  ds_read_b64_tr_b16 a[16:17], v233 offset:32768
  v_mfma_f32_16x16x32_bf16 v[60:63], a[24:27], a[100:103], v[60:63]
  v_mfma_f32_16x16x32_bf16 v[60:63], a[28:31], a[116:119], v[60:63]
  ds_read_b64_tr_b16 a[18:19], v233 offset:33280
  v_mfma_f32_16x16x32_bf16 v[56:59], a[28:31], a[112:115], v[56:59]
  s_lshl_b32 s60, s44, 5
  s_add_u32 s60, s60, 0x72000
  v_mfma_f32_16x16x32_bf16 v[56:59], a[24:27], a[96:99], v[56:59]
  ds_read_b64_tr_b16 a[20:21], v233 offset:47104
  v_mfma_f32_16x16x32_bf16 v[52:55], a[24:27], a[92:95], v[52:55]
  ds_read_b128 a[64:67], v226 offset:4096
  v_mfma_f32_16x16x32_bf16 v[52:55], a[28:31], a[108:111], v[52:55]
  ds_read_b64_tr_b16 a[22:23], v233 offset:47616
  v_mfma_f32_16x16x32_bf16 v[48:51], a[28:31], a[104:107], v[48:51]
  ds_read_b128 a[80:83], v227 offset:4096
  v_mfma_f32_16x16x32_bf16 v[48:51], a[24:27], a[88:91], v[48:51]
  ds_read_b64_tr_b16 a[24:25], v234 offset:32768
  s_waitcnt lgkmcnt(8)
  v_mfma_f32_16x16x32_bf16 v[64:67], a[32:35], a[88:91], v[64:67]
  buffer_load_dwordx4 a[168:171], v228, s[16:19], s60 offen sc1
  s_lshl_b32 s60, s44, 5
  s_add_u32 s60, s60, 0x72400
  v_mfma_f32_16x16x32_bf16 v[64:67], a[36:39], a[104:107], v[64:67]
  ds_read_b64_tr_b16 a[26:27], v234 offset:33280
  v_mfma_f32_16x16x32_bf16 v[68:71], a[36:39], a[108:111], v[68:71]
  buffer_load_dwordx4 a[172:175], v228, s[16:19], s60 offen sc1
  v_mfma_f32_16x16x32_bf16 v[68:71], a[32:35], a[92:95], v[68:71]
  ds_read_b64_tr_b16 a[28:29], v234 offset:47104
  v_mfma_f32_16x16x32_bf16 v[72:75], a[32:35], a[96:99], v[72:75]
  v_mfma_f32_16x16x32_bf16 v[72:75], a[36:39], a[112:115], v[72:75]
  ds_read_b64_tr_b16 a[30:31], v234 offset:47616
  v_mfma_f32_16x16x32_bf16 v[76:79], a[36:39], a[116:119], v[76:79]
  s_lshl_b32 s60, s44, 5
  s_add_u32 s60, s60, 0x72800
  v_mfma_f32_16x16x32_bf16 v[76:79], a[32:35], a[100:103], v[76:79]
  ds_read_b64_tr_b16 a[32:33], v235 offset:32768
  v_mfma_f32_16x16x32_bf16 v[92:95], a[40:43], a[100:103], v[92:95]
  buffer_load_dwordx4 a[176:179], v228, s[16:19], s60 offen sc1
  v_mfma_f32_16x16x32_bf16 v[92:95], a[44:47], a[116:119], v[92:95]
  ds_read_b64_tr_b16 a[34:35], v235 offset:33280
  v_mfma_f32_16x16x32_bf16 v[88:91], a[44:47], a[112:115], v[88:91]
  ds_read_b128 a[68:71], v226 offset:6144
  v_mfma_f32_16x16x32_bf16 v[88:91], a[40:43], a[96:99], v[88:91]
  ds_read_b64_tr_b16 a[36:37], v235 offset:47104
  v_mfma_f32_16x16x32_bf16 v[84:87], a[40:43], a[92:95], v[84:87]
  ds_read_b128 a[84:87], v227 offset:6144
  s_lshl_b32 s60, s44, 5
  s_add_u32 s60, s60, 0x72c00
  v_mfma_f32_16x16x32_bf16 v[84:87], a[44:47], a[108:111], v[84:87]
  ds_read_b64_tr_b16 a[38:39], v235 offset:47616
  v_mfma_f32_16x16x32_bf16 v[80:83], a[44:47], a[104:107], v[80:83]
  buffer_load_dwordx4 a[180:183], v228, s[16:19], s60 offen sc1
  v_mfma_f32_16x16x32_bf16 v[80:83], a[40:43], a[88:91], v[80:83]
  ds_read_b64_tr_b16 a[40:41], v240 offset:30720
  v_mfma_f32_16x16x32_bf16 v[96:99], a[48:51], a[88:91], v[96:99]
  v_mfma_f32_16x16x32_bf16 v[96:99], a[52:55], a[104:107], v[96:99]
  ds_read_b64_tr_b16 a[42:43], v240 offset:30976
  v_mfma_f32_16x16x32_bf16 v[100:103], a[52:55], a[108:111], v[100:103]
  s_lshl_b32 s60, s45, 5
  s_add_u32 s60, s60, 0x70000
  v_mfma_f32_16x16x32_bf16 v[100:103], a[48:51], a[92:95], v[100:103]
  ds_read_b64_tr_b16 a[44:45], v240 offset:45056
  v_mfma_f32_16x16x32_bf16 v[104:107], a[48:51], a[96:99], v[104:107]
  buffer_load_dwordx4 a[184:187], v228, s[16:19], s60 offen sc1
  v_mfma_f32_16x16x32_bf16 v[104:107], a[52:55], a[112:115], v[104:107]
  ds_read_b64_tr_b16 a[46:47], v240 offset:45312
  v_mfma_f32_16x16x32_bf16 v[108:111], a[52:55], a[116:119], v[108:111]
  v_mfma_f32_16x16x32_bf16 v[108:111], a[48:51], a[100:103], v[108:111]
  ds_read_b64_tr_b16 a[48:49], v241 offset:30720
  v_mfma_f32_16x16x32_bf16 v[124:127], a[0:3], a[100:103], v[124:127]
  ds_read_b64_tr_b16 a[50:51], v241 offset:30976
  s_lshl_b32 s60, s45, 5
  s_add_u32 s60, s60, 0x70400
  v_mfma_f32_16x16x32_bf16 v[124:127], a[4:7], a[116:119], v[124:127]
  ds_read_b64_tr_b16 a[52:53], v241 offset:45056
  v_lshrrev_b32 v252, 7, v228
  v_mfma_f32_16x16x32_bf16 v[120:123], a[4:7], a[112:115], v[120:123]
  ds_read_b64_tr_b16 a[54:55], v241 offset:45312
  v_lshlrev_b32 v252, 11, v252
  v_mfma_f32_16x16x32_bf16 v[120:123], a[0:3], a[96:99], v[120:123]
  buffer_load_dwordx4 a[188:191], v228, s[16:19], s60 offen sc1
  v_bfe_u32 v253, v228, 5, 2
  v_mfma_f32_16x16x32_bf16 v[116:119], a[0:3], a[92:95], v[116:119]
  v_lshrrev_b32 v254, 8, v228
  s_lshr_b32 s46, s62, 16
  v_mfma_f32_16x16x32_bf16 v[116:119], a[4:7], a[108:111], v[116:119]
  v_xor_b32 v253, v253, v254
  s_mul_i32 s46, s46, 144
  v_mfma_f32_16x16x32_bf16 v[112:115], a[4:7], a[104:107], v[112:115]
  v_lshl_add_u32 v252, v253, 5, v252
  s_lshr_b32 s47, s44, 6
  v_mfma_f32_16x16x32_bf16 v[112:115], a[0:3], a[88:91], v[112:115]
  s_waitcnt lgkmcnt(0)
  s_barrier
  ds_read_b64_tr_b16 a[0:1], v236 offset:2048
  v_and_b32 v253, 16, v228
  v_mfma_f32_16x16x32_bf16 v[128:131], a[8:11], a[88:91], v[128:131]
  v_add_u32 v252, v252, v253
  s_add_u32 s47, s47, s46
  v_mfma_f32_16x16x32_bf16 v[128:131], a[12:15], a[104:107], v[128:131]
  ds_read_b64_tr_b16 a[2:3], v236 offset:2560
  s_lshr_b32 s3, s2, 5
  s_lshl_b32 s3, s3, 2
  s_lshr_b32 s3, 0x76345210, s3
  s_and_b32 s3, s3, 7
  s_lshl_b32 s3, s3, 1
  s_bfe_u32 s23, s2, 0x10001
  s_add_u32 s3, s3, s23
  s_lshl_b32 s24, s3, 7
  v_mfma_f32_16x16x32_bf16 v[132:135], a[12:15], a[108:111], v[132:135]
  s_lshl_b32 s3, s25, 15
  s_add_u32 s3, s3, s24
  v_add_u32 v224, s3, v252
  s_add_u32 s47, s47, 32
  v_mfma_f32_16x16x32_bf16 v[132:135], a[8:11], a[92:95], v[132:135]
  ds_read_b64_tr_b16 a[4:5], v236 offset:16384
  v_add_u32 v225, 0x4000, v224
  v_mfma_f32_16x16x32_bf16 v[136:139], a[8:11], a[96:99], v[136:139]
  v_xor_b32 v229, 0x80, v224
  s_lshl_b32 s47, s47, 11
  v_mfma_f32_16x16x32_bf16 v[136:139], a[12:15], a[112:115], v[136:139]
  ds_read_b64_tr_b16 a[6:7], v236 offset:16896
  v_xor_b32 v230, 0x80, v225
  v_mfma_f32_16x16x32_bf16 v[140:143], a[12:15], a[116:119], v[140:143]
  s_lshl_b32 s23, s25, 11
  s_lshr_b32 s46, s64, 16
  v_mfma_f32_16x16x32_bf16 v[140:143], a[8:11], a[100:103], v[140:143]
  ds_read_b64_tr_b16 a[8:9], v237 offset:2048
  s_bfe_u32 s3, s2, 0x20001
  s_mul_i32 s20, s3, 1835008
  v_mfma_f32_16x16x32_bf16 v[156:159], a[16:19], a[100:103], v[156:159]
  s_bfe_u32 s3, s2, 0x20005
  s_cmp_eq_u32 s3, 0
  s_mov_b32 s40, 0x74963210
  s_mov_b32 s41, 0xb85a
  s_mul_i32 s46, s46, 144
  v_mfma_f32_16x16x32_bf16 v[156:159], a[20:23], a[116:119], v[156:159]
  ds_read_b64_tr_b16 a[10:11], v237 offset:2560
  s_bfe_u32 s3, s2, 0x20005
  s_cmp_eq_u32 s3, 1
  s_cselect_b32 s40, 0xa7096543, s40
  s_cselect_b32 s41, 0x2b81, s41
  v_mfma_f32_16x16x32_bf16 v[152:155], a[20:23], a[112:115], v[152:155]
  s_bfe_u32 s3, s2, 0x20005
  s_cmp_eq_u32 s3, 2
  s_cselect_b32 s40, 0x1a309876, s40
  s_cselect_b32 s41, 0x52b4, s41
  s_lshr_b32 s48, s44, 6
  v_mfma_f32_16x16x32_bf16 v[152:155], a[16:19], a[96:99], v[152:155]
  ds_read_b64_tr_b16 a[12:13], v237 offset:16384
  s_bfe_u32 s3, s2, 0x20005
  s_cmp_eq_u32 s3, 3
  s_cselect_b32 s40, 0x41630ba9, s40
  s_cselect_b32 s41, 0x8527, s41
  v_mfma_f32_16x16x32_bf16 v[148:151], a[16:19], a[92:95], v[148:151]
  s_bfe_u32 s21, s40, 0x40000
  s_lshl_b32 s21, s21, 17
  s_add_u32 s21, s21, s20
  s_add_u32 s48, s48, s46
  v_mfma_f32_16x16x32_bf16 v[148:151], a[20:23], a[108:111], v[148:151]
  ds_read_b64_tr_b16 a[14:15], v237 offset:16896
  s_add_u32 s48, s48, 32
  v_mfma_f32_16x16x32_bf16 v[144:147], a[20:23], a[104:107], v[144:147]
  s_lshl_b32 s48, s48, 11
  v_mfma_f32_16x16x32_bf16 v[144:147], a[16:19], a[88:91], v[144:147]
  ds_read_b64_tr_b16 a[16:17], v238 offset:2048
  s_sub_u32 s49, s45, s44
  v_mfma_f32_16x16x32_bf16 v[160:163], a[24:27], a[88:91], v[160:163]
  s_lshl_b32 s49, s49, 5
  v_mfma_f32_16x16x32_bf16 v[160:163], a[28:31], a[104:107], v[160:163]
  ds_read_b64_tr_b16 a[18:19], v238 offset:2560
  v_mfma_f32_16x16x32_bf16 v[164:167], a[28:31], a[108:111], v[164:167]
  v_mfma_f32_16x16x32_bf16 v[164:167], a[24:27], a[92:95], v[164:167]
  ds_read_b64_tr_b16 a[20:21], v238 offset:16384
  v_mfma_f32_16x16x32_bf16 v[168:171], a[24:27], a[96:99], v[168:171]
  v_mfma_f32_16x16x32_bf16 v[168:171], a[28:31], a[112:115], v[168:171]
  ds_read_b64_tr_b16 a[22:23], v238 offset:16896
  v_mfma_f32_16x16x32_bf16 v[172:175], a[28:31], a[116:119], v[172:175]
  v_mfma_f32_16x16x32_bf16 v[172:175], a[24:27], a[100:103], v[172:175]
  s_waitcnt vmcnt(11)
  s_barrier
  ds_read_b64_tr_b16 a[24:25], v232 offset:2048
  v_mfma_f32_16x16x32_bf16 v[188:191], a[32:35], a[100:103], v[188:191]
  v_mfma_f32_16x16x32_bf16 v[188:191], a[36:39], a[116:119], v[188:191]
  ds_read_b64_tr_b16 a[26:27], v232 offset:2560
  v_mfma_f32_16x16x32_bf16 v[184:187], a[36:39], a[112:115], v[184:187]
  v_mfma_f32_16x16x32_bf16 v[184:187], a[32:35], a[96:99], v[184:187]
  ds_read_b64_tr_b16 a[28:29], v232 offset:16384
  v_mfma_f32_16x16x32_bf16 v[180:183], a[32:35], a[92:95], v[180:183]
  v_mfma_f32_16x16x32_bf16 v[180:183], a[36:39], a[108:111], v[180:183]
  ds_read_b64_tr_b16 a[30:31], v232 offset:16896
  v_mfma_f32_16x16x32_bf16 v[176:179], a[36:39], a[104:107], v[176:179]
  v_mfma_f32_16x16x32_bf16 v[176:179], a[32:35], a[88:91], v[176:179]
  ds_read_b64_tr_b16 a[32:33], v239 offset:2048
  v_mfma_f32_16x16x32_bf16 v[192:195], a[40:43], a[88:91], v[192:195]
  v_mfma_f32_16x16x32_bf16 v[192:195], a[44:47], a[104:107], v[192:195]
  ds_read_b64_tr_b16 a[34:35], v239 offset:2560
  v_mfma_f32_16x16x32_bf16 v[196:199], a[44:47], a[108:111], v[196:199]
  v_mfma_f32_16x16x32_bf16 v[196:199], a[40:43], a[92:95], v[196:199]
  ds_read_b64_tr_b16 a[36:37], v239 offset:16384
  v_mfma_f32_16x16x32_bf16 v[200:203], a[40:43], a[96:99], v[200:203]
  v_mfma_f32_16x16x32_bf16 v[200:203], a[44:47], a[112:115], v[200:203]
  ds_read_b64_tr_b16 a[38:39], v239 offset:16896
  v_mfma_f32_16x16x32_bf16 v[204:207], a[44:47], a[116:119], v[204:207]
  v_mfma_f32_16x16x32_bf16 v[204:207], a[40:43], a[100:103], v[204:207]
  ds_read_b64_tr_b16 a[40:41], v233 offset:2048
  v_mfma_f32_16x16x32_bf16 v[220:223], a[48:51], a[100:103], v[220:223]
  v_mfma_f32_16x16x32_bf16 v[220:223], a[52:55], a[116:119], v[220:223]
  ds_read_b64_tr_b16 a[42:43], v233 offset:2560
  v_mfma_f32_16x16x32_bf16 v[216:219], a[52:55], a[112:115], v[216:219]
  v_mfma_f32_16x16x32_bf16 v[216:219], a[48:51], a[96:99], v[216:219]
  ds_read_b64_tr_b16 a[44:45], v233 offset:16384
  v_mfma_f32_16x16x32_bf16 v[212:215], a[48:51], a[92:95], v[212:215]
  v_mfma_f32_16x16x32_bf16 v[212:215], a[52:55], a[108:111], v[212:215]
  ds_read_b64_tr_b16 a[46:47], v233 offset:16896
  v_mfma_f32_16x16x32_bf16 v[208:211], a[52:55], a[104:107], v[208:211]
  v_mfma_f32_16x16x32_bf16 v[208:211], a[48:51], a[88:91], v[208:211]
  ds_read_b64_tr_b16 a[48:49], v236 offset:3072
  s_waitcnt lgkmcnt(8)
  v_mfma_f32_16x16x32_bf16 v[0:3], a[0:3], a[56:59], v[0:3]
  ds_read_b128 a[88:91], v226 offset:8192
  v_mfma_f32_16x16x32_bf16 v[0:3], a[4:7], a[72:75], v[0:3]
  ds_read_b64_tr_b16 a[50:51], v236 offset:3584
  v_mfma_f32_16x16x32_bf16 v[4:7], a[4:7], a[76:79], v[4:7]
  ds_read_b128 a[104:107], v227 offset:8192
  v_mfma_f32_16x16x32_bf16 v[4:7], a[0:3], a[60:63], v[4:7]
  ds_read_b64_tr_b16 a[52:53], v236 offset:17408
  v_mfma_f32_16x16x32_bf16 v[8:11], a[0:3], a[64:67], v[8:11]
  ds_read_b128 a[92:95], v226 offset:10240
  v_mfma_f32_16x16x32_bf16 v[8:11], a[4:7], a[80:83], v[8:11]
  ds_read_b64_tr_b16 a[54:55], v236 offset:17920
  v_mfma_f32_16x16x32_bf16 v[12:15], a[4:7], a[84:87], v[12:15]
  ds_read_b128 a[108:111], v227 offset:10240
  v_mfma_f32_16x16x32_bf16 v[12:15], a[0:3], a[68:71], v[12:15]
  ds_read_b64_tr_b16 a[0:1], v234 offset:2048
  v_mfma_f32_16x16x32_bf16 v[28:31], a[8:11], a[68:71], v[28:31]
  ds_read_b128 a[96:99], v226 offset:12288
  v_mfma_f32_16x16x32_bf16 v[28:31], a[12:15], a[84:87], v[28:31]
  ds_read_b64_tr_b16 a[2:3], v234 offset:2560
  v_mfma_f32_16x16x32_bf16 v[24:27], a[12:15], a[80:83], v[24:27]
  ds_read_b128 a[112:115], v227 offset:12288
  v_mfma_f32_16x16x32_bf16 v[24:27], a[8:11], a[64:67], v[24:27]
  ds_read_b64_tr_b16 a[4:5], v234 offset:16384
  v_mfma_f32_16x16x32_bf16 v[20:23], a[8:11], a[60:63], v[20:23]
  ds_read_b128 a[100:103], v226 offset:14336
  v_mfma_f32_16x16x32_bf16 v[20:23], a[12:15], a[76:79], v[20:23]
  ds_read_b64_tr_b16 a[6:7], v234 offset:16896
  v_mfma_f32_16x16x32_bf16 v[16:19], a[12:15], a[72:75], v[16:19]
  ds_read_b128 a[116:119], v227 offset:14336
  v_mfma_f32_16x16x32_bf16 v[16:19], a[8:11], a[56:59], v[16:19]
  ds_read_b64_tr_b16 a[8:9], v237 offset:3072
  v_mfma_f32_16x16x32_bf16 v[32:35], a[16:19], a[56:59], v[32:35]
  v_mfma_f32_16x16x32_bf16 v[32:35], a[20:23], a[72:75], v[32:35]
  ds_read_b64_tr_b16 a[10:11], v237 offset:3584
  v_mfma_f32_16x16x32_bf16 v[36:39], a[20:23], a[76:79], v[36:39]
  v_mfma_f32_16x16x32_bf16 v[36:39], a[16:19], a[60:63], v[36:39]
  ds_read_b64_tr_b16 a[12:13], v237 offset:17408
  v_mfma_f32_16x16x32_bf16 v[40:43], a[16:19], a[64:67], v[40:43]
  v_mfma_f32_16x16x32_bf16 v[40:43], a[20:23], a[80:83], v[40:43]
  ds_read_b64_tr_b16 a[14:15], v237 offset:17920
  v_mfma_f32_16x16x32_bf16 v[44:47], a[20:23], a[84:87], v[44:47]
  v_mfma_f32_16x16x32_bf16 v[44:47], a[16:19], a[68:71], v[44:47]
  ds_read_b64_tr_b16 a[16:17], v235 offset:2048
  s_waitcnt lgkmcnt(5)
  v_mfma_f32_16x16x32_bf16 v[12:15], a[24:27], a[100:103], v[12:15]
  s_waitcnt lgkmcnt(0)
  s_barrier
  v_mfma_f32_16x16x32_bf16 v[12:15], a[136:139], a[212:215], v[12:15]
  ds_read_b64_tr_b16 a[18:19], v235 offset:2560
  s_add_u32 m0, s23, 0x16000
  v_mfma_f32_16x16x32_bf16 v[12:15], a[28:31], a[116:119], v[12:15]
  buffer_load_dwordx4 v224, s[36:39], s21 offen lds
  s_mov_b32 s101, s24
  s_mov_b32 s67, 0
  v_mfma_f32_16x16x32_bf16 v[8:11], a[28:31], a[112:115], v[8:11]
  ds_read_b64_tr_b16 a[20:21], v235 offset:16384
  s_lshl_b32 s3, s26, 2
  s_add_u32 s3, s3, s25
  s_lshl_b32 s3, s3, 1
  s_bfe_u32 s43, s2, 0x10002
  s_add_u32 s43, s43, s3
  v_mfma_f32_16x16x32_bf16 v[8:11], a[136:139], a[208:211], v[8:11]
  s_mul_i32 s3, s43, 294912
  v_add_u32 v226, s3, v228
  v_mfma_f32_16x16x32_bf16 v[8:11], a[24:27], a[96:99], v[8:11]
  ds_read_b64_tr_b16 a[22:23], v235 offset:16896
  s_xor_b32 s3, s43, 1
  s_mul_i32 s3, s3, 294912
  v_add_u32 v227, s3, v228
  v_mfma_f32_16x16x32_bf16 v[4:7], a[24:27], a[92:95], v[4:7]
  s_bfe_u32 s3, s2, 0x20001
  s_mul_i32 s42, s3, 57344
  s_add_u32 s42, s42, 65536
  v_mfma_f32_16x16x32_bf16 v[4:7], a[136:139], a[204:207], v[4:7]
  s_bfe_u32 s22, s40, 0x4000c
  s_lshl_b32 s22, s22, 12
  s_add_u32 s22, s22, s42
  v_mfma_f32_16x16x32_bf16 v[4:7], a[28:31], a[108:111], v[4:7]
  s_add_u32 m0, s23, 0x16400
  v_bfe_u32 v252, v228, 4, 2
  v_mfma_f32_16x16x32_bf16 v[0:3], a[28:31], a[104:107], v[0:3]
  buffer_load_dwordx4 v225, s[36:39], s21 offen lds
  v_lshlrev_b32 v253, 1, v252
  v_mfma_f32_16x16x32_bf16 v[0:3], a[136:139], a[200:203], v[0:3]
  v_xor_b32 v231, s2, v253
  v_mul_f32 v12, v12, |v12|
  v_mul_f32 v13, v13, |v13|
  v_mfma_f32_16x16x32_bf16 v[0:3], a[24:27], a[88:91], v[0:3]
  ds_read_b64_tr_b16 a[24:25], v238 offset:3072
  v_lshlrev_b32 v253, 5, v252
  v_mul_f32 v14, v14, |v14|
  v_mfma_f32_16x16x32_bf16 v[48:51], a[32:35], a[56:59], v[48:51]
  s_and_b32 s3, s2, 0x1f
  s_or_b32 s3, s3, 0x80
  s_mov_b32 exec_hi, 0
  v_add_u32 v231, s3, v253
  s_mov_b32 exec_hi, -1
  v_mul_f32 v15, v15, |v15|
  v_cvt_pk_bf16_f32 v12, v12, v13
  v_mfma_f32_16x16x32_bf16 v[48:51], a[36:39], a[72:75], v[48:51]
  ds_read_b64_tr_b16 a[26:27], v238 offset:3584
  s_bfe_u32 s3, s2, 0x20005
  v_add_u32 v252, s3, v252
  v_cvt_pk_bf16_f32 v13, v14, v15
  v_mfma_f32_16x16x32_bf16 v[52:55], a[36:39], a[76:79], v[52:55]
  v_and_b32 v252, 3, v252
  v_pk_max_i16 v12, v12, 0
  v_pk_max_i16 v13, v13, 0
  v_mfma_f32_16x16x32_bf16 v[52:55], a[32:35], a[60:63], v[52:55]
  ds_read_b64_tr_b16 a[28:29], v238 offset:17408
  s_add_u32 m0, s23, 0x18000
  v_mul_f32 v8, v8, |v8|
  v_mfma_f32_16x16x32_bf16 v[56:59], a[32:35], a[64:67], v[56:59]
  buffer_load_dwordx4 v229, s[36:39], s21 offen lds
  v_lshlrev_b32 v252, 5, v252
  v_mul_f32 v9, v9, |v9|
  v_mfma_f32_16x16x32_bf16 v[56:59], a[36:39], a[80:83], v[56:59]
  ds_read_b64_tr_b16 a[30:31], v238 offset:17920
  s_and_b32 s3, s2, 0x1f
  s_mov_b64 exec, 0xffff
  v_add_u32 v231, s3, v252
  s_mov_b64 exec, -1
  v_mul_f32 v10, v10, |v10|
  v_mfma_f32_16x16x32_bf16 v[60:63], a[36:39], a[84:87], v[60:63]
  v_lshlrev_b32 v231, 9, v231
  v_mul_f32 v11, v11, |v11|
  v_cvt_pk_bf16_f32 v8, v8, v9
  v_mfma_f32_16x16x32_bf16 v[60:63], a[32:35], a[68:71], v[60:63]
  ds_read_b64_tr_b16 a[32:33], v232 offset:3072
  s_lshl_b32 s3, s25, 7
  s_add_u32 s3, s3, 0xa8000
  v_add_u32 v231, s3, v231
  v_cvt_pk_bf16_f32 v9, v10, v11
  v_mfma_f32_16x16x32_bf16 v[28:31], a[40:43], a[100:103], v[28:31]
  v_pk_max_i16 v8, v8, 0
  v_pk_max_i16 v9, v9, 0
  v_mul_f32 v4, v4, |v4|
  v_mfma_f32_16x16x32_bf16 v[28:31], a[140:143], a[212:215], v[28:31]
  ds_read_b64_tr_b16 a[34:35], v232 offset:3584
  v_mul_f32 v5, v5, |v5|
  v_mul_f32 v6, v6, |v6|
  v_mfma_f32_16x16x32_bf16 v[28:31], a[44:47], a[116:119], v[28:31]
  v_mul_f32 v7, v7, |v7|
  v_cvt_pk_bf16_f32 v4, v4, v5
  v_cvt_pk_bf16_f32 v5, v6, v7
  v_mfma_f32_16x16x32_bf16 v[24:27], a[44:47], a[112:115], v[24:27]
  ds_read_b64_tr_b16 a[36:37], v232 offset:17408
  s_add_u32 m0, s23, 0x18400
  v_pk_max_i16 v4, v4, 0
  v_mfma_f32_16x16x32_bf16 v[24:27], a[140:143], a[208:211], v[24:27]
  buffer_load_dwordx4 v230, s[36:39], s21 offen lds
  s_bfe_u32 s21, s40, 0x40004
  s_lshl_b32 s21, s21, 17
  s_add_u32 s21, s21, s20
  v_pk_max_i16 v5, v5, 0
  v_mul_f32 v0, v0, |v0|
  v_mfma_f32_16x16x32_bf16 v[24:27], a[40:43], a[96:99], v[24:27]
  ds_read_b64_tr_b16 a[38:39], v232 offset:17920
  v_mul_f32 v1, v1, |v1|
  v_mul_f32 v2, v2, |v2|
  v_mfma_f32_16x16x32_bf16 v[20:23], a[40:43], a[92:95], v[20:23]
  v_mul_f32 v3, v3, |v3|
  v_cvt_pk_bf16_f32 v0, v0, v1
  v_cvt_pk_bf16_f32 v1, v2, v3
  v_mfma_f32_16x16x32_bf16 v[20:23], a[140:143], a[204:207], v[20:23]
  v_pk_max_i16 v0, v0, 0
  v_pk_max_i16 v1, v1, 0
  v_mfma_f32_16x16x32_bf16 v[20:23], a[44:47], a[108:111], v[20:23]
  v_mfma_f32_16x16x32_bf16 v[16:19], a[44:47], a[104:107], v[16:19]
  v_mfma_f32_16x16x32_bf16 v[16:19], a[140:143], a[200:203], v[16:19]
  s_add_u32 m0, s23, 0x1a000
  v_mul_f32 v28, v28, |v28|
  v_mul_f32 v29, v29, |v29|
  v_mfma_f32_16x16x32_bf16 v[16:19], a[40:43], a[88:91], v[16:19]
  ds_read_b64_tr_b16 a[40:41], v239 offset:3072
  buffer_load_dwordx4 v224, s[36:39], s21 offen lds
  v_mul_f32 v30, v30, |v30|
  v_mfma_f32_16x16x32_bf16 v[64:67], a[48:51], a[56:59], v[64:67]
  v_mul_f32 v31, v31, |v31|
  v_cvt_pk_bf16_f32 v14, v28, v29
  v_cvt_pk_bf16_f32 v15, v30, v31
  v_mfma_f32_16x16x32_bf16 v[64:67], a[52:55], a[72:75], v[64:67]
  ds_read_b64_tr_b16 a[42:43], v239 offset:3584
  v_pk_max_i16 v14, v14, 0
  v_pk_max_i16 v15, v15, 0
  v_mfma_f32_16x16x32_bf16 v[68:71], a[52:55], a[76:79], v[68:71]
  s_add_u32 s60, s48, 0x0
  buffer_store_dwordx4 v[12:15], v228, s[12:15], s60 offen offset:1024 sc1
  v_mul_f32 v24, v24, |v24|
  v_mul_f32 v25, v25, |v25|
  v_mfma_f32_16x16x32_bf16 v[68:71], a[48:51], a[60:63], v[68:71]
  ds_read_b64_tr_b16 a[44:45], v239 offset:17408
  v_mul_f32 v26, v26, |v26|
  v_mul_f32 v27, v27, |v27|
  v_mfma_f32_16x16x32_bf16 v[72:75], a[48:51], a[64:67], v[72:75]
  v_cvt_pk_bf16_f32 v10, v24, v25
  v_cvt_pk_bf16_f32 v11, v26, v27
  v_pk_max_i16 v10, v10, 0
  v_mfma_f32_16x16x32_bf16 v[72:75], a[52:55], a[80:83], v[72:75]
  ds_read_b64_tr_b16 a[46:47], v239 offset:17920
  v_pk_max_i16 v11, v11, 0
  s_add_u32 s60, s48, 0x0
  buffer_store_dwordx4 v[8:11], v228, s[12:15], s60 offen offset:0 sc1
  v_mfma_f32_16x16x32_bf16 v[76:79], a[52:55], a[84:87], v[76:79]
  s_add_u32 m0, s23, 0x1a400
  v_mul_f32 v20, v20, |v20|
  v_mul_f32 v21, v21, |v21|
  v_mfma_f32_16x16x32_bf16 v[76:79], a[48:51], a[68:71], v[76:79]
  ds_read_b64_tr_b16 a[48:49], v233 offset:3072
  buffer_load_dwordx4 v225, s[36:39], s21 offen lds
  v_mul_f32 v22, v22, |v22|
  v_mfma_f32_16x16x32_bf16 v[44:47], a[0:3], a[100:103], v[44:47]
  v_mul_f32 v23, v23, |v23|
  v_cvt_pk_bf16_f32 v6, v20, v21
  v_cvt_pk_bf16_f32 v7, v22, v23
  v_mfma_f32_16x16x32_bf16 v[44:47], a[144:147], a[212:215], v[44:47]
  ds_read_b64_tr_b16 a[50:51], v233 offset:3584
  v_pk_max_i16 v6, v6, 0
  v_pk_max_i16 v7, v7, 0
  v_mfma_f32_16x16x32_bf16 v[44:47], a[4:7], a[116:119], v[44:47]
  s_add_u32 s60, s47, 0x0
  buffer_store_dwordx4 v[4:7], v228, s[12:15], s60 offen offset:1024 sc1
  v_mul_f32 v16, v16, |v16|
  v_mul_f32 v17, v17, |v17|
  v_mfma_f32_16x16x32_bf16 v[40:43], a[4:7], a[112:115], v[40:43]
  ds_read_b64_tr_b16 a[52:53], v233 offset:17408
  v_mul_f32 v18, v18, |v18|
  v_mul_f32 v19, v19, |v19|
  v_mfma_f32_16x16x32_bf16 v[40:43], a[144:147], a[208:211], v[40:43]
  v_cvt_pk_bf16_f32 v2, v16, v17
  v_cvt_pk_bf16_f32 v3, v18, v19
  v_pk_max_i16 v2, v2, 0
  v_mfma_f32_16x16x32_bf16 v[40:43], a[0:3], a[96:99], v[40:43]
  ds_read_b64_tr_b16 a[54:55], v233 offset:17920
  s_add_u32 m0, s23, 0x1c000
  v_pk_max_i16 v3, v3, 0
  v_mfma_f32_16x16x32_bf16 v[36:39], a[0:3], a[92:95], v[36:39]
  buffer_load_dwordx4 v229, s[36:39], s21 offen lds
  s_add_u32 s60, s47, 0x0
  buffer_store_dwordx4 v[0:3], v228, s[12:15], s60 offen offset:0 sc1
  v_mfma_f32_16x16x32_bf16 v[36:39], a[144:147], a[204:207], v[36:39]
  v_mfma_f32_16x16x32_bf16 v[36:39], a[4:7], a[108:111], v[36:39]
  v_mfma_f32_16x16x32_bf16 v[32:35], a[4:7], a[104:107], v[32:35]
  v_mfma_f32_16x16x32_bf16 v[32:35], a[144:147], a[200:203], v[32:35]
  v_mul_f32 v44, v44, |v44|
  v_mul_f32 v45, v45, |v45|
  v_mul_f32 v46, v46, |v46|
  v_mfma_f32_16x16x32_bf16 v[32:35], a[0:3], a[88:91], v[32:35]
  ds_read_b64_tr_b16 a[0:1], v236 offset:4096
  v_mul_f32 v47, v47, |v47|
  v_cvt_pk_bf16_f32 v44, v44, v45
  v_mfma_f32_16x16x32_bf16 v[80:83], a[8:11], a[56:59], v[80:83]
  s_add_u32 m0, s23, 0x1c400
  v_cvt_pk_bf16_f32 v45, v46, v47
  v_pk_max_i16 v44, v44, 0
  v_mfma_f32_16x16x32_bf16 v[80:83], a[12:15], a[72:75], v[80:83]
  ds_read_b64_tr_b16 a[2:3], v236 offset:4608
  buffer_load_dwordx4 v230, s[36:39], s21 offen lds
  s_bfe_u32 s21, s40, 0x40008
  s_lshl_b32 s21, s21, 17
  s_add_u32 s21, s21, s20
  v_pk_max_i16 v45, v45, 0
  v_mfma_f32_16x16x32_bf16 v[84:87], a[12:15], a[76:79], v[84:87]
  v_mul_f32 v40, v40, |v40|
  v_mul_f32 v41, v41, |v41|
  v_mul_f32 v42, v42, |v42|
  v_mfma_f32_16x16x32_bf16 v[84:87], a[8:11], a[60:63], v[84:87]
  ds_read_b64_tr_b16 a[4:5], v236 offset:18432
  v_mul_f32 v43, v43, |v43|
  v_cvt_pk_bf16_f32 v40, v40, v41
  v_mfma_f32_16x16x32_bf16 v[88:91], a[8:11], a[64:67], v[88:91]
  v_cvt_pk_bf16_f32 v41, v42, v43
  v_pk_max_i16 v40, v40, 0
  v_pk_max_i16 v41, v41, 0
  v_mfma_f32_16x16x32_bf16 v[88:91], a[12:15], a[80:83], v[88:91]
  ds_read_b64_tr_b16 a[6:7], v236 offset:18944
  v_mul_f32 v36, v36, |v36|
  v_mul_f32 v37, v37, |v37|
  v_mfma_f32_16x16x32_bf16 v[92:95], a[12:15], a[84:87], v[92:95]
  v_mul_f32 v38, v38, |v38|
  v_mul_f32 v39, v39, |v39|
  v_cvt_pk_bf16_f32 v36, v36, v37
  v_mfma_f32_16x16x32_bf16 v[92:95], a[8:11], a[68:71], v[92:95]
  ds_read_b64_tr_b16 a[8:9], v234 offset:3072
  v_cvt_pk_bf16_f32 v37, v38, v39
  v_pk_max_i16 v36, v36, 0
  s_waitcnt lgkmcnt(8)
  v_mfma_f32_16x16x32_bf16 v[60:63], a[16:19], a[100:103], v[60:63]
  s_add_u32 m0, s23, 0x1e000
  v_pk_max_i16 v37, v37, 0
  v_mul_f32 v32, v32, |v32|
  s_waitcnt vmcnt(22)
  v_mfma_f32_16x16x32_bf16 v[60:63], a[148:151], a[212:215], v[60:63]
  ds_read_b64_tr_b16 a[10:11], v234 offset:3584
  buffer_load_dwordx4 v224, s[36:39], s21 offen lds
  v_mul_f32 v33, v33, |v33|
  v_mfma_f32_16x16x32_bf16 v[60:63], a[20:23], a[116:119], v[60:63]
  v_mul_f32 v34, v34, |v34|
  v_mul_f32 v35, v35, |v35|
  v_cvt_pk_bf16_f32 v32, v32, v33
  v_mfma_f32_16x16x32_bf16 v[56:59], a[20:23], a[112:115], v[56:59]
  ds_read_b64_tr_b16 a[12:13], v234 offset:17408
  v_cvt_pk_bf16_f32 v33, v34, v35
  v_pk_max_i16 v32, v32, 0
  v_mfma_f32_16x16x32_bf16 v[56:59], a[148:151], a[208:211], v[56:59]
  v_pk_max_i16 v33, v33, 0
  v_mfma_f32_16x16x32_bf16 v[56:59], a[16:19], a[96:99], v[56:59]
  ds_read_b64_tr_b16 a[14:15], v234 offset:17920
  v_mfma_f32_16x16x32_bf16 v[52:55], a[16:19], a[92:95], v[52:55]
  v_mfma_f32_16x16x32_bf16 v[52:55], a[148:151], a[204:207], v[52:55]
  s_add_u32 m0, s23, 0x1e400
  v_mfma_f32_16x16x32_bf16 v[52:55], a[20:23], a[108:111], v[52:55]
  buffer_load_dwordx4 v225, s[36:39], s21 offen lds
  v_mfma_f32_16x16x32_bf16 v[48:51], a[20:23], a[104:107], v[48:51]
  v_mfma_f32_16x16x32_bf16 v[48:51], a[148:151], a[200:203], v[48:51]
  v_mul_f32 v60, v60, |v60|
  v_mul_f32 v61, v61, |v61|
  v_mul_f32 v62, v62, |v62|
  v_mfma_f32_16x16x32_bf16 v[48:51], a[16:19], a[88:91], v[48:51]
  ds_read_b64_tr_b16 a[16:17], v237 offset:4096
  v_mul_f32 v63, v63, |v63|
  v_cvt_pk_bf16_f32 v46, v60, v61
  v_mfma_f32_16x16x32_bf16 v[96:99], a[24:27], a[56:59], v[96:99]
  v_cvt_pk_bf16_f32 v47, v62, v63
  v_pk_max_i16 v46, v46, 0
  v_pk_max_i16 v47, v47, 0
  v_mfma_f32_16x16x32_bf16 v[96:99], a[28:31], a[72:75], v[96:99]
  ds_read_b64_tr_b16 a[18:19], v237 offset:4608
  s_add_u32 s60, s48, 0x800
  buffer_store_dwordx4 v[44:47], v228, s[12:15], s60 offen offset:1024 sc1
  v_mul_f32 v56, v56, |v56|
  v_mfma_f32_16x16x32_bf16 v[100:103], a[28:31], a[76:79], v[100:103]
  v_mul_f32 v57, v57, |v57|
  v_mul_f32 v58, v58, |v58|
  v_mul_f32 v59, v59, |v59|
  v_mfma_f32_16x16x32_bf16 v[100:103], a[24:27], a[60:63], v[100:103]
  ds_read_b64_tr_b16 a[20:21], v237 offset:18432
  s_add_u32 m0, s23, 0x20000
  v_cvt_pk_bf16_f32 v42, v56, v57
  v_mfma_f32_16x16x32_bf16 v[104:107], a[24:27], a[64:67], v[104:107]
  buffer_load_dwordx4 v229, s[36:39], s21 offen lds
  v_cvt_pk_bf16_f32 v43, v58, v59
  v_pk_max_i16 v42, v42, 0
  v_mfma_f32_16x16x32_bf16 v[104:107], a[28:31], a[80:83], v[104:107]
  ds_read_b64_tr_b16 a[22:23], v237 offset:18944
  v_pk_max_i16 v43, v43, 0
  s_add_u32 s60, s48, 0x800
  buffer_store_dwordx4 v[40:43], v228, s[12:15], s60 offen offset:0 sc1
  v_mfma_f32_16x16x32_bf16 v[108:111], a[28:31], a[84:87], v[108:111]
  v_mul_f32 v52, v52, |v52|
  v_mul_f32 v53, v53, |v53|
  v_mul_f32 v54, v54, |v54|
  v_mfma_f32_16x16x32_bf16 v[108:111], a[24:27], a[68:71], v[108:111]
  ds_read_b64_tr_b16 a[24:25], v235 offset:3072
  v_mul_f32 v55, v55, |v55|
  v_cvt_pk_bf16_f32 v38, v52, v53
  v_mfma_f32_16x16x32_bf16 v[76:79], a[32:35], a[100:103], v[76:79]
  ds_read_b64_tr_b16 a[26:27], v235 offset:3584
  v_cvt_pk_bf16_f32 v39, v54, v55
  v_pk_max_i16 v38, v38, 0
  s_waitcnt vmcnt(26)
  v_mfma_f32_16x16x32_bf16 v[76:79], a[152:155], a[212:215], v[76:79]
  ds_read_b64_tr_b16 a[28:29], v235 offset:17408
  v_pk_max_i16 v39, v39, 0
  s_add_u32 s60, s47, 0x800
  buffer_store_dwordx4 v[36:39], v228, s[12:15], s60 offen offset:1024 sc1
  v_mfma_f32_16x16x32_bf16 v[76:79], a[36:39], a[116:119], v[76:79]
  ds_read_b64_tr_b16 a[30:31], v235 offset:17920
  s_add_u32 m0, s23, 0x20400
  v_mul_f32 v48, v48, |v48|
  v_mfma_f32_16x16x32_bf16 v[72:75], a[36:39], a[112:115], v[72:75]
  buffer_load_dwordx4 v230, s[36:39], s21 offen lds
  s_bfe_u32 s21, s40, 0x4000c
  s_lshl_b32 s21, s21, 17
  s_add_u32 s21, s21, s20
  v_mul_f32 v49, v49, |v49|
  v_mul_f32 v50, v50, |v50|
  v_mfma_f32_16x16x32_bf16 v[72:75], a[152:155], a[208:211], v[72:75]
  v_mul_f32 v51, v51, |v51|
  v_cvt_pk_bf16_f32 v34, v48, v49
  v_cvt_pk_bf16_f32 v35, v50, v51
  v_mfma_f32_16x16x32_bf16 v[72:75], a[32:35], a[96:99], v[72:75]
  v_pk_max_i16 v34, v34, 0
  v_pk_max_i16 v35, v35, 0
  s_add_u32 s60, s47, 0x800
  buffer_store_dwordx4 v[32:35], v228, s[12:15], s60 offen offset:0 sc1
  v_mfma_f32_16x16x32_bf16 v[68:71], a[32:35], a[92:95], v[68:71]
  v_mfma_f32_16x16x32_bf16 v[68:71], a[152:155], a[204:207], v[68:71]
  v_mfma_f32_16x16x32_bf16 v[68:71], a[36:39], a[108:111], v[68:71]
  v_mfma_f32_16x16x32_bf16 v[64:67], a[36:39], a[104:107], v[64:67]
  v_mfma_f32_16x16x32_bf16 v[64:67], a[152:155], a[200:203], v[64:67]
  v_mul_f32 v76, v76, |v76|
  v_mul_f32 v77, v77, |v77|
  v_mul_f32 v78, v78, |v78|
  v_mfma_f32_16x16x32_bf16 v[64:67], a[32:35], a[88:91], v[64:67]
  ds_read_b64_tr_b16 a[32:33], v238 offset:4096
  v_mul_f32 v79, v79, |v79|
  v_cvt_pk_bf16_f32 v76, v76, v77
  v_mfma_f32_16x16x32_bf16 v[112:115], a[40:43], a[56:59], v[112:115]
  v_cvt_pk_bf16_f32 v77, v78, v79
  v_pk_max_i16 v76, v76, 0
  v_pk_max_i16 v77, v77, 0
  v_mfma_f32_16x16x32_bf16 v[112:115], a[44:47], a[72:75], v[112:115]
  ds_read_b64_tr_b16 a[34:35], v238 offset:4608
  v_mul_f32 v72, v72, |v72|
  v_mul_f32 v73, v73, |v73|
  v_mfma_f32_16x16x32_bf16 v[116:119], a[44:47], a[76:79], v[116:119]
  v_mul_f32 v74, v74, |v74|
  v_mul_f32 v75, v75, |v75|
  v_cvt_pk_bf16_f32 v72, v72, v73
  v_mfma_f32_16x16x32_bf16 v[116:119], a[40:43], a[60:63], v[116:119]
  ds_read_b64_tr_b16 a[36:37], v238 offset:18432
  v_cvt_pk_bf16_f32 v73, v74, v75
  v_pk_max_i16 v72, v72, 0
  v_mfma_f32_16x16x32_bf16 v[120:123], a[40:43], a[64:67], v[120:123]
  v_pk_max_i16 v73, v73, 0
  v_mul_f32 v68, v68, |v68|
  v_mul_f32 v69, v69, |v69|
  v_mfma_f32_16x16x32_bf16 v[120:123], a[44:47], a[80:83], v[120:123]
  ds_read_b64_tr_b16 a[38:39], v238 offset:18944
  v_mul_f32 v70, v70, |v70|
  v_mul_f32 v71, v71, |v71|
  v_mfma_f32_16x16x32_bf16 v[124:127], a[44:47], a[84:87], v[124:127]
  v_cvt_pk_bf16_f32 v68, v68, v69
  v_cvt_pk_bf16_f32 v69, v70, v71
  v_pk_max_i16 v68, v68, 0
  v_mfma_f32_16x16x32_bf16 v[124:127], a[40:43], a[68:71], v[124:127]
  ds_read_b64_tr_b16 a[40:41], v232 offset:4096
  v_pk_max_i16 v69, v69, 0
  v_mul_f32 v64, v64, |v64|
  s_waitcnt lgkmcnt(8)
  v_mfma_f32_16x16x32_bf16 v[92:95], a[48:51], a[100:103], v[92:95]
  v_mul_f32 v65, v65, |v65|
  v_mul_f32 v66, v66, |v66|
  v_mul_f32 v67, v67, |v67|
  s_waitcnt vmcnt(28)
  v_mfma_f32_16x16x32_bf16 v[92:95], a[156:159], a[212:215], v[92:95]
  ds_read_b64_tr_b16 a[42:43], v232 offset:4608
  v_cvt_pk_bf16_f32 v64, v64, v65
  v_cvt_pk_bf16_f32 v65, v66, v67
  v_mfma_f32_16x16x32_bf16 v[92:95], a[52:55], a[116:119], v[92:95]
  v_pk_max_i16 v64, v64, 0
  v_pk_max_i16 v65, v65, 0
  v_mfma_f32_16x16x32_bf16 v[88:91], a[52:55], a[112:115], v[88:91]
  ds_read_b64_tr_b16 a[44:45], v232 offset:18432
  v_mfma_f32_16x16x32_bf16 v[88:91], a[156:159], a[208:211], v[88:91]
  v_mfma_f32_16x16x32_bf16 v[88:91], a[48:51], a[96:99], v[88:91]
  ds_read_b64_tr_b16 a[46:47], v232 offset:18944
  v_mfma_f32_16x16x32_bf16 v[84:87], a[48:51], a[92:95], v[84:87]
  v_mfma_f32_16x16x32_bf16 v[84:87], a[156:159], a[204:207], v[84:87]
  v_mfma_f32_16x16x32_bf16 v[84:87], a[52:55], a[108:111], v[84:87]
  v_mfma_f32_16x16x32_bf16 v[80:83], a[52:55], a[104:107], v[80:83]
  v_mfma_f32_16x16x32_bf16 v[80:83], a[156:159], a[200:203], v[80:83]
  v_mul_f32 v92, v92, |v92|
  v_mul_f32 v93, v93, |v93|
  v_mul_f32 v94, v94, |v94|
  v_mfma_f32_16x16x32_bf16 v[80:83], a[48:51], a[88:91], v[80:83]
  ds_read_b64_tr_b16 a[48:49], v239 offset:4096
  v_mul_f32 v95, v95, |v95|
  v_cvt_pk_bf16_f32 v78, v92, v93
  v_mfma_f32_16x16x32_bf16 v[128:131], a[0:3], a[56:59], v[128:131]
  v_cvt_pk_bf16_f32 v79, v94, v95
  v_pk_max_i16 v78, v78, 0
  v_pk_max_i16 v79, v79, 0
  v_mfma_f32_16x16x32_bf16 v[128:131], a[4:7], a[72:75], v[128:131]
  ds_read_b64_tr_b16 a[50:51], v239 offset:4608
  s_add_u32 s60, s48, 0x1000
  buffer_store_dwordx4 v[76:79], v228, s[12:15], s60 offen offset:1024 sc1
  v_mul_f32 v88, v88, |v88|
  v_mfma_f32_16x16x32_bf16 v[132:135], a[4:7], a[76:79], v[132:135]
  v_mul_f32 v89, v89, |v89|
  v_mul_f32 v90, v90, |v90|
  v_mul_f32 v91, v91, |v91|
  v_mfma_f32_16x16x32_bf16 v[132:135], a[0:3], a[60:63], v[132:135]
  ds_read_b64_tr_b16 a[52:53], v239 offset:18432
  v_cvt_pk_bf16_f32 v74, v88, v89
  v_cvt_pk_bf16_f32 v75, v90, v91
  v_mfma_f32_16x16x32_bf16 v[136:139], a[0:3], a[64:67], v[136:139]
  v_pk_max_i16 v74, v74, 0
  v_pk_max_i16 v75, v75, 0
  s_add_u32 s60, s48, 0x1000
  buffer_store_dwordx4 v[72:75], v228, s[12:15], s60 offen offset:0 sc1
  v_mfma_f32_16x16x32_bf16 v[136:139], a[4:7], a[80:83], v[136:139]
  ds_read_b64_tr_b16 a[54:55], v239 offset:18944
  v_mul_f32 v84, v84, |v84|
  v_mul_f32 v85, v85, |v85|
  v_mfma_f32_16x16x32_bf16 v[140:143], a[4:7], a[84:87], v[140:143]
  v_mul_f32 v86, v86, |v86|
  v_mul_f32 v87, v87, |v87|
  v_cvt_pk_bf16_f32 v70, v84, v85
  v_mfma_f32_16x16x32_bf16 v[140:143], a[0:3], a[68:71], v[140:143]
  ds_read_b64_tr_b16 a[0:1], v233 offset:4096
  v_cvt_pk_bf16_f32 v71, v86, v87
  v_pk_max_i16 v70, v70, 0
  v_mfma_f32_16x16x32_bf16 v[108:111], a[8:11], a[100:103], v[108:111]
  v_pk_max_i16 v71, v71, 0
  s_add_u32 s60, s47, 0x1000
  buffer_store_dwordx4 v[68:71], v228, s[12:15], s60 offen offset:1024 sc1
  v_mul_f32 v80, v80, |v80|
  s_waitcnt vmcnt(30)
  v_mfma_f32_16x16x32_bf16 v[108:111], a[160:163], a[212:215], v[108:111]
  ds_read_b64_tr_b16 a[2:3], v233 offset:4608
  v_mul_f32 v81, v81, |v81|
  v_mul_f32 v82, v82, |v82|
  v_mfma_f32_16x16x32_bf16 v[108:111], a[12:15], a[116:119], v[108:111]
  v_mul_f32 v83, v83, |v83|
  v_cvt_pk_bf16_f32 v66, v80, v81
  v_cvt_pk_bf16_f32 v67, v82, v83
  v_mfma_f32_16x16x32_bf16 v[104:107], a[12:15], a[112:115], v[104:107]
  ds_read_b64_tr_b16 a[4:5], v233 offset:18432
  v_pk_max_i16 v66, v66, 0
  v_pk_max_i16 v67, v67, 0
  v_mfma_f32_16x16x32_bf16 v[104:107], a[160:163], a[208:211], v[104:107]
  s_add_u32 s60, s47, 0x1000
  buffer_store_dwordx4 v[64:67], v228, s[12:15], s60 offen offset:0 sc1
  s_waitcnt vmcnt(4)
  s_lshl_b32 s60, s2, 2
  s_add_u32 s60, s60, s25
  s_lshl_b32 s60, s60, 7
  s_add_u32 s60, s60, 0xa8000
  s_mov_b64 exec, 1
  buffer_store_dwordx2 a[226:227], off, s[16:19], s60 offset:0 sc1
  s_mov_b64 exec, -1
  v_mfma_f32_16x16x32_bf16 v[104:107], a[8:11], a[96:99], v[104:107]
  ds_read_b64_tr_b16 a[6:7], v233 offset:18944
  v_mfma_f32_16x16x32_bf16 v[100:103], a[8:11], a[92:95], v[100:103]
  v_mfma_f32_16x16x32_bf16 v[100:103], a[160:163], a[204:207], v[100:103]
  v_mfma_f32_16x16x32_bf16 v[100:103], a[12:15], a[108:111], v[100:103]
  v_mfma_f32_16x16x32_bf16 v[96:99], a[12:15], a[104:107], v[96:99]
  v_mfma_f32_16x16x32_bf16 v[96:99], a[160:163], a[200:203], v[96:99]
  v_mul_f32 v108, v108, |v108|
  v_mul_f32 v109, v109, |v109|
  v_mul_f32 v110, v110, |v110|
  v_mfma_f32_16x16x32_bf16 v[96:99], a[8:11], a[88:91], v[96:99]
  ds_read_b64_tr_b16 a[8:9], v242 offset:2048
  v_mul_f32 v111, v111, |v111|
  v_cvt_pk_bf16_f32 v108, v108, v109
  v_mfma_f32_16x16x32_bf16 v[144:147], a[16:19], a[56:59], v[144:147]
  ds_read_b64_tr_b16 a[10:11], v242 offset:2304
  v_cvt_pk_bf16_f32 v109, v110, v111
  v_pk_max_i16 v108, v108, 0
  v_mfma_f32_16x16x32_bf16 v[144:147], a[20:23], a[72:75], v[144:147]
  ds_read_b64_tr_b16 a[12:13], v242 offset:16384
  v_pk_max_i16 v109, v109, 0
  v_mul_f32 v104, v104, |v104|
  v_mfma_f32_16x16x32_bf16 v[148:151], a[20:23], a[76:79], v[148:151]
  ds_read_b64_tr_b16 a[14:15], v242 offset:16640
  v_mul_f32 v105, v105, |v105|
  v_mul_f32 v106, v106, |v106|
  v_mfma_f32_16x16x32_bf16 v[148:151], a[16:19], a[60:63], v[148:151]
  v_mul_f32 v107, v107, |v107|
  v_cvt_pk_bf16_f32 v104, v104, v105
  v_cvt_pk_bf16_f32 v105, v106, v107
  v_mfma_f32_16x16x32_bf16 v[152:155], a[16:19], a[64:67], v[152:155]
  v_pk_max_i16 v104, v104, 0
  v_pk_max_i16 v105, v105, 0
  v_mul_f32 v100, v100, |v100|
  v_mfma_f32_16x16x32_bf16 v[152:155], a[20:23], a[80:83], v[152:155]
  v_mul_f32 v101, v101, |v101|
  v_mul_f32 v102, v102, |v102|
  v_mul_f32 v103, v103, |v103|
  v_mfma_f32_16x16x32_bf16 v[156:159], a[20:23], a[84:87], v[156:159]
  v_cvt_pk_bf16_f32 v100, v100, v101
  v_cvt_pk_bf16_f32 v101, v102, v103
  v_pk_max_i16 v100, v100, 0
  v_mfma_f32_16x16x32_bf16 v[156:159], a[16:19], a[68:71], v[156:159]
  ds_read_b64_tr_b16 a[16:17], v234 offset:4096
  v_pk_max_i16 v101, v101, 0
  v_mul_f32 v96, v96, |v96|
  s_waitcnt lgkmcnt(8)
  v_mfma_f32_16x16x32_bf16 v[124:127], a[24:27], a[100:103], v[124:127]
  v_mul_f32 v97, v97, |v97|
  v_mul_f32 v98, v98, |v98|
  v_mul_f32 v99, v99, |v99|
  v_mfma_f32_16x16x32_bf16 v[124:127], a[164:167], a[212:215], v[124:127]
  ds_read_b64_tr_b16 a[18:19], v234 offset:4608
  v_cvt_pk_bf16_f32 v96, v96, v97
  v_cvt_pk_bf16_f32 v97, v98, v99
  v_mfma_f32_16x16x32_bf16 v[124:127], a[28:31], a[116:119], v[124:127]
  v_pk_max_i16 v96, v96, 0
  v_pk_max_i16 v97, v97, 0
  v_mfma_f32_16x16x32_bf16 v[120:123], a[28:31], a[112:115], v[120:123]
  ds_read_b64_tr_b16 a[20:21], v234 offset:18432
  v_mfma_f32_16x16x32_bf16 v[120:123], a[164:167], a[208:211], v[120:123]
  v_mfma_f32_16x16x32_bf16 v[120:123], a[24:27], a[96:99], v[120:123]
  ds_read_b64_tr_b16 a[22:23], v234 offset:18944
  v_mfma_f32_16x16x32_bf16 v[116:119], a[24:27], a[92:95], v[116:119]
  v_mfma_f32_16x16x32_bf16 v[116:119], a[164:167], a[204:207], v[116:119]
  v_mfma_f32_16x16x32_bf16 v[116:119], a[28:31], a[108:111], v[116:119]
  v_mfma_f32_16x16x32_bf16 v[112:115], a[28:31], a[104:107], v[112:115]
  v_mfma_f32_16x16x32_bf16 v[112:115], a[164:167], a[200:203], v[112:115]
  v_mul_f32 v124, v124, |v124|
  v_mul_f32 v125, v125, |v125|
  v_mul_f32 v126, v126, |v126|
  v_mfma_f32_16x16x32_bf16 v[112:115], a[24:27], a[88:91], v[112:115]
  ds_read_b64_tr_b16 a[24:25], v243 offset:2048
  v_mul_f32 v127, v127, |v127|
  v_cvt_pk_bf16_f32 v110, v124, v125
  v_mfma_f32_16x16x32_bf16 v[160:163], a[32:35], a[56:59], v[160:163]
  v_cvt_pk_bf16_f32 v111, v126, v127
  v_pk_max_i16 v110, v110, 0
  v_pk_max_i16 v111, v111, 0
  v_mfma_f32_16x16x32_bf16 v[160:163], a[36:39], a[72:75], v[160:163]
  ds_read_b64_tr_b16 a[26:27], v243 offset:2304
  s_add_u32 s60, s48, 0x1800
  buffer_store_dwordx4 v[108:111], v228, s[12:15], s60 offen offset:1024 sc1
  v_mul_f32 v120, v120, |v120|
  v_mfma_f32_16x16x32_bf16 v[164:167], a[36:39], a[76:79], v[164:167]
  v_mul_f32 v121, v121, |v121|
  v_mul_f32 v122, v122, |v122|
  v_mul_f32 v123, v123, |v123|
  v_mfma_f32_16x16x32_bf16 v[164:167], a[32:35], a[60:63], v[164:167]
  ds_read_b64_tr_b16 a[28:29], v243 offset:16384
  v_cvt_pk_bf16_f32 v106, v120, v121
  v_cvt_pk_bf16_f32 v107, v122, v123
  v_mfma_f32_16x16x32_bf16 v[168:171], a[32:35], a[64:67], v[168:171]
  v_pk_max_i16 v106, v106, 0
  v_pk_max_i16 v107, v107, 0
  s_add_u32 s60, s48, 0x1800
  buffer_store_dwordx4 v[104:107], v228, s[12:15], s60 offen offset:0 sc1
  v_mfma_f32_16x16x32_bf16 v[168:171], a[36:39], a[80:83], v[168:171]
  ds_read_b64_tr_b16 a[30:31], v243 offset:16640
  v_mul_f32 v116, v116, |v116|
  v_mul_f32 v117, v117, |v117|
  v_mfma_f32_16x16x32_bf16 v[172:175], a[36:39], a[84:87], v[172:175]
  v_mul_f32 v118, v118, |v118|
  v_mul_f32 v119, v119, |v119|
  v_cvt_pk_bf16_f32 v102, v116, v117
  v_mfma_f32_16x16x32_bf16 v[172:175], a[32:35], a[68:71], v[172:175]
  ds_read_b64_tr_b16 a[32:33], v235 offset:4096
  v_cvt_pk_bf16_f32 v103, v118, v119
  v_pk_max_i16 v102, v102, 0
  v_mfma_f32_16x16x32_bf16 v[140:143], a[40:43], a[100:103], v[140:143]
  v_pk_max_i16 v103, v103, 0
  s_add_u32 s60, s47, 0x1800
  buffer_store_dwordx4 v[100:103], v228, s[12:15], s60 offen offset:1024 sc1
  v_mul_f32 v112, v112, |v112|
  v_mfma_f32_16x16x32_bf16 v[140:143], a[168:171], a[212:215], v[140:143]
  ds_read_b64_tr_b16 a[34:35], v235 offset:4608
  v_mul_f32 v113, v113, |v113|
  v_mul_f32 v114, v114, |v114|
  v_mfma_f32_16x16x32_bf16 v[140:143], a[44:47], a[116:119], v[140:143]
  v_mul_f32 v115, v115, |v115|
  v_cvt_pk_bf16_f32 v98, v112, v113
  v_cvt_pk_bf16_f32 v99, v114, v115
  v_mfma_f32_16x16x32_bf16 v[136:139], a[44:47], a[112:115], v[136:139]
  ds_read_b64_tr_b16 a[36:37], v235 offset:18432
  v_pk_max_i16 v98, v98, 0
  v_pk_max_i16 v99, v99, 0
  v_mfma_f32_16x16x32_bf16 v[136:139], a[168:171], a[208:211], v[136:139]
  s_add_u32 s60, s47, 0x1800
  buffer_store_dwordx4 v[96:99], v228, s[12:15], s60 offen offset:0 sc1
  v_mfma_f32_16x16x32_bf16 v[136:139], a[40:43], a[96:99], v[136:139]
  ds_read_b64_tr_b16 a[38:39], v235 offset:18944
  v_mfma_f32_16x16x32_bf16 v[132:135], a[40:43], a[92:95], v[132:135]
  v_mfma_f32_16x16x32_bf16 v[132:135], a[168:171], a[204:207], v[132:135]
  v_mfma_f32_16x16x32_bf16 v[132:135], a[44:47], a[108:111], v[132:135]
  v_mfma_f32_16x16x32_bf16 v[128:131], a[44:47], a[104:107], v[128:131]
  v_mfma_f32_16x16x32_bf16 v[128:131], a[168:171], a[200:203], v[128:131]
  v_mul_f32 v140, v140, |v140|
  v_mul_f32 v141, v141, |v141|
  v_mul_f32 v142, v142, |v142|
  v_mfma_f32_16x16x32_bf16 v[128:131], a[40:43], a[88:91], v[128:131]
  ds_read_b64_tr_b16 a[40:41], v240 offset:2048
  v_mul_f32 v143, v143, |v143|
  v_cvt_pk_bf16_f32 v140, v140, v141
  v_mfma_f32_16x16x32_bf16 v[176:179], a[48:51], a[56:59], v[176:179]
  v_cvt_pk_bf16_f32 v141, v142, v143
  v_pk_max_i16 v140, v140, 0
  v_pk_max_i16 v141, v141, 0
  v_mfma_f32_16x16x32_bf16 v[176:179], a[52:55], a[72:75], v[176:179]
  ds_read_b64_tr_b16 a[42:43], v240 offset:2304
  v_mul_f32 v136, v136, |v136|
  v_mul_f32 v137, v137, |v137|
  v_mfma_f32_16x16x32_bf16 v[180:183], a[52:55], a[76:79], v[180:183]
  v_mul_f32 v138, v138, |v138|
  v_mul_f32 v139, v139, |v139|
  v_cvt_pk_bf16_f32 v136, v136, v137
  v_mfma_f32_16x16x32_bf16 v[180:183], a[48:51], a[60:63], v[180:183]
  ds_read_b64_tr_b16 a[44:45], v240 offset:16384
  v_cvt_pk_bf16_f32 v137, v138, v139
  v_pk_max_i16 v136, v136, 0
  v_mfma_f32_16x16x32_bf16 v[184:187], a[48:51], a[64:67], v[184:187]
  v_pk_max_i16 v137, v137, 0
  v_mul_f32 v132, v132, |v132|
  v_mul_f32 v133, v133, |v133|
  v_mfma_f32_16x16x32_bf16 v[184:187], a[52:55], a[80:83], v[184:187]
  ds_read_b64_tr_b16 a[46:47], v240 offset:16640
  v_mul_f32 v134, v134, |v134|
  v_mul_f32 v135, v135, |v135|
  v_mfma_f32_16x16x32_bf16 v[188:191], a[52:55], a[84:87], v[188:191]
  v_cvt_pk_bf16_f32 v132, v132, v133
  v_cvt_pk_bf16_f32 v133, v134, v135
  v_pk_max_i16 v132, v132, 0
  v_mfma_f32_16x16x32_bf16 v[188:191], a[48:51], a[68:71], v[188:191]
  ds_read_b64_tr_b16 a[48:49], v241 offset:2048
  v_pk_max_i16 v133, v133, 0
  v_mul_f32 v128, v128, |v128|
  s_waitcnt lgkmcnt(8)
  v_mfma_f32_16x16x32_bf16 v[156:159], a[0:3], a[100:103], v[156:159]
  v_mul_f32 v129, v129, |v129|
  v_mul_f32 v130, v130, |v130|
  v_mul_f32 v131, v131, |v131|
  v_mfma_f32_16x16x32_bf16 v[156:159], a[172:175], a[212:215], v[156:159]
  ds_read_b64_tr_b16 a[50:51], v241 offset:2304
  v_cvt_pk_bf16_f32 v128, v128, v129
  v_cvt_pk_bf16_f32 v129, v130, v131
  v_mfma_f32_16x16x32_bf16 v[156:159], a[4:7], a[116:119], v[156:159]
  v_pk_max_i16 v128, v128, 0
  v_pk_max_i16 v129, v129, 0
  v_mfma_f32_16x16x32_bf16 v[152:155], a[4:7], a[112:115], v[152:155]
  ds_read_b64_tr_b16 a[52:53], v241 offset:16384
  v_mfma_f32_16x16x32_bf16 v[152:155], a[172:175], a[208:211], v[152:155]
  v_mfma_f32_16x16x32_bf16 v[152:155], a[0:3], a[96:99], v[152:155]
  ds_read_b64_tr_b16 a[54:55], v241 offset:16640
  v_mfma_f32_16x16x32_bf16 v[148:151], a[0:3], a[92:95], v[148:151]
  v_mfma_f32_16x16x32_bf16 v[148:151], a[172:175], a[204:207], v[148:151]
  v_mfma_f32_16x16x32_bf16 v[148:151], a[4:7], a[108:111], v[148:151]
  v_mfma_f32_16x16x32_bf16 v[144:147], a[4:7], a[104:107], v[144:147]
  v_mfma_f32_16x16x32_bf16 v[144:147], a[172:175], a[200:203], v[144:147]
  v_mul_f32 v156, v156, |v156|
  v_mul_f32 v157, v157, |v157|
  v_mul_f32 v158, v158, |v158|
  v_mfma_f32_16x16x32_bf16 v[144:147], a[0:3], a[88:91], v[144:147]
  v_mul_f32 v159, v159, |v159|
  v_cvt_pk_bf16_f32 v142, v156, v157
  v_cvt_pk_bf16_f32 v143, v158, v159
  v_mfma_f32_16x16x32_bf16 v[192:195], a[8:11], a[56:59], v[192:195]
  v_pk_max_i16 v142, v142, 0
  v_pk_max_i16 v143, v143, 0
  s_add_u32 s60, s48, 0x2000
  buffer_store_dwordx4 v[140:143], v228, s[12:15], s60 offen offset:1024 sc1
  v_mfma_f32_16x16x32_bf16 v[192:195], a[12:15], a[72:75], v[192:195]
  v_mul_f32 v152, v152, |v152|
  v_mul_f32 v153, v153, |v153|
  v_mul_f32 v154, v154, |v154|
  v_mfma_f32_16x16x32_bf16 v[196:199], a[12:15], a[76:79], v[196:199]
  v_mul_f32 v155, v155, |v155|
  v_cvt_pk_bf16_f32 v138, v152, v153
  v_cvt_pk_bf16_f32 v139, v154, v155
  v_mfma_f32_16x16x32_bf16 v[196:199], a[8:11], a[60:63], v[196:199]
  v_pk_max_i16 v138, v138, 0
  v_pk_max_i16 v139, v139, 0
  s_add_u32 s60, s48, 0x2000
  buffer_store_dwordx4 v[136:139], v228, s[12:15], s60 offen offset:0 sc1
  v_mfma_f32_16x16x32_bf16 v[200:203], a[8:11], a[64:67], v[200:203]
  v_mul_f32 v148, v148, |v148|
  v_mul_f32 v149, v149, |v149|
  v_mul_f32 v150, v150, |v150|
  v_mfma_f32_16x16x32_bf16 v[200:203], a[12:15], a[80:83], v[200:203]
  v_mul_f32 v151, v151, |v151|
  v_cvt_pk_bf16_f32 v134, v148, v149
  v_cvt_pk_bf16_f32 v135, v150, v151
  v_mfma_f32_16x16x32_bf16 v[204:207], a[12:15], a[84:87], v[204:207]
  v_pk_max_i16 v134, v134, 0
  v_pk_max_i16 v135, v135, 0
  s_add_u32 s60, s47, 0x2000
  buffer_store_dwordx4 v[132:135], v228, s[12:15], s60 offen offset:1024 sc1
  v_mfma_f32_16x16x32_bf16 v[204:207], a[8:11], a[68:71], v[204:207]
  v_mul_f32 v144, v144, |v144|
  v_mul_f32 v145, v145, |v145|
  v_mul_f32 v146, v146, |v146|
  v_mfma_f32_16x16x32_bf16 v[172:175], a[16:19], a[100:103], v[172:175]
  v_mul_f32 v147, v147, |v147|
  v_cvt_pk_bf16_f32 v130, v144, v145
  v_cvt_pk_bf16_f32 v131, v146, v147
  v_mfma_f32_16x16x32_bf16 v[172:175], a[176:179], a[212:215], v[172:175]
  v_pk_max_i16 v130, v130, 0
  v_pk_max_i16 v131, v131, 0
  s_add_u32 s60, s47, 0x2000
  buffer_store_dwordx4 v[128:131], v228, s[12:15], s60 offen offset:0 sc1
  v_mfma_f32_16x16x32_bf16 v[172:175], a[20:23], a[116:119], v[172:175]
  s_waitcnt vmcnt(4)
  s_lshl_b32 s60, s2, 2
  s_add_u32 s60, s60, s25
  s_lshl_b32 s60, s60, 7
  s_add_u32 s60, s60, 0xa8000
  s_mov_b64 exec, 1
  buffer_store_dwordx2 a[226:227], off, s[16:19], s60 offset:8 sc1
  s_mov_b64 exec, -1
  v_mfma_f32_16x16x32_bf16 v[168:171], a[20:23], a[112:115], v[168:171]
  v_mfma_f32_16x16x32_bf16 v[168:171], a[176:179], a[208:211], v[168:171]
  v_mfma_f32_16x16x32_bf16 v[168:171], a[16:19], a[96:99], v[168:171]
  v_mfma_f32_16x16x32_bf16 v[164:167], a[16:19], a[92:95], v[164:167]
  v_mfma_f32_16x16x32_bf16 v[164:167], a[176:179], a[204:207], v[164:167]
  v_mfma_f32_16x16x32_bf16 v[164:167], a[20:23], a[108:111], v[164:167]
  v_mfma_f32_16x16x32_bf16 v[160:163], a[20:23], a[104:107], v[160:163]
  v_mfma_f32_16x16x32_bf16 v[160:163], a[176:179], a[200:203], v[160:163]
  v_mul_f32 v172, v172, |v172|
  v_mul_f32 v173, v173, |v173|
  v_mul_f32 v174, v174, |v174|
  v_mfma_f32_16x16x32_bf16 v[160:163], a[16:19], a[88:91], v[160:163]
  v_mul_f32 v175, v175, |v175|
  v_cvt_pk_bf16_f32 v172, v172, v173
  v_cvt_pk_bf16_f32 v173, v174, v175
  v_mfma_f32_16x16x32_bf16 v[208:211], a[24:27], a[56:59], v[208:211]
  v_pk_max_i16 v172, v172, 0
  v_pk_max_i16 v173, v173, 0
  v_mfma_f32_16x16x32_bf16 v[208:211], a[28:31], a[72:75], v[208:211]
  v_mul_f32 v168, v168, |v168|
  v_mul_f32 v169, v169, |v169|
  v_mul_f32 v170, v170, |v170|
  v_mfma_f32_16x16x32_bf16 v[212:215], a[28:31], a[76:79], v[212:215]
  v_mul_f32 v171, v171, |v171|
  v_cvt_pk_bf16_f32 v168, v168, v169
  v_cvt_pk_bf16_f32 v169, v170, v171
  v_mfma_f32_16x16x32_bf16 v[212:215], a[24:27], a[60:63], v[212:215]
  v_pk_max_i16 v168, v168, 0
  v_pk_max_i16 v169, v169, 0
  v_mfma_f32_16x16x32_bf16 v[216:219], a[24:27], a[64:67], v[216:219]
  v_mul_f32 v164, v164, |v164|
  v_mul_f32 v165, v165, |v165|
  v_mul_f32 v166, v166, |v166|
  v_mfma_f32_16x16x32_bf16 v[216:219], a[28:31], a[80:83], v[216:219]
  v_mul_f32 v167, v167, |v167|
  v_cvt_pk_bf16_f32 v164, v164, v165
  v_cvt_pk_bf16_f32 v165, v166, v167
  v_mfma_f32_16x16x32_bf16 v[220:223], a[28:31], a[84:87], v[220:223]
  v_pk_max_i16 v164, v164, 0
  v_pk_max_i16 v165, v165, 0
  v_mfma_f32_16x16x32_bf16 v[220:223], a[24:27], a[68:71], v[220:223]
  v_mul_f32 v160, v160, |v160|
  v_mul_f32 v161, v161, |v161|
  v_mul_f32 v162, v162, |v162|
  s_waitcnt lgkmcnt(8)
  v_mfma_f32_16x16x32_bf16 v[188:191], a[32:35], a[100:103], v[188:191]
  v_mul_f32 v163, v163, |v163|
  v_cvt_pk_bf16_f32 v160, v160, v161
  v_cvt_pk_bf16_f32 v161, v162, v163
  v_mfma_f32_16x16x32_bf16 v[188:191], a[180:183], a[212:215], v[188:191]
  v_pk_max_i16 v160, v160, 0
  v_pk_max_i16 v161, v161, 0
  v_mfma_f32_16x16x32_bf16 v[188:191], a[36:39], a[116:119], v[188:191]
  v_mfma_f32_16x16x32_bf16 v[184:187], a[36:39], a[112:115], v[184:187]
  v_mfma_f32_16x16x32_bf16 v[184:187], a[180:183], a[208:211], v[184:187]
  v_mfma_f32_16x16x32_bf16 v[184:187], a[32:35], a[96:99], v[184:187]
  v_mfma_f32_16x16x32_bf16 v[180:183], a[32:35], a[92:95], v[180:183]
  v_mfma_f32_16x16x32_bf16 v[180:183], a[180:183], a[204:207], v[180:183]
  v_mfma_f32_16x16x32_bf16 v[180:183], a[36:39], a[108:111], v[180:183]
  v_mfma_f32_16x16x32_bf16 v[176:179], a[36:39], a[104:107], v[176:179]
  v_mfma_f32_16x16x32_bf16 v[176:179], a[180:183], a[200:203], v[176:179]
  v_mul_f32 v188, v188, |v188|
  v_mul_f32 v189, v189, |v189|
  v_mul_f32 v190, v190, |v190|
  v_mfma_f32_16x16x32_bf16 v[176:179], a[32:35], a[88:91], v[176:179]
  v_mul_f32 v191, v191, |v191|
  v_cvt_pk_bf16_f32 v174, v188, v189
  v_cvt_pk_bf16_f32 v175, v190, v191
  s_waitcnt lgkmcnt(4)
  v_mfma_f32_16x16x32_bf16 v[192:195], a[40:43], a[88:91], v[192:195]
  v_pk_max_i16 v174, v174, 0
  v_pk_max_i16 v175, v175, 0
  s_add_u32 s60, s48, 0x2800
  buffer_store_dwordx4 v[172:175], v228, s[12:15], s60 offen offset:1024 sc1
  v_mfma_f32_16x16x32_bf16 v[192:195], a[184:187], a[200:203], v[192:195]
  v_mul_f32 v184, v184, |v184|
  v_mul_f32 v185, v185, |v185|
  v_mul_f32 v186, v186, |v186|
  v_mfma_f32_16x16x32_bf16 v[192:195], a[44:47], a[104:107], v[192:195]
  v_mul_f32 v187, v187, |v187|
  v_cvt_pk_bf16_f32 v170, v184, v185
  v_cvt_pk_bf16_f32 v171, v186, v187
  v_mfma_f32_16x16x32_bf16 v[196:199], a[44:47], a[108:111], v[196:199]
  v_pk_max_i16 v170, v170, 0
  v_pk_max_i16 v171, v171, 0
  s_add_u32 s60, s48, 0x2800
  buffer_store_dwordx4 v[168:171], v228, s[12:15], s60 offen offset:0 sc1
  v_mfma_f32_16x16x32_bf16 v[196:199], a[184:187], a[204:207], v[196:199]
  v_mul_f32 v180, v180, |v180|
  v_mul_f32 v181, v181, |v181|
  v_mul_f32 v182, v182, |v182|
  v_mfma_f32_16x16x32_bf16 v[196:199], a[40:43], a[92:95], v[196:199]
  v_mul_f32 v183, v183, |v183|
  v_cvt_pk_bf16_f32 v166, v180, v181
  v_cvt_pk_bf16_f32 v167, v182, v183
  v_mfma_f32_16x16x32_bf16 v[200:203], a[40:43], a[96:99], v[200:203]
  v_pk_max_i16 v166, v166, 0
  v_pk_max_i16 v167, v167, 0
  s_add_u32 s60, s47, 0x2800
  buffer_store_dwordx4 v[164:167], v228, s[12:15], s60 offen offset:1024 sc1
  v_mfma_f32_16x16x32_bf16 v[200:203], a[184:187], a[208:211], v[200:203]
  v_mul_f32 v176, v176, |v176|
  v_mul_f32 v177, v177, |v177|
  v_mul_f32 v178, v178, |v178|
  v_mfma_f32_16x16x32_bf16 v[200:203], a[44:47], a[112:115], v[200:203]
  v_mul_f32 v179, v179, |v179|
  v_cvt_pk_bf16_f32 v162, v176, v177
  v_cvt_pk_bf16_f32 v163, v178, v179
  v_mfma_f32_16x16x32_bf16 v[204:207], a[44:47], a[116:119], v[204:207]
  v_pk_max_i16 v162, v162, 0
  v_pk_max_i16 v163, v163, 0
  s_add_u32 s60, s47, 0x2800
  buffer_store_dwordx4 v[160:163], v228, s[12:15], s60 offen offset:0 sc1
  v_mfma_f32_16x16x32_bf16 v[204:207], a[184:187], a[212:215], v[204:207]
  v_mul_f32 v192, v192, |v192|
  v_mul_f32 v193, v193, |v193|
  v_mul_f32 v194, v194, |v194|
  v_mfma_f32_16x16x32_bf16 v[204:207], a[40:43], a[100:103], v[204:207]
  v_mul_f32 v195, v195, |v195|
  v_cvt_pk_bf16_f32 v192, v192, v193
  v_cvt_pk_bf16_f32 v193, v194, v195
  s_waitcnt lgkmcnt(0)
  v_mfma_f32_16x16x32_bf16 v[220:223], a[48:51], a[100:103], v[220:223]
  v_pk_max_i16 v192, v192, 0
  v_pk_max_i16 v193, v193, 0
  v_mfma_f32_16x16x32_bf16 v[220:223], a[188:191], a[212:215], v[220:223]
  v_mul_f32 v196, v196, |v196|
  v_mul_f32 v197, v197, |v197|
  v_mul_f32 v198, v198, |v198|
  v_mfma_f32_16x16x32_bf16 v[220:223], a[52:55], a[116:119], v[220:223]
  v_mul_f32 v199, v199, |v199|
  v_cvt_pk_bf16_f32 v196, v196, v197
  v_cvt_pk_bf16_f32 v197, v198, v199
  v_mfma_f32_16x16x32_bf16 v[216:219], a[52:55], a[112:115], v[216:219]
  v_pk_max_i16 v196, v196, 0
  v_pk_max_i16 v197, v197, 0
  v_mfma_f32_16x16x32_bf16 v[216:219], a[188:191], a[208:211], v[216:219]
  v_mul_f32 v200, v200, |v200|
  v_mul_f32 v201, v201, |v201|
  v_mul_f32 v202, v202, |v202|
  v_mfma_f32_16x16x32_bf16 v[216:219], a[48:51], a[96:99], v[216:219]
  v_mul_f32 v203, v203, |v203|
  v_cvt_pk_bf16_f32 v200, v200, v201
  v_cvt_pk_bf16_f32 v201, v202, v203
  v_mfma_f32_16x16x32_bf16 v[212:215], a[48:51], a[92:95], v[212:215]
  v_pk_max_i16 v200, v200, 0
  v_pk_max_i16 v201, v201, 0
  v_mfma_f32_16x16x32_bf16 v[212:215], a[188:191], a[204:207], v[212:215]
  v_mul_f32 v204, v204, |v204|
  v_mul_f32 v205, v205, |v205|
  v_mul_f32 v206, v206, |v206|
  v_mfma_f32_16x16x32_bf16 v[212:215], a[52:55], a[108:111], v[212:215]
  v_mul_f32 v207, v207, |v207|
  v_cvt_pk_bf16_f32 v204, v204, v205
  v_cvt_pk_bf16_f32 v205, v206, v207
  v_mfma_f32_16x16x32_bf16 v[208:211], a[52:55], a[104:107], v[208:211]
  v_pk_max_i16 v204, v204, 0
  v_pk_max_i16 v205, v205, 0
  v_mfma_f32_16x16x32_bf16 v[208:211], a[188:191], a[200:203], v[208:211]
  v_mul_f32 v220, v220, |v220|
  v_mul_f32 v221, v221, |v221|
  v_mul_f32 v222, v222, |v222|
  v_mfma_f32_16x16x32_bf16 v[208:211], a[48:51], a[88:91], v[208:211]
  s_nop 7
  v_mul_f32 v223, v223, |v223|
  v_cvt_pk_bf16_f32 v206, v220, v221
  v_cvt_pk_bf16_f32 v207, v222, v223
  v_pk_max_i16 v206, v206, 0
  v_pk_max_i16 v207, v207, 0
  s_add_u32 s60, s48, s49
  buffer_store_dwordx4 v[204:207], v228, s[12:15], s60 offen offset:1024 sc1
  v_mul_f32 v216, v216, |v216|
  v_mul_f32 v217, v217, |v217|
  v_mul_f32 v218, v218, |v218|
  v_mul_f32 v219, v219, |v219|
  v_cvt_pk_bf16_f32 v202, v216, v217
  v_cvt_pk_bf16_f32 v203, v218, v219
  v_pk_max_i16 v202, v202, 0
  v_pk_max_i16 v203, v203, 0
  s_add_u32 s60, s48, s49
  buffer_store_dwordx4 v[200:203], v228, s[12:15], s60 offen offset:0 sc1
  v_mul_f32 v212, v212, |v212|
  v_mul_f32 v213, v213, |v213|
  v_mul_f32 v214, v214, |v214|
  v_mul_f32 v215, v215, |v215|
  v_cvt_pk_bf16_f32 v198, v212, v213
  v_cvt_pk_bf16_f32 v199, v214, v215
  v_pk_max_i16 v198, v198, 0
  v_pk_max_i16 v199, v199, 0
  s_add_u32 s60, s47, s49
  buffer_store_dwordx4 v[196:199], v228, s[12:15], s60 offen offset:1024 sc1
  v_mul_f32 v208, v208, |v208|
  v_mul_f32 v209, v209, |v209|
  v_mul_f32 v210, v210, |v210|
  v_mul_f32 v211, v211, |v211|
  v_cvt_pk_bf16_f32 v194, v208, v209
  v_cvt_pk_bf16_f32 v195, v210, v211
  v_pk_max_i16 v194, v194, 0
  v_pk_max_i16 v195, v195, 0
  s_add_u32 s60, s47, s49
  buffer_store_dwordx4 v[192:195], v228, s[12:15], s60 offen offset:0 sc1
  s_branch L_k2_start
L_k1_spin_w1:
  s_mov_b32 s61, 0
L_k1_spin1_w1:
  s_sleep 8
  buffer_load_dwordx2 v[252:253], v254, s[16:19], 0 offen sc1
  s_waitcnt vmcnt(0)
  s_add_u32 s61, s61, 1
  s_cmp_gt_u32 s61, 0x10000
  s_cbranch_scc1 L_k1_back_w1
  v_cmp_ne_u64 vcc, s[56:57], v[252:253]
  s_cbranch_vccnz L_k1_spin1_w1
  s_branch L_k1_back_w1
L_k1_tspin_w1:
  s_mov_b32 s61, 0
L_k1_tspin1_w1:
  s_sleep 8
  buffer_load_dwordx2 a[226:227], off, s[32:35], 0 sc1
  s_waitcnt vmcnt(0)
  s_add_u32 s61, s61, 1
  s_cmp_gt_u32 s61, 0x10000
  s_cbranch_scc1 L_k1_tback_w1
  v_accvgpr_read_b32 v252, a226
  v_accvgpr_read_b32 v253, a227
  s_nop 0
  v_readfirstlane_b32 s56, v252
  v_readfirstlane_b32 s57, v253
  s_nop 3
  s_cmp_lg_u32 s56, 0
  s_cbranch_scc0 L_k1_tspin1_w1
  s_branch L_k1_tback_w1
L_k1_end:
  s_endpgm
L_k2_start:
  s_load_dwordx2 s[48:49], s[0:1], 16
  s_load_dwordx4 s[52:55], s[0:1], 56
  v_bfe_u32 v248, v228, 6, 4
  v_lshlrev_b32 v248, 7, v248
  v_bfe_u32 v249, v228, 4, 2
  v_lshl_add_u32 v248, v249, 3, v248
  v_bfe_u32 v249, v228, 7, 2
  v_xor_b32 v250, 0, v249
  v_lshl_add_u32 v232, v250, 5, v248
  v_add_u32 v236, 0x10000, v232
  v_xor_b32 v250, 1, v249
  v_lshl_add_u32 v233, v250, 5, v248
  v_add_u32 v237, 0x10000, v233
  v_xor_b32 v250, 2, v249
  v_lshl_add_u32 v234, v250, 5, v248
  v_add_u32 v238, 0x10000, v234
  v_xor_b32 v250, 3, v249
  v_lshl_add_u32 v235, v250, 5, v248
  v_add_u32 v239, 0x10000, v235
  s_barrier
  ds_read_b64_tr_b16 a[0:1], v236 offset:24576
  ds_read_b64_tr_b16 a[2:3], v236 offset:26624
  ds_read_b64_tr_b16 a[4:5], v236 offset:28672
  ds_read_b64_tr_b16 a[6:7], v236 offset:30720
  ds_read_b64_tr_b16 a[8:9], v237 offset:24576
  ds_read_b64_tr_b16 a[10:11], v237 offset:26624
  ds_read_b64_tr_b16 a[12:13], v237 offset:28672
  ds_read_b64_tr_b16 a[14:15], v237 offset:30720
  ds_read_b64_tr_b16 a[16:17], v238 offset:24576
  ds_read_b64_tr_b16 a[18:19], v238 offset:26624
  ds_read_b64_tr_b16 a[20:21], v238 offset:28672
  ds_read_b64_tr_b16 a[22:23], v238 offset:30720
  v_add_u32 v240, 0x20000, v232
  v_add_u32 v241, 0x20000, v233
  v_add_u32 v242, 0x20000, v234
  v_add_u32 v243, 0x20000, v235
  s_mul_i32 s24, s25, 12288
  s_lshr_b32 s100, s2, 3
  s_lshl_b32 s100, s100, 2
  s_add_u32 s100, s100, s25
  s_cmp_lt_u32 s2, 128
  s_cbranch_scc1 L_p2_go
  s_cmp_lg_u32 s67, 0
  s_cbranch_scc1 L_p2_go
  s_branch L_sp_qa
L_bk_qa:
  s_bfe_u32 s60, s40, 0x40000
  s_lshl_b32 s60, s60, 12
  s_add_u32 s60, s60, s42
  buffer_load_dwordx4 v[0:3], v226, s[12:15], s60 offen offset:0 sc1
  buffer_load_dwordx4 v[4:7], v226, s[12:15], s60 offen offset:1024 sc1
  buffer_load_dwordx4 v[8:11], v227, s[12:15], s60 offen offset:0 sc1
  buffer_load_dwordx4 v[12:15], v227, s[12:15], s60 offen offset:1024 sc1
  s_bfe_u32 s60, s40, 0x40000
  s_lshl_b32 s60, s60, 12
  s_add_u32 s60, s60, s42
  buffer_load_dwordx4 v[32:35], v226, s[12:15], s60 offen offset:2048 sc1
  buffer_load_dwordx4 v[36:39], v226, s[12:15], s60 offen offset:3072 sc1
  buffer_load_dwordx4 v[40:43], v227, s[12:15], s60 offen offset:2048 sc1
  buffer_load_dwordx4 v[44:47], v227, s[12:15], s60 offen offset:3072 sc1
  s_bfe_u32 s60, s40, 0x40004
  s_lshl_b32 s60, s60, 12
  s_add_u32 s60, s60, s42
  buffer_load_dwordx4 v[64:67], v226, s[12:15], s60 offen offset:0 sc1
  buffer_load_dwordx4 v[68:71], v226, s[12:15], s60 offen offset:1024 sc1
  buffer_load_dwordx4 v[72:75], v227, s[12:15], s60 offen offset:0 sc1
  buffer_load_dwordx4 v[76:79], v227, s[12:15], s60 offen offset:1024 sc1
  s_bfe_u32 s60, s40, 0x40004
  s_lshl_b32 s60, s60, 12
  s_add_u32 s60, s60, s42
  buffer_load_dwordx4 v[96:99], v226, s[12:15], s60 offen offset:2048 sc1
  buffer_load_dwordx4 v[100:103], v226, s[12:15], s60 offen offset:3072 sc1
  buffer_load_dwordx4 v[104:107], v227, s[12:15], s60 offen offset:2048 sc1
  buffer_load_dwordx4 v[108:111], v227, s[12:15], s60 offen offset:3072 sc1
L_p2_go:
  s_waitcnt lgkmcnt(8) vmcnt(8)
  v_mfma_f32_16x16x32_bf16 v[16:19], a[0:3], v[0:3], 0
  ds_read_b64_tr_b16 a[24:25], v239 offset:24576
  v_mfma_f32_16x16x32_bf16 v[16:19], a[4:7], v[32:35], v[16:19]
  ds_read_b64_tr_b16 a[26:27], v239 offset:26624
  s_add_u32 m0, s23, 0x22000
  v_mfma_f32_16x16x32_bf16 v[20:23], a[4:7], v[36:39], 0
  ds_read_b64_tr_b16 a[28:29], v239 offset:28672
  buffer_load_dwordx4 v224, s[36:39], s21 offen lds
  v_mfma_f32_16x16x32_bf16 v[20:23], a[0:3], v[4:7], v[20:23]
  ds_read_b64_tr_b16 a[30:31], v239 offset:30720
  v_mfma_f32_16x16x32_bf16 v[144:147], a[0:3], v[8:11], 0
  ds_read_b64_tr_b16 a[32:33], v236 offset:32768
  v_mfma_f32_16x16x32_bf16 v[144:147], a[4:7], v[40:43], v[144:147]
  s_barrier
  ds_read_b64_tr_b16 a[34:35], v236 offset:34816
  v_mfma_f32_16x16x32_bf16 v[148:151], a[4:7], v[44:47], 0
  ds_read_b64_tr_b16 a[36:37], v236 offset:36864
  s_mov_b32 exec_lo, 0xe
  s_mov_b32 exec_hi, 0x0
  buffer_load_dwordx2 v[244:245], v231, s[16:19], 0 offen offset:0 sc1
  s_mov_b64 exec, -1
  v_mfma_f32_16x16x32_bf16 v[148:151], a[0:3], v[12:15], v[148:151]
  ds_read_b64_tr_b16 a[38:39], v236 offset:38912
  s_waitcnt lgkmcnt(8)
  v_mfma_f32_16x16x32_bf16 v[156:159], a[8:11], v[12:15], 0
  ds_read_b64_tr_b16 a[40:41], v237 offset:32768
  v_mfma_f32_16x16x32_bf16 v[156:159], a[12:15], v[44:47], v[156:159]
  ds_read_b64_tr_b16 a[42:43], v237 offset:34816
  s_add_u32 m0, s23, 0x22400
  v_mfma_f32_16x16x32_bf16 v[152:155], a[12:15], v[40:43], 0
  ds_read_b64_tr_b16 a[44:45], v237 offset:36864
  buffer_load_dwordx4 v225, s[36:39], s21 offen lds
  v_mfma_f32_16x16x32_bf16 v[152:155], a[8:11], v[8:11], v[152:155]
  ds_read_b64_tr_b16 a[46:47], v237 offset:38912
  v_mfma_f32_16x16x32_bf16 v[28:31], a[8:11], v[4:7], 0
  ds_read_b64_tr_b16 a[48:49], v238 offset:32768
  v_mfma_f32_16x16x32_bf16 v[28:31], a[12:15], v[36:39], v[28:31]
  ds_read_b64_tr_b16 a[50:51], v238 offset:34816
  s_add_u32 m0, s23, 0x24000
  v_mfma_f32_16x16x32_bf16 v[24:27], a[12:15], v[32:35], 0
  ds_read_b64_tr_b16 a[52:53], v238 offset:36864
  buffer_load_dwordx4 v229, s[36:39], s21 offen lds
  v_mfma_f32_16x16x32_bf16 v[24:27], a[8:11], v[0:3], v[24:27]
  ds_read_b64_tr_b16 a[54:55], v238 offset:38912
  v_mfma_f32_16x16x32_bf16 v[48:51], a[16:19], v[0:3], 0
  ds_read_b64_tr_b16 a[56:57], v239 offset:32768
  v_mfma_f32_16x16x32_bf16 v[48:51], a[20:23], v[32:35], v[48:51]
  ds_read_b64_tr_b16 a[58:59], v239 offset:34816
  s_add_u32 m0, s23, 0x24400
  v_mfma_f32_16x16x32_bf16 v[52:55], a[20:23], v[36:39], 0
  ds_read_b64_tr_b16 a[60:61], v239 offset:36864
  buffer_load_dwordx4 v230, s[36:39], s21 offen lds
  s_bfe_u32 s21, s40, 0x40010
  s_lshl_b32 s21, s21, 17
  s_add_u32 s21, s21, s20
  v_mfma_f32_16x16x32_bf16 v[52:55], a[16:19], v[4:7], v[52:55]
  ds_read_b64_tr_b16 a[62:63], v239 offset:38912
  v_mfma_f32_16x16x32_bf16 v[176:179], a[16:19], v[8:11], 0
  ds_read_b64_tr_b16 a[4:5], v236 offset:45056
  v_mfma_f32_16x16x32_bf16 v[176:179], a[20:23], v[40:43], v[176:179]
  ds_read_b64_tr_b16 a[6:7], v236 offset:47104
  s_add_u32 m0, s23, 0x26000
  v_mfma_f32_16x16x32_bf16 v[180:183], a[20:23], v[44:47], 0
  ds_read_b64_tr_b16 a[0:1], v236 offset:40960
  buffer_load_dwordx4 v224, s[36:39], s21 offen lds
  v_mfma_f32_16x16x32_bf16 v[180:183], a[16:19], v[12:15], v[180:183]
  ds_read_b64_tr_b16 a[2:3], v236 offset:43008
  s_waitcnt lgkmcnt(8)
  v_mfma_f32_16x16x32_bf16 v[188:191], a[24:27], v[12:15], 0
  ds_read_b64_tr_b16 a[12:13], v237 offset:45056
  v_mfma_f32_16x16x32_bf16 v[188:191], a[28:31], v[44:47], v[188:191]
  ds_read_b64_tr_b16 a[14:15], v237 offset:47104
  s_add_u32 m0, s23, 0x26400
  v_mfma_f32_16x16x32_bf16 v[184:187], a[28:31], v[40:43], 0
  ds_read_b64_tr_b16 a[8:9], v237 offset:40960
  buffer_load_dwordx4 v225, s[36:39], s21 offen lds
  v_mfma_f32_16x16x32_bf16 v[184:187], a[24:27], v[8:11], v[184:187]
  ds_read_b64_tr_b16 a[10:11], v237 offset:43008
  v_mfma_f32_16x16x32_bf16 v[60:63], a[24:27], v[4:7], 0
  ds_read_b64_tr_b16 a[20:21], v238 offset:45056
  v_mfma_f32_16x16x32_bf16 v[60:63], a[28:31], v[36:39], v[60:63]
  ds_read_b64_tr_b16 a[22:23], v238 offset:47104
  s_add_u32 m0, s23, 0x8000
  v_mfma_f32_16x16x32_bf16 v[56:59], a[28:31], v[32:35], 0
  ds_read_b64_tr_b16 a[16:17], v238 offset:40960
  buffer_load_dwordx4 v229, s[36:39], s21 offen lds
  v_mfma_f32_16x16x32_bf16 v[56:59], a[24:27], v[0:3], v[56:59]
  ds_read_b64_tr_b16 a[18:19], v238 offset:43008
  v_mfma_f32_16x16x32_bf16 v[80:83], a[32:35], v[0:3], 0
  ds_read_b64_tr_b16 a[28:29], v239 offset:45056
  v_mfma_f32_16x16x32_bf16 v[80:83], a[36:39], v[32:35], v[80:83]
  ds_read_b64_tr_b16 a[30:31], v239 offset:47104
  s_add_u32 m0, s23, 0x8400
  v_mfma_f32_16x16x32_bf16 v[84:87], a[36:39], v[36:39], 0
  ds_read_b64_tr_b16 a[24:25], v239 offset:40960
  buffer_load_dwordx4 v230, s[36:39], s21 offen lds
  s_bfe_u32 s21, s40, 0x40014
  s_lshl_b32 s21, s21, 17
  s_add_u32 s21, s21, s20
  v_mfma_f32_16x16x32_bf16 v[84:87], a[32:35], v[4:7], v[84:87]
  ds_read_b64_tr_b16 a[26:27], v239 offset:43008
  v_mfma_f32_16x16x32_bf16 v[192:195], a[32:35], v[8:11], 0
  v_mfma_f32_16x16x32_bf16 v[192:195], a[36:39], v[40:43], v[192:195]
  s_add_u32 m0, s23, 0xa000
  v_mfma_f32_16x16x32_bf16 v[196:199], a[36:39], v[44:47], 0
  buffer_load_dwordx4 v224, s[36:39], s21 offen lds
  v_mfma_f32_16x16x32_bf16 v[196:199], a[32:35], v[12:15], v[196:199]
  ds_read_b64_tr_b16 a[36:37], v236 offset:53248
  v_mfma_f32_16x16x32_bf16 v[204:207], a[40:43], v[12:15], 0
  ds_read_b64_tr_b16 a[38:39], v236 offset:55296
  v_mfma_f32_16x16x32_bf16 v[204:207], a[44:47], v[44:47], v[204:207]
  ds_read_b64_tr_b16 a[32:33], v236 offset:49152
  s_add_u32 m0, s23, 0xa400
  v_mfma_f32_16x16x32_bf16 v[200:203], a[44:47], v[40:43], 0
  ds_read_b64_tr_b16 a[34:35], v236 offset:51200
  buffer_load_dwordx4 v225, s[36:39], s21 offen lds
  v_mfma_f32_16x16x32_bf16 v[200:203], a[40:43], v[8:11], v[200:203]
  v_mfma_f32_16x16x32_bf16 v[92:95], a[40:43], v[4:7], 0
  v_mfma_f32_16x16x32_bf16 v[92:95], a[44:47], v[36:39], v[92:95]
  s_add_u32 m0, s23, 0xc000
  v_mfma_f32_16x16x32_bf16 v[88:91], a[44:47], v[32:35], 0
  buffer_load_dwordx4 v229, s[36:39], s21 offen lds
  v_mfma_f32_16x16x32_bf16 v[88:91], a[40:43], v[0:3], v[88:91]
  ds_read_b64_tr_b16 a[44:45], v237 offset:53248
  v_mfma_f32_16x16x32_bf16 v[112:115], a[48:51], v[0:3], 0
  v_mfma_f32_16x16x32_bf16 v[112:115], a[52:55], v[32:35], v[112:115]
  ds_read_b64_tr_b16 a[46:47], v237 offset:55296
  s_add_u32 m0, s23, 0xc400
  v_mfma_f32_16x16x32_bf16 v[116:119], a[52:55], v[36:39], 0
  buffer_load_dwordx4 v230, s[36:39], s21 offen lds
  s_bfe_u32 s21, s40, 0x40018
  s_lshl_b32 s21, s21, 17
  s_add_u32 s21, s21, s20
  v_mfma_f32_16x16x32_bf16 v[116:119], a[48:51], v[4:7], v[116:119]
  ds_read_b64_tr_b16 a[40:41], v237 offset:49152
  v_mfma_f32_16x16x32_bf16 v[208:211], a[48:51], v[8:11], 0
  s_waitcnt vmcnt(11)
  v_cmp_ne_u64 vcc, s[56:57], v[244:245]
  s_nop 1
  s_and_b32 s3, vcc_lo, 0xe
  s_cbranch_scc1 L_sp_c1
L_bk_c1:
  v_mfma_f32_16x16x32_bf16 v[208:211], a[52:55], v[40:43], v[208:211]
  ds_read_b64_tr_b16 a[42:43], v237 offset:51200
  s_cmp_lt_u32 s2, 128
  s_cbranch_scc1 L_p2_nof
  s_cmp_lg_u32 s67, 0
  s_cbranch_scc1 L_p2_nof
  s_bfe_u32 s60, s40, 0x40008
  s_lshl_b32 s60, s60, 12
  s_add_u32 s60, s60, s42
  buffer_load_dwordx4 v[128:131], v226, s[12:15], s60 offen offset:0 sc1
  buffer_load_dwordx4 v[132:135], v226, s[12:15], s60 offen offset:1024 sc1
  buffer_load_dwordx4 v[136:139], v227, s[12:15], s60 offen offset:0 sc1
  buffer_load_dwordx4 v[140:143], v227, s[12:15], s60 offen offset:1024 sc1
  s_bfe_u32 s60, s40, 0x40008
  s_lshl_b32 s60, s60, 12
  s_add_u32 s60, s60, s42
  buffer_load_dwordx4 v[160:163], v226, s[12:15], s60 offen offset:2048 sc1
  buffer_load_dwordx4 v[164:167], v226, s[12:15], s60 offen offset:3072 sc1
  buffer_load_dwordx4 v[168:171], v227, s[12:15], s60 offen offset:2048 sc1
  buffer_load_dwordx4 v[172:175], v227, s[12:15], s60 offen offset:3072 sc1
L_p2_nof:
  v_mfma_f32_16x16x32_bf16 v[212:215], a[52:55], v[44:47], 0
  buffer_load_dwordx4 a[64:67], v227, s[12:15], s22 offen offset:0 sc1
  v_mfma_f32_16x16x32_bf16 v[212:215], a[48:51], v[12:15], v[212:215]
  ds_read_b64_tr_b16 a[52:53], v238 offset:53248
  s_waitcnt lgkmcnt(8)
  v_mfma_f32_16x16x32_bf16 v[220:223], a[56:59], v[12:15], 0
  v_mfma_f32_16x16x32_bf16 v[220:223], a[60:63], v[44:47], v[220:223]
  ds_read_b64_tr_b16 a[54:55], v238 offset:55296
  v_mfma_f32_16x16x32_bf16 v[216:219], a[60:63], v[40:43], 0
  buffer_load_dwordx4 a[68:71], v227, s[12:15], s22 offen offset:1024 sc1
  v_mfma_f32_16x16x32_bf16 v[216:219], a[56:59], v[8:11], v[216:219]
  ds_read_b64_tr_b16 a[48:49], v238 offset:49152
  v_mfma_f32_16x16x32_bf16 v[124:127], a[56:59], v[4:7], 0
  v_mfma_f32_16x16x32_bf16 v[124:127], a[60:63], v[36:39], v[124:127]
  ds_read_b64_tr_b16 a[50:51], v238 offset:51200
  v_mfma_f32_16x16x32_bf16 v[120:123], a[60:63], v[32:35], 0
  buffer_load_dwordx4 a[72:75], v227, s[12:15], s22 offen offset:2048 sc1
  v_mfma_f32_16x16x32_bf16 v[120:123], a[56:59], v[0:3], v[120:123]
  ds_read_b64_tr_b16 a[60:61], v239 offset:53248
  v_mfma_f32_16x16x32_bf16 v[16:19], a[0:3], v[64:67], v[16:19]
  s_waitcnt lgkmcnt(0)
  s_mov_b32 s8, s48
  s_mov_b32 s9, s49
  s_mov_b32 s10, 0x200000
  s_mov_b32 s11, 0x20000
  s_mov_b32 s32, s52
  s_mov_b32 s33, s53
  s_mov_b32 s34, 0x800
  s_mov_b32 s35, 0x20000
  s_mov_b32 s44, s54
  s_mov_b32 s45, s55
  s_mov_b32 s46, 0x400000
  s_mov_b32 s47, 0x20000
  v_mfma_f32_16x16x32_bf16 v[16:19], a[4:7], v[96:99], v[16:19]
  ds_read_b64_tr_b16 a[62:63], v239 offset:55296
  v_mfma_f32_16x16x32_bf16 v[20:23], a[4:7], v[100:103], v[20:23]
  buffer_load_dwordx4 a[76:79], v227, s[12:15], s22 offen offset:3072 sc1
  v_mfma_f32_16x16x32_bf16 v[20:23], a[0:3], v[68:71], v[20:23]
  ds_read_b64_tr_b16 a[56:57], v239 offset:49152
  v_mfma_f32_16x16x32_bf16 v[144:147], a[0:3], v[72:75], v[144:147]
  v_mfma_f32_16x16x32_bf16 v[144:147], a[4:7], v[104:107], v[144:147]
  s_barrier
  ds_read_b64_tr_b16 a[58:59], v239 offset:51200
  v_mfma_f32_16x16x32_bf16 v[148:151], a[4:7], v[108:111], v[148:151]
  s_mov_b32 exec_lo, 0xf
  s_mov_b32 exec_hi, 0x0
  buffer_load_dwordx2 v[244:245], v231, s[16:19], 0 offen offset:8 sc1
  s_mov_b64 exec, -1
  v_mfma_f32_16x16x32_bf16 v[148:151], a[0:3], v[76:79], v[148:151]
  ds_read_b64_tr_b16 a[4:5], v236 offset:61440
  v_mfma_f32_16x16x32_bf16 v[156:159], a[8:11], v[76:79], v[156:159]
  v_mfma_f32_16x16x32_bf16 v[156:159], a[12:15], v[108:111], v[156:159]
  ds_read_b64_tr_b16 a[6:7], v236 offset:63488
  v_mfma_f32_16x16x32_bf16 v[152:155], a[12:15], v[104:107], v[152:155]
  buffer_load_dwordx4 a[80:83], v226, s[12:15], s22 offen offset:0 sc1
  v_mfma_f32_16x16x32_bf16 v[152:155], a[8:11], v[72:75], v[152:155]
  ds_read_b64_tr_b16 a[0:1], v236 offset:57344
  v_mfma_f32_16x16x32_bf16 v[28:31], a[8:11], v[68:71], v[28:31]
  v_mfma_f32_16x16x32_bf16 v[28:31], a[12:15], v[100:103], v[28:31]
  ds_read_b64_tr_b16 a[2:3], v236 offset:59392
  v_mfma_f32_16x16x32_bf16 v[24:27], a[12:15], v[96:99], v[24:27]
  buffer_load_dwordx4 a[84:87], v226, s[12:15], s22 offen offset:1024 sc1
  v_mfma_f32_16x16x32_bf16 v[24:27], a[8:11], v[64:67], v[24:27]
  ds_read_b64_tr_b16 a[12:13], v237 offset:61440
  v_mfma_f32_16x16x32_bf16 v[48:51], a[16:19], v[64:67], v[48:51]
  v_mfma_f32_16x16x32_bf16 v[48:51], a[20:23], v[96:99], v[48:51]
  ds_read_b64_tr_b16 a[14:15], v237 offset:63488
  v_mfma_f32_16x16x32_bf16 v[52:55], a[20:23], v[100:103], v[52:55]
  buffer_load_dwordx4 a[88:91], v226, s[12:15], s22 offen offset:2048 sc1
  v_mfma_f32_16x16x32_bf16 v[52:55], a[16:19], v[68:71], v[52:55]
  ds_read_b64_tr_b16 a[8:9], v237 offset:57344
  v_mfma_f32_16x16x32_bf16 v[176:179], a[16:19], v[72:75], v[176:179]
  v_mfma_f32_16x16x32_bf16 v[176:179], a[20:23], v[104:107], v[176:179]
  ds_read_b64_tr_b16 a[10:11], v237 offset:59392
  v_mfma_f32_16x16x32_bf16 v[180:183], a[20:23], v[108:111], v[180:183]
  buffer_load_dwordx4 a[92:95], v226, s[12:15], s22 offen offset:3072 sc1
  s_bfe_u32 s22, s40, 0x40010
  s_lshl_b32 s22, s22, 12
  s_add_u32 s22, s22, s42
  v_mfma_f32_16x16x32_bf16 v[180:183], a[16:19], v[76:79], v[180:183]
  ds_read_b64_tr_b16 a[20:21], v238 offset:61440
  v_mfma_f32_16x16x32_bf16 v[188:191], a[24:27], v[76:79], v[188:191]
  v_mfma_f32_16x16x32_bf16 v[188:191], a[28:31], v[108:111], v[188:191]
  ds_read_b64_tr_b16 a[22:23], v238 offset:63488
  s_add_u32 m0, s23, 0xe000
  v_mfma_f32_16x16x32_bf16 v[184:187], a[28:31], v[104:107], v[184:187]
  buffer_load_dwordx4 v224, s[36:39], s21 offen lds
  v_mfma_f32_16x16x32_bf16 v[184:187], a[24:27], v[72:75], v[184:187]
  ds_read_b64_tr_b16 a[16:17], v238 offset:57344
  v_mfma_f32_16x16x32_bf16 v[60:63], a[24:27], v[68:71], v[60:63]
  v_mfma_f32_16x16x32_bf16 v[60:63], a[28:31], v[100:103], v[60:63]
  ds_read_b64_tr_b16 a[18:19], v238 offset:59392
  v_mfma_f32_16x16x32_bf16 v[56:59], a[28:31], v[96:99], v[56:59]
  s_lshl_b32 s60, s2, 2
  s_add_u32 s60, s60, s25
  s_lshl_b32 s60, s60, 7
  s_add_u32 s60, s60, 0xa8000
  s_mov_b64 exec, 1
  buffer_store_dwordx2 a[226:227], off, s[16:19], s60 offset:16 sc1
  s_mov_b64 exec, -1
  v_mfma_f32_16x16x32_bf16 v[56:59], a[24:27], v[64:67], v[56:59]
  ds_read_b64_tr_b16 a[28:29], v239 offset:61440
  s_waitcnt lgkmcnt(8)
  v_mfma_f32_16x16x32_bf16 v[80:83], a[32:35], v[64:67], v[80:83]
  v_mfma_f32_16x16x32_bf16 v[80:83], a[36:39], v[96:99], v[80:83]
  ds_read_b64_tr_b16 a[30:31], v239 offset:63488
  s_add_u32 m0, s23, 0xe400
  v_mfma_f32_16x16x32_bf16 v[84:87], a[36:39], v[100:103], v[84:87]
  buffer_load_dwordx4 v225, s[36:39], s21 offen lds
  v_mfma_f32_16x16x32_bf16 v[84:87], a[32:35], v[68:71], v[84:87]
  ds_read_b64_tr_b16 a[24:25], v239 offset:57344
  v_mfma_f32_16x16x32_bf16 v[192:195], a[32:35], v[72:75], v[192:195]
  v_mfma_f32_16x16x32_bf16 v[192:195], a[36:39], v[104:107], v[192:195]
  ds_read_b64_tr_b16 a[26:27], v239 offset:59392
  s_add_u32 m0, s23, 0x10000
  v_mfma_f32_16x16x32_bf16 v[196:199], a[36:39], v[108:111], v[196:199]
  buffer_load_dwordx4 v229, s[36:39], s21 offen lds
  v_mfma_f32_16x16x32_bf16 v[196:199], a[32:35], v[76:79], v[196:199]
  ds_read_b64_tr_b16 a[36:37], v240 offset:4096
  v_mfma_f32_16x16x32_bf16 v[204:207], a[40:43], v[76:79], v[204:207]
  v_mfma_f32_16x16x32_bf16 v[204:207], a[44:47], v[108:111], v[204:207]
  ds_read_b64_tr_b16 a[38:39], v240 offset:6144
  s_add_u32 m0, s23, 0x10400
  v_mfma_f32_16x16x32_bf16 v[200:203], a[44:47], v[104:107], v[200:203]
  buffer_load_dwordx4 v230, s[36:39], s21 offen lds
  s_bfe_u32 s21, s40, 0x4001c
  s_lshl_b32 s21, s21, 17
  s_add_u32 s21, s21, s20
  v_mfma_f32_16x16x32_bf16 v[200:203], a[40:43], v[72:75], v[200:203]
  ds_read_b64_tr_b16 a[32:33], v240 offset:0
  v_mfma_f32_16x16x32_bf16 v[92:95], a[40:43], v[68:71], v[92:95]
  v_mfma_f32_16x16x32_bf16 v[92:95], a[44:47], v[100:103], v[92:95]
  ds_read_b64_tr_b16 a[34:35], v240 offset:2048
  s_add_u32 m0, s23, 0x12000
  v_mfma_f32_16x16x32_bf16 v[88:91], a[44:47], v[96:99], v[88:91]
  buffer_load_dwordx4 v224, s[36:39], s21 offen lds
  v_mfma_f32_16x16x32_bf16 v[88:91], a[40:43], v[64:67], v[88:91]
  ds_read_b64_tr_b16 a[44:45], v241 offset:4096
  v_mfma_f32_16x16x32_bf16 v[112:115], a[48:51], v[64:67], v[112:115]
  v_mfma_f32_16x16x32_bf16 v[112:115], a[52:55], v[96:99], v[112:115]
  ds_read_b64_tr_b16 a[46:47], v241 offset:6144
  s_add_u32 m0, s23, 0x12400
  v_mfma_f32_16x16x32_bf16 v[116:119], a[52:55], v[100:103], v[116:119]
  s_waitcnt vmcnt(10)
  v_cmp_ne_u64 vcc, s[56:57], v[244:245]
  s_nop 1
  s_and_b32 s3, vcc_lo, 0xf
  s_cbranch_scc1 L_sp_c2
L_bk_c2:
  buffer_load_dwordx4 v225, s[36:39], s21 offen lds
  v_mfma_f32_16x16x32_bf16 v[116:119], a[48:51], v[68:71], v[116:119]
  ds_read_b64_tr_b16 a[40:41], v241 offset:0
  v_mfma_f32_16x16x32_bf16 v[208:211], a[48:51], v[72:75], v[208:211]
  v_mfma_f32_16x16x32_bf16 v[208:211], a[52:55], v[104:107], v[208:211]
  ds_read_b64_tr_b16 a[42:43], v241 offset:2048
  v_mfma_f32_16x16x32_bf16 v[212:215], a[52:55], v[108:111], v[212:215]
  buffer_load_dwordx4 a[96:99], v227, s[12:15], s22 offen offset:0 sc1
  v_mfma_f32_16x16x32_bf16 v[212:215], a[48:51], v[76:79], v[212:215]
  ds_read_b64_tr_b16 a[52:53], v242 offset:4096
  v_mfma_f32_16x16x32_bf16 v[220:223], a[56:59], v[76:79], v[220:223]
  v_mfma_f32_16x16x32_bf16 v[220:223], a[60:63], v[108:111], v[220:223]
  ds_read_b64_tr_b16 a[54:55], v242 offset:6144
  v_mfma_f32_16x16x32_bf16 v[216:219], a[60:63], v[104:107], v[216:219]
  buffer_load_dwordx4 a[100:103], v227, s[12:15], s22 offen offset:1024 sc1
  v_mfma_f32_16x16x32_bf16 v[216:219], a[56:59], v[72:75], v[216:219]
  ds_read_b64_tr_b16 a[48:49], v242 offset:0
  v_mfma_f32_16x16x32_bf16 v[124:127], a[56:59], v[68:71], v[124:127]
  v_mfma_f32_16x16x32_bf16 v[124:127], a[60:63], v[100:103], v[124:127]
  ds_read_b64_tr_b16 a[50:51], v242 offset:2048
  v_mfma_f32_16x16x32_bf16 v[120:123], a[60:63], v[96:99], v[120:123]
  buffer_load_dwordx4 a[104:107], v227, s[12:15], s22 offen offset:2048 sc1
  v_mfma_f32_16x16x32_bf16 v[120:123], a[56:59], v[64:67], v[120:123]
  ds_read_b64_tr_b16 a[60:61], v243 offset:4096
  v_mfma_f32_16x16x32_bf16 v[16:19], a[0:3], v[128:131], v[16:19]
  v_mfma_f32_16x16x32_bf16 v[16:19], a[4:7], v[160:163], v[16:19]
  ds_read_b64_tr_b16 a[62:63], v243 offset:6144
  v_mfma_f32_16x16x32_bf16 v[20:23], a[4:7], v[164:167], v[20:23]
  buffer_load_dwordx4 a[108:111], v227, s[12:15], s22 offen offset:3072 sc1
  v_mfma_f32_16x16x32_bf16 v[20:23], a[0:3], v[132:135], v[20:23]
  ds_read_b64_tr_b16 a[56:57], v243 offset:0
  v_mfma_f32_16x16x32_bf16 v[144:147], a[0:3], v[136:139], v[144:147]
  v_mfma_f32_16x16x32_bf16 v[144:147], a[4:7], v[168:171], v[144:147]
  s_barrier
  ds_read_b64_tr_b16 a[58:59], v243 offset:2048
  v_mfma_f32_16x16x32_bf16 v[148:151], a[4:7], v[172:175], v[148:151]
  buffer_load_dwordx4 a[112:115], v226, s[12:15], s22 offen offset:0 sc1
  v_mfma_f32_16x16x32_bf16 v[148:151], a[0:3], v[140:143], v[148:151]
  ds_read_b64_tr_b16 a[4:5], v240 offset:12288
  s_waitcnt lgkmcnt(8)
  v_mfma_f32_16x16x32_bf16 v[156:159], a[8:11], v[140:143], v[156:159]
  v_mfma_f32_16x16x32_bf16 v[156:159], a[12:15], v[172:175], v[156:159]
  ds_read_b64_tr_b16 a[6:7], v240 offset:14336
  v_mfma_f32_16x16x32_bf16 v[152:155], a[12:15], v[168:171], v[152:155]
  s_getpc_b64 s[48:49]
L_k2_pc3_2:
  s_mov_b32 s50, L_k2_spin-L_k2_pc3_2
  s_mov_b32 s51, 0x20000
  s_lshl_b32 s61, s100, 8
  v_lshlrev_b32 v254, 3, v228
  s_mov_b64 exec, 3
  buffer_load_dword v255, v254, s[48:51], s61 offen
  s_mov_b64 exec, -1
  v_mfma_f32_16x16x32_bf16 v[152:155], a[8:11], v[136:139], v[152:155]
  ds_read_b64_tr_b16 a[0:1], v240 offset:8192
  v_mfma_f32_16x16x32_bf16 v[28:31], a[8:11], v[132:135], v[28:31]
  v_mfma_f32_16x16x32_bf16 v[28:31], a[12:15], v[164:167], v[28:31]
  ds_read_b64_tr_b16 a[2:3], v240 offset:10240
  v_mfma_f32_16x16x32_bf16 v[24:27], a[12:15], v[160:163], v[24:27]
  buffer_load_dwordx4 a[116:119], v226, s[12:15], s22 offen offset:1024 sc1
  v_mfma_f32_16x16x32_bf16 v[24:27], a[8:11], v[128:131], v[24:27]
  ds_read_b64_tr_b16 a[12:13], v241 offset:12288
  v_mfma_f32_16x16x32_bf16 v[48:51], a[16:19], v[128:131], v[48:51]
  v_mfma_f32_16x16x32_bf16 v[48:51], a[20:23], v[160:163], v[48:51]
  ds_read_b64_tr_b16 a[14:15], v241 offset:14336
  v_mfma_f32_16x16x32_bf16 v[52:55], a[20:23], v[164:167], v[52:55]
  buffer_load_dwordx4 a[120:123], v226, s[12:15], s22 offen offset:2048 sc1
  v_mfma_f32_16x16x32_bf16 v[52:55], a[16:19], v[132:135], v[52:55]
  ds_read_b64_tr_b16 a[8:9], v241 offset:8192
  v_mfma_f32_16x16x32_bf16 v[176:179], a[16:19], v[136:139], v[176:179]
  v_mfma_f32_16x16x32_bf16 v[176:179], a[20:23], v[168:171], v[176:179]
  ds_read_b64_tr_b16 a[10:11], v241 offset:10240
  v_mfma_f32_16x16x32_bf16 v[180:183], a[20:23], v[172:175], v[180:183]
  buffer_load_dwordx4 a[124:127], v226, s[12:15], s22 offen offset:3072 sc1
  s_bfe_u32 s22, s40, 0x40014
  s_lshl_b32 s22, s22, 12
  s_add_u32 s22, s22, s42
  v_mfma_f32_16x16x32_bf16 v[180:183], a[16:19], v[140:143], v[180:183]
  ds_read_b64_tr_b16 a[20:21], v242 offset:12288
  v_mfma_f32_16x16x32_bf16 v[188:191], a[24:27], v[140:143], v[188:191]
  v_mfma_f32_16x16x32_bf16 v[188:191], a[28:31], v[172:175], v[188:191]
  ds_read_b64_tr_b16 a[22:23], v242 offset:14336
  v_mfma_f32_16x16x32_bf16 v[184:187], a[28:31], v[168:171], v[184:187]
  buffer_load_dwordx4 a[128:131], v227, s[12:15], s22 offen offset:0 sc1
  v_mfma_f32_16x16x32_bf16 v[184:187], a[24:27], v[136:139], v[184:187]
  ds_read_b64_tr_b16 a[16:17], v242 offset:8192
  v_mfma_f32_16x16x32_bf16 v[60:63], a[24:27], v[132:135], v[60:63]
  v_mfma_f32_16x16x32_bf16 v[60:63], a[28:31], v[164:167], v[60:63]
  ds_read_b64_tr_b16 a[18:19], v242 offset:10240
  v_mfma_f32_16x16x32_bf16 v[56:59], a[28:31], v[160:163], v[56:59]
  buffer_load_dwordx4 a[132:135], v227, s[12:15], s22 offen offset:1024 sc1
  v_mfma_f32_16x16x32_bf16 v[56:59], a[24:27], v[128:131], v[56:59]
  ds_read_b64_tr_b16 a[28:29], v243 offset:12288
  v_mfma_f32_16x16x32_bf16 v[80:83], a[32:35], v[128:131], v[80:83]
  v_mfma_f32_16x16x32_bf16 v[80:83], a[36:39], v[160:163], v[80:83]
  ds_read_b64_tr_b16 a[30:31], v243 offset:14336
  v_mfma_f32_16x16x32_bf16 v[84:87], a[36:39], v[164:167], v[84:87]
  buffer_load_dwordx4 a[136:139], v227, s[12:15], s22 offen offset:2048 sc1
  v_mfma_f32_16x16x32_bf16 v[84:87], a[32:35], v[132:135], v[84:87]
  ds_read_b64_tr_b16 a[24:25], v243 offset:8192
  v_mfma_f32_16x16x32_bf16 v[192:195], a[32:35], v[136:139], v[192:195]
  v_mfma_f32_16x16x32_bf16 v[192:195], a[36:39], v[168:171], v[192:195]
  ds_read_b64_tr_b16 a[26:27], v243 offset:10240
  v_mfma_f32_16x16x32_bf16 v[196:199], a[36:39], v[172:175], v[196:199]
  buffer_load_dwordx4 a[140:143], v227, s[12:15], s22 offen offset:3072 sc1
  v_mfma_f32_16x16x32_bf16 v[196:199], a[32:35], v[140:143], v[196:199]
  ds_read_b64_tr_b16 a[36:37], v240 offset:20480
  v_mfma_f32_16x16x32_bf16 v[204:207], a[40:43], v[140:143], v[204:207]
  v_mfma_f32_16x16x32_bf16 v[204:207], a[44:47], v[172:175], v[204:207]
  ds_read_b64_tr_b16 a[38:39], v240 offset:22528
  v_mfma_f32_16x16x32_bf16 v[200:203], a[44:47], v[168:171], v[200:203]
  buffer_load_dwordx4 a[144:147], v226, s[12:15], s22 offen offset:0 sc1
  v_mfma_f32_16x16x32_bf16 v[200:203], a[40:43], v[136:139], v[200:203]
  ds_read_b64_tr_b16 a[32:33], v240 offset:16384
  v_mfma_f32_16x16x32_bf16 v[92:95], a[40:43], v[132:135], v[92:95]
  v_mfma_f32_16x16x32_bf16 v[92:95], a[44:47], v[164:167], v[92:95]
  ds_read_b64_tr_b16 a[34:35], v240 offset:18432
  v_mfma_f32_16x16x32_bf16 v[88:91], a[44:47], v[160:163], v[88:91]
  buffer_load_dwordx4 a[148:151], v226, s[12:15], s22 offen offset:1024 sc1
  v_mfma_f32_16x16x32_bf16 v[88:91], a[40:43], v[128:131], v[88:91]
  ds_read_b64_tr_b16 a[44:45], v241 offset:20480
  s_waitcnt lgkmcnt(8)
  v_mfma_f32_16x16x32_bf16 v[112:115], a[48:51], v[128:131], v[112:115]
  v_mfma_f32_16x16x32_bf16 v[112:115], a[52:55], v[160:163], v[112:115]
  ds_read_b64_tr_b16 a[46:47], v241 offset:22528
  v_mfma_f32_16x16x32_bf16 v[116:119], a[52:55], v[164:167], v[116:119]
  buffer_load_dwordx4 a[152:155], v226, s[12:15], s22 offen offset:2048 sc1
  v_mfma_f32_16x16x32_bf16 v[116:119], a[48:51], v[132:135], v[116:119]
  ds_read_b64_tr_b16 a[40:41], v241 offset:16384
  v_mfma_f32_16x16x32_bf16 v[208:211], a[48:51], v[136:139], v[208:211]
  v_mfma_f32_16x16x32_bf16 v[208:211], a[52:55], v[168:171], v[208:211]
  ds_read_b64_tr_b16 a[42:43], v241 offset:18432
  v_mfma_f32_16x16x32_bf16 v[212:215], a[52:55], v[172:175], v[212:215]
  buffer_load_dwordx4 a[156:159], v226, s[12:15], s22 offen offset:3072 sc1
  s_bfe_u32 s22, s40, 0x40018
  s_lshl_b32 s22, s22, 12
  s_add_u32 s22, s22, s42
  v_mfma_f32_16x16x32_bf16 v[212:215], a[48:51], v[140:143], v[212:215]
  ds_read_b64_tr_b16 a[52:53], v242 offset:20480
  v_mfma_f32_16x16x32_bf16 v[220:223], a[56:59], v[140:143], v[220:223]
  v_mfma_f32_16x16x32_bf16 v[220:223], a[60:63], v[172:175], v[220:223]
  ds_read_b64_tr_b16 a[54:55], v242 offset:22528
  v_mfma_f32_16x16x32_bf16 v[216:219], a[60:63], v[168:171], v[216:219]
  buffer_load_dwordx4 a[160:163], v227, s[12:15], s22 offen offset:0 sc1
  v_mfma_f32_16x16x32_bf16 v[216:219], a[56:59], v[136:139], v[216:219]
  ds_read_b64_tr_b16 a[48:49], v242 offset:16384
  v_mfma_f32_16x16x32_bf16 v[124:127], a[56:59], v[132:135], v[124:127]
  v_mfma_f32_16x16x32_bf16 v[124:127], a[60:63], v[164:167], v[124:127]
  ds_read_b64_tr_b16 a[50:51], v242 offset:18432
  v_mfma_f32_16x16x32_bf16 v[120:123], a[60:63], v[160:163], v[120:123]
  buffer_load_dwordx4 a[164:167], v227, s[12:15], s22 offen offset:1024 sc1
  v_mfma_f32_16x16x32_bf16 v[120:123], a[56:59], v[128:131], v[120:123]
  ds_read_b64_tr_b16 a[60:61], v243 offset:20480
  s_waitcnt vmcnt(26)
  v_mfma_f32_16x16x32_bf16 v[16:19], a[0:3], a[80:83], v[16:19]
  v_mfma_f32_16x16x32_bf16 v[16:19], a[4:7], a[88:91], v[16:19]
  ds_read_b64_tr_b16 a[62:63], v243 offset:22528
  v_mfma_f32_16x16x32_bf16 v[20:23], a[4:7], a[92:95], v[20:23]
  buffer_load_dwordx4 a[168:171], v227, s[12:15], s22 offen offset:2048 sc1
  v_mfma_f32_16x16x32_bf16 v[20:23], a[0:3], a[84:87], v[20:23]
  ds_read_b64_tr_b16 a[56:57], v243 offset:16384
  v_mfma_f32_16x16x32_bf16 v[144:147], a[0:3], a[64:67], v[144:147]
  v_mfma_f32_16x16x32_bf16 v[144:147], a[4:7], a[72:75], v[144:147]
  s_barrier
  ds_read_b64_tr_b16 a[58:59], v243 offset:18432
  v_mfma_f32_16x16x32_bf16 v[148:151], a[4:7], a[76:79], v[148:151]
  buffer_load_dwordx4 a[172:175], v227, s[12:15], s22 offen offset:3072 sc1
  v_mfma_f32_16x16x32_bf16 v[148:151], a[0:3], a[68:71], v[148:151]
  ds_read_b64_tr_b16 a[4:5], v240 offset:28672
  v_mfma_f32_16x16x32_bf16 v[156:159], a[8:11], a[68:71], v[156:159]
  v_mfma_f32_16x16x32_bf16 v[156:159], a[12:15], a[76:79], v[156:159]
  ds_read_b64_tr_b16 a[6:7], v240 offset:30720
  v_mfma_f32_16x16x32_bf16 v[152:155], a[12:15], a[72:75], v[152:155]
  buffer_load_dwordx4 a[176:179], v226, s[12:15], s22 offen offset:0 sc1
  v_mfma_f32_16x16x32_bf16 v[152:155], a[8:11], a[64:67], v[152:155]
  ds_read_b64_tr_b16 a[0:1], v240 offset:24576
  v_mfma_f32_16x16x32_bf16 v[28:31], a[8:11], a[84:87], v[28:31]
  v_mfma_f32_16x16x32_bf16 v[28:31], a[12:15], a[92:95], v[28:31]
  ds_read_b64_tr_b16 a[2:3], v240 offset:26624
  v_mfma_f32_16x16x32_bf16 v[24:27], a[12:15], a[88:91], v[24:27]
  buffer_load_dwordx4 a[180:183], v226, s[12:15], s22 offen offset:1024 sc1
  v_mfma_f32_16x16x32_bf16 v[24:27], a[8:11], a[80:83], v[24:27]
  ds_read_b64_tr_b16 a[12:13], v241 offset:28672
  v_mfma_f32_16x16x32_bf16 v[48:51], a[16:19], a[80:83], v[48:51]
  v_mfma_f32_16x16x32_bf16 v[48:51], a[20:23], a[88:91], v[48:51]
  ds_read_b64_tr_b16 a[14:15], v241 offset:30720
  v_mfma_f32_16x16x32_bf16 v[52:55], a[20:23], a[92:95], v[52:55]
  buffer_load_dwordx4 a[184:187], v226, s[12:15], s22 offen offset:2048 sc1
  v_mfma_f32_16x16x32_bf16 v[52:55], a[16:19], a[84:87], v[52:55]
  ds_read_b64_tr_b16 a[8:9], v241 offset:24576
  v_mfma_f32_16x16x32_bf16 v[176:179], a[16:19], a[64:67], v[176:179]
  v_mfma_f32_16x16x32_bf16 v[176:179], a[20:23], a[72:75], v[176:179]
  ds_read_b64_tr_b16 a[10:11], v241 offset:26624
  v_mfma_f32_16x16x32_bf16 v[180:183], a[20:23], a[76:79], v[180:183]
  buffer_load_dwordx4 a[188:191], v226, s[12:15], s22 offen offset:3072 sc1
  s_bfe_u32 s22, s40, 0x4001c
  s_lshl_b32 s22, s22, 12
  s_add_u32 s22, s22, s42
  v_mfma_f32_16x16x32_bf16 v[180:183], a[16:19], a[68:71], v[180:183]
  ds_read_b64_tr_b16 a[20:21], v242 offset:28672
  s_waitcnt lgkmcnt(8)
  v_mfma_f32_16x16x32_bf16 v[188:191], a[24:27], a[68:71], v[188:191]
  v_mfma_f32_16x16x32_bf16 v[188:191], a[28:31], a[76:79], v[188:191]
  ds_read_b64_tr_b16 a[22:23], v242 offset:30720
  s_add_u32 m0, s23, 0x14000
  v_mfma_f32_16x16x32_bf16 v[184:187], a[28:31], a[72:75], v[184:187]
  buffer_load_dwordx4 v229, s[36:39], s21 offen lds
  v_mfma_f32_16x16x32_bf16 v[184:187], a[24:27], a[64:67], v[184:187]
  ds_read_b64_tr_b16 a[16:17], v242 offset:24576
  v_mfma_f32_16x16x32_bf16 v[60:63], a[24:27], a[84:87], v[60:63]
  v_mfma_f32_16x16x32_bf16 v[60:63], a[28:31], a[92:95], v[60:63]
  ds_read_b64_tr_b16 a[18:19], v242 offset:26624
  s_add_u32 m0, s23, 0x14400
  v_mfma_f32_16x16x32_bf16 v[56:59], a[28:31], a[88:91], v[56:59]
  buffer_load_dwordx4 v230, s[36:39], s21 offen lds
  s_bfe_u32 s21, s41, 0x40000
  s_lshl_b32 s21, s21, 17
  s_add_u32 s21, s21, s20
  v_mfma_f32_16x16x32_bf16 v[56:59], a[24:27], a[80:83], v[56:59]
  ds_read_b64_tr_b16 a[28:29], v243 offset:28672
  v_mfma_f32_16x16x32_bf16 v[80:83], a[32:35], a[80:83], v[80:83]
  v_mfma_f32_16x16x32_bf16 v[80:83], a[36:39], a[88:91], v[80:83]
  ds_read_b64_tr_b16 a[30:31], v243 offset:30720
  v_mfma_f32_16x16x32_bf16 v[84:87], a[36:39], a[92:95], v[84:87]
  buffer_load_dwordx4 a[192:195], v227, s[12:15], s22 offen offset:0 sc1
  v_mfma_f32_16x16x32_bf16 v[84:87], a[32:35], a[84:87], v[84:87]
  ds_read_b64_tr_b16 a[24:25], v243 offset:24576
  v_mfma_f32_16x16x32_bf16 v[192:195], a[32:35], a[64:67], v[192:195]
  v_mfma_f32_16x16x32_bf16 v[192:195], a[36:39], a[72:75], v[192:195]
  ds_read_b64_tr_b16 a[26:27], v243 offset:26624
  v_mfma_f32_16x16x32_bf16 v[196:199], a[36:39], a[76:79], v[196:199]
  buffer_load_dwordx4 a[196:199], v227, s[12:15], s22 offen offset:1024 sc1
  v_mfma_f32_16x16x32_bf16 v[196:199], a[32:35], a[68:71], v[196:199]
  ds_read_b64_tr_b16 a[36:37], v232 offset:36864
  v_mfma_f32_16x16x32_bf16 v[204:207], a[40:43], a[68:71], v[204:207]
  v_mfma_f32_16x16x32_bf16 v[204:207], a[44:47], a[76:79], v[204:207]
  ds_read_b64_tr_b16 a[38:39], v232 offset:38912
  v_mfma_f32_16x16x32_bf16 v[200:203], a[44:47], a[72:75], v[200:203]
  buffer_load_dwordx4 a[200:203], v227, s[12:15], s22 offen offset:2048 sc1
  v_mfma_f32_16x16x32_bf16 v[200:203], a[40:43], a[64:67], v[200:203]
  ds_read_b64_tr_b16 a[32:33], v232 offset:32768
  v_mfma_f32_16x16x32_bf16 v[92:95], a[40:43], a[84:87], v[92:95]
  v_mfma_f32_16x16x32_bf16 v[92:95], a[44:47], a[92:95], v[92:95]
  ds_read_b64_tr_b16 a[34:35], v232 offset:34816
  v_mfma_f32_16x16x32_bf16 v[88:91], a[44:47], a[88:91], v[88:91]
  buffer_load_dwordx4 a[204:207], v227, s[12:15], s22 offen offset:3072 sc1
  v_mfma_f32_16x16x32_bf16 v[88:91], a[40:43], a[80:83], v[88:91]
  ds_read_b64_tr_b16 a[44:45], v233 offset:36864
  v_mfma_f32_16x16x32_bf16 v[112:115], a[48:51], a[80:83], v[112:115]
  v_mfma_f32_16x16x32_bf16 v[112:115], a[52:55], a[88:91], v[112:115]
  ds_read_b64_tr_b16 a[46:47], v233 offset:38912
  v_mfma_f32_16x16x32_bf16 v[116:119], a[52:55], a[92:95], v[116:119]
  buffer_load_dwordx4 a[208:211], v226, s[12:15], s22 offen offset:0 sc1
  v_mfma_f32_16x16x32_bf16 v[116:119], a[48:51], a[84:87], v[116:119]
  ds_read_b64_tr_b16 a[40:41], v233 offset:32768
  v_mfma_f32_16x16x32_bf16 v[208:211], a[48:51], a[64:67], v[208:211]
  v_mfma_f32_16x16x32_bf16 v[208:211], a[52:55], a[72:75], v[208:211]
  ds_read_b64_tr_b16 a[42:43], v233 offset:34816
  v_mfma_f32_16x16x32_bf16 v[212:215], a[52:55], a[76:79], v[212:215]
  buffer_load_dwordx4 a[212:215], v226, s[12:15], s22 offen offset:1024 sc1
  v_mfma_f32_16x16x32_bf16 v[212:215], a[48:51], a[68:71], v[212:215]
  ds_read_b64_tr_b16 a[52:53], v234 offset:36864
  v_mfma_f32_16x16x32_bf16 v[220:223], a[56:59], a[68:71], v[220:223]
  v_mfma_f32_16x16x32_bf16 v[220:223], a[60:63], a[76:79], v[220:223]
  ds_read_b64_tr_b16 a[54:55], v234 offset:38912
  v_mfma_f32_16x16x32_bf16 v[216:219], a[60:63], a[72:75], v[216:219]
  buffer_load_dwordx4 a[216:219], v226, s[12:15], s22 offen offset:2048 sc1
  v_mfma_f32_16x16x32_bf16 v[216:219], a[56:59], a[64:67], v[216:219]
  ds_read_b64_tr_b16 a[48:49], v234 offset:32768
  v_mfma_f32_16x16x32_bf16 v[124:127], a[56:59], a[84:87], v[124:127]
  v_mfma_f32_16x16x32_bf16 v[124:127], a[60:63], a[92:95], v[124:127]
  ds_read_b64_tr_b16 a[50:51], v234 offset:34816
  v_mfma_f32_16x16x32_bf16 v[120:123], a[60:63], a[88:91], v[120:123]
  buffer_load_dwordx4 a[220:223], v226, s[12:15], s22 offen offset:3072 sc1
  s_bfe_u32 s22, s41, 0x40000
  s_lshl_b32 s22, s22, 12
  s_add_u32 s22, s22, s42
  v_mfma_f32_16x16x32_bf16 v[120:123], a[56:59], a[80:83], v[120:123]
  ds_read_b64_tr_b16 a[60:61], v235 offset:36864
  s_waitcnt lgkmcnt(8) vmcnt(26)
  v_mfma_f32_16x16x32_bf16 v[16:19], a[0:3], a[112:115], v[16:19]
  v_mfma_f32_16x16x32_bf16 v[16:19], a[4:7], a[120:123], v[16:19]
  ds_read_b64_tr_b16 a[62:63], v235 offset:38912
  s_add_u32 m0, s23, 0x0
  v_mfma_f32_16x16x32_bf16 v[20:23], a[4:7], a[124:127], v[20:23]
  buffer_load_dwordx4 v224, s[36:39], s21 offen lds
  v_mfma_f32_16x16x32_bf16 v[20:23], a[0:3], a[116:119], v[20:23]
  ds_read_b64_tr_b16 a[56:57], v235 offset:32768
  v_mfma_f32_16x16x32_bf16 v[144:147], a[0:3], a[96:99], v[144:147]
  v_mfma_f32_16x16x32_bf16 v[144:147], a[4:7], a[104:107], v[144:147]
  s_barrier
  ds_read_b64_tr_b16 a[58:59], v235 offset:34816
  s_add_u32 m0, s23, 0x400
  v_mfma_f32_16x16x32_bf16 v[148:151], a[4:7], a[108:111], v[148:151]
  buffer_load_dwordx4 v225, s[36:39], s21 offen lds
  v_mfma_f32_16x16x32_bf16 v[148:151], a[0:3], a[100:103], v[148:151]
  ds_read_b64_tr_b16 a[4:5], v232 offset:45056
  v_mfma_f32_16x16x32_bf16 v[156:159], a[8:11], a[100:103], v[156:159]
  v_mfma_f32_16x16x32_bf16 v[156:159], a[12:15], a[108:111], v[156:159]
  ds_read_b64_tr_b16 a[6:7], v232 offset:47104
  s_add_u32 m0, s23, 0x2000
  v_mfma_f32_16x16x32_bf16 v[152:155], a[12:15], a[104:107], v[152:155]
  buffer_load_dwordx4 v229, s[36:39], s21 offen lds
  v_mfma_f32_16x16x32_bf16 v[152:155], a[8:11], a[96:99], v[152:155]
  ds_read_b64_tr_b16 a[0:1], v232 offset:40960
  v_mfma_f32_16x16x32_bf16 v[28:31], a[8:11], a[116:119], v[28:31]
  v_mfma_f32_16x16x32_bf16 v[28:31], a[12:15], a[124:127], v[28:31]
  ds_read_b64_tr_b16 a[2:3], v232 offset:43008
  s_add_u32 m0, s23, 0x2400
  v_mfma_f32_16x16x32_bf16 v[24:27], a[12:15], a[120:123], v[24:27]
  buffer_load_dwordx4 v230, s[36:39], s21 offen lds
  s_bfe_u32 s21, s41, 0x40004
  s_lshl_b32 s21, s21, 17
  s_add_u32 s21, s21, s20
  v_mfma_f32_16x16x32_bf16 v[24:27], a[8:11], a[112:115], v[24:27]
  ds_read_b64_tr_b16 a[12:13], v233 offset:45056
  v_mfma_f32_16x16x32_bf16 v[48:51], a[16:19], a[112:115], v[48:51]
  v_mfma_f32_16x16x32_bf16 v[48:51], a[20:23], a[120:123], v[48:51]
  ds_read_b64_tr_b16 a[14:15], v233 offset:47104
  v_mfma_f32_16x16x32_bf16 v[52:55], a[20:23], a[124:127], v[52:55]
  s_mov_b32 exec_lo, 0xf
  s_mov_b32 exec_hi, 0x0
  buffer_load_dwordx2 v[244:245], v231, s[16:19], 0 offen offset:16 sc1
  s_mov_b64 exec, -1
  v_mfma_f32_16x16x32_bf16 v[52:55], a[16:19], a[116:119], v[52:55]
  ds_read_b64_tr_b16 a[8:9], v233 offset:40960
  v_mfma_f32_16x16x32_bf16 v[176:179], a[16:19], a[96:99], v[176:179]
  v_mfma_f32_16x16x32_bf16 v[176:179], a[20:23], a[104:107], v[176:179]
  ds_read_b64_tr_b16 a[10:11], v233 offset:43008
  s_add_u32 m0, s23, 0x4000
  v_mfma_f32_16x16x32_bf16 v[180:183], a[20:23], a[108:111], v[180:183]
  buffer_load_dwordx4 v224, s[36:39], s21 offen lds
  v_mfma_f32_16x16x32_bf16 v[180:183], a[16:19], a[100:103], v[180:183]
  ds_read_b64_tr_b16 a[20:21], v234 offset:45056
  v_mfma_f32_16x16x32_bf16 v[188:191], a[24:27], a[100:103], v[188:191]
  v_mfma_f32_16x16x32_bf16 v[188:191], a[28:31], a[108:111], v[188:191]
  ds_read_b64_tr_b16 a[22:23], v234 offset:47104
  s_add_u32 m0, s23, 0x4400
  v_mfma_f32_16x16x32_bf16 v[184:187], a[28:31], a[104:107], v[184:187]
  buffer_load_dwordx4 v225, s[36:39], s21 offen lds
  v_mfma_f32_16x16x32_bf16 v[184:187], a[24:27], a[96:99], v[184:187]
  ds_read_b64_tr_b16 a[16:17], v234 offset:40960
  v_mfma_f32_16x16x32_bf16 v[60:63], a[24:27], a[116:119], v[60:63]
  v_mfma_f32_16x16x32_bf16 v[60:63], a[28:31], a[124:127], v[60:63]
  ds_read_b64_tr_b16 a[18:19], v234 offset:43008
  s_add_u32 m0, s23, 0x6000
  v_mfma_f32_16x16x32_bf16 v[56:59], a[28:31], a[120:123], v[56:59]
  buffer_load_dwordx4 v229, s[36:39], s21 offen lds
  v_mfma_f32_16x16x32_bf16 v[56:59], a[24:27], a[112:115], v[56:59]
  ds_read_b64_tr_b16 a[28:29], v235 offset:45056
  v_mfma_f32_16x16x32_bf16 v[80:83], a[32:35], a[112:115], v[80:83]
  v_mfma_f32_16x16x32_bf16 v[80:83], a[36:39], a[120:123], v[80:83]
  ds_read_b64_tr_b16 a[30:31], v235 offset:47104
  s_add_u32 m0, s23, 0x6400
  v_mfma_f32_16x16x32_bf16 v[84:87], a[36:39], a[124:127], v[84:87]
  buffer_load_dwordx4 v230, s[36:39], s21 offen lds
  s_bfe_u32 s21, s41, 0x40008
  s_lshl_b32 s21, s21, 17
  s_add_u32 s21, s21, s20
  v_mfma_f32_16x16x32_bf16 v[84:87], a[32:35], a[116:119], v[84:87]
  ds_read_b64_tr_b16 a[24:25], v235 offset:40960
  v_mfma_f32_16x16x32_bf16 v[192:195], a[32:35], a[96:99], v[192:195]
  v_mfma_f32_16x16x32_bf16 v[192:195], a[36:39], a[104:107], v[192:195]
  ds_read_b64_tr_b16 a[26:27], v235 offset:43008
  s_add_u32 m0, s23, 0x16000
  v_mfma_f32_16x16x32_bf16 v[196:199], a[36:39], a[108:111], v[196:199]
  buffer_load_dwordx4 v224, s[36:39], s21 offen lds
  v_mfma_f32_16x16x32_bf16 v[196:199], a[32:35], a[100:103], v[196:199]
  ds_read_b64_tr_b16 a[36:37], v232 offset:53248
  s_waitcnt lgkmcnt(8)
  v_mfma_f32_16x16x32_bf16 v[204:207], a[40:43], a[100:103], v[204:207]
  v_mfma_f32_16x16x32_bf16 v[204:207], a[44:47], a[108:111], v[204:207]
  ds_read_b64_tr_b16 a[38:39], v232 offset:55296
  s_add_u32 m0, s23, 0x16400
  v_mfma_f32_16x16x32_bf16 v[200:203], a[44:47], a[104:107], v[200:203]
  buffer_load_dwordx4 v225, s[36:39], s21 offen lds
  v_mfma_f32_16x16x32_bf16 v[200:203], a[40:43], a[96:99], v[200:203]
  ds_read_b64_tr_b16 a[32:33], v232 offset:49152
  v_mfma_f32_16x16x32_bf16 v[92:95], a[40:43], a[116:119], v[92:95]
  v_mfma_f32_16x16x32_bf16 v[92:95], a[44:47], a[124:127], v[92:95]
  ds_read_b64_tr_b16 a[34:35], v232 offset:51200
  s_add_u32 m0, s23, 0x18000
  v_mfma_f32_16x16x32_bf16 v[88:91], a[44:47], a[120:123], v[88:91]
  buffer_load_dwordx4 v229, s[36:39], s21 offen lds
  v_mfma_f32_16x16x32_bf16 v[88:91], a[40:43], a[112:115], v[88:91]
  ds_read_b64_tr_b16 a[44:45], v233 offset:53248
  v_mfma_f32_16x16x32_bf16 v[112:115], a[48:51], a[112:115], v[112:115]
  v_mfma_f32_16x16x32_bf16 v[112:115], a[52:55], a[120:123], v[112:115]
  ds_read_b64_tr_b16 a[46:47], v233 offset:55296
  s_add_u32 m0, s23, 0x18400
  v_mfma_f32_16x16x32_bf16 v[116:119], a[52:55], a[124:127], v[116:119]
  buffer_load_dwordx4 v230, s[36:39], s21 offen lds
  s_bfe_u32 s21, s41, 0x4000c
  s_lshl_b32 s21, s21, 17
  s_add_u32 s21, s21, s20
  v_mfma_f32_16x16x32_bf16 v[116:119], a[48:51], a[116:119], v[116:119]
  ds_read_b64_tr_b16 a[40:41], v233 offset:49152
  v_mfma_f32_16x16x32_bf16 v[208:211], a[48:51], a[96:99], v[208:211]
  v_mfma_f32_16x16x32_bf16 v[208:211], a[52:55], a[104:107], v[208:211]
  ds_read_b64_tr_b16 a[42:43], v233 offset:51200
  s_add_u32 m0, s23, 0x1a000
  v_mfma_f32_16x16x32_bf16 v[212:215], a[52:55], a[108:111], v[212:215]
  buffer_load_dwordx4 v224, s[36:39], s21 offen lds
  v_mfma_f32_16x16x32_bf16 v[212:215], a[48:51], a[100:103], v[212:215]
  ds_read_b64_tr_b16 a[52:53], v234 offset:53248
  v_mfma_f32_16x16x32_bf16 v[220:223], a[56:59], a[100:103], v[220:223]
  v_mfma_f32_16x16x32_bf16 v[220:223], a[60:63], a[108:111], v[220:223]
  ds_read_b64_tr_b16 a[54:55], v234 offset:55296
  s_add_u32 m0, s23, 0x1a400
  v_mfma_f32_16x16x32_bf16 v[216:219], a[60:63], a[104:107], v[216:219]
  buffer_load_dwordx4 v225, s[36:39], s21 offen lds
  v_mfma_f32_16x16x32_bf16 v[216:219], a[56:59], a[96:99], v[216:219]
  ds_read_b64_tr_b16 a[48:49], v234 offset:49152
  v_mfma_f32_16x16x32_bf16 v[124:127], a[56:59], a[116:119], v[124:127]
  v_mfma_f32_16x16x32_bf16 v[124:127], a[60:63], a[124:127], v[124:127]
  ds_read_b64_tr_b16 a[50:51], v234 offset:51200
  s_add_u32 m0, s23, 0x1c000
  v_mfma_f32_16x16x32_bf16 v[120:123], a[60:63], a[120:123], v[120:123]
  buffer_load_dwordx4 v229, s[36:39], s21 offen lds
  v_mfma_f32_16x16x32_bf16 v[120:123], a[56:59], a[112:115], v[120:123]
  ds_read_b64_tr_b16 a[60:61], v235 offset:53248
  s_waitcnt vmcnt(34)
  v_mfma_f32_16x16x32_bf16 v[16:19], a[0:3], a[144:147], v[16:19]
  s_waitcnt vmcnt(11)
  v_cmp_ne_u64 vcc, s[56:57], v[244:245]
  s_nop 1
  s_and_b32 s3, vcc_lo, 0xf
  s_cbranch_scc1 L_sp_c4
L_bk_c4:
  v_mfma_f32_16x16x32_bf16 v[16:19], a[4:7], a[152:155], v[16:19]
  ds_read_b64_tr_b16 a[62:63], v235 offset:55296
  v_mfma_f32_16x16x32_bf16 v[20:23], a[4:7], a[156:159], v[20:23]
  buffer_load_dwordx4 a[224:227], v227, s[12:15], s22 offen offset:0 sc1
  v_mfma_f32_16x16x32_bf16 v[20:23], a[0:3], a[148:151], v[20:23]
  ds_read_b64_tr_b16 a[56:57], v235 offset:49152
  v_mfma_f32_16x16x32_bf16 v[144:147], a[0:3], a[128:131], v[144:147]
  v_mfma_f32_16x16x32_bf16 v[144:147], a[4:7], a[136:139], v[144:147]
  s_barrier
  ds_read_b64_tr_b16 a[58:59], v235 offset:51200
  v_mfma_f32_16x16x32_bf16 v[148:151], a[4:7], a[140:143], v[148:151]
  buffer_load_dwordx4 a[228:231], v227, s[12:15], s22 offen offset:1024 sc1
  v_mfma_f32_16x16x32_bf16 v[148:151], a[0:3], a[132:135], v[148:151]
  ds_read_b64_tr_b16 a[4:5], v232 offset:61440
  v_mfma_f32_16x16x32_bf16 v[156:159], a[8:11], a[132:135], v[156:159]
  v_mfma_f32_16x16x32_bf16 v[156:159], a[12:15], a[140:143], v[156:159]
  ds_read_b64_tr_b16 a[6:7], v232 offset:63488
  v_mfma_f32_16x16x32_bf16 v[152:155], a[12:15], a[136:139], v[152:155]
  v_and_b32 v254, 0x70, v228
  buffer_load_dwordx4 v[96:99], v254, s[32:35], s101 offen
  v_mfma_f32_16x16x32_bf16 v[152:155], a[8:11], a[128:131], v[152:155]
  ds_read_b64_tr_b16 a[0:1], v232 offset:57344
  v_mfma_f32_16x16x32_bf16 v[28:31], a[8:11], a[148:151], v[28:31]
  v_mfma_f32_16x16x32_bf16 v[28:31], a[12:15], a[156:159], v[28:31]
  ds_read_b64_tr_b16 a[2:3], v232 offset:59392
  v_mfma_f32_16x16x32_bf16 v[24:27], a[12:15], a[152:155], v[24:27]
  buffer_load_dwordx4 a[232:235], v227, s[12:15], s22 offen offset:2048 sc1
  v_mfma_f32_16x16x32_bf16 v[24:27], a[8:11], a[144:147], v[24:27]
  ds_read_b64_tr_b16 a[12:13], v233 offset:61440
  s_waitcnt lgkmcnt(8)
  v_mfma_f32_16x16x32_bf16 v[48:51], a[16:19], a[144:147], v[48:51]
  v_mfma_f32_16x16x32_bf16 v[48:51], a[20:23], a[152:155], v[48:51]
  ds_read_b64_tr_b16 a[14:15], v233 offset:63488
  v_mfma_f32_16x16x32_bf16 v[52:55], a[20:23], a[156:159], v[52:55]
  buffer_load_dwordx4 a[236:239], v227, s[12:15], s22 offen offset:3072 sc1
  v_mfma_f32_16x16x32_bf16 v[52:55], a[16:19], a[148:151], v[52:55]
  ds_read_b64_tr_b16 a[8:9], v233 offset:57344
  v_mfma_f32_16x16x32_bf16 v[176:179], a[16:19], a[128:131], v[176:179]
  v_mfma_f32_16x16x32_bf16 v[176:179], a[20:23], a[136:139], v[176:179]
  ds_read_b64_tr_b16 a[10:11], v233 offset:59392
  v_mfma_f32_16x16x32_bf16 v[180:183], a[20:23], a[140:143], v[180:183]
  buffer_load_dwordx4 a[240:243], v226, s[12:15], s22 offen offset:0 sc1
  v_mfma_f32_16x16x32_bf16 v[180:183], a[16:19], a[132:135], v[180:183]
  ds_read_b64_tr_b16 a[20:21], v234 offset:61440
  v_mfma_f32_16x16x32_bf16 v[188:191], a[24:27], a[132:135], v[188:191]
  v_mfma_f32_16x16x32_bf16 v[188:191], a[28:31], a[140:143], v[188:191]
  ds_read_b64_tr_b16 a[22:23], v234 offset:63488
  v_mfma_f32_16x16x32_bf16 v[184:187], a[28:31], a[136:139], v[184:187]
  buffer_load_dwordx4 a[244:247], v226, s[12:15], s22 offen offset:1024 sc1
  v_mfma_f32_16x16x32_bf16 v[184:187], a[24:27], a[128:131], v[184:187]
  ds_read_b64_tr_b16 a[16:17], v234 offset:57344
  v_mfma_f32_16x16x32_bf16 v[60:63], a[24:27], a[148:151], v[60:63]
  v_mfma_f32_16x16x32_bf16 v[60:63], a[28:31], a[156:159], v[60:63]
  ds_read_b64_tr_b16 a[18:19], v234 offset:59392
  v_mfma_f32_16x16x32_bf16 v[56:59], a[28:31], a[152:155], v[56:59]
  buffer_load_dwordx4 a[248:251], v226, s[12:15], s22 offen offset:2048 sc1
  v_mfma_f32_16x16x32_bf16 v[56:59], a[24:27], a[144:147], v[56:59]
  ds_read_b64_tr_b16 a[28:29], v235 offset:61440
  v_mfma_f32_16x16x32_bf16 v[80:83], a[32:35], a[144:147], v[80:83]
  v_mfma_f32_16x16x32_bf16 v[80:83], a[36:39], a[152:155], v[80:83]
  ds_read_b64_tr_b16 a[30:31], v235 offset:63488
  v_mfma_f32_16x16x32_bf16 v[84:87], a[36:39], a[156:159], v[84:87]
  buffer_load_dwordx4 a[252:255], v226, s[12:15], s22 offen offset:3072 sc1
  s_bfe_u32 s22, s41, 0x40004
  s_lshl_b32 s22, s22, 12
  s_add_u32 s22, s22, s42
  v_mfma_f32_16x16x32_bf16 v[84:87], a[32:35], a[148:151], v[84:87]
  ds_read_b64_tr_b16 a[24:25], v235 offset:57344
  v_mfma_f32_16x16x32_bf16 v[192:195], a[32:35], a[128:131], v[192:195]
  v_mfma_f32_16x16x32_bf16 v[192:195], a[36:39], a[136:139], v[192:195]
  ds_read_b64_tr_b16 a[26:27], v235 offset:59392
  v_mfma_f32_16x16x32_bf16 v[196:199], a[36:39], a[140:143], v[196:199]
  buffer_load_dwordx4 v[0:3], v227, s[12:15], s22 offen offset:0 sc1
  v_mfma_f32_16x16x32_bf16 v[196:199], a[32:35], a[132:135], v[196:199]
  ds_read_b64_tr_b16 a[36:37], v236 offset:4096
  v_mfma_f32_16x16x32_bf16 v[204:207], a[40:43], a[132:135], v[204:207]
  v_mfma_f32_16x16x32_bf16 v[204:207], a[44:47], a[140:143], v[204:207]
  ds_read_b64_tr_b16 a[38:39], v236 offset:6144
  v_mfma_f32_16x16x32_bf16 v[200:203], a[44:47], a[136:139], v[200:203]
  buffer_load_dwordx4 v[4:7], v227, s[12:15], s22 offen offset:1024 sc1
  v_mfma_f32_16x16x32_bf16 v[200:203], a[40:43], a[128:131], v[200:203]
  ds_read_b64_tr_b16 a[32:33], v236 offset:0
  v_mfma_f32_16x16x32_bf16 v[92:95], a[40:43], a[148:151], v[92:95]
  v_mfma_f32_16x16x32_bf16 v[92:95], a[44:47], a[156:159], v[92:95]
  ds_read_b64_tr_b16 a[34:35], v236 offset:2048
  v_mfma_f32_16x16x32_bf16 v[88:91], a[44:47], a[152:155], v[88:91]
  buffer_load_dwordx4 v[8:11], v227, s[12:15], s22 offen offset:2048 sc1
  v_mfma_f32_16x16x32_bf16 v[88:91], a[40:43], a[144:147], v[88:91]
  ds_read_b64_tr_b16 a[44:45], v237 offset:4096
  v_mfma_f32_16x16x32_bf16 v[112:115], a[48:51], a[144:147], v[112:115]
  v_mfma_f32_16x16x32_bf16 v[112:115], a[52:55], a[152:155], v[112:115]
  ds_read_b64_tr_b16 a[46:47], v237 offset:6144
  v_mfma_f32_16x16x32_bf16 v[116:119], a[52:55], a[156:159], v[116:119]
  buffer_load_dwordx4 v[12:15], v227, s[12:15], s22 offen offset:3072 sc1
  v_mfma_f32_16x16x32_bf16 v[116:119], a[48:51], a[148:151], v[116:119]
  ds_read_b64_tr_b16 a[40:41], v237 offset:0
  v_mfma_f32_16x16x32_bf16 v[208:211], a[48:51], a[128:131], v[208:211]
  v_mfma_f32_16x16x32_bf16 v[208:211], a[52:55], a[136:139], v[208:211]
  ds_read_b64_tr_b16 a[42:43], v237 offset:2048
  v_mfma_f32_16x16x32_bf16 v[212:215], a[52:55], a[140:143], v[212:215]
  buffer_load_dwordx4 v[32:35], v226, s[12:15], s22 offen offset:0 sc1
  v_mfma_f32_16x16x32_bf16 v[212:215], a[48:51], a[132:135], v[212:215]
  ds_read_b64_tr_b16 a[52:53], v238 offset:4096
  s_waitcnt lgkmcnt(8)
  v_mfma_f32_16x16x32_bf16 v[220:223], a[56:59], a[132:135], v[220:223]
  v_mfma_f32_16x16x32_bf16 v[220:223], a[60:63], a[140:143], v[220:223]
  ds_read_b64_tr_b16 a[54:55], v238 offset:6144
  v_mfma_f32_16x16x32_bf16 v[216:219], a[60:63], a[136:139], v[216:219]
  buffer_load_dwordx4 v[36:39], v226, s[12:15], s22 offen offset:1024 sc1
  v_mfma_f32_16x16x32_bf16 v[216:219], a[56:59], a[128:131], v[216:219]
  ds_read_b64_tr_b16 a[48:49], v238 offset:0
  v_mfma_f32_16x16x32_bf16 v[124:127], a[56:59], a[148:151], v[124:127]
  v_mfma_f32_16x16x32_bf16 v[124:127], a[60:63], a[156:159], v[124:127]
  ds_read_b64_tr_b16 a[50:51], v238 offset:2048
  v_mfma_f32_16x16x32_bf16 v[120:123], a[60:63], a[152:155], v[120:123]
  buffer_load_dwordx4 v[40:43], v226, s[12:15], s22 offen offset:2048 sc1
  v_mfma_f32_16x16x32_bf16 v[120:123], a[56:59], a[144:147], v[120:123]
  ds_read_b64_tr_b16 a[60:61], v239 offset:4096
  v_mfma_f32_16x16x32_bf16 v[16:19], a[0:3], a[176:179], v[16:19]
  v_mfma_f32_16x16x32_bf16 v[16:19], a[4:7], a[184:187], v[16:19]
  ds_read_b64_tr_b16 a[62:63], v239 offset:6144
  v_mfma_f32_16x16x32_bf16 v[20:23], a[4:7], a[188:191], v[20:23]
  buffer_load_dwordx4 v[44:47], v226, s[12:15], s22 offen offset:3072 sc1
  s_bfe_u32 s22, s41, 0x40008
  s_lshl_b32 s22, s22, 12
  s_add_u32 s22, s22, s42
  v_mfma_f32_16x16x32_bf16 v[20:23], a[0:3], a[180:183], v[20:23]
  ds_read_b64_tr_b16 a[56:57], v239 offset:0
  v_mfma_f32_16x16x32_bf16 v[144:147], a[0:3], a[160:163], v[144:147]
  v_mfma_f32_16x16x32_bf16 v[144:147], a[4:7], a[168:171], v[144:147]
  s_barrier
  ds_read_b64_tr_b16 a[58:59], v239 offset:2048
  v_mfma_f32_16x16x32_bf16 v[148:151], a[4:7], a[172:175], v[148:151]
  buffer_load_dwordx4 a[64:67], v227, s[12:15], s22 offen offset:0 sc1
  v_mfma_f32_16x16x32_bf16 v[148:151], a[0:3], a[164:167], v[148:151]
  ds_read_b64_tr_b16 a[4:5], v236 offset:12288
  v_mfma_f32_16x16x32_bf16 v[156:159], a[8:11], a[164:167], v[156:159]
  v_mfma_f32_16x16x32_bf16 v[156:159], a[12:15], a[172:175], v[156:159]
  ds_read_b64_tr_b16 a[6:7], v236 offset:14336
  v_mfma_f32_16x16x32_bf16 v[152:155], a[12:15], a[168:171], v[152:155]
  buffer_load_dwordx4 a[68:71], v227, s[12:15], s22 offen offset:1024 sc1
  v_mfma_f32_16x16x32_bf16 v[152:155], a[8:11], a[160:163], v[152:155]
  ds_read_b64_tr_b16 a[0:1], v236 offset:8192
  v_mfma_f32_16x16x32_bf16 v[28:31], a[8:11], a[180:183], v[28:31]
  v_mfma_f32_16x16x32_bf16 v[28:31], a[12:15], a[188:191], v[28:31]
  ds_read_b64_tr_b16 a[2:3], v236 offset:10240
  v_mfma_f32_16x16x32_bf16 v[24:27], a[12:15], a[184:187], v[24:27]
  buffer_load_dwordx4 a[72:75], v227, s[12:15], s22 offen offset:2048 sc1
  v_mfma_f32_16x16x32_bf16 v[24:27], a[8:11], a[176:179], v[24:27]
  ds_read_b64_tr_b16 a[12:13], v237 offset:12288
  v_mfma_f32_16x16x32_bf16 v[48:51], a[16:19], a[176:179], v[48:51]
  v_mfma_f32_16x16x32_bf16 v[48:51], a[20:23], a[184:187], v[48:51]
  ds_read_b64_tr_b16 a[14:15], v237 offset:14336
  v_mfma_f32_16x16x32_bf16 v[52:55], a[20:23], a[188:191], v[52:55]
  s_mov_b32 exec_lo, 0xf0000
  s_mov_b32 exec_hi, 0x0
  buffer_load_dwordx2 v[244:245], v231, s[16:19], 0 offen offset:16 sc1
  s_mov_b64 exec, -1
  v_mfma_f32_16x16x32_bf16 v[52:55], a[16:19], a[180:183], v[52:55]
  ds_read_b64_tr_b16 a[8:9], v237 offset:8192
  v_mfma_f32_16x16x32_bf16 v[176:179], a[16:19], a[160:163], v[176:179]
  v_mfma_f32_16x16x32_bf16 v[176:179], a[20:23], a[168:171], v[176:179]
  ds_read_b64_tr_b16 a[10:11], v237 offset:10240
  v_mfma_f32_16x16x32_bf16 v[180:183], a[20:23], a[172:175], v[180:183]
  buffer_load_dwordx4 a[76:79], v227, s[12:15], s22 offen offset:3072 sc1
  v_mfma_f32_16x16x32_bf16 v[180:183], a[16:19], a[164:167], v[180:183]
  ds_read_b64_tr_b16 a[20:21], v238 offset:12288
  v_mfma_f32_16x16x32_bf16 v[188:191], a[24:27], a[164:167], v[188:191]
  v_mfma_f32_16x16x32_bf16 v[188:191], a[28:31], a[172:175], v[188:191]
  ds_read_b64_tr_b16 a[22:23], v238 offset:14336
  v_mfma_f32_16x16x32_bf16 v[184:187], a[28:31], a[168:171], v[184:187]
  buffer_load_dwordx4 a[80:83], v226, s[12:15], s22 offen offset:0 sc1
  v_mfma_f32_16x16x32_bf16 v[184:187], a[24:27], a[160:163], v[184:187]
  ds_read_b64_tr_b16 a[16:17], v238 offset:8192
  v_mfma_f32_16x16x32_bf16 v[60:63], a[24:27], a[180:183], v[60:63]
  v_mfma_f32_16x16x32_bf16 v[60:63], a[28:31], a[188:191], v[60:63]
  ds_read_b64_tr_b16 a[18:19], v238 offset:10240
  v_mfma_f32_16x16x32_bf16 v[56:59], a[28:31], a[184:187], v[56:59]
  buffer_load_dwordx4 a[84:87], v226, s[12:15], s22 offen offset:1024 sc1
  v_mfma_f32_16x16x32_bf16 v[56:59], a[24:27], a[176:179], v[56:59]
  ds_read_b64_tr_b16 a[28:29], v239 offset:12288
  s_waitcnt lgkmcnt(8)
  v_mfma_f32_16x16x32_bf16 v[80:83], a[32:35], a[176:179], v[80:83]
  v_mfma_f32_16x16x32_bf16 v[80:83], a[36:39], a[184:187], v[80:83]
  ds_read_b64_tr_b16 a[30:31], v239 offset:14336
  v_mfma_f32_16x16x32_bf16 v[84:87], a[36:39], a[188:191], v[84:87]
  buffer_load_dwordx4 a[88:91], v226, s[12:15], s22 offen offset:2048 sc1
  v_mfma_f32_16x16x32_bf16 v[84:87], a[32:35], a[180:183], v[84:87]
  ds_read_b64_tr_b16 a[24:25], v239 offset:8192
  v_mfma_f32_16x16x32_bf16 v[192:195], a[32:35], a[160:163], v[192:195]
  v_mfma_f32_16x16x32_bf16 v[192:195], a[36:39], a[168:171], v[192:195]
  ds_read_b64_tr_b16 a[26:27], v239 offset:10240
  v_mfma_f32_16x16x32_bf16 v[196:199], a[36:39], a[172:175], v[196:199]
  buffer_load_dwordx4 a[92:95], v226, s[12:15], s22 offen offset:3072 sc1
  s_bfe_u32 s22, s41, 0x4000c
  s_lshl_b32 s22, s22, 12
  s_add_u32 s22, s22, s42
  v_mfma_f32_16x16x32_bf16 v[196:199], a[32:35], a[164:167], v[196:199]
  ds_read_b64_tr_b16 a[36:37], v236 offset:20480
  v_mfma_f32_16x16x32_bf16 v[204:207], a[40:43], a[164:167], v[204:207]
  v_mfma_f32_16x16x32_bf16 v[204:207], a[44:47], a[172:175], v[204:207]
  ds_read_b64_tr_b16 a[38:39], v236 offset:22528
  s_add_u32 m0, s23, 0x1c400
  v_mfma_f32_16x16x32_bf16 v[200:203], a[44:47], a[168:171], v[200:203]
  buffer_load_dwordx4 v230, s[36:39], s21 offen lds
  s_add_u32 s21, s20, 0x180000
  v_mfma_f32_16x16x32_bf16 v[200:203], a[40:43], a[160:163], v[200:203]
  ds_read_b64_tr_b16 a[32:33], v236 offset:16384
  v_mfma_f32_16x16x32_bf16 v[92:95], a[40:43], a[180:183], v[92:95]
  v_mfma_f32_16x16x32_bf16 v[92:95], a[44:47], a[188:191], v[92:95]
  ds_read_b64_tr_b16 a[34:35], v236 offset:18432
  v_mfma_f32_16x16x32_bf16 v[88:91], a[44:47], a[184:187], v[88:91]
  buffer_load_dwordx4 a[96:99], v227, s[12:15], s22 offen offset:0 sc1
  v_mfma_f32_16x16x32_bf16 v[88:91], a[40:43], a[176:179], v[88:91]
  ds_read_b64_tr_b16 a[44:45], v237 offset:20480
  v_mfma_f32_16x16x32_bf16 v[112:115], a[48:51], a[176:179], v[112:115]
  v_mfma_f32_16x16x32_bf16 v[112:115], a[52:55], a[184:187], v[112:115]
  ds_read_b64_tr_b16 a[46:47], v237 offset:22528
  v_mfma_f32_16x16x32_bf16 v[116:119], a[52:55], a[188:191], v[116:119]
  buffer_load_dwordx4 a[100:103], v227, s[12:15], s22 offen offset:1024 sc1
  v_mfma_f32_16x16x32_bf16 v[116:119], a[48:51], a[180:183], v[116:119]
  ds_read_b64_tr_b16 a[40:41], v237 offset:16384
  v_mfma_f32_16x16x32_bf16 v[208:211], a[48:51], a[160:163], v[208:211]
  v_mfma_f32_16x16x32_bf16 v[208:211], a[52:55], a[168:171], v[208:211]
  ds_read_b64_tr_b16 a[42:43], v237 offset:18432
  v_mfma_f32_16x16x32_bf16 v[212:215], a[52:55], a[172:175], v[212:215]
  buffer_load_dwordx4 a[104:107], v227, s[12:15], s22 offen offset:2048 sc1
  v_mfma_f32_16x16x32_bf16 v[212:215], a[48:51], a[164:167], v[212:215]
  ds_read_b64_tr_b16 a[52:53], v238 offset:20480
  v_mfma_f32_16x16x32_bf16 v[220:223], a[56:59], a[164:167], v[220:223]
  v_mfma_f32_16x16x32_bf16 v[220:223], a[60:63], a[172:175], v[220:223]
  ds_read_b64_tr_b16 a[54:55], v238 offset:22528
  v_mfma_f32_16x16x32_bf16 v[216:219], a[60:63], a[168:171], v[216:219]
  buffer_load_dwordx4 a[108:111], v227, s[12:15], s22 offen offset:3072 sc1
  v_mfma_f32_16x16x32_bf16 v[216:219], a[56:59], a[160:163], v[216:219]
  ds_read_b64_tr_b16 a[48:49], v238 offset:16384
  v_mfma_f32_16x16x32_bf16 v[124:127], a[56:59], a[180:183], v[124:127]
  v_mfma_f32_16x16x32_bf16 v[124:127], a[60:63], a[188:191], v[124:127]
  ds_read_b64_tr_b16 a[50:51], v238 offset:18432
  v_mfma_f32_16x16x32_bf16 v[120:123], a[60:63], a[184:187], v[120:123]
  buffer_load_dwordx4 a[112:115], v226, s[12:15], s22 offen offset:0 sc1
  v_mfma_f32_16x16x32_bf16 v[120:123], a[56:59], a[176:179], v[120:123]
  ds_read_b64_tr_b16 a[60:61], v239 offset:20480
  v_mfma_f32_16x16x32_bf16 v[16:19], a[0:3], a[208:211], v[16:19]
  s_waitcnt vmcnt(11)
  v_cmp_ne_u64 vcc, s[56:57], v[244:245]
  s_nop 1
  s_and_b32 s3, vcc_lo, 0xf0000
  s_cbranch_scc1 L_sp_c5
L_bk_c5:
  v_mfma_f32_16x16x32_bf16 v[16:19], a[4:7], a[216:219], v[16:19]
  ds_read_b64_tr_b16 a[62:63], v239 offset:22528
  v_mfma_f32_16x16x32_bf16 v[20:23], a[4:7], a[220:223], v[20:23]
  buffer_load_dwordx4 a[116:119], v226, s[12:15], s22 offen offset:1024 sc1
  v_mfma_f32_16x16x32_bf16 v[20:23], a[0:3], a[212:215], v[20:23]
  ds_read_b64_tr_b16 a[56:57], v239 offset:16384
  v_mfma_f32_16x16x32_bf16 v[144:147], a[0:3], a[192:195], v[144:147]
  v_mfma_f32_16x16x32_bf16 v[144:147], a[4:7], a[200:203], v[144:147]
  s_barrier
  ds_read_b64_tr_b16 a[58:59], v239 offset:18432
  v_mfma_f32_16x16x32_bf16 v[148:151], a[4:7], a[204:207], v[148:151]
  buffer_load_dwordx4 a[120:123], v226, s[12:15], s22 offen offset:2048 sc1
  v_mfma_f32_16x16x32_bf16 v[148:151], a[0:3], a[196:199], v[148:151]
  ds_read_b64_tr_b16 a[4:5], v232 offset:12288
  s_waitcnt lgkmcnt(8)
  v_mfma_f32_16x16x32_bf16 v[156:159], a[8:11], a[196:199], v[156:159]
  v_mfma_f32_16x16x32_bf16 v[156:159], a[12:15], a[204:207], v[156:159]
  ds_read_b64_tr_b16 a[6:7], v232 offset:14336
  v_mfma_f32_16x16x32_bf16 v[152:155], a[12:15], a[200:203], v[152:155]
  buffer_load_dwordx4 a[124:127], v226, s[12:15], s22 offen offset:3072 sc1
  s_add_u32 s22, s42, 0xc000
  v_mfma_f32_16x16x32_bf16 v[152:155], a[8:11], a[192:195], v[152:155]
  ds_read_b64_tr_b16 a[0:1], v232 offset:8192
  v_mfma_f32_16x16x32_bf16 v[28:31], a[8:11], a[212:215], v[28:31]
  v_mfma_f32_16x16x32_bf16 v[28:31], a[12:15], a[220:223], v[28:31]
  ds_read_b64_tr_b16 a[2:3], v232 offset:10240
  s_add_u32 m0, s23, 0x1e000
  v_mfma_f32_16x16x32_bf16 v[24:27], a[12:15], a[216:219], v[24:27]
  buffer_load_dwordx4 v224, s[36:39], s21 offen lds
  v_mfma_f32_16x16x32_bf16 v[24:27], a[8:11], a[208:211], v[24:27]
  ds_read_b64_tr_b16 a[12:13], v233 offset:12288
  v_mfma_f32_16x16x32_bf16 v[48:51], a[16:19], a[208:211], v[48:51]
  v_mfma_f32_16x16x32_bf16 v[48:51], a[20:23], a[216:219], v[48:51]
  ds_read_b64_tr_b16 a[14:15], v233 offset:14336
  s_add_u32 m0, s23, 0x1e400
  v_mfma_f32_16x16x32_bf16 v[52:55], a[20:23], a[220:223], v[52:55]
  buffer_load_dwordx4 v225, s[36:39], s21 offen lds
  v_mfma_f32_16x16x32_bf16 v[52:55], a[16:19], a[212:215], v[52:55]
  ds_read_b64_tr_b16 a[8:9], v233 offset:8192
  v_mfma_f32_16x16x32_bf16 v[176:179], a[16:19], a[192:195], v[176:179]
  v_mfma_f32_16x16x32_bf16 v[176:179], a[20:23], a[200:203], v[176:179]
  ds_read_b64_tr_b16 a[10:11], v233 offset:10240
  s_add_u32 m0, s23, 0x20000
  v_mfma_f32_16x16x32_bf16 v[180:183], a[20:23], a[204:207], v[180:183]
  buffer_load_dwordx4 v229, s[36:39], s21 offen lds
  v_mfma_f32_16x16x32_bf16 v[180:183], a[16:19], a[196:199], v[180:183]
  ds_read_b64_tr_b16 a[20:21], v234 offset:12288
  v_mfma_f32_16x16x32_bf16 v[188:191], a[24:27], a[196:199], v[188:191]
  v_mfma_f32_16x16x32_bf16 v[188:191], a[28:31], a[204:207], v[188:191]
  ds_read_b64_tr_b16 a[22:23], v234 offset:14336
  s_add_u32 m0, s23, 0x20400
  v_mfma_f32_16x16x32_bf16 v[184:187], a[28:31], a[200:203], v[184:187]
  buffer_load_dwordx4 v230, s[36:39], s21 offen lds
  s_add_u32 s21, s20, 0x1a0000
  v_mfma_f32_16x16x32_bf16 v[184:187], a[24:27], a[192:195], v[184:187]
  ds_read_b64_tr_b16 a[16:17], v234 offset:8192
  v_mfma_f32_16x16x32_bf16 v[60:63], a[24:27], a[212:215], v[60:63]
  v_mfma_f32_16x16x32_bf16 v[60:63], a[28:31], a[220:223], v[60:63]
  ds_read_b64_tr_b16 a[18:19], v234 offset:10240
  v_mfma_f32_16x16x32_bf16 v[56:59], a[28:31], a[216:219], v[56:59]
  buffer_load_dwordx4 a[128:131], v227, s[12:15], s22 offen offset:0 sc1
  v_mfma_f32_16x16x32_bf16 v[56:59], a[24:27], a[208:211], v[56:59]
  ds_read_b64_tr_b16 a[28:29], v235 offset:12288
  v_mfma_f32_16x16x32_bf16 v[80:83], a[32:35], a[208:211], v[80:83]
  v_mfma_f32_16x16x32_bf16 v[80:83], a[36:39], a[216:219], v[80:83]
  ds_read_b64_tr_b16 a[30:31], v235 offset:14336
  v_mfma_f32_16x16x32_bf16 v[84:87], a[36:39], a[220:223], v[84:87]
  buffer_load_dwordx4 a[132:135], v227, s[12:15], s22 offen offset:1024 sc1
  v_mfma_f32_16x16x32_bf16 v[84:87], a[32:35], a[212:215], v[84:87]
  ds_read_b64_tr_b16 a[24:25], v235 offset:8192
  v_mfma_f32_16x16x32_bf16 v[192:195], a[32:35], a[192:195], v[192:195]
  v_mfma_f32_16x16x32_bf16 v[192:195], a[36:39], a[200:203], v[192:195]
  ds_read_b64_tr_b16 a[26:27], v235 offset:10240
  v_mfma_f32_16x16x32_bf16 v[196:199], a[36:39], a[204:207], v[196:199]
  buffer_load_dwordx4 a[136:139], v227, s[12:15], s22 offen offset:2048 sc1
  v_mfma_f32_16x16x32_bf16 v[196:199], a[32:35], a[196:199], v[196:199]
  ds_read_b64_tr_b16 a[36:37], v232 offset:4096
  v_mfma_f32_16x16x32_bf16 v[204:207], a[40:43], a[196:199], v[204:207]
  v_mfma_f32_16x16x32_bf16 v[204:207], a[44:47], a[204:207], v[204:207]
  ds_read_b64_tr_b16 a[38:39], v232 offset:6144
  v_mfma_f32_16x16x32_bf16 v[200:203], a[44:47], a[200:203], v[200:203]
  buffer_load_dwordx4 a[140:143], v227, s[12:15], s22 offen offset:3072 sc1
  v_mfma_f32_16x16x32_bf16 v[200:203], a[40:43], a[192:195], v[200:203]
  ds_read_b64_tr_b16 a[32:33], v232 offset:0
  v_mfma_f32_16x16x32_bf16 v[92:95], a[40:43], a[212:215], v[92:95]
  v_mfma_f32_16x16x32_bf16 v[92:95], a[44:47], a[220:223], v[92:95]
  ds_read_b64_tr_b16 a[34:35], v232 offset:2048
  v_mfma_f32_16x16x32_bf16 v[88:91], a[44:47], a[216:219], v[88:91]
  buffer_load_dwordx4 a[144:147], v226, s[12:15], s22 offen offset:0 sc1
  v_mfma_f32_16x16x32_bf16 v[88:91], a[40:43], a[208:211], v[88:91]
  ds_read_b64_tr_b16 a[44:45], v233 offset:4096
  s_waitcnt lgkmcnt(8)
  v_mfma_f32_16x16x32_bf16 v[112:115], a[48:51], a[208:211], v[112:115]
  v_mfma_f32_16x16x32_bf16 v[112:115], a[52:55], a[216:219], v[112:115]
  ds_read_b64_tr_b16 a[46:47], v233 offset:6144
  v_mfma_f32_16x16x32_bf16 v[116:119], a[52:55], a[220:223], v[116:119]
  buffer_load_dwordx4 a[148:151], v226, s[12:15], s22 offen offset:1024 sc1
  v_mfma_f32_16x16x32_bf16 v[116:119], a[48:51], a[212:215], v[116:119]
  ds_read_b64_tr_b16 a[40:41], v233 offset:0
  v_mfma_f32_16x16x32_bf16 v[208:211], a[48:51], a[192:195], v[208:211]
  v_mfma_f32_16x16x32_bf16 v[208:211], a[52:55], a[200:203], v[208:211]
  ds_read_b64_tr_b16 a[42:43], v233 offset:2048
  v_mfma_f32_16x16x32_bf16 v[212:215], a[52:55], a[204:207], v[212:215]
  buffer_load_dwordx4 a[152:155], v226, s[12:15], s22 offen offset:2048 sc1
  v_mfma_f32_16x16x32_bf16 v[212:215], a[48:51], a[196:199], v[212:215]
  ds_read_b64_tr_b16 a[52:53], v234 offset:4096
  v_mfma_f32_16x16x32_bf16 v[220:223], a[56:59], a[196:199], v[220:223]
  v_mfma_f32_16x16x32_bf16 v[220:223], a[60:63], a[204:207], v[220:223]
  ds_read_b64_tr_b16 a[54:55], v234 offset:6144
  v_mfma_f32_16x16x32_bf16 v[216:219], a[60:63], a[200:203], v[216:219]
  buffer_load_dwordx4 a[156:159], v226, s[12:15], s22 offen offset:3072 sc1
  s_add_u32 s22, s42, 0xd000
  v_mfma_f32_16x16x32_bf16 v[216:219], a[56:59], a[192:195], v[216:219]
  ds_read_b64_tr_b16 a[48:49], v234 offset:0
  v_mfma_f32_16x16x32_bf16 v[124:127], a[56:59], a[212:215], v[124:127]
  v_mfma_f32_16x16x32_bf16 v[124:127], a[60:63], a[220:223], v[124:127]
  ds_read_b64_tr_b16 a[50:51], v234 offset:2048
  s_add_u32 m0, s23, 0x22000
  v_mfma_f32_16x16x32_bf16 v[120:123], a[60:63], a[216:219], v[120:123]
  buffer_load_dwordx4 v224, s[36:39], s21 offen lds
  v_mfma_f32_16x16x32_bf16 v[120:123], a[56:59], a[208:211], v[120:123]
  ds_read_b64_tr_b16 a[60:61], v235 offset:4096
  v_mfma_f32_16x16x32_bf16 v[80:83], a[0:3], a[240:243], v[80:83]
  v_mfma_f32_16x16x32_bf16 v[80:83], a[4:7], a[248:251], v[80:83]
  ds_read_b64_tr_b16 a[62:63], v235 offset:6144
  s_add_u32 m0, s23, 0x22400
  v_mfma_f32_16x16x32_bf16 v[84:87], a[4:7], a[252:255], v[84:87]
  buffer_load_dwordx4 v225, s[36:39], s21 offen lds
  v_mfma_f32_16x16x32_bf16 v[84:87], a[0:3], a[244:247], v[84:87]
  ds_read_b64_tr_b16 a[56:57], v235 offset:0
  v_mfma_f32_16x16x32_bf16 v[192:195], a[0:3], a[224:227], v[192:195]
  v_mfma_f32_16x16x32_bf16 v[192:195], a[4:7], a[232:235], v[192:195]
  s_barrier
  ds_read_b64_tr_b16 a[58:59], v235 offset:2048
  s_add_u32 m0, s23, 0x24000
  v_mfma_f32_16x16x32_bf16 v[196:199], a[4:7], a[236:239], v[196:199]
  buffer_load_dwordx4 v229, s[36:39], s21 offen lds
  v_mfma_f32_16x16x32_bf16 v[196:199], a[0:3], a[228:231], v[196:199]
  ds_read_b64_tr_b16 a[4:5], v232 offset:28672
  v_mfma_f32_16x16x32_bf16 v[204:207], a[8:11], a[228:231], v[204:207]
  v_mfma_f32_16x16x32_bf16 v[204:207], a[12:15], a[236:239], v[204:207]
  ds_read_b64_tr_b16 a[6:7], v232 offset:30720
  v_mfma_f32_16x16x32_bf16 v[200:203], a[12:15], a[232:235], v[200:203]
  s_lshl_b32 s60, s43, 7
  s_add_u32 s60, s60, 0x20000
  v_bfe_u32 v254, v228, 4, 4
  v_lshlrev_b32 v254, 2, v254
  buffer_load_dword v108, v254, s[16:19], s60 offen offset:0 sc1
  v_mfma_f32_16x16x32_bf16 v[200:203], a[8:11], a[224:227], v[200:203]
  ds_read_b64_tr_b16 a[0:1], v232 offset:24576
  v_mfma_f32_16x16x32_bf16 v[92:95], a[8:11], a[244:247], v[92:95]
  v_mfma_f32_16x16x32_bf16 v[92:95], a[12:15], a[252:255], v[92:95]
  ds_read_b64_tr_b16 a[2:3], v232 offset:26624
  v_mfma_f32_16x16x32_bf16 v[88:91], a[12:15], a[248:251], v[88:91]
  s_lshl_b32 s60, s43, 7
  s_add_u32 s60, s60, 0x20000
  v_bfe_u32 v254, v228, 4, 4
  v_lshlrev_b32 v254, 2, v254
  buffer_load_dword v109, v254, s[16:19], s60 offen offset:64 sc1
  v_mfma_f32_16x16x32_bf16 v[88:91], a[8:11], a[240:243], v[88:91]
  ds_read_b64_tr_b16 a[12:13], v233 offset:28672
  v_mfma_f32_16x16x32_bf16 v[112:115], a[16:19], a[240:243], v[112:115]
  v_mfma_f32_16x16x32_bf16 v[112:115], a[20:23], a[248:251], v[112:115]
  ds_read_b64_tr_b16 a[14:15], v233 offset:30720
  s_add_u32 m0, s23, 0x24400
  v_mfma_f32_16x16x32_bf16 v[116:119], a[20:23], a[252:255], v[116:119]
  buffer_load_dwordx4 v230, s[36:39], s21 offen lds
  s_bfe_u32 s21, s2, 0x20001
  s_lshl_b32 s21, s21, 19
  v_mfma_f32_16x16x32_bf16 v[116:119], a[16:19], a[244:247], v[116:119]
  ds_read_b64_tr_b16 a[8:9], v233 offset:24576
  v_mfma_f32_16x16x32_bf16 v[208:211], a[16:19], a[224:227], v[208:211]
  v_mfma_f32_16x16x32_bf16 v[208:211], a[20:23], a[232:235], v[208:211]
  ds_read_b64_tr_b16 a[10:11], v233 offset:26624
  v_mfma_f32_16x16x32_bf16 v[212:215], a[20:23], a[236:239], v[212:215]
  buffer_load_dwordx4 a[160:163], v227, s[12:15], s22 offen offset:0 sc1
  v_mfma_f32_16x16x32_bf16 v[212:215], a[16:19], a[228:231], v[212:215]
  ds_read_b64_tr_b16 a[20:21], v234 offset:28672
  s_waitcnt lgkmcnt(8)
  v_mfma_f32_16x16x32_bf16 v[220:223], a[24:27], a[228:231], v[220:223]
  v_mfma_f32_16x16x32_bf16 v[220:223], a[28:31], a[236:239], v[220:223]
  ds_read_b64_tr_b16 a[22:23], v234 offset:30720
  v_mfma_f32_16x16x32_bf16 v[216:219], a[28:31], a[232:235], v[216:219]
  buffer_load_dwordx4 a[164:167], v227, s[12:15], s22 offen offset:1024 sc1
  v_mfma_f32_16x16x32_bf16 v[216:219], a[24:27], a[224:227], v[216:219]
  ds_read_b64_tr_b16 a[16:17], v234 offset:24576
  v_mfma_f32_16x16x32_bf16 v[124:127], a[24:27], a[244:247], v[124:127]
  v_mfma_f32_16x16x32_bf16 v[124:127], a[28:31], a[252:255], v[124:127]
  ds_read_b64_tr_b16 a[18:19], v234 offset:26624
  v_mfma_f32_16x16x32_bf16 v[120:123], a[28:31], a[248:251], v[120:123]
  buffer_load_dwordx4 a[168:171], v227, s[12:15], s22 offen offset:2048 sc1
  v_mfma_f32_16x16x32_bf16 v[120:123], a[24:27], a[240:243], v[120:123]
  ds_read_b64_tr_b16 a[28:29], v235 offset:28672
  v_mfma_f32_16x16x32_bf16 v[144:147], a[32:35], a[224:227], v[144:147]
  ds_read_b64_tr_b16 a[30:31], v235 offset:30720
  v_mfma_f32_16x16x32_bf16 v[144:147], a[36:39], a[232:235], v[144:147]
  ds_read_b64_tr_b16 a[24:25], v235 offset:24576
  v_mfma_f32_16x16x32_bf16 v[148:151], a[36:39], a[236:239], v[148:151]
  ds_read_b64_tr_b16 a[26:27], v235 offset:26624
  buffer_load_dwordx4 a[172:175], v227, s[12:15], s22 offen offset:3072 sc1
  v_mfma_f32_16x16x32_bf16 v[148:151], a[32:35], a[228:231], v[148:151]
  ds_read_b64_tr_b16 a[36:37], v232 offset:20480
  v_mfma_f32_16x16x32_bf16 v[156:159], a[40:43], a[228:231], v[156:159]
  ds_read_b64_tr_b16 a[38:39], v232 offset:22528
  v_mfma_f32_16x16x32_bf16 v[156:159], a[44:47], a[236:239], v[156:159]
  ds_read_b64_tr_b16 a[32:33], v232 offset:16384
  v_mfma_f32_16x16x32_bf16 v[152:155], a[44:47], a[232:235], v[152:155]
  ds_read_b64_tr_b16 a[34:35], v232 offset:18432
  buffer_load_dwordx4 a[176:179], v226, s[12:15], s22 offen offset:0 sc1
  v_mfma_f32_16x16x32_bf16 v[152:155], a[40:43], a[224:227], v[152:155]
  ds_read_b64_tr_b16 a[44:45], v233 offset:20480
  v_mfma_f32_16x16x32_bf16 v[176:179], a[48:51], a[224:227], v[176:179]
  ds_read_b64_tr_b16 a[46:47], v233 offset:22528
  v_mfma_f32_16x16x32_bf16 v[176:179], a[52:55], a[232:235], v[176:179]
  ds_read_b64_tr_b16 a[40:41], v233 offset:16384
  v_mfma_f32_16x16x32_bf16 v[180:183], a[52:55], a[236:239], v[180:183]
  ds_read_b64_tr_b16 a[42:43], v233 offset:18432
  buffer_load_dwordx4 a[180:183], v226, s[12:15], s22 offen offset:1024 sc1
  v_mfma_f32_16x16x32_bf16 v[180:183], a[48:51], a[228:231], v[180:183]
  ds_read_b64_tr_b16 a[52:53], v234 offset:20480
  v_mfma_f32_16x16x32_bf16 v[188:191], a[56:59], a[228:231], v[188:191]
  ds_read_b64_tr_b16 a[54:55], v234 offset:22528
  v_mfma_f32_16x16x32_bf16 v[188:191], a[60:63], a[236:239], v[188:191]
  ds_read_b64_tr_b16 a[48:49], v234 offset:16384
  v_mfma_f32_16x16x32_bf16 v[184:187], a[60:63], a[232:235], v[184:187]
  ds_read_b64_tr_b16 a[50:51], v234 offset:18432
  buffer_load_dwordx4 a[184:187], v226, s[12:15], s22 offen offset:2048 sc1
  v_mfma_f32_16x16x32_bf16 v[184:187], a[56:59], a[224:227], v[184:187]
  ds_read_b64_tr_b16 a[60:61], v235 offset:20480
  s_waitcnt lgkmcnt(8)
  v_mfma_f32_16x16x32_bf16 v[80:83], a[0:3], v[32:35], v[80:83]
  v_mfma_f32_16x16x32_bf16 v[80:83], a[4:7], v[40:43], v[80:83]
  ds_read_b64_tr_b16 a[62:63], v235 offset:22528
  v_mfma_f32_16x16x32_bf16 v[84:87], a[4:7], v[44:47], v[84:87]
  buffer_load_dwordx4 a[188:191], v226, s[12:15], s22 offen offset:3072 sc1
  s_bfe_u32 s22, s2, 0x20001
  s_lshl_b32 s22, s22, 14
  v_mfma_f32_16x16x32_bf16 v[84:87], a[0:3], v[36:39], v[84:87]
  ds_read_b64_tr_b16 a[56:57], v235 offset:16384
  v_mfma_f32_16x16x32_bf16 v[192:195], a[0:3], v[0:3], v[192:195]
  v_mfma_f32_16x16x32_bf16 v[192:195], a[4:7], v[8:11], v[192:195]
  s_barrier
  ds_read_b64_tr_b16 a[58:59], v235 offset:18432
  s_add_u32 m0, s23, 0x8000
  v_mfma_f32_16x16x32_bf16 v[196:199], a[4:7], v[12:15], v[196:199]
  v_lshrrev_b32 v110, 7, v228
  v_lshlrev_b32 v110, 11, v110
  v_and_b32 v111, 0x70, v228
  v_add_u32 v110, v110, v111
  s_lshl_b32 s60, s43, 16
  s_add_u32 s60, s60, s101
  v_add_u32 v110, s60, v110
  buffer_load_dwordx4 v224, s[8:11], s21 offen lds
  v_mfma_f32_16x16x32_bf16 v[196:199], a[0:3], v[4:7], v[196:199]
  ds_read_b64_tr_b16 a[4:5], v236 offset:36864
  v_mfma_f32_16x16x32_bf16 v[204:207], a[8:11], v[4:7], v[204:207]
  v_mfma_f32_16x16x32_bf16 v[204:207], a[12:15], v[12:15], v[204:207]
  ds_read_b64_tr_b16 a[6:7], v236 offset:38912
  v_mfma_f32_16x16x32_bf16 v[200:203], a[12:15], v[8:11], v[200:203]
  s_getpc_b64 s[48:49]
L_k2_pc3_9:
  s_mov_b32 s50, L_k2_spin-L_k2_pc3_9
  s_mov_b32 s51, 0x20000
  s_lshl_b32 s61, s100, 8
  v_lshlrev_b32 v254, 3, v228
  s_mov_b64 exec, 3
  buffer_load_dword v255, v254, s[48:51], s61 offen
  s_mov_b64 exec, -1
  v_mfma_f32_16x16x32_bf16 v[200:203], a[8:11], v[0:3], v[200:203]
  ds_read_b64_tr_b16 a[0:1], v236 offset:32768
  v_mfma_f32_16x16x32_bf16 v[92:95], a[8:11], v[36:39], v[92:95]
  v_mfma_f32_16x16x32_bf16 v[92:95], a[12:15], v[44:47], v[92:95]
  ds_read_b64_tr_b16 a[2:3], v236 offset:34816
  v_mfma_f32_16x16x32_bf16 v[88:91], a[12:15], v[40:43], v[88:91]
  s_mov_b32 s60, 0x0
  buffer_load_dwordx4 v[64:67], v110, s[4:7], s60 offen
  v_mfma_f32_16x16x32_bf16 v[88:91], a[8:11], v[32:35], v[88:91]
  ds_read_b64_tr_b16 a[12:13], v237 offset:36864
  v_mfma_f32_16x16x32_bf16 v[112:115], a[16:19], v[32:35], v[112:115]
  v_mfma_f32_16x16x32_bf16 v[112:115], a[20:23], v[40:43], v[112:115]
  ds_read_b64_tr_b16 a[14:15], v237 offset:38912
  v_mfma_f32_16x16x32_bf16 v[116:119], a[20:23], v[44:47], v[116:119]
  s_mov_b32 s60, 0x4000
  buffer_load_dwordx4 v[68:71], v110, s[4:7], s60 offen
  v_mfma_f32_16x16x32_bf16 v[116:119], a[16:19], v[36:39], v[116:119]
  ds_read_b64_tr_b16 a[8:9], v237 offset:32768
  v_mfma_f32_16x16x32_bf16 v[208:211], a[16:19], v[0:3], v[208:211]
  v_mfma_f32_16x16x32_bf16 v[208:211], a[20:23], v[8:11], v[208:211]
  ds_read_b64_tr_b16 a[10:11], v237 offset:34816
  v_mfma_f32_16x16x32_bf16 v[212:215], a[20:23], v[12:15], v[212:215]
  s_mov_b32 s60, 0x8000
  buffer_load_dwordx4 v[72:75], v110, s[4:7], s60 offen
  v_mfma_f32_16x16x32_bf16 v[212:215], a[16:19], v[4:7], v[212:215]
  ds_read_b64_tr_b16 a[20:21], v238 offset:36864
  v_mfma_f32_16x16x32_bf16 v[220:223], a[24:27], v[4:7], v[220:223]
  v_mfma_f32_16x16x32_bf16 v[220:223], a[28:31], v[12:15], v[220:223]
  ds_read_b64_tr_b16 a[22:23], v238 offset:38912
  v_mfma_f32_16x16x32_bf16 v[216:219], a[28:31], v[8:11], v[216:219]
  s_mov_b32 s60, 0xc000
  buffer_load_dwordx4 v[76:79], v110, s[4:7], s60 offen
  v_mfma_f32_16x16x32_bf16 v[216:219], a[24:27], v[0:3], v[216:219]
  ds_read_b64_tr_b16 a[16:17], v238 offset:32768
  v_mfma_f32_16x16x32_bf16 v[124:127], a[24:27], v[36:39], v[124:127]
  v_mfma_f32_16x16x32_bf16 v[124:127], a[28:31], v[44:47], v[124:127]
  ds_read_b64_tr_b16 a[18:19], v238 offset:34816
  s_add_u32 m0, s23, 0x8400
  v_mfma_f32_16x16x32_bf16 v[120:123], a[28:31], v[40:43], v[120:123]
  buffer_load_dwordx4 v225, s[8:11], s21 offen lds
  v_mfma_f32_16x16x32_bf16 v[120:123], a[24:27], v[32:35], v[120:123]
  ds_read_b64_tr_b16 a[28:29], v239 offset:36864
  v_mfma_f32_16x16x32_bf16 v[144:147], a[32:35], v[0:3], v[144:147]
  ds_read_b64_tr_b16 a[30:31], v239 offset:38912
  v_mfma_f32_16x16x32_bf16 v[144:147], a[36:39], v[8:11], v[144:147]
  ds_read_b64_tr_b16 a[24:25], v239 offset:32768
  s_add_u32 m0, s23, 0x26000
  v_mfma_f32_16x16x32_bf16 v[148:151], a[36:39], v[12:15], v[148:151]
  ds_read_b64_tr_b16 a[26:27], v239 offset:34816
  buffer_load_dwordx4 v229, s[8:11], s21 offen lds
  v_mfma_f32_16x16x32_bf16 v[148:151], a[32:35], v[4:7], v[148:151]
  ds_read_b64_tr_b16 a[36:37], v236 offset:28672
  s_waitcnt lgkmcnt(8)
  v_mfma_f32_16x16x32_bf16 v[156:159], a[40:43], v[4:7], v[156:159]
  ds_read_b64_tr_b16 a[38:39], v236 offset:30720
  v_mfma_f32_16x16x32_bf16 v[156:159], a[44:47], v[12:15], v[156:159]
  ds_read_b64_tr_b16 a[32:33], v236 offset:24576
  s_add_u32 m0, s23, 0x26400
  v_mfma_f32_16x16x32_bf16 v[152:155], a[44:47], v[8:11], v[152:155]
  ds_read_b64_tr_b16 a[34:35], v236 offset:26624
  buffer_load_dwordx4 v230, s[8:11], s21 offen lds
  s_add_u32 s21, s21, 0x20000
  v_mfma_f32_16x16x32_bf16 v[152:155], a[40:43], v[0:3], v[152:155]
  ds_read_b64_tr_b16 a[44:45], v237 offset:28672
  v_mfma_f32_16x16x32_bf16 v[176:179], a[48:51], v[0:3], v[176:179]
  ds_read_b64_tr_b16 a[46:47], v237 offset:30720
  v_mfma_f32_16x16x32_bf16 v[176:179], a[52:55], v[8:11], v[176:179]
  ds_read_b64_tr_b16 a[40:41], v237 offset:24576
  v_mfma_f32_16x16x32_bf16 v[180:183], a[52:55], v[12:15], v[180:183]
  ds_read_b64_tr_b16 a[42:43], v237 offset:26624
  buffer_load_dwordx4 a[192:195], v227, s[12:15], s22 offen offset:0 sc1
  v_mfma_f32_16x16x32_bf16 v[180:183], a[48:51], v[4:7], v[180:183]
  ds_read_b64_tr_b16 a[52:53], v238 offset:28672
  v_mfma_f32_16x16x32_bf16 v[188:191], a[56:59], v[4:7], v[188:191]
  ds_read_b64_tr_b16 a[54:55], v238 offset:30720
  v_mfma_f32_16x16x32_bf16 v[188:191], a[60:63], v[12:15], v[188:191]
  ds_read_b64_tr_b16 a[48:49], v238 offset:24576
  v_mfma_f32_16x16x32_bf16 v[184:187], a[60:63], v[8:11], v[184:187]
  ds_read_b64_tr_b16 a[50:51], v238 offset:26624
  buffer_load_dwordx4 a[196:199], v227, s[12:15], s22 offen offset:1024 sc1
  v_mfma_f32_16x16x32_bf16 v[184:187], a[56:59], v[0:3], v[184:187]
  ds_read_b64_tr_b16 a[60:61], v239 offset:28672
  s_waitcnt vmcnt(46)
  v_mfma_f32_16x16x32_bf16 v[80:83], a[0:3], a[80:83], v[80:83]
  v_mfma_f32_16x16x32_bf16 v[80:83], a[4:7], a[88:91], v[80:83]
  ds_read_b64_tr_b16 a[62:63], v239 offset:30720
  v_mfma_f32_16x16x32_bf16 v[84:87], a[4:7], a[92:95], v[84:87]
  buffer_load_dwordx4 a[200:203], v227, s[12:15], s22 offen offset:2048 sc1
  v_mfma_f32_16x16x32_bf16 v[84:87], a[0:3], a[84:87], v[84:87]
  ds_read_b64_tr_b16 a[56:57], v239 offset:24576
  v_mfma_f32_16x16x32_bf16 v[192:195], a[0:3], a[64:67], v[192:195]
  v_mfma_f32_16x16x32_bf16 v[192:195], a[4:7], a[72:75], v[192:195]
  s_waitcnt vmcnt(46)
  s_barrier
  ds_read_b64_tr_b16 a[58:59], v239 offset:26624
  v_mfma_f32_16x16x32_bf16 v[196:199], a[4:7], a[76:79], v[196:199]
  buffer_load_dwordx4 a[204:207], v227, s[12:15], s22 offen offset:3072 sc1
  v_mfma_f32_16x16x32_bf16 v[196:199], a[0:3], a[68:71], v[196:199]
  ds_read_b64_tr_b16 a[4:5], v236 offset:53248
  v_mfma_f32_16x16x32_bf16 v[204:207], a[8:11], a[68:71], v[204:207]
  v_mfma_f32_16x16x32_bf16 v[204:207], a[12:15], a[76:79], v[204:207]
  ds_read_b64_tr_b16 a[6:7], v236 offset:55296
  v_mfma_f32_16x16x32_bf16 v[200:203], a[12:15], a[72:75], v[200:203]
  buffer_load_dwordx4 a[208:211], v226, s[12:15], s22 offen offset:0 sc1
  v_mfma_f32_16x16x32_bf16 v[200:203], a[8:11], a[64:67], v[200:203]
  ds_read_b64_tr_b16 a[0:1], v236 offset:49152
  v_mfma_f32_16x16x32_bf16 v[92:95], a[8:11], a[84:87], v[92:95]
  v_mfma_f32_16x16x32_bf16 v[92:95], a[12:15], a[92:95], v[92:95]
  ds_read_b64_tr_b16 a[2:3], v236 offset:51200
  v_mfma_f32_16x16x32_bf16 v[88:91], a[12:15], a[88:91], v[88:91]
  buffer_load_dwordx4 a[212:215], v226, s[12:15], s22 offen offset:1024 sc1
  v_mfma_f32_16x16x32_bf16 v[88:91], a[8:11], a[80:83], v[88:91]
  ds_read_b64_tr_b16 a[12:13], v237 offset:53248
  s_waitcnt lgkmcnt(8)
  v_mfma_f32_16x16x32_bf16 v[112:115], a[16:19], a[80:83], v[112:115]
  v_mfma_f32_16x16x32_bf16 v[112:115], a[20:23], a[88:91], v[112:115]
  ds_read_b64_tr_b16 a[14:15], v237 offset:55296
  v_mfma_f32_16x16x32_bf16 v[116:119], a[20:23], a[92:95], v[116:119]
  buffer_load_dwordx4 a[216:219], v226, s[12:15], s22 offen offset:2048 sc1
  v_mfma_f32_16x16x32_bf16 v[116:119], a[16:19], a[84:87], v[116:119]
  ds_read_b64_tr_b16 a[8:9], v237 offset:49152
  v_mfma_f32_16x16x32_bf16 v[208:211], a[16:19], a[64:67], v[208:211]
  v_mfma_f32_16x16x32_bf16 v[208:211], a[20:23], a[72:75], v[208:211]
  ds_read_b64_tr_b16 a[10:11], v237 offset:51200
  v_mfma_f32_16x16x32_bf16 v[212:215], a[20:23], a[76:79], v[212:215]
  buffer_load_dwordx4 a[220:223], v226, s[12:15], s22 offen offset:3072 sc1
  s_add_u32 s22, s22, 0x1000
  v_mfma_f32_16x16x32_bf16 v[212:215], a[16:19], a[68:71], v[212:215]
  ds_read_b64_tr_b16 a[20:21], v238 offset:53248
  v_mfma_f32_16x16x32_bf16 v[220:223], a[24:27], a[68:71], v[220:223]
  v_mfma_f32_16x16x32_bf16 v[220:223], a[28:31], a[76:79], v[220:223]
  ds_read_b64_tr_b16 a[22:23], v238 offset:55296
  s_add_u32 m0, s23, 0xa000
  v_mfma_f32_16x16x32_bf16 v[216:219], a[28:31], a[72:75], v[216:219]
  buffer_load_dwordx4 v224, s[8:11], s21 offen lds
  v_mfma_f32_16x16x32_bf16 v[216:219], a[24:27], a[64:67], v[216:219]
  ds_read_b64_tr_b16 a[16:17], v238 offset:49152
  v_mfma_f32_16x16x32_bf16 v[124:127], a[24:27], a[84:87], v[124:127]
  v_mfma_f32_16x16x32_bf16 v[124:127], a[28:31], a[92:95], v[124:127]
  ds_read_b64_tr_b16 a[18:19], v238 offset:51200
  s_add_u32 m0, s23, 0xa400
  v_mfma_f32_16x16x32_bf16 v[120:123], a[28:31], a[88:91], v[120:123]
  s_waitcnt vmcnt(40)
  buffer_load_dwordx4 v225, s[8:11], s21 offen lds
  v_mfma_f32_16x16x32_bf16 v[120:123], a[24:27], a[80:83], v[120:123]
  ds_read_b64_tr_b16 a[28:29], v239 offset:53248
  v_mfma_f32_16x16x32_bf16 v[144:147], a[32:35], a[64:67], v[144:147]
  ds_read_b64_tr_b16 a[30:31], v239 offset:55296
  v_mfma_f32_16x16x32_bf16 v[144:147], a[36:39], a[72:75], v[144:147]
  ds_read_b64_tr_b16 a[24:25], v239 offset:49152
  s_add_u32 m0, s23, 0xc000
  v_mfma_f32_16x16x32_bf16 v[148:151], a[36:39], a[76:79], v[148:151]
  ds_read_b64_tr_b16 a[26:27], v239 offset:51200
  buffer_load_dwordx4 v229, s[8:11], s21 offen lds
  v_mfma_f32_16x16x32_bf16 v[148:151], a[32:35], a[68:71], v[148:151]
  ds_read_b64_tr_b16 a[36:37], v236 offset:45056
  v_mfma_f32_16x16x32_bf16 v[156:159], a[40:43], a[68:71], v[156:159]
  ds_read_b64_tr_b16 a[38:39], v236 offset:47104
  v_mfma_f32_16x16x32_bf16 v[156:159], a[44:47], a[76:79], v[156:159]
  ds_read_b64_tr_b16 a[32:33], v236 offset:40960
  s_add_u32 m0, s23, 0xc400
  v_mfma_f32_16x16x32_bf16 v[152:155], a[44:47], a[72:75], v[152:155]
  ds_read_b64_tr_b16 a[34:35], v236 offset:43008
  buffer_load_dwordx4 v230, s[8:11], s21 offen lds
  s_add_u32 s21, s21, 0x20000
  v_mfma_f32_16x16x32_bf16 v[152:155], a[40:43], a[64:67], v[152:155]
  ds_read_b64_tr_b16 a[44:45], v237 offset:45056
  v_mfma_f32_16x16x32_bf16 v[176:179], a[48:51], a[64:67], v[176:179]
  ds_read_b64_tr_b16 a[46:47], v237 offset:47104
  v_mfma_f32_16x16x32_bf16 v[176:179], a[52:55], a[72:75], v[176:179]
  ds_read_b64_tr_b16 a[40:41], v237 offset:40960
  s_add_u32 m0, s23, 0xe000
  v_mfma_f32_16x16x32_bf16 v[180:183], a[52:55], a[76:79], v[180:183]
  ds_read_b64_tr_b16 a[42:43], v237 offset:43008
  buffer_load_dwordx4 v224, s[8:11], s21 offen lds
  v_mfma_f32_16x16x32_bf16 v[180:183], a[48:51], a[68:71], v[180:183]
  ds_read_b64_tr_b16 a[52:53], v238 offset:45056
  s_waitcnt lgkmcnt(8)
  v_mfma_f32_16x16x32_bf16 v[188:191], a[56:59], a[68:71], v[188:191]
  ds_read_b64_tr_b16 a[54:55], v238 offset:47104
  v_mfma_f32_16x16x32_bf16 v[188:191], a[60:63], a[76:79], v[188:191]
  ds_read_b64_tr_b16 a[48:49], v238 offset:40960
  s_add_u32 m0, s23, 0xe400
  v_mfma_f32_16x16x32_bf16 v[184:187], a[60:63], a[72:75], v[184:187]
  ds_read_b64_tr_b16 a[50:51], v238 offset:43008
  buffer_load_dwordx4 v225, s[8:11], s21 offen lds
  v_mfma_f32_16x16x32_bf16 v[184:187], a[56:59], a[64:67], v[184:187]
  ds_read_b64_tr_b16 a[60:61], v239 offset:45056
  v_mfma_f32_16x16x32_bf16 v[80:83], a[0:3], a[112:115], v[80:83]
  v_mfma_f32_16x16x32_bf16 v[80:83], a[4:7], a[120:123], v[80:83]
  ds_read_b64_tr_b16 a[62:63], v239 offset:47104
  s_add_u32 m0, s23, 0x10000
  v_mfma_f32_16x16x32_bf16 v[84:87], a[4:7], a[124:127], v[84:87]
  buffer_load_dwordx4 v229, s[8:11], s21 offen lds
  v_mfma_f32_16x16x32_bf16 v[84:87], a[0:3], a[116:119], v[84:87]
  ds_read_b64_tr_b16 a[56:57], v239 offset:40960
  v_mfma_f32_16x16x32_bf16 v[192:195], a[0:3], a[96:99], v[192:195]
  v_mfma_f32_16x16x32_bf16 v[192:195], a[4:7], a[104:107], v[192:195]
  s_barrier
  ds_read_b64_tr_b16 a[58:59], v239 offset:43008
  s_add_u32 m0, s23, 0x10400
  v_mfma_f32_16x16x32_bf16 v[196:199], a[4:7], a[108:111], v[196:199]
  buffer_load_dwordx4 v230, s[8:11], s21 offen lds
  s_add_u32 s21, s21, 0x20000
  v_mfma_f32_16x16x32_bf16 v[196:199], a[0:3], a[100:103], v[196:199]
  ds_read_b64_tr_b16 a[4:5], v240 offset:4096
  v_mfma_f32_16x16x32_bf16 v[204:207], a[8:11], a[100:103], v[204:207]
  v_mfma_f32_16x16x32_bf16 v[204:207], a[12:15], a[108:111], v[204:207]
  ds_read_b64_tr_b16 a[6:7], v240 offset:6144
  v_mfma_f32_16x16x32_bf16 v[200:203], a[12:15], a[104:107], v[200:203]
  buffer_load_dwordx4 a[224:227], v227, s[12:15], s22 offen offset:0 sc1
  v_mfma_f32_16x16x32_bf16 v[200:203], a[8:11], a[96:99], v[200:203]
  ds_read_b64_tr_b16 a[0:1], v240 offset:0
  v_mfma_f32_16x16x32_bf16 v[92:95], a[8:11], a[116:119], v[92:95]
  v_mfma_f32_16x16x32_bf16 v[92:95], a[12:15], a[124:127], v[92:95]
  ds_read_b64_tr_b16 a[2:3], v240 offset:2048
  v_mfma_f32_16x16x32_bf16 v[88:91], a[12:15], a[120:123], v[88:91]
  buffer_load_dwordx4 a[228:231], v227, s[12:15], s22 offen offset:1024 sc1
  v_mfma_f32_16x16x32_bf16 v[88:91], a[8:11], a[112:115], v[88:91]
  ds_read_b64_tr_b16 a[12:13], v241 offset:4096
  v_mfma_f32_16x16x32_bf16 v[112:115], a[16:19], a[112:115], v[112:115]
  v_mfma_f32_16x16x32_bf16 v[112:115], a[20:23], a[120:123], v[112:115]
  ds_read_b64_tr_b16 a[14:15], v241 offset:6144
  v_mfma_f32_16x16x32_bf16 v[116:119], a[20:23], a[124:127], v[116:119]
  buffer_load_dwordx4 a[232:235], v227, s[12:15], s22 offen offset:2048 sc1
  v_mfma_f32_16x16x32_bf16 v[116:119], a[16:19], a[116:119], v[116:119]
  ds_read_b64_tr_b16 a[8:9], v241 offset:0
  v_mfma_f32_16x16x32_bf16 v[208:211], a[16:19], a[96:99], v[208:211]
  v_mfma_f32_16x16x32_bf16 v[208:211], a[20:23], a[104:107], v[208:211]
  ds_read_b64_tr_b16 a[10:11], v241 offset:2048
  v_mfma_f32_16x16x32_bf16 v[212:215], a[20:23], a[108:111], v[212:215]
  buffer_load_dwordx4 a[236:239], v227, s[12:15], s22 offen offset:3072 sc1
  v_mfma_f32_16x16x32_bf16 v[212:215], a[16:19], a[100:103], v[212:215]
  ds_read_b64_tr_b16 a[20:21], v242 offset:4096
  v_mfma_f32_16x16x32_bf16 v[220:223], a[24:27], a[100:103], v[220:223]
  v_mfma_f32_16x16x32_bf16 v[220:223], a[28:31], a[108:111], v[220:223]
  ds_read_b64_tr_b16 a[22:23], v242 offset:6144
  v_mfma_f32_16x16x32_bf16 v[216:219], a[28:31], a[104:107], v[216:219]
  buffer_load_dwordx4 v[0:3], v226, s[12:15], s22 offen offset:0 sc1
  v_mfma_f32_16x16x32_bf16 v[216:219], a[24:27], a[96:99], v[216:219]
  ds_read_b64_tr_b16 a[16:17], v242 offset:0
  v_mfma_f32_16x16x32_bf16 v[124:127], a[24:27], a[116:119], v[124:127]
  v_mfma_f32_16x16x32_bf16 v[124:127], a[28:31], a[124:127], v[124:127]
  ds_read_b64_tr_b16 a[18:19], v242 offset:2048
  v_mfma_f32_16x16x32_bf16 v[120:123], a[28:31], a[120:123], v[120:123]
  s_waitcnt vmcnt(40)
  buffer_load_dwordx4 v[4:7], v226, s[12:15], s22 offen offset:1024 sc1
  v_mfma_f32_16x16x32_bf16 v[120:123], a[24:27], a[112:115], v[120:123]
  ds_read_b64_tr_b16 a[28:29], v243 offset:4096
  s_waitcnt lgkmcnt(8)
  v_mfma_f32_16x16x32_bf16 v[144:147], a[32:35], a[96:99], v[144:147]
  ds_read_b64_tr_b16 a[30:31], v243 offset:6144
  v_mfma_f32_16x16x32_bf16 v[144:147], a[36:39], a[104:107], v[144:147]
  ds_read_b64_tr_b16 a[24:25], v243 offset:0
  v_mfma_f32_16x16x32_bf16 v[148:151], a[36:39], a[108:111], v[148:151]
  ds_read_b64_tr_b16 a[26:27], v243 offset:2048
  buffer_load_dwordx4 v[8:11], v226, s[12:15], s22 offen offset:2048 sc1
  v_mfma_f32_16x16x32_bf16 v[148:151], a[32:35], a[100:103], v[148:151]
  ds_read_b64_tr_b16 a[36:37], v236 offset:61440
  v_mfma_f32_16x16x32_bf16 v[156:159], a[40:43], a[100:103], v[156:159]
  ds_read_b64_tr_b16 a[38:39], v236 offset:63488
  v_mfma_f32_16x16x32_bf16 v[156:159], a[44:47], a[108:111], v[156:159]
  ds_read_b64_tr_b16 a[32:33], v236 offset:57344
  v_mfma_f32_16x16x32_bf16 v[152:155], a[44:47], a[104:107], v[152:155]
  ds_read_b64_tr_b16 a[34:35], v236 offset:59392
  buffer_load_dwordx4 v[12:15], v226, s[12:15], s22 offen offset:3072 sc1
  s_add_u32 s22, s22, 0x1000
  v_mfma_f32_16x16x32_bf16 v[152:155], a[40:43], a[96:99], v[152:155]
  ds_read_b64_tr_b16 a[44:45], v237 offset:61440
  v_mfma_f32_16x16x32_bf16 v[176:179], a[48:51], a[96:99], v[176:179]
  ds_read_b64_tr_b16 a[46:47], v237 offset:63488
  v_mfma_f32_16x16x32_bf16 v[176:179], a[52:55], a[104:107], v[176:179]
  ds_read_b64_tr_b16 a[40:41], v237 offset:57344
  s_add_u32 m0, s23, 0x12000
  v_mfma_f32_16x16x32_bf16 v[180:183], a[52:55], a[108:111], v[180:183]
  ds_read_b64_tr_b16 a[42:43], v237 offset:59392
  buffer_load_dwordx4 v224, s[8:11], s21 offen lds
  v_mfma_f32_16x16x32_bf16 v[180:183], a[48:51], a[100:103], v[180:183]
  ds_read_b64_tr_b16 a[52:53], v238 offset:61440
  v_mfma_f32_16x16x32_bf16 v[188:191], a[56:59], a[100:103], v[188:191]
  ds_read_b64_tr_b16 a[54:55], v238 offset:63488
  v_mfma_f32_16x16x32_bf16 v[188:191], a[60:63], a[108:111], v[188:191]
  ds_read_b64_tr_b16 a[48:49], v238 offset:57344
  s_add_u32 m0, s23, 0x12400
  v_mfma_f32_16x16x32_bf16 v[184:187], a[60:63], a[104:107], v[184:187]
  ds_read_b64_tr_b16 a[50:51], v238 offset:59392
  buffer_load_dwordx4 v225, s[8:11], s21 offen lds
  v_mfma_f32_16x16x32_bf16 v[184:187], a[56:59], a[96:99], v[184:187]
  ds_read_b64_tr_b16 a[60:61], v239 offset:61440
  v_mfma_f32_16x16x32_bf16 v[80:83], a[0:3], a[144:147], v[80:83]
  s_lshl_b32 s62, s25, 3
  s_lshr_b32 s62, 0x8060301, s62
  s_and_b32 s62, s62, 0xff
  s_lshl_b32 s62, s62, 13
  s_mov_b32 s63, 0xffff0000
  s_waitcnt vmcnt(29)
  v_lshlrev_b32 v100, 16, v96
  v_mfma_f32_16x16x32_bf16 v[80:83], a[4:7], a[152:155], v[80:83]
  ds_read_b64_tr_b16 a[62:63], v239 offset:63488
  s_add_u32 m0, s23, 0x14000
  v_mfma_f32_16x16x32_bf16 v[84:87], a[4:7], a[156:159], v[84:87]
  buffer_load_dwordx4 v229, s[8:11], s21 offen lds
  v_and_b32 v101, s63, v96
  v_mfma_f32_16x16x32_bf16 v[84:87], a[0:3], a[148:151], v[84:87]
  ds_read_b64_tr_b16 a[56:57], v239 offset:57344
  v_lshlrev_b32 v102, 16, v97
  v_mfma_f32_16x16x32_bf16 v[192:195], a[0:3], a[128:131], v[192:195]
  v_and_b32 v103, s63, v97
  v_lshlrev_b32 v104, 16, v98
  v_mfma_f32_16x16x32_bf16 v[192:195], a[4:7], a[136:139], v[192:195]
  s_barrier
  ds_read_b64_tr_b16 a[58:59], v239 offset:59392
  s_add_u32 m0, s23, 0x14400
  v_mfma_f32_16x16x32_bf16 v[196:199], a[4:7], a[140:143], v[196:199]
  buffer_load_dwordx4 v230, s[8:11], s21 offen lds
  s_nop 0
  v_and_b32 v105, s63, v98
  v_mfma_f32_16x16x32_bf16 v[196:199], a[0:3], a[132:135], v[196:199]
  ds_read_b64_tr_b16 a[4:5], v240 offset:20480
  v_lshlrev_b32 v106, 16, v99
  s_waitcnt lgkmcnt(8)
  v_mfma_f32_16x16x32_bf16 v[204:207], a[8:11], a[132:135], v[204:207]
  v_and_b32 v107, s63, v99
  v_mul_f32 v108, v108, v108
  v_mfma_f32_16x16x32_bf16 v[204:207], a[12:15], a[140:143], v[204:207]
  ds_read_b64_tr_b16 a[6:7], v240 offset:22528
  v_mul_f32 v109, v109, v109
  v_mfma_f32_16x16x32_bf16 v[200:203], a[12:15], a[136:139], v[200:203]
  buffer_load_dwordx4 a[64:67], v227, s[12:15], s22 offen offset:0 sc1
  v_lshlrev_b32 v128, 16, v64
  v_mfma_f32_16x16x32_bf16 v[200:203], a[8:11], a[128:131], v[200:203]
  ds_read_b64_tr_b16 a[0:1], v240 offset:16384
  v_and_b32 v129, s63, v64
  v_mfma_f32_16x16x32_bf16 v[92:95], a[8:11], a[148:151], v[92:95]
  v_add_f32 v128, v128, v100
  v_add_f32 v129, v129, v101
  v_mfma_f32_16x16x32_bf16 v[92:95], a[12:15], a[156:159], v[92:95]
  ds_read_b64_tr_b16 a[2:3], v240 offset:18432
  v_lshlrev_b32 v130, 16, v65
  v_mfma_f32_16x16x32_bf16 v[88:91], a[12:15], a[152:155], v[88:91]
  buffer_load_dwordx4 a[68:71], v227, s[12:15], s22 offen offset:1024 sc1
  v_and_b32 v131, s63, v65
  v_mfma_f32_16x16x32_bf16 v[88:91], a[8:11], a[144:147], v[88:91]
  ds_read_b64_tr_b16 a[12:13], v241 offset:20480
  v_add_f32 v130, v130, v102
  v_mfma_f32_16x16x32_bf16 v[112:115], a[16:19], a[144:147], v[112:115]
  v_add_f32 v131, v131, v103
  v_lshlrev_b32 v132, 16, v66
  v_mfma_f32_16x16x32_bf16 v[112:115], a[20:23], a[152:155], v[112:115]
  ds_read_b64_tr_b16 a[14:15], v241 offset:22528
  v_and_b32 v133, s63, v66
  v_mfma_f32_16x16x32_bf16 v[116:119], a[20:23], a[156:159], v[116:119]
  buffer_load_dwordx4 a[72:75], v227, s[12:15], s22 offen offset:2048 sc1
  v_add_f32 v132, v132, v104
  v_mfma_f32_16x16x32_bf16 v[116:119], a[16:19], a[148:151], v[116:119]
  ds_read_b64_tr_b16 a[8:9], v241 offset:16384
  v_add_f32 v133, v133, v105
  v_mfma_f32_16x16x32_bf16 v[208:211], a[16:19], a[128:131], v[208:211]
  v_lshlrev_b32 v134, 16, v67
  v_and_b32 v135, s63, v67
  v_mfma_f32_16x16x32_bf16 v[208:211], a[20:23], a[136:139], v[208:211]
  ds_read_b64_tr_b16 a[10:11], v241 offset:18432
  v_add_f32 v134, v134, v106
  v_mfma_f32_16x16x32_bf16 v[212:215], a[20:23], a[140:143], v[212:215]
  buffer_load_dwordx4 a[76:79], v227, s[12:15], s22 offen offset:3072 sc1
  v_add_f32 v135, v135, v107
  v_mfma_f32_16x16x32_bf16 v[212:215], a[16:19], a[132:135], v[212:215]
  ds_read_b64_tr_b16 a[20:21], v242 offset:20480
  v_lshlrev_b32 v136, 16, v68
  v_mfma_f32_16x16x32_bf16 v[220:223], a[24:27], a[132:135], v[220:223]
  v_and_b32 v137, s63, v68
  v_add_f32 v136, v136, v100
  v_mfma_f32_16x16x32_bf16 v[220:223], a[28:31], a[140:143], v[220:223]
  ds_read_b64_tr_b16 a[22:23], v242 offset:22528
  v_add_f32 v137, v137, v101
  v_mfma_f32_16x16x32_bf16 v[216:219], a[28:31], a[136:139], v[216:219]
  buffer_load_dwordx4 a[96:99], v226, s[12:15], s22 offen offset:0 sc1
  v_lshlrev_b32 v138, 16, v69
  v_mfma_f32_16x16x32_bf16 v[216:219], a[24:27], a[128:131], v[216:219]
  ds_read_b64_tr_b16 a[16:17], v242 offset:16384
  v_and_b32 v139, s63, v69
  v_mfma_f32_16x16x32_bf16 v[124:127], a[24:27], a[148:151], v[124:127]
  v_add_f32 v138, v138, v102
  v_add_f32 v139, v139, v103
  v_mfma_f32_16x16x32_bf16 v[124:127], a[28:31], a[156:159], v[124:127]
  ds_read_b64_tr_b16 a[18:19], v242 offset:18432
  v_lshlrev_b32 v140, 16, v70
  v_mfma_f32_16x16x32_bf16 v[120:123], a[28:31], a[152:155], v[120:123]
  buffer_load_dwordx4 a[100:103], v226, s[12:15], s22 offen offset:1024 sc1
  v_and_b32 v141, s63, v70
  v_mfma_f32_16x16x32_bf16 v[120:123], a[24:27], a[144:147], v[120:123]
  ds_read_b64_tr_b16 a[28:29], v243 offset:20480
  v_add_f32 v140, v140, v104
  v_mfma_f32_16x16x32_bf16 v[144:147], a[32:35], a[128:131], v[144:147]
  ds_read_b64_tr_b16 a[30:31], v243 offset:22528
  v_add_f32 v141, v141, v105
  v_mfma_f32_16x16x32_bf16 v[144:147], a[36:39], a[136:139], v[144:147]
  ds_read_b64_tr_b16 a[24:25], v243 offset:16384
  v_lshlrev_b32 v142, 16, v71
  v_mfma_f32_16x16x32_bf16 v[148:151], a[36:39], a[140:143], v[148:151]
  ds_read_b64_tr_b16 a[26:27], v243 offset:18432
  buffer_load_dwordx4 a[104:107], v226, s[12:15], s22 offen offset:2048 sc1
  v_mfma_f32_16x16x32_bf16 v[148:151], a[32:35], a[132:135], v[148:151]
  ds_read_b64_tr_b16 a[36:37], v240 offset:12288
  v_and_b32 v143, s63, v71
  v_mfma_f32_16x16x32_bf16 v[156:159], a[40:43], a[132:135], v[156:159]
  ds_read_b64_tr_b16 a[38:39], v240 offset:14336
  v_add_f32 v142, v142, v106
  v_mfma_f32_16x16x32_bf16 v[156:159], a[44:47], a[140:143], v[156:159]
  ds_read_b64_tr_b16 a[32:33], v240 offset:8192
  v_add_f32 v143, v143, v107
  v_mfma_f32_16x16x32_bf16 v[152:155], a[44:47], a[136:139], v[152:155]
  ds_read_b64_tr_b16 a[34:35], v240 offset:10240
  buffer_load_dwordx4 a[108:111], v226, s[12:15], s22 offen offset:3072 sc1
  s_add_u32 s22, s22, 0x1000
  v_mfma_f32_16x16x32_bf16 v[152:155], a[40:43], a[128:131], v[152:155]
  ds_read_b64_tr_b16 a[44:45], v241 offset:12288
  v_lshlrev_b32 v160, 16, v72
  s_waitcnt lgkmcnt(8)
  v_mfma_f32_16x16x32_bf16 v[176:179], a[48:51], a[128:131], v[176:179]
  ds_read_b64_tr_b16 a[46:47], v241 offset:14336
  v_and_b32 v161, s63, v72
  v_mfma_f32_16x16x32_bf16 v[176:179], a[52:55], a[136:139], v[176:179]
  ds_read_b64_tr_b16 a[40:41], v241 offset:8192
  v_add_f32 v160, v160, v100
  v_mfma_f32_16x16x32_bf16 v[180:183], a[52:55], a[140:143], v[180:183]
  ds_read_b64_tr_b16 a[42:43], v241 offset:10240
  v_add_f32 v161, v161, v101
  v_mfma_f32_16x16x32_bf16 v[180:183], a[48:51], a[132:135], v[180:183]
  ds_read_b64_tr_b16 a[52:53], v242 offset:12288
  v_lshlrev_b32 v162, 16, v73
  v_mfma_f32_16x16x32_bf16 v[188:191], a[56:59], a[132:135], v[188:191]
  ds_read_b64_tr_b16 a[54:55], v242 offset:14336
  v_and_b32 v163, s63, v73
  v_mfma_f32_16x16x32_bf16 v[188:191], a[60:63], a[140:143], v[188:191]
  ds_read_b64_tr_b16 a[48:49], v242 offset:8192
  v_add_f32 v162, v162, v102
  v_mfma_f32_16x16x32_bf16 v[184:187], a[60:63], a[136:139], v[184:187]
  ds_read_b64_tr_b16 a[50:51], v242 offset:10240
  v_add_f32 v163, v163, v103
  v_mfma_f32_16x16x32_bf16 v[184:187], a[56:59], a[128:131], v[184:187]
  ds_read_b64_tr_b16 a[60:61], v243 offset:12288
  v_lshlrev_b32 v164, 16, v74
  v_mfma_f32_16x16x32_bf16 v[80:83], a[0:3], a[176:179], v[80:83]
  v_and_b32 v165, s63, v74
  v_add_f32 v164, v164, v104
  v_mfma_f32_16x16x32_bf16 v[80:83], a[4:7], a[184:187], v[80:83]
  ds_read_b64_tr_b16 a[62:63], v243 offset:14336
  buffer_load_dwordx4 a[128:131], v227, s[12:15], s22 offen offset:0 sc1
  v_mfma_f32_16x16x32_bf16 v[84:87], a[4:7], a[188:191], v[84:87]
  v_add_f32 v165, v165, v105
  v_lshlrev_b32 v166, 16, v75
  v_mfma_f32_16x16x32_bf16 v[84:87], a[0:3], a[180:183], v[84:87]
  ds_read_b64_tr_b16 a[56:57], v243 offset:8192
  v_and_b32 v167, s63, v75
  v_mfma_f32_16x16x32_bf16 v[192:195], a[0:3], a[160:163], v[192:195]
  v_add_f32 v166, v166, v106
  v_add_f32 v167, v167, v107
  v_mfma_f32_16x16x32_bf16 v[192:195], a[4:7], a[168:171], v[192:195]
  s_waitcnt vmcnt(37)
  s_barrier
  ds_read_b64_tr_b16 a[58:59], v243 offset:10240
  buffer_load_dwordx4 a[132:135], v227, s[12:15], s22 offen offset:1024 sc1
  v_mfma_f32_16x16x32_bf16 v[196:199], a[4:7], a[172:175], v[196:199]
  v_lshlrev_b32 v168, 16, v76
  v_and_b32 v169, s63, v76
  v_mfma_f32_16x16x32_bf16 v[196:199], a[0:3], a[164:167], v[196:199]
  ds_read_b64_tr_b16 a[4:5], v240 offset:28672
  v_add_f32 v168, v168, v100
  v_mfma_f32_16x16x32_bf16 v[204:207], a[8:11], a[164:167], v[204:207]
  v_add_f32 v169, v169, v101
  v_lshlrev_b32 v170, 16, v77
  v_mfma_f32_16x16x32_bf16 v[204:207], a[12:15], a[172:175], v[204:207]
  ds_read_b64_tr_b16 a[6:7], v240 offset:30720
  buffer_load_dwordx4 a[136:139], v227, s[12:15], s22 offen offset:2048 sc1
  v_mfma_f32_16x16x32_bf16 v[200:203], a[12:15], a[168:171], v[200:203]
  v_and_b32 v171, s63, v77
  v_add_f32 v170, v170, v102
  v_mfma_f32_16x16x32_bf16 v[200:203], a[8:11], a[160:163], v[200:203]
  ds_read_b64_tr_b16 a[0:1], v240 offset:24576
  v_add_f32 v171, v171, v103
  v_mfma_f32_16x16x32_bf16 v[92:95], a[8:11], a[180:183], v[92:95]
  v_lshlrev_b32 v172, 16, v78
  v_and_b32 v173, s63, v78
  v_mfma_f32_16x16x32_bf16 v[92:95], a[12:15], a[188:191], v[92:95]
  ds_read_b64_tr_b16 a[2:3], v240 offset:26624
  buffer_load_dwordx4 a[140:143], v227, s[12:15], s22 offen offset:3072 sc1
  v_mfma_f32_16x16x32_bf16 v[88:91], a[12:15], a[184:187], v[88:91]
  v_add_f32 v172, v172, v104
  v_add_f32 v173, v173, v105
  v_mfma_f32_16x16x32_bf16 v[88:91], a[8:11], a[176:179], v[88:91]
  ds_read_b64_tr_b16 a[12:13], v241 offset:28672
  v_lshlrev_b32 v174, 16, v79
  v_mfma_f32_16x16x32_bf16 v[112:115], a[16:19], a[176:179], v[112:115]
  v_and_b32 v175, s63, v79
  v_add_f32 v174, v174, v106
  v_mfma_f32_16x16x32_bf16 v[112:115], a[20:23], a[184:187], v[112:115]
  ds_read_b64_tr_b16 a[14:15], v241 offset:30720
  v_add_f32 v175, v175, v107
  v_mfma_f32_16x16x32_bf16 v[116:119], a[20:23], a[188:191], v[116:119]
  v_bfe_u32 v248, v228, 4, 3
  v_lshrrev_b32 v249, 8, v228
  v_xor_b32 v248, v248, v249
  v_mfma_f32_16x16x32_bf16 v[116:119], a[16:19], a[180:183], v[116:119]
  ds_read_b64_tr_b16 a[8:9], v241 offset:24576
  v_and_b32 v249, 0xf0, v228
  v_lshlrev_b32 v249, 4, v249
  v_mfma_f32_16x16x32_bf16 v[208:211], a[16:19], a[160:163], v[208:211]
  v_add_u32 v249, s62, v249
  v_lshl_add_u32 v224, v248, 4, v249
  v_xor_b32 v248, 4, v248
  v_mfma_f32_16x16x32_bf16 v[208:211], a[20:23], a[168:171], v[208:211]
  ds_read_b64_tr_b16 a[10:11], v241 offset:26624
  v_lshl_add_u32 v225, v248, 4, v249
  v_lshrrev_b32 v248, 7, v228
  v_mfma_f32_16x16x32_bf16 v[212:215], a[20:23], a[172:175], v[212:215]
  v_bfe_u32 v249, v228, 4, 3
  v_lshlrev_b32 v249, 1, v249
  v_xor_b32 v249, v249, v248
  v_mfma_f32_16x16x32_bf16 v[212:215], a[16:19], a[164:167], v[212:215]
  ds_read_b64_tr_b16 a[20:21], v242 offset:28672
  v_lshlrev_b32 v248, 8, v248
  v_add_u32 v248, s62, v248
  s_waitcnt lgkmcnt(8)
  v_mfma_f32_16x16x32_bf16 v[220:223], a[24:27], a[164:167], v[220:223]
  v_lshl_add_u32 v229, v249, 4, v248
  v_xor_b32 v230, 16, v229
  v_mfma_f32_16x16x32_bf16 v[220:223], a[28:31], a[172:175], v[220:223]
  ds_read_b64_tr_b16 a[22:23], v242 offset:30720
  v_mfma_f32_16x16x32_bf16 v[216:219], a[28:31], a[168:171], v[216:219]
  v_mfma_f32_16x16x32_bf16 v[216:219], a[24:27], a[160:163], v[216:219]
  ds_read_b64_tr_b16 a[16:17], v242 offset:24576
  v_mfma_f32_16x16x32_bf16 v[124:127], a[24:27], a[180:183], v[124:127]
  v_mfma_f32_16x16x32_bf16 v[124:127], a[28:31], a[188:191], v[124:127]
  ds_read_b64_tr_b16 a[18:19], v242 offset:26624
  v_mfma_f32_16x16x32_bf16 v[120:123], a[28:31], a[184:187], v[120:123]
  v_mfma_f32_16x16x32_bf16 v[120:123], a[24:27], a[176:179], v[120:123]
  ds_read_b64_tr_b16 a[28:29], v243 offset:28672
  v_mfma_f32_16x16x32_bf16 v[144:147], a[32:35], a[160:163], v[144:147]
  ds_read_b64_tr_b16 a[30:31], v243 offset:30720
  v_mfma_f32_16x16x32_bf16 v[144:147], a[36:39], a[168:171], v[144:147]
  ds_read_b64_tr_b16 a[24:25], v243 offset:24576
  v_mfma_f32_16x16x32_bf16 v[148:151], a[36:39], a[172:175], v[148:151]
  ds_read_b64_tr_b16 a[26:27], v243 offset:26624
  v_mfma_f32_16x16x32_bf16 v[148:151], a[32:35], a[164:167], v[148:151]
  ds_read_b64_tr_b16 a[36:37], v232 offset:36864
  v_mfma_f32_16x16x32_bf16 v[156:159], a[40:43], a[164:167], v[156:159]
  ds_read_b64_tr_b16 a[38:39], v232 offset:38912
  v_mfma_f32_16x16x32_bf16 v[156:159], a[44:47], a[172:175], v[156:159]
  ds_read_b64_tr_b16 a[32:33], v232 offset:32768
  v_mfma_f32_16x16x32_bf16 v[152:155], a[44:47], a[168:171], v[152:155]
  ds_read_b64_tr_b16 a[34:35], v232 offset:34816
  v_mfma_f32_16x16x32_bf16 v[152:155], a[40:43], a[160:163], v[152:155]
  ds_read_b64_tr_b16 a[44:45], v233 offset:36864
  v_mfma_f32_16x16x32_bf16 v[176:179], a[48:51], a[160:163], v[176:179]
  ds_read_b64_tr_b16 a[46:47], v233 offset:38912
  v_mfma_f32_16x16x32_bf16 v[176:179], a[52:55], a[168:171], v[176:179]
  ds_read_b64_tr_b16 a[40:41], v233 offset:32768
  v_mfma_f32_16x16x32_bf16 v[180:183], a[52:55], a[172:175], v[180:183]
  ds_read_b64_tr_b16 a[42:43], v233 offset:34816
  v_mfma_f32_16x16x32_bf16 v[180:183], a[48:51], a[164:167], v[180:183]
  ds_read_b64_tr_b16 a[52:53], v234 offset:36864
  v_mfma_f32_16x16x32_bf16 v[188:191], a[56:59], a[164:167], v[188:191]
  ds_read_b64_tr_b16 a[54:55], v234 offset:38912
  v_mfma_f32_16x16x32_bf16 v[188:191], a[60:63], a[172:175], v[188:191]
  ds_read_b64_tr_b16 a[48:49], v234 offset:32768
  v_mfma_f32_16x16x32_bf16 v[184:187], a[60:63], a[168:171], v[184:187]
  ds_read_b64_tr_b16 a[50:51], v234 offset:34816
  v_mfma_f32_16x16x32_bf16 v[184:187], a[56:59], a[160:163], v[184:187]
  ds_read_b64_tr_b16 a[60:61], v235 offset:36864
  s_waitcnt lgkmcnt(8) vmcnt(32)
  v_mfma_f32_16x16x32_bf16 v[80:83], a[0:3], a[208:211], v[80:83]
  v_mfma_f32_16x16x32_bf16 v[80:83], a[4:7], a[216:219], v[80:83]
  ds_read_b64_tr_b16 a[62:63], v235 offset:38912
  buffer_load_dwordx4 a[160:163], v226, s[12:15], s22 offen offset:0 sc1
  v_mfma_f32_16x16x32_bf16 v[84:87], a[4:7], a[220:223], v[84:87]
  v_mfma_f32_16x16x32_bf16 v[84:87], a[0:3], a[212:215], v[84:87]
  ds_read_b64_tr_b16 a[56:57], v235 offset:32768
  v_mfma_f32_16x16x32_bf16 v[192:195], a[0:3], a[192:195], v[192:195]
  v_mfma_f32_16x16x32_bf16 v[192:195], a[4:7], a[200:203], v[192:195]
  s_waitcnt vmcnt(29)
  s_barrier
  ds_read_b64_tr_b16 a[58:59], v235 offset:34816
  buffer_load_dwordx4 a[164:167], v226, s[12:15], s22 offen offset:1024 sc1
  v_mfma_f32_16x16x32_bf16 v[196:199], a[4:7], a[204:207], v[196:199]
  v_mfma_f32_16x16x32_bf16 v[196:199], a[0:3], a[196:199], v[196:199]
  ds_read_b64_tr_b16 a[4:5], v232 offset:53248
  buffer_load_dwordx4 a[168:171], v226, s[12:15], s22 offen offset:2048 sc1
  v_mfma_f32_16x16x32_bf16 v[204:207], a[8:11], a[196:199], v[204:207]
  v_mfma_f32_16x16x32_bf16 v[204:207], a[12:15], a[204:207], v[204:207]
  ds_read_b64_tr_b16 a[6:7], v232 offset:55296
  buffer_load_dwordx4 a[172:175], v226, s[12:15], s22 offen offset:3072 sc1
  s_nop 0
  v_mfma_f32_16x16x32_bf16 v[200:203], a[12:15], a[200:203], v[200:203]
  v_mfma_f32_16x16x32_bf16 v[200:203], a[8:11], a[192:195], v[200:203]
  ds_read_b64_tr_b16 a[0:1], v232 offset:49152
  v_mfma_f32_16x16x32_bf16 v[92:95], a[8:11], a[212:215], v[92:95]
  v_mfma_f32_16x16x32_bf16 v[92:95], a[12:15], a[220:223], v[92:95]
  ds_read_b64_tr_b16 a[2:3], v232 offset:51200
  v_mfma_f32_16x16x32_bf16 v[88:91], a[12:15], a[216:219], v[88:91]
  v_mfma_f32_16x16x32_bf16 v[88:91], a[8:11], a[208:211], v[88:91]
  ds_read_b64_tr_b16 a[12:13], v233 offset:53248
  v_mfma_f32_16x16x32_bf16 v[112:115], a[16:19], a[208:211], v[112:115]
  v_mfma_f32_16x16x32_bf16 v[112:115], a[20:23], a[216:219], v[112:115]
  ds_read_b64_tr_b16 a[14:15], v233 offset:55296
  v_mfma_f32_16x16x32_bf16 v[116:119], a[20:23], a[220:223], v[116:119]
  v_mfma_f32_16x16x32_bf16 v[116:119], a[16:19], a[212:215], v[116:119]
  ds_read_b64_tr_b16 a[8:9], v233 offset:49152
  v_mfma_f32_16x16x32_bf16 v[208:211], a[16:19], a[192:195], v[208:211]
  v_mfma_f32_16x16x32_bf16 v[208:211], a[20:23], a[200:203], v[208:211]
  ds_read_b64_tr_b16 a[10:11], v233 offset:51200
  v_mfma_f32_16x16x32_bf16 v[212:215], a[20:23], a[204:207], v[212:215]
  v_mfma_f32_16x16x32_bf16 v[212:215], a[16:19], a[196:199], v[212:215]
  ds_read_b64_tr_b16 a[20:21], v234 offset:53248
  v_mfma_f32_16x16x32_bf16 v[220:223], a[24:27], a[196:199], v[220:223]
  v_mfma_f32_16x16x32_bf16 v[220:223], a[28:31], a[204:207], v[220:223]
  ds_read_b64_tr_b16 a[22:23], v234 offset:55296
  v_mfma_f32_16x16x32_bf16 v[216:219], a[28:31], a[200:203], v[216:219]
  v_mfma_f32_16x16x32_bf16 v[216:219], a[24:27], a[192:195], v[216:219]
  ds_read_b64_tr_b16 a[16:17], v234 offset:49152
  v_mfma_f32_16x16x32_bf16 v[124:127], a[24:27], a[212:215], v[124:127]
  v_mfma_f32_16x16x32_bf16 v[124:127], a[28:31], a[220:223], v[124:127]
  ds_read_b64_tr_b16 a[18:19], v234 offset:51200
  v_mfma_f32_16x16x32_bf16 v[120:123], a[28:31], a[216:219], v[120:123]
  v_mfma_f32_16x16x32_bf16 v[120:123], a[24:27], a[208:211], v[120:123]
  ds_read_b64_tr_b16 a[28:29], v235 offset:53248
  v_mfma_f32_16x16x32_bf16 v[144:147], a[32:35], a[192:195], v[144:147]
  ds_read_b64_tr_b16 a[30:31], v235 offset:55296
  v_mfma_f32_16x16x32_bf16 v[144:147], a[36:39], a[200:203], v[144:147]
  s_waitcnt vmcnt(28)
  s_barrier
  ds_read_b64_tr_b16 a[24:25], v235 offset:49152
  v_mfma_f32_16x16x32_bf16 v[148:151], a[36:39], a[204:207], v[148:151]
  ds_read_b64_tr_b16 a[26:27], v235 offset:51200
  v_mfma_f32_16x16x32_bf16 v[148:151], a[32:35], a[196:199], v[148:151]
  ds_read_b64_tr_b16 a[36:37], v236 offset:4096
  s_waitcnt lgkmcnt(8)
  v_mfma_f32_16x16x32_bf16 v[156:159], a[40:43], a[196:199], v[156:159]
  ds_read_b64_tr_b16 a[38:39], v236 offset:6144
  v_mfma_f32_16x16x32_bf16 v[156:159], a[44:47], a[204:207], v[156:159]
  ds_read_b64_tr_b16 a[32:33], v236 offset:0
  v_mfma_f32_16x16x32_bf16 v[152:155], a[44:47], a[200:203], v[152:155]
  ds_read_b64_tr_b16 a[34:35], v236 offset:2048
  v_mfma_f32_16x16x32_bf16 v[152:155], a[40:43], a[192:195], v[152:155]
  ds_read_b64_tr_b16 a[44:45], v237 offset:4096
  v_mfma_f32_16x16x32_bf16 v[176:179], a[48:51], a[192:195], v[176:179]
  ds_read_b64_tr_b16 a[46:47], v237 offset:6144
  v_mfma_f32_16x16x32_bf16 v[176:179], a[52:55], a[200:203], v[176:179]
  ds_read_b64_tr_b16 a[40:41], v237 offset:0
  v_mfma_f32_16x16x32_bf16 v[180:183], a[52:55], a[204:207], v[180:183]
  ds_read_b64_tr_b16 a[42:43], v237 offset:2048
  v_mfma_f32_16x16x32_bf16 v[180:183], a[48:51], a[196:199], v[180:183]
  ds_read_b64_tr_b16 a[52:53], v238 offset:4096
  v_mfma_f32_16x16x32_bf16 v[188:191], a[56:59], a[196:199], v[188:191]
  ds_read_b64_tr_b16 a[54:55], v238 offset:6144
  v_mfma_f32_16x16x32_bf16 v[188:191], a[60:63], a[204:207], v[188:191]
  ds_read_b64_tr_b16 a[48:49], v238 offset:0
  v_mfma_f32_16x16x32_bf16 v[184:187], a[60:63], a[200:203], v[184:187]
  ds_read_b64_tr_b16 a[50:51], v238 offset:2048
  v_mfma_f32_16x16x32_bf16 v[184:187], a[56:59], a[192:195], v[184:187]
  ds_read_b64_tr_b16 a[60:61], v239 offset:4096
  s_waitcnt vmcnt(20)
  v_mfma_f32_16x16x32_bf16 v[80:83], a[0:3], v[0:3], v[80:83]
  v_mfma_f32_16x16x32_bf16 v[80:83], a[4:7], v[8:11], v[80:83]
  ds_read_b64_tr_b16 a[62:63], v239 offset:6144
  v_mfma_f32_16x16x32_bf16 v[84:87], a[4:7], v[12:15], v[84:87]
  v_mfma_f32_16x16x32_bf16 v[84:87], a[0:3], v[4:7], v[84:87]
  ds_read_b64_tr_b16 a[56:57], v239 offset:0
  v_mfma_f32_16x16x32_bf16 v[192:195], a[0:3], a[224:227], v[192:195]
  v_mfma_f32_16x16x32_bf16 v[192:195], a[4:7], a[232:235], v[192:195]
  s_waitcnt vmcnt(16)
  s_barrier
  ds_read_b64_tr_b16 a[58:59], v239 offset:2048
  v_mfma_f32_16x16x32_bf16 v[196:199], a[4:7], a[236:239], v[196:199]
  v_mfma_f32_16x16x32_bf16 v[196:199], a[0:3], a[228:231], v[196:199]
  ds_read_b64_tr_b16 a[4:5], v236 offset:20480
  v_mfma_f32_16x16x32_bf16 v[204:207], a[8:11], a[228:231], v[204:207]
  v_mfma_f32_16x16x32_bf16 v[204:207], a[12:15], a[236:239], v[204:207]
  ds_read_b64_tr_b16 a[6:7], v236 offset:22528
  v_mfma_f32_16x16x32_bf16 v[200:203], a[12:15], a[232:235], v[200:203]
  v_mfma_f32_16x16x32_bf16 v[200:203], a[8:11], a[224:227], v[200:203]
  ds_read_b64_tr_b16 a[0:1], v236 offset:16384
  v_mfma_f32_16x16x32_bf16 v[92:95], a[8:11], v[4:7], v[92:95]
  v_mfma_f32_16x16x32_bf16 v[92:95], a[12:15], v[12:15], v[92:95]
  ds_read_b64_tr_b16 a[2:3], v236 offset:18432
  v_mfma_f32_16x16x32_bf16 v[88:91], a[12:15], v[8:11], v[88:91]
  v_mfma_f32_16x16x32_bf16 v[88:91], a[8:11], v[0:3], v[88:91]
  ds_read_b64_tr_b16 a[12:13], v237 offset:20480
  s_waitcnt lgkmcnt(8)
  v_mfma_f32_16x16x32_bf16 v[112:115], a[16:19], v[0:3], v[112:115]
  v_mfma_f32_16x16x32_bf16 v[112:115], a[20:23], v[8:11], v[112:115]
  ds_read_b64_tr_b16 a[14:15], v237 offset:22528
  v_mfma_f32_16x16x32_bf16 v[116:119], a[20:23], v[12:15], v[116:119]
  v_mfma_f32_16x16x32_bf16 v[116:119], a[16:19], v[4:7], v[116:119]
  ds_read_b64_tr_b16 a[8:9], v237 offset:16384
  v_mfma_f32_16x16x32_bf16 v[208:211], a[16:19], a[224:227], v[208:211]
  v_mfma_f32_16x16x32_bf16 v[208:211], a[20:23], a[232:235], v[208:211]
  ds_read_b64_tr_b16 a[10:11], v237 offset:18432
  v_mfma_f32_16x16x32_bf16 v[212:215], a[20:23], a[236:239], v[212:215]
  v_mfma_f32_16x16x32_bf16 v[212:215], a[16:19], a[228:231], v[212:215]
  ds_read_b64_tr_b16 a[20:21], v238 offset:20480
  v_mfma_f32_16x16x32_bf16 v[220:223], a[24:27], a[228:231], v[220:223]
  v_mfma_f32_16x16x32_bf16 v[220:223], a[28:31], a[236:239], v[220:223]
  ds_read_b64_tr_b16 a[22:23], v238 offset:22528
  v_mfma_f32_16x16x32_bf16 v[216:219], a[28:31], a[232:235], v[216:219]
  v_mfma_f32_16x16x32_bf16 v[216:219], a[24:27], a[224:227], v[216:219]
  ds_read_b64_tr_b16 a[16:17], v238 offset:16384
  v_mfma_f32_16x16x32_bf16 v[124:127], a[24:27], v[4:7], v[124:127]
  v_mfma_f32_16x16x32_bf16 v[124:127], a[28:31], v[12:15], v[124:127]
  ds_read_b64_tr_b16 a[18:19], v238 offset:18432
  v_mfma_f32_16x16x32_bf16 v[120:123], a[28:31], v[8:11], v[120:123]
  v_mfma_f32_16x16x32_bf16 v[120:123], a[24:27], v[0:3], v[120:123]
  ds_read_b64_tr_b16 a[28:29], v239 offset:20480
  s_waitcnt vmcnt(8)
  v_mfma_f32_16x16x32_bf16 v[80:83], a[32:35], a[96:99], v[80:83]
  v_mfma_f32_16x16x32_bf16 v[80:83], a[36:39], a[104:107], v[80:83]
  ds_read_b64_tr_b16 a[30:31], v239 offset:22528
  v_mfma_f32_16x16x32_bf16 v[84:87], a[36:39], a[108:111], v[84:87]
  v_mfma_f32_16x16x32_bf16 v[84:87], a[32:35], a[100:103], v[84:87]
  ds_read_b64_tr_b16 a[24:25], v239 offset:16384
  v_mfma_f32_16x16x32_bf16 v[192:195], a[32:35], a[64:67], v[192:195]
  v_mfma_f32_16x16x32_bf16 v[192:195], a[36:39], a[72:75], v[192:195]
  ds_read_b64_tr_b16 a[26:27], v239 offset:18432
  v_mfma_f32_16x16x32_bf16 v[196:199], a[36:39], a[76:79], v[196:199]
  v_mfma_f32_16x16x32_bf16 v[196:199], a[32:35], a[68:71], v[196:199]
  ds_read_b64_tr_b16 a[36:37], v232 offset:45056
  v_mfma_f32_16x16x32_bf16 v[204:207], a[40:43], a[68:71], v[204:207]
  v_mfma_f32_16x16x32_bf16 v[204:207], a[44:47], a[76:79], v[204:207]
  ds_read_b64_tr_b16 a[38:39], v232 offset:47104
  v_mfma_f32_16x16x32_bf16 v[200:203], a[44:47], a[72:75], v[200:203]
  v_mfma_f32_16x16x32_bf16 v[200:203], a[40:43], a[64:67], v[200:203]
  ds_read_b64_tr_b16 a[32:33], v232 offset:40960
  v_mfma_f32_16x16x32_bf16 v[92:95], a[40:43], a[100:103], v[92:95]
  v_mfma_f32_16x16x32_bf16 v[92:95], a[44:47], a[108:111], v[92:95]
  ds_read_b64_tr_b16 a[34:35], v232 offset:43008
  v_mfma_f32_16x16x32_bf16 v[88:91], a[44:47], a[104:107], v[88:91]
  v_mfma_f32_16x16x32_bf16 v[88:91], a[40:43], a[96:99], v[88:91]
  ds_read_b64_tr_b16 a[44:45], v233 offset:45056
  v_mfma_f32_16x16x32_bf16 v[112:115], a[48:51], a[96:99], v[112:115]
  v_mfma_f32_16x16x32_bf16 v[112:115], a[52:55], a[104:107], v[112:115]
  ds_read_b64_tr_b16 a[46:47], v233 offset:47104
  v_mfma_f32_16x16x32_bf16 v[116:119], a[52:55], a[108:111], v[116:119]
  v_mfma_f32_16x16x32_bf16 v[116:119], a[48:51], a[100:103], v[116:119]
  ds_read_b64_tr_b16 a[40:41], v233 offset:40960
  v_mfma_f32_16x16x32_bf16 v[208:211], a[48:51], a[64:67], v[208:211]
  v_mfma_f32_16x16x32_bf16 v[208:211], a[52:55], a[72:75], v[208:211]
  ds_read_b64_tr_b16 a[42:43], v233 offset:43008
  v_mfma_f32_16x16x32_bf16 v[212:215], a[52:55], a[76:79], v[212:215]
  v_mfma_f32_16x16x32_bf16 v[212:215], a[48:51], a[68:71], v[212:215]
  ds_read_b64_tr_b16 a[52:53], v234 offset:45056
  s_waitcnt lgkmcnt(8)
  v_mfma_f32_16x16x32_bf16 v[220:223], a[56:59], a[68:71], v[220:223]
  v_mfma_f32_16x16x32_bf16 v[220:223], a[60:63], a[76:79], v[220:223]
  ds_read_b64_tr_b16 a[54:55], v234 offset:47104
  v_mfma_f32_16x16x32_bf16 v[216:219], a[60:63], a[72:75], v[216:219]
  v_mfma_f32_16x16x32_bf16 v[216:219], a[56:59], a[64:67], v[216:219]
  ds_read_b64_tr_b16 a[48:49], v234 offset:40960
  v_mfma_f32_16x16x32_bf16 v[124:127], a[56:59], a[100:103], v[124:127]
  v_mfma_f32_16x16x32_bf16 v[124:127], a[60:63], a[108:111], v[124:127]
  ds_read_b64_tr_b16 a[50:51], v234 offset:43008
  v_mfma_f32_16x16x32_bf16 v[120:123], a[60:63], a[104:107], v[120:123]
  v_mfma_f32_16x16x32_bf16 v[120:123], a[56:59], a[96:99], v[120:123]
  ds_read_b64_tr_b16 a[60:61], v235 offset:45056
  s_waitcnt vmcnt(0)
  v_mfma_f32_16x16x32_bf16 v[80:83], a[0:3], a[160:163], v[80:83]
  v_mfma_f32_16x16x32_bf16 v[80:83], a[4:7], a[168:171], v[80:83]
  ds_read_b64_tr_b16 a[62:63], v235 offset:47104
  v_mfma_f32_16x16x32_bf16 v[84:87], a[4:7], a[172:175], v[84:87]
  v_mfma_f32_16x16x32_bf16 v[84:87], a[0:3], a[164:167], v[84:87]
  ds_read_b64_tr_b16 a[56:57], v235 offset:40960
  v_mfma_f32_16x16x32_bf16 v[192:195], a[0:3], a[128:131], v[192:195]
  v_mfma_f32_16x16x32_bf16 v[192:195], a[4:7], a[136:139], v[192:195]
  ds_read_b64_tr_b16 a[58:59], v235 offset:43008
  v_mfma_f32_16x16x32_bf16 v[196:199], a[4:7], a[140:143], v[196:199]
  v_mfma_f32_16x16x32_bf16 v[196:199], a[0:3], a[132:135], v[196:199]
  ds_read_b64_tr_b16 a[4:5], v232 offset:61440
  v_mfma_f32_16x16x32_bf16 v[204:207], a[8:11], a[132:135], v[204:207]
  v_mfma_f32_16x16x32_bf16 v[204:207], a[12:15], a[140:143], v[204:207]
  ds_read_b64_tr_b16 a[6:7], v232 offset:63488
  v_mfma_f32_16x16x32_bf16 v[200:203], a[12:15], a[136:139], v[200:203]
  v_mfma_f32_16x16x32_bf16 v[200:203], a[8:11], a[128:131], v[200:203]
  ds_read_b64_tr_b16 a[0:1], v232 offset:57344
  v_cvt_pk_bf16_f32 v80, v80, v81
  v_mfma_f32_16x16x32_bf16 v[92:95], a[8:11], a[164:167], v[92:95]
  v_cvt_pk_bf16_f32 v81, v82, v83
  v_cvt_pk_bf16_f32 v82, v84, v85
  v_mfma_f32_16x16x32_bf16 v[92:95], a[12:15], a[172:175], v[92:95]
  ds_read_b64_tr_b16 a[2:3], v232 offset:59392
  v_cvt_pk_bf16_f32 v83, v86, v87
  v_mfma_f32_16x16x32_bf16 v[88:91], a[12:15], a[168:171], v[88:91]
  v_mfma_f32_16x16x32_bf16 v[88:91], a[8:11], a[160:163], v[88:91]
  ds_read_b64_tr_b16 a[12:13], v233 offset:61440
  v_cvt_pk_bf16_f32 v192, v192, v193
  s_mul_i32 s60, s2, 49152
  s_add_u32 s60, s60, s24
  s_add_u32 s60, s60, 0
  buffer_store_dwordx4 v[80:83], v228, s[28:31], s60 offen offset:0 sc1
  v_mfma_f32_16x16x32_bf16 v[112:115], a[16:19], a[160:163], v[112:115]
  v_cvt_pk_bf16_f32 v193, v194, v195
  v_cvt_pk_bf16_f32 v194, v196, v197
  v_mfma_f32_16x16x32_bf16 v[112:115], a[20:23], a[168:171], v[112:115]
  ds_read_b64_tr_b16 a[14:15], v233 offset:63488
  v_cvt_pk_bf16_f32 v195, v198, v199
  v_mfma_f32_16x16x32_bf16 v[116:119], a[20:23], a[172:175], v[116:119]
  v_mfma_f32_16x16x32_bf16 v[116:119], a[16:19], a[164:167], v[116:119]
  ds_read_b64_tr_b16 a[8:9], v233 offset:57344
  v_cvt_pk_bf16_f32 v200, v200, v201
  s_mul_i32 s60, s2, 49152
  s_add_u32 s60, s60, s24
  s_add_u32 s60, s60, 8192
  buffer_store_dwordx4 v[192:195], v228, s[28:31], s60 offen offset:0 sc1
  v_mfma_f32_16x16x32_bf16 v[208:211], a[16:19], a[128:131], v[208:211]
  v_cvt_pk_bf16_f32 v201, v202, v203
  v_cvt_pk_bf16_f32 v202, v204, v205
  v_mfma_f32_16x16x32_bf16 v[208:211], a[20:23], a[136:139], v[208:211]
  ds_read_b64_tr_b16 a[10:11], v233 offset:59392
  v_cvt_pk_bf16_f32 v203, v206, v207
  v_mfma_f32_16x16x32_bf16 v[212:215], a[20:23], a[140:143], v[212:215]
  v_mfma_f32_16x16x32_bf16 v[212:215], a[16:19], a[132:135], v[212:215]
  ds_read_b64_tr_b16 a[20:21], v234 offset:61440
  v_cvt_pk_bf16_f32 v88, v88, v89
  s_mul_i32 s60, s2, 49152
  s_add_u32 s60, s60, s24
  s_add_u32 s60, s60, 8192
  buffer_store_dwordx4 v[200:203], v228, s[28:31], s60 offen offset:1024 sc1
  v_mfma_f32_16x16x32_bf16 v[220:223], a[24:27], a[132:135], v[220:223]
  v_cvt_pk_bf16_f32 v89, v90, v91
  v_cvt_pk_bf16_f32 v90, v92, v93
  v_mfma_f32_16x16x32_bf16 v[220:223], a[28:31], a[140:143], v[220:223]
  ds_read_b64_tr_b16 a[22:23], v234 offset:63488
  v_cvt_pk_bf16_f32 v91, v94, v95
  v_mfma_f32_16x16x32_bf16 v[216:219], a[28:31], a[136:139], v[216:219]
  v_mfma_f32_16x16x32_bf16 v[216:219], a[24:27], a[128:131], v[216:219]
  ds_read_b64_tr_b16 a[16:17], v234 offset:57344
  v_cvt_pk_bf16_f32 v112, v112, v113
  s_mul_i32 s60, s2, 49152
  s_add_u32 s60, s60, s24
  s_add_u32 s60, s60, 0
  buffer_store_dwordx4 v[88:91], v228, s[28:31], s60 offen offset:1024 sc1
  v_mfma_f32_16x16x32_bf16 v[124:127], a[24:27], a[164:167], v[124:127]
  v_cvt_pk_bf16_f32 v113, v114, v115
  v_cvt_pk_bf16_f32 v114, v116, v117
  v_mfma_f32_16x16x32_bf16 v[124:127], a[28:31], a[172:175], v[124:127]
  ds_read_b64_tr_b16 a[18:19], v234 offset:59392
  v_cvt_pk_bf16_f32 v115, v118, v119
  v_mfma_f32_16x16x32_bf16 v[120:123], a[28:31], a[168:171], v[120:123]
  v_mfma_f32_16x16x32_bf16 v[120:123], a[24:27], a[160:163], v[120:123]
  ds_read_b64_tr_b16 a[28:29], v235 offset:61440
  v_cvt_pk_bf16_f32 v208, v208, v209
  s_mul_i32 s60, s2, 49152
  s_add_u32 s60, s60, s24
  s_add_u32 s60, s60, 0
  buffer_store_dwordx4 v[112:115], v228, s[28:31], s60 offen offset:2048 sc1
  s_waitcnt lgkmcnt(8)
  v_mfma_f32_16x16x32_bf16 v[144:147], a[32:35], a[224:227], v[144:147]
  ds_read_b64_tr_b16 a[30:31], v235 offset:63488
  v_cvt_pk_bf16_f32 v209, v210, v211
  v_mfma_f32_16x16x32_bf16 v[144:147], a[36:39], a[232:235], v[144:147]
  ds_read_b64_tr_b16 a[24:25], v235 offset:57344
  v_cvt_pk_bf16_f32 v210, v212, v213
  v_mfma_f32_16x16x32_bf16 v[148:151], a[36:39], a[236:239], v[148:151]
  ds_read_b64_tr_b16 a[26:27], v235 offset:59392
  v_cvt_pk_bf16_f32 v211, v214, v215
  v_mfma_f32_16x16x32_bf16 v[148:151], a[32:35], a[228:231], v[148:151]
  ds_read_b64_tr_b16 a[36:37], v236 offset:12288
  v_cvt_pk_bf16_f32 v216, v216, v217
  v_mfma_f32_16x16x32_bf16 v[156:159], a[40:43], a[228:231], v[156:159]
  ds_read_b64_tr_b16 a[38:39], v236 offset:14336
  v_cvt_pk_bf16_f32 v217, v218, v219
  s_mul_i32 s60, s2, 49152
  s_add_u32 s60, s60, s24
  s_add_u32 s60, s60, 8192
  buffer_store_dwordx4 v[208:211], v228, s[28:31], s60 offen offset:2048 sc1
  v_mfma_f32_16x16x32_bf16 v[156:159], a[44:47], a[236:239], v[156:159]
  ds_read_b64_tr_b16 a[32:33], v236 offset:8192
  v_cvt_pk_bf16_f32 v218, v220, v221
  v_mfma_f32_16x16x32_bf16 v[152:155], a[44:47], a[232:235], v[152:155]
  ds_read_b64_tr_b16 a[34:35], v236 offset:10240
  v_cvt_pk_bf16_f32 v219, v222, v223
  v_mfma_f32_16x16x32_bf16 v[152:155], a[40:43], a[224:227], v[152:155]
  ds_read_b64_tr_b16 a[44:45], v237 offset:12288
  v_cvt_pk_bf16_f32 v120, v120, v121
  v_mfma_f32_16x16x32_bf16 v[176:179], a[48:51], a[224:227], v[176:179]
  ds_read_b64_tr_b16 a[46:47], v237 offset:14336
  v_cvt_pk_bf16_f32 v121, v122, v123
  s_mul_i32 s60, s2, 49152
  s_add_u32 s60, s60, s24
  s_add_u32 s60, s60, 8192
  buffer_store_dwordx4 v[216:219], v228, s[28:31], s60 offen offset:3072 sc1
  v_mfma_f32_16x16x32_bf16 v[176:179], a[52:55], a[232:235], v[176:179]
  ds_read_b64_tr_b16 a[40:41], v237 offset:8192
  v_cvt_pk_bf16_f32 v122, v124, v125
  v_mfma_f32_16x16x32_bf16 v[180:183], a[52:55], a[236:239], v[180:183]
  ds_read_b64_tr_b16 a[42:43], v237 offset:10240
  v_cvt_pk_bf16_f32 v123, v126, v127
  v_mfma_f32_16x16x32_bf16 v[180:183], a[48:51], a[228:231], v[180:183]
  ds_read_b64_tr_b16 a[52:53], v238 offset:12288
  v_mfma_f32_16x16x32_bf16 v[188:191], a[56:59], a[228:231], v[188:191]
  ds_read_b64_tr_b16 a[54:55], v238 offset:14336
  s_mul_i32 s60, s2, 49152
  s_add_u32 s60, s60, s24
  s_add_u32 s60, s60, 0
  buffer_store_dwordx4 v[120:123], v228, s[28:31], s60 offen offset:3072 sc1
  v_mfma_f32_16x16x32_bf16 v[188:191], a[60:63], a[236:239], v[188:191]
  ds_read_b64_tr_b16 a[48:49], v238 offset:8192
  v_mfma_f32_16x16x32_bf16 v[184:187], a[60:63], a[232:235], v[184:187]
  ds_read_b64_tr_b16 a[50:51], v238 offset:10240
  v_mfma_f32_16x16x32_bf16 v[184:187], a[56:59], a[224:227], v[184:187]
  ds_read_b64_tr_b16 a[60:61], v239 offset:12288
  v_mfma_f32_16x16x32_bf16 v[144:147], a[0:3], a[64:67], v[144:147]
  ds_read_b64_tr_b16 a[62:63], v239 offset:14336
  v_mfma_f32_16x16x32_bf16 v[144:147], a[4:7], a[72:75], v[144:147]
  ds_read_b64_tr_b16 a[56:57], v239 offset:8192
  v_mfma_f32_16x16x32_bf16 v[148:151], a[4:7], a[76:79], v[148:151]
  ds_read_b64_tr_b16 a[58:59], v239 offset:10240
  v_mfma_f32_16x16x32_bf16 v[148:151], a[0:3], a[68:71], v[148:151]
  ds_read_b64_tr_b16 a[4:5], v232 offset:4096
  s_waitcnt lgkmcnt(8)
  v_mfma_f32_16x16x32_bf16 v[156:159], a[8:11], a[68:71], v[156:159]
  ds_read_b64_tr_b16 a[6:7], v232 offset:6144
  v_mfma_f32_16x16x32_bf16 v[156:159], a[12:15], a[76:79], v[156:159]
  ds_read_b64_tr_b16 a[0:1], v232 offset:0
  v_mfma_f32_16x16x32_bf16 v[152:155], a[12:15], a[72:75], v[152:155]
  ds_read_b64_tr_b16 a[2:3], v232 offset:2048
  v_mfma_f32_16x16x32_bf16 v[152:155], a[8:11], a[64:67], v[152:155]
  ds_read_b64_tr_b16 a[12:13], v233 offset:4096
  v_mfma_f32_16x16x32_bf16 v[176:179], a[16:19], a[64:67], v[176:179]
  ds_read_b64_tr_b16 a[14:15], v233 offset:6144
  v_mfma_f32_16x16x32_bf16 v[176:179], a[20:23], a[72:75], v[176:179]
  ds_read_b64_tr_b16 a[8:9], v233 offset:0
  v_mfma_f32_16x16x32_bf16 v[180:183], a[20:23], a[76:79], v[180:183]
  ds_read_b64_tr_b16 a[10:11], v233 offset:2048
  v_mfma_f32_16x16x32_bf16 v[180:183], a[16:19], a[68:71], v[180:183]
  ds_read_b64_tr_b16 a[20:21], v234 offset:4096
  v_mfma_f32_16x16x32_bf16 v[188:191], a[24:27], a[68:71], v[188:191]
  ds_read_b64_tr_b16 a[22:23], v234 offset:6144
  v_mfma_f32_16x16x32_bf16 v[188:191], a[28:31], a[76:79], v[188:191]
  ds_read_b64_tr_b16 a[16:17], v234 offset:0
  v_mfma_f32_16x16x32_bf16 v[184:187], a[28:31], a[72:75], v[184:187]
  ds_read_b64_tr_b16 a[18:19], v234 offset:2048
  v_mfma_f32_16x16x32_bf16 v[184:187], a[24:27], a[64:67], v[184:187]
  ds_read_b64_tr_b16 a[28:29], v235 offset:4096
  v_mfma_f32_16x16x32_bf16 v[144:147], a[32:35], a[128:131], v[144:147]
  ds_read_b64_tr_b16 a[30:31], v235 offset:6144
  v_mfma_f32_16x16x32_bf16 v[144:147], a[36:39], a[136:139], v[144:147]
  ds_read_b64_tr_b16 a[24:25], v235 offset:0
  v_mfma_f32_16x16x32_bf16 v[148:151], a[36:39], a[140:143], v[148:151]
  ds_read_b64_tr_b16 a[26:27], v235 offset:2048
  v_mfma_f32_16x16x32_bf16 v[148:151], a[32:35], a[132:135], v[148:151]
  ds_read_b64_tr_b16 a[36:37], v232 offset:20480
  v_mfma_f32_16x16x32_bf16 v[156:159], a[40:43], a[132:135], v[156:159]
  ds_read_b64_tr_b16 a[38:39], v232 offset:22528
  v_mfma_f32_16x16x32_bf16 v[156:159], a[44:47], a[140:143], v[156:159]
  ds_read_b64_tr_b16 a[32:33], v232 offset:16384
  v_mfma_f32_16x16x32_bf16 v[152:155], a[44:47], a[136:139], v[152:155]
  ds_read_b64_tr_b16 a[34:35], v232 offset:18432
  v_mfma_f32_16x16x32_bf16 v[152:155], a[40:43], a[128:131], v[152:155]
  ds_read_b64_tr_b16 a[44:45], v233 offset:20480
  s_waitcnt lgkmcnt(8)
  v_mfma_f32_16x16x32_bf16 v[176:179], a[48:51], a[128:131], v[176:179]
  ds_read_b64_tr_b16 a[46:47], v233 offset:22528
  v_mfma_f32_16x16x32_bf16 v[176:179], a[52:55], a[136:139], v[176:179]
  ds_read_b64_tr_b16 a[40:41], v233 offset:16384
  v_mfma_f32_16x16x32_bf16 v[180:183], a[52:55], a[140:143], v[180:183]
  ds_read_b64_tr_b16 a[42:43], v233 offset:18432
  v_mfma_f32_16x16x32_bf16 v[180:183], a[48:51], a[132:135], v[180:183]
  ds_read_b64_tr_b16 a[52:53], v234 offset:20480
  v_cvt_pk_bf16_f32 v144, v144, v145
  v_mfma_f32_16x16x32_bf16 v[188:191], a[56:59], a[132:135], v[188:191]
  ds_read_b64_tr_b16 a[54:55], v234 offset:22528
  v_cvt_pk_bf16_f32 v145, v146, v147
  v_mfma_f32_16x16x32_bf16 v[188:191], a[60:63], a[140:143], v[188:191]
  ds_read_b64_tr_b16 a[48:49], v234 offset:16384
  v_cvt_pk_bf16_f32 v146, v148, v149
  v_mfma_f32_16x16x32_bf16 v[184:187], a[60:63], a[136:139], v[184:187]
  ds_read_b64_tr_b16 a[50:51], v234 offset:18432
  v_cvt_pk_bf16_f32 v147, v150, v151
  v_mfma_f32_16x16x32_bf16 v[184:187], a[56:59], a[128:131], v[184:187]
  ds_read_b64_tr_b16 a[60:61], v235 offset:20480
  v_cvt_pk_bf16_f32 v152, v152, v153
  v_mfma_f32_16x16x32_bf16 v[16:19], a[0:3], a[240:243], v[16:19]
  ds_read_b64_tr_b16 a[62:63], v235 offset:22528
  v_cvt_pk_bf16_f32 v153, v154, v155
  s_mul_i32 s60, s2, 49152
  s_add_u32 s60, s60, s24
  s_add_u32 s60, s60, 4096
  buffer_store_dwordx4 v[144:147], v228, s[28:31], s60 offen offset:0 sc1
  v_mfma_f32_16x16x32_bf16 v[16:19], a[4:7], a[248:251], v[16:19]
  ds_read_b64_tr_b16 a[56:57], v235 offset:16384
  v_cvt_pk_bf16_f32 v154, v156, v157
  v_mfma_f32_16x16x32_bf16 v[20:23], a[4:7], a[252:255], v[20:23]
  ds_read_b64_tr_b16 a[58:59], v235 offset:18432
  v_cvt_pk_bf16_f32 v155, v158, v159
  v_mfma_f32_16x16x32_bf16 v[20:23], a[0:3], a[244:247], v[20:23]
  ds_read_b64_tr_b16 a[4:5], v236 offset:28672
  v_cvt_pk_bf16_f32 v176, v176, v177
  v_mfma_f32_16x16x32_bf16 v[28:31], a[8:11], a[244:247], v[28:31]
  ds_read_b64_tr_b16 a[6:7], v236 offset:30720
  v_cvt_pk_bf16_f32 v177, v178, v179
  s_mul_i32 s60, s2, 49152
  s_add_u32 s60, s60, s24
  s_add_u32 s60, s60, 4096
  buffer_store_dwordx4 v[152:155], v228, s[28:31], s60 offen offset:1024 sc1
  v_mfma_f32_16x16x32_bf16 v[28:31], a[12:15], a[252:255], v[28:31]
  ds_read_b64_tr_b16 a[0:1], v236 offset:24576
  v_cvt_pk_bf16_f32 v178, v180, v181
  v_mfma_f32_16x16x32_bf16 v[24:27], a[12:15], a[248:251], v[24:27]
  ds_read_b64_tr_b16 a[2:3], v236 offset:26624
  v_cvt_pk_bf16_f32 v179, v182, v183
  v_mfma_f32_16x16x32_bf16 v[24:27], a[8:11], a[240:243], v[24:27]
  ds_read_b64_tr_b16 a[12:13], v237 offset:28672
  v_cvt_pk_bf16_f32 v184, v184, v185
  v_mfma_f32_16x16x32_bf16 v[48:51], a[16:19], a[240:243], v[48:51]
  s_barrier
  ds_read_b64_tr_b16 a[14:15], v237 offset:30720
  v_cvt_pk_bf16_f32 v185, v186, v187
  s_mul_i32 s60, s2, 49152
  s_add_u32 s60, s60, s24
  s_add_u32 s60, s60, 4096
  buffer_store_dwordx4 v[176:179], v228, s[28:31], s60 offen offset:2048 sc1
  v_mfma_f32_16x16x32_bf16 v[48:51], a[20:23], a[248:251], v[48:51]
  ds_read_b64_tr_b16 a[8:9], v237 offset:24576
  v_cvt_pk_bf16_f32 v186, v188, v189
  v_mfma_f32_16x16x32_bf16 v[52:55], a[20:23], a[252:255], v[52:55]
  ds_read_b64_tr_b16 a[10:11], v237 offset:26624
  v_cvt_pk_bf16_f32 v187, v190, v191
  v_mfma_f32_16x16x32_bf16 v[52:55], a[16:19], a[244:247], v[52:55]
  ds_read_b64_tr_b16 a[20:21], v238 offset:28672
  s_waitcnt lgkmcnt(8)
  v_mfma_f32_16x16x32_bf16 v[60:63], a[24:27], a[244:247], v[60:63]
  ds_read_b64_tr_b16 a[22:23], v238 offset:30720
  s_mul_i32 s60, s2, 49152
  s_add_u32 s60, s60, s24
  s_add_u32 s60, s60, 4096
  buffer_store_dwordx4 v[184:187], v228, s[28:31], s60 offen offset:3072 sc1
  v_mfma_f32_16x16x32_bf16 v[60:63], a[28:31], a[252:255], v[60:63]
  ds_read_b64_tr_b16 a[16:17], v238 offset:24576
  v_mfma_f32_16x16x32_bf16 v[56:59], a[28:31], a[248:251], v[56:59]
  ds_read_b64_tr_b16 a[18:19], v238 offset:26624
  s_waitcnt vmcnt(4)
  v_mov_b32 v252, s56
  v_mov_b32 v253, s57
  s_lshl_b32 s60, s2, 2
  s_add_u32 s60, s60, s25
  s_lshl_b32 s60, s60, 7
  s_add_u32 s60, s60, 0xa8000
  s_mov_b64 exec, 1
  buffer_store_dwordx2 v[252:253], off, s[16:19], s60 offset:32 sc1
  s_mov_b64 exec, -1
  v_mfma_f32_16x16x32_bf16 v[56:59], a[24:27], a[240:243], v[56:59]
  ds_read_b64_tr_b16 a[28:29], v239 offset:28672
  v_mfma_f32_16x16x32_bf16 v[16:19], a[32:35], v[32:35], v[16:19]
  ds_read_b64_tr_b16 a[30:31], v239 offset:30720
  v_mfma_f32_16x16x32_bf16 v[16:19], a[36:39], v[40:43], v[16:19]
  ds_read_b64_tr_b16 a[24:25], v239 offset:24576
  v_mfma_f32_16x16x32_bf16 v[20:23], a[36:39], v[44:47], v[20:23]
  ds_read_b64_tr_b16 a[26:27], v239 offset:26624
  v_mfma_f32_16x16x32_bf16 v[20:23], a[32:35], v[36:39], v[20:23]
  ds_read_b64_tr_b16 a[36:37], v236 offset:45056
  v_mfma_f32_16x16x32_bf16 v[28:31], a[40:43], v[36:39], v[28:31]
  ds_read_b64_tr_b16 a[38:39], v236 offset:47104
  v_mfma_f32_16x16x32_bf16 v[28:31], a[44:47], v[44:47], v[28:31]
  ds_read_b64_tr_b16 a[32:33], v236 offset:40960
  v_mfma_f32_16x16x32_bf16 v[24:27], a[44:47], v[40:43], v[24:27]
  ds_read_b64_tr_b16 a[34:35], v236 offset:43008
  v_mfma_f32_16x16x32_bf16 v[24:27], a[40:43], v[32:35], v[24:27]
  ds_read_b64_tr_b16 a[44:45], v237 offset:45056
  v_mfma_f32_16x16x32_bf16 v[48:51], a[48:51], v[32:35], v[48:51]
  ds_read_b64_tr_b16 a[46:47], v237 offset:47104
  v_mfma_f32_16x16x32_bf16 v[48:51], a[52:55], v[40:43], v[48:51]
  ds_read_b64_tr_b16 a[40:41], v237 offset:40960
  v_mfma_f32_16x16x32_bf16 v[52:55], a[52:55], v[44:47], v[52:55]
  ds_read_b64_tr_b16 a[42:43], v237 offset:43008
  v_mfma_f32_16x16x32_bf16 v[52:55], a[48:51], v[36:39], v[52:55]
  ds_read_b64_tr_b16 a[52:53], v238 offset:45056
  v_mfma_f32_16x16x32_bf16 v[60:63], a[56:59], v[36:39], v[60:63]
  ds_read_b64_tr_b16 a[54:55], v238 offset:47104
  v_mfma_f32_16x16x32_bf16 v[60:63], a[60:63], v[44:47], v[60:63]
  ds_read_b64_tr_b16 a[48:49], v238 offset:40960
  v_mfma_f32_16x16x32_bf16 v[56:59], a[60:63], v[40:43], v[56:59]
  ds_read_b64_tr_b16 a[50:51], v238 offset:43008
  v_mfma_f32_16x16x32_bf16 v[56:59], a[56:59], v[32:35], v[56:59]
  ds_read_b64_tr_b16 a[60:61], v239 offset:45056
  s_waitcnt lgkmcnt(8)
  v_mfma_f32_16x16x32_bf16 v[16:19], a[0:3], a[80:83], v[16:19]
  ds_read_b64_tr_b16 a[62:63], v239 offset:47104
  v_mfma_f32_16x16x32_bf16 v[16:19], a[4:7], a[88:91], v[16:19]
  ds_read_b64_tr_b16 a[56:57], v239 offset:40960
  v_mfma_f32_16x16x32_bf16 v[20:23], a[4:7], a[92:95], v[20:23]
  ds_read_b64_tr_b16 a[58:59], v239 offset:43008
  v_mfma_f32_16x16x32_bf16 v[20:23], a[0:3], a[84:87], v[20:23]
  ds_read_b64_tr_b16 a[4:5], v236 offset:61440
  v_mfma_f32_16x16x32_bf16 v[28:31], a[8:11], a[84:87], v[28:31]
  ds_read_b64_tr_b16 a[6:7], v236 offset:63488
  v_mfma_f32_16x16x32_bf16 v[28:31], a[12:15], a[92:95], v[28:31]
  ds_read_b64_tr_b16 a[0:1], v236 offset:57344
  v_mfma_f32_16x16x32_bf16 v[24:27], a[12:15], a[88:91], v[24:27]
  ds_read_b64_tr_b16 a[2:3], v236 offset:59392
  v_mfma_f32_16x16x32_bf16 v[24:27], a[8:11], a[80:83], v[24:27]
  ds_read_b64_tr_b16 a[12:13], v237 offset:61440
  v_mfma_f32_16x16x32_bf16 v[48:51], a[16:19], a[80:83], v[48:51]
  ds_read_b64_tr_b16 a[14:15], v237 offset:63488
  v_mfma_f32_16x16x32_bf16 v[48:51], a[20:23], a[88:91], v[48:51]
  ds_read_b64_tr_b16 a[8:9], v237 offset:57344
  v_mfma_f32_16x16x32_bf16 v[52:55], a[20:23], a[92:95], v[52:55]
  ds_read_b64_tr_b16 a[10:11], v237 offset:59392
  v_mfma_f32_16x16x32_bf16 v[52:55], a[16:19], a[84:87], v[52:55]
  ds_read_b64_tr_b16 a[20:21], v238 offset:61440
  v_mfma_f32_16x16x32_bf16 v[60:63], a[24:27], a[84:87], v[60:63]
  ds_read_b64_tr_b16 a[22:23], v238 offset:63488
  s_mov_b32 exec_lo, 0x0
  s_mov_b32 exec_hi, 0xa
  buffer_load_dwordx2 v[244:245], v231, s[16:19], 0 offen offset:32 sc1
  s_mov_b64 exec, -1
  v_mfma_f32_16x16x32_bf16 v[60:63], a[28:31], a[92:95], v[60:63]
  ds_read_b64_tr_b16 a[16:17], v238 offset:57344
  v_mfma_f32_16x16x32_bf16 v[56:59], a[28:31], a[88:91], v[56:59]
  ds_read_b64_tr_b16 a[18:19], v238 offset:59392
  v_mfma_f32_16x16x32_bf16 v[56:59], a[24:27], a[80:83], v[56:59]
  ds_read_b64_tr_b16 a[28:29], v239 offset:61440
  v_mfma_f32_16x16x32_bf16 v[16:19], a[32:35], a[112:115], v[16:19]
  ds_read_b64_tr_b16 a[30:31], v239 offset:63488
  v_mfma_f32_16x16x32_bf16 v[16:19], a[36:39], a[120:123], v[16:19]
  ds_read_b64_tr_b16 a[24:25], v239 offset:57344
  v_mfma_f32_16x16x32_bf16 v[20:23], a[36:39], a[124:127], v[20:23]
  ds_read_b64_tr_b16 a[26:27], v239 offset:59392
  v_mfma_f32_16x16x32_bf16 v[20:23], a[32:35], a[116:119], v[20:23]
  ds_read_b64_tr_b16 a[36:37], v240 offset:12288
  s_waitcnt lgkmcnt(8)
  v_mfma_f32_16x16x32_bf16 v[28:31], a[40:43], a[116:119], v[28:31]
  ds_read_b64_tr_b16 a[38:39], v240 offset:14336
  v_mfma_f32_16x16x32_bf16 v[28:31], a[44:47], a[124:127], v[28:31]
  ds_read_b64_tr_b16 a[32:33], v240 offset:8192
  v_mfma_f32_16x16x32_bf16 v[24:27], a[44:47], a[120:123], v[24:27]
  ds_read_b64_tr_b16 a[34:35], v240 offset:10240
  v_mfma_f32_16x16x32_bf16 v[24:27], a[40:43], a[112:115], v[24:27]
  ds_read_b64_tr_b16 a[44:45], v241 offset:12288
  v_mfma_f32_16x16x32_bf16 v[48:51], a[48:51], a[112:115], v[48:51]
  ds_read_b64_tr_b16 a[46:47], v241 offset:14336
  v_mfma_f32_16x16x32_bf16 v[48:51], a[52:55], a[120:123], v[48:51]
  ds_read_b64_tr_b16 a[40:41], v241 offset:8192
  v_mfma_f32_16x16x32_bf16 v[52:55], a[52:55], a[124:127], v[52:55]
  ds_read_b64_tr_b16 a[42:43], v241 offset:10240
  v_mfma_f32_16x16x32_bf16 v[52:55], a[48:51], a[116:119], v[52:55]
  ds_read_b64_tr_b16 a[52:53], v242 offset:12288
  v_mfma_f32_16x16x32_bf16 v[60:63], a[56:59], a[116:119], v[60:63]
  ds_read_b64_tr_b16 a[54:55], v242 offset:14336
  v_mfma_f32_16x16x32_bf16 v[60:63], a[60:63], a[124:127], v[60:63]
  ds_read_b64_tr_b16 a[48:49], v242 offset:8192
  v_mfma_f32_16x16x32_bf16 v[56:59], a[60:63], a[120:123], v[56:59]
  ds_read_b64_tr_b16 a[50:51], v242 offset:10240
  s_waitcnt vmcnt(2)
  v_mov_b32 v252, s56
  v_mov_b32 v253, s57
  s_lshl_b32 s60, s2, 2
  s_add_u32 s60, s60, s25
  s_lshl_b32 s60, s60, 7
  s_add_u32 s60, s60, 0xa8000
  s_mov_b64 exec, 1
  buffer_store_dwordx2 v[252:253], off, s[16:19], s60 offset:40 sc1
  s_mov_b64 exec, -1
  v_mfma_f32_16x16x32_bf16 v[56:59], a[56:59], a[112:115], v[56:59]
  ds_read_b64_tr_b16 a[60:61], v243 offset:12288
  v_mfma_f32_16x16x32_bf16 v[16:19], a[0:3], a[144:147], v[16:19]
  ds_read_b64_tr_b16 a[62:63], v243 offset:14336
  v_mfma_f32_16x16x32_bf16 v[16:19], a[4:7], a[152:155], v[16:19]
  ds_read_b64_tr_b16 a[56:57], v243 offset:8192
  v_mfma_f32_16x16x32_bf16 v[20:23], a[4:7], a[156:159], v[20:23]
  ds_read_b64_tr_b16 a[58:59], v243 offset:10240
  v_mfma_f32_16x16x32_bf16 v[20:23], a[0:3], a[148:151], v[20:23]
  ds_read_b64_tr_b16 a[4:5], v232 offset:36864
  v_mfma_f32_16x16x32_bf16 v[28:31], a[8:11], a[148:151], v[28:31]
  ds_read_b64_tr_b16 a[6:7], v232 offset:38912
  v_mfma_f32_16x16x32_bf16 v[28:31], a[12:15], a[156:159], v[28:31]
  ds_read_b64_tr_b16 a[0:1], v232 offset:32768
  v_mfma_f32_16x16x32_bf16 v[24:27], a[12:15], a[152:155], v[24:27]
  ds_read_b64_tr_b16 a[2:3], v232 offset:34816
  v_mfma_f32_16x16x32_bf16 v[24:27], a[8:11], a[144:147], v[24:27]
  ds_read_b64_tr_b16 a[12:13], v233 offset:36864
  s_waitcnt lgkmcnt(8)
  v_mfma_f32_16x16x32_bf16 v[48:51], a[16:19], a[144:147], v[48:51]
  ds_read_b64_tr_b16 a[14:15], v233 offset:38912
  v_mfma_f32_16x16x32_bf16 v[48:51], a[20:23], a[152:155], v[48:51]
  ds_read_b64_tr_b16 a[8:9], v233 offset:32768
  v_mfma_f32_16x16x32_bf16 v[52:55], a[20:23], a[156:159], v[52:55]
  ds_read_b64_tr_b16 a[10:11], v233 offset:34816
  v_mfma_f32_16x16x32_bf16 v[52:55], a[16:19], a[148:151], v[52:55]
  ds_read_b64_tr_b16 a[20:21], v234 offset:36864
  v_mfma_f32_16x16x32_bf16 v[60:63], a[24:27], a[148:151], v[60:63]
  ds_read_b64_tr_b16 a[22:23], v234 offset:38912
  v_mfma_f32_16x16x32_bf16 v[60:63], a[28:31], a[156:159], v[60:63]
  ds_read_b64_tr_b16 a[16:17], v234 offset:32768
  v_mfma_f32_16x16x32_bf16 v[56:59], a[28:31], a[152:155], v[56:59]
  ds_read_b64_tr_b16 a[18:19], v234 offset:34816
  v_mfma_f32_16x16x32_bf16 v[56:59], a[24:27], a[144:147], v[56:59]
  ds_read_b64_tr_b16 a[28:29], v235 offset:36864
  v_mfma_f32_16x16x32_bf16 v[16:19], a[32:35], a[176:179], v[16:19]
  ds_read_b64_tr_b16 a[30:31], v235 offset:38912
  v_mfma_f32_16x16x32_bf16 v[16:19], a[36:39], a[184:187], v[16:19]
  ds_read_b64_tr_b16 a[24:25], v235 offset:32768
  v_mfma_f32_16x16x32_bf16 v[20:23], a[36:39], a[188:191], v[20:23]
  ds_read_b64_tr_b16 a[26:27], v235 offset:34816
  v_mfma_f32_16x16x32_bf16 v[20:23], a[32:35], a[180:183], v[20:23]
  ds_read_b64_tr_b16 a[36:37], v232 offset:45056
  v_mfma_f32_16x16x32_bf16 v[28:31], a[40:43], a[180:183], v[28:31]
  ds_read_b64_tr_b16 a[38:39], v232 offset:47104
  s_waitcnt vmcnt(1)
  v_cmp_ne_u64 vcc, s[56:57], v[244:245]
  s_nop 1
  s_and_b32 s3, vcc_hi, 0xa
  s_cbranch_scc1 L_sp_x1
L_bk_x1:
  s_xor_b32 s60, s2, 2
  s_mul_i32 s60, s60, 49152
  s_add_u32 s60, s60, s24
  s_add_u32 s60, s60, 0
  buffer_load_dwordx4 v[84:87], v228, s[28:31], s60 offen offset:0 sc1
  v_mfma_f32_16x16x32_bf16 v[28:31], a[44:47], a[188:191], v[28:31]
  ds_read_b64_tr_b16 a[32:33], v232 offset:40960
  v_mfma_f32_16x16x32_bf16 v[24:27], a[44:47], a[184:187], v[24:27]
  ds_read_b64_tr_b16 a[34:35], v232 offset:43008
  s_xor_b32 s60, s2, 2
  s_mul_i32 s60, s60, 49152
  s_add_u32 s60, s60, s24
  s_add_u32 s60, s60, 0
  buffer_load_dwordx4 v[92:95], v228, s[28:31], s60 offen offset:1024 sc1
  v_mfma_f32_16x16x32_bf16 v[24:27], a[40:43], a[176:179], v[24:27]
  ds_read_b64_tr_b16 a[44:45], v233 offset:45056
  v_mfma_f32_16x16x32_bf16 v[48:51], a[48:51], a[176:179], v[48:51]
  ds_read_b64_tr_b16 a[46:47], v233 offset:47104
  s_xor_b32 s60, s2, 2
  s_mul_i32 s60, s60, 49152
  s_add_u32 s60, s60, s24
  s_add_u32 s60, s60, 0
  buffer_load_dwordx4 v[116:119], v228, s[28:31], s60 offen offset:2048 sc1
  v_mfma_f32_16x16x32_bf16 v[48:51], a[52:55], a[184:187], v[48:51]
  ds_read_b64_tr_b16 a[40:41], v233 offset:40960
  v_mfma_f32_16x16x32_bf16 v[52:55], a[52:55], a[188:191], v[52:55]
  ds_read_b64_tr_b16 a[42:43], v233 offset:43008
  s_xor_b32 s60, s2, 2
  s_mul_i32 s60, s60, 49152
  s_add_u32 s60, s60, s24
  s_add_u32 s60, s60, 0
  buffer_load_dwordx4 v[124:127], v228, s[28:31], s60 offen offset:3072 sc1
  v_mfma_f32_16x16x32_bf16 v[52:55], a[48:51], a[180:183], v[52:55]
  ds_read_b64_tr_b16 a[52:53], v234 offset:45056
  s_waitcnt lgkmcnt(8)
  v_mfma_f32_16x16x32_bf16 v[60:63], a[56:59], a[180:183], v[60:63]
  ds_read_b64_tr_b16 a[54:55], v234 offset:47104
  s_xor_b32 s60, s2, 6
  s_mul_i32 s60, s60, 49152
  s_add_u32 s60, s60, s24
  s_add_u32 s60, s60, 8192
  buffer_load_dwordx4 v[196:199], v228, s[28:31], s60 offen offset:0 sc1
  v_mfma_f32_16x16x32_bf16 v[60:63], a[60:63], a[188:191], v[60:63]
  ds_read_b64_tr_b16 a[48:49], v234 offset:40960
  v_mfma_f32_16x16x32_bf16 v[56:59], a[60:63], a[184:187], v[56:59]
  ds_read_b64_tr_b16 a[50:51], v234 offset:43008
  s_xor_b32 s60, s2, 6
  s_mul_i32 s60, s60, 49152
  s_add_u32 s60, s60, s24
  s_add_u32 s60, s60, 8192
  buffer_load_dwordx4 v[204:207], v228, s[28:31], s60 offen offset:1024 sc1
  v_mfma_f32_16x16x32_bf16 v[56:59], a[56:59], a[176:179], v[56:59]
  ds_read_b64_tr_b16 a[60:61], v235 offset:45056
  v_mfma_f32_16x16x32_bf16 v[16:19], a[0:3], a[208:211], v[16:19]
  ds_read_b64_tr_b16 a[62:63], v235 offset:47104
  s_xor_b32 s60, s2, 6
  s_mul_i32 s60, s60, 49152
  s_add_u32 s60, s60, s24
  s_add_u32 s60, s60, 8192
  buffer_load_dwordx4 v[212:215], v228, s[28:31], s60 offen offset:2048 sc1
  v_mfma_f32_16x16x32_bf16 v[16:19], a[4:7], a[216:219], v[16:19]
  ds_read_b64_tr_b16 a[56:57], v235 offset:40960
  v_mfma_f32_16x16x32_bf16 v[20:23], a[4:7], a[220:223], v[20:23]
  ds_read_b64_tr_b16 a[58:59], v235 offset:43008
  s_xor_b32 s60, s2, 6
  s_mul_i32 s60, s60, 49152
  s_add_u32 s60, s60, s24
  s_add_u32 s60, s60, 8192
  buffer_load_dwordx4 v[220:223], v228, s[28:31], s60 offen offset:3072 sc1
  v_mfma_f32_16x16x32_bf16 v[20:23], a[0:3], a[212:215], v[20:23]
  ds_read_b64_tr_b16 a[4:5], v232 offset:61440
  v_mfma_f32_16x16x32_bf16 v[28:31], a[8:11], a[212:215], v[28:31]
  ds_read_b64_tr_b16 a[6:7], v232 offset:63488
  s_mov_b32 exec_lo, 0x0
  s_mov_b32 exec_hi, 0x4
  buffer_load_dwordx2 v[244:245], v231, s[16:19], 0 offen offset:40 sc1
  s_mov_b64 exec, -1
  v_mfma_f32_16x16x32_bf16 v[28:31], a[12:15], a[220:223], v[28:31]
  ds_read_b64_tr_b16 a[0:1], v232 offset:57344
  v_mfma_f32_16x16x32_bf16 v[24:27], a[12:15], a[216:219], v[24:27]
  ds_read_b64_tr_b16 a[2:3], v232 offset:59392
  v_mfma_f32_16x16x32_bf16 v[24:27], a[8:11], a[208:211], v[24:27]
  ds_read_b64_tr_b16 a[12:13], v233 offset:61440
  v_mfma_f32_16x16x32_bf16 v[48:51], a[16:19], a[208:211], v[48:51]
  ds_read_b64_tr_b16 a[14:15], v233 offset:63488
  v_mfma_f32_16x16x32_bf16 v[48:51], a[20:23], a[216:219], v[48:51]
  ds_read_b64_tr_b16 a[8:9], v233 offset:57344
  v_mfma_f32_16x16x32_bf16 v[52:55], a[20:23], a[220:223], v[52:55]
  ds_read_b64_tr_b16 a[10:11], v233 offset:59392
  v_mfma_f32_16x16x32_bf16 v[52:55], a[16:19], a[212:215], v[52:55]
  ds_read_b64_tr_b16 a[20:21], v234 offset:61440
  v_mfma_f32_16x16x32_bf16 v[60:63], a[24:27], a[212:215], v[60:63]
  ds_read_b64_tr_b16 a[22:23], v234 offset:63488
  v_mfma_f32_16x16x32_bf16 v[60:63], a[28:31], a[220:223], v[60:63]
  ds_read_b64_tr_b16 a[16:17], v234 offset:57344
  v_mfma_f32_16x16x32_bf16 v[56:59], a[28:31], a[216:219], v[56:59]
  ds_read_b64_tr_b16 a[18:19], v234 offset:59392
  v_mfma_f32_16x16x32_bf16 v[56:59], a[24:27], a[208:211], v[56:59]
  ds_read_b64_tr_b16 a[28:29], v235 offset:61440
  s_waitcnt lgkmcnt(8)
  v_mfma_f32_16x16x32_bf16 v[16:19], a[32:35], v[0:3], v[16:19]
  ds_read_b64_tr_b16 a[30:31], v235 offset:63488
  v_mfma_f32_16x16x32_bf16 v[16:19], a[36:39], v[8:11], v[16:19]
  ds_read_b64_tr_b16 a[24:25], v235 offset:57344
  v_mfma_f32_16x16x32_bf16 v[20:23], a[36:39], v[12:15], v[20:23]
  ds_read_b64_tr_b16 a[26:27], v235 offset:59392
  v_mfma_f32_16x16x32_bf16 v[20:23], a[32:35], v[4:7], v[20:23]
  ds_read_b64_tr_b16 a[36:37], v236 offset:12288
  v_mfma_f32_16x16x32_bf16 v[28:31], a[40:43], v[4:7], v[28:31]
  ds_read_b64_tr_b16 a[38:39], v236 offset:14336
  v_mfma_f32_16x16x32_bf16 v[28:31], a[44:47], v[12:15], v[28:31]
  ds_read_b64_tr_b16 a[32:33], v236 offset:8192
  v_mfma_f32_16x16x32_bf16 v[24:27], a[44:47], v[8:11], v[24:27]
  ds_read_b64_tr_b16 a[34:35], v236 offset:10240
  v_mfma_f32_16x16x32_bf16 v[24:27], a[40:43], v[0:3], v[24:27]
  ds_read_b64_tr_b16 a[44:45], v237 offset:12288
  v_mfma_f32_16x16x32_bf16 v[48:51], a[48:51], v[0:3], v[48:51]
  ds_read_b64_tr_b16 a[46:47], v237 offset:14336
  v_mfma_f32_16x16x32_bf16 v[48:51], a[52:55], v[8:11], v[48:51]
  ds_read_b64_tr_b16 a[40:41], v237 offset:8192
  v_mfma_f32_16x16x32_bf16 v[52:55], a[52:55], v[12:15], v[52:55]
  ds_read_b64_tr_b16 a[42:43], v237 offset:10240
  v_mfma_f32_16x16x32_bf16 v[52:55], a[48:51], v[4:7], v[52:55]
  ds_read_b64_tr_b16 a[52:53], v238 offset:12288
  v_mfma_f32_16x16x32_bf16 v[60:63], a[56:59], v[4:7], v[60:63]
  ds_read_b64_tr_b16 a[54:55], v238 offset:14336
  v_mfma_f32_16x16x32_bf16 v[60:63], a[60:63], v[12:15], v[60:63]
  ds_read_b64_tr_b16 a[48:49], v238 offset:8192
  v_mfma_f32_16x16x32_bf16 v[56:59], a[60:63], v[8:11], v[56:59]
  ds_read_b64_tr_b16 a[50:51], v238 offset:10240
  v_mfma_f32_16x16x32_bf16 v[56:59], a[56:59], v[0:3], v[56:59]
  ds_read_b64_tr_b16 a[60:61], v239 offset:12288
  v_mfma_f32_16x16x32_bf16 v[16:19], a[0:3], a[96:99], v[16:19]
  ds_read_b64_tr_b16 a[62:63], v239 offset:14336
  v_mfma_f32_16x16x32_bf16 v[16:19], a[4:7], a[104:107], v[16:19]
  ds_read_b64_tr_b16 a[56:57], v239 offset:8192
  v_mfma_f32_16x16x32_bf16 v[20:23], a[4:7], a[108:111], v[20:23]
  ds_read_b64_tr_b16 a[58:59], v239 offset:10240
  v_mfma_f32_16x16x32_bf16 v[20:23], a[0:3], a[100:103], v[20:23]
  s_waitcnt lgkmcnt(8)
  v_mfma_f32_16x16x32_bf16 v[28:31], a[8:11], a[100:103], v[28:31]
  s_waitcnt vmcnt(0)
  v_cmp_ne_u64 vcc, s[56:57], v[244:245]
  s_nop 1
  s_and_b32 s3, vcc_hi, 0x4
  s_cbranch_scc1 L_sp_x2
L_bk_x2:
  s_xor_b32 s60, s2, 4
  s_mul_i32 s60, s60, 49152
  s_add_u32 s60, s60, s24
  s_add_u32 s60, s60, 4096
  buffer_load_dwordx4 v[148:151], v228, s[28:31], s60 offen offset:0 sc1
  v_mfma_f32_16x16x32_bf16 v[28:31], a[12:15], a[108:111], v[28:31]
  v_mfma_f32_16x16x32_bf16 v[24:27], a[12:15], a[104:107], v[24:27]
  s_xor_b32 s60, s2, 4
  s_mul_i32 s60, s60, 49152
  s_add_u32 s60, s60, s24
  s_add_u32 s60, s60, 4096
  buffer_load_dwordx4 v[156:159], v228, s[28:31], s60 offen offset:1024 sc1
  v_mfma_f32_16x16x32_bf16 v[24:27], a[8:11], a[96:99], v[24:27]
  v_mfma_f32_16x16x32_bf16 v[48:51], a[16:19], a[96:99], v[48:51]
  s_xor_b32 s60, s2, 4
  s_mul_i32 s60, s60, 49152
  s_add_u32 s60, s60, s24
  s_add_u32 s60, s60, 4096
  buffer_load_dwordx4 v[180:183], v228, s[28:31], s60 offen offset:2048 sc1
  v_mfma_f32_16x16x32_bf16 v[48:51], a[20:23], a[104:107], v[48:51]
  v_mfma_f32_16x16x32_bf16 v[52:55], a[20:23], a[108:111], v[52:55]
  s_xor_b32 s60, s2, 4
  s_mul_i32 s60, s60, 49152
  s_add_u32 s60, s60, s24
  s_add_u32 s60, s60, 4096
  buffer_load_dwordx4 v[188:191], v228, s[28:31], s60 offen offset:3072 sc1
  v_mfma_f32_16x16x32_bf16 v[52:55], a[16:19], a[100:103], v[52:55]
  v_mfma_f32_16x16x32_bf16 v[60:63], a[24:27], a[100:103], v[60:63]
  v_mfma_f32_16x16x32_bf16 v[60:63], a[28:31], a[108:111], v[60:63]
  v_mfma_f32_16x16x32_bf16 v[56:59], a[28:31], a[104:107], v[56:59]
  v_mfma_f32_16x16x32_bf16 v[56:59], a[24:27], a[96:99], v[56:59]
  v_mfma_f32_16x16x32_bf16 v[16:19], a[32:35], a[160:163], v[16:19]
  v_mfma_f32_16x16x32_bf16 v[16:19], a[36:39], a[168:171], v[16:19]
  v_mfma_f32_16x16x32_bf16 v[20:23], a[36:39], a[172:175], v[20:23]
  v_mfma_f32_16x16x32_bf16 v[20:23], a[32:35], a[164:167], v[20:23]
  v_mfma_f32_16x16x32_bf16 v[28:31], a[40:43], a[164:167], v[28:31]
  v_mfma_f32_16x16x32_bf16 v[28:31], a[44:47], a[172:175], v[28:31]
  v_mfma_f32_16x16x32_bf16 v[24:27], a[44:47], a[168:171], v[24:27]
  v_mfma_f32_16x16x32_bf16 v[24:27], a[40:43], a[160:163], v[24:27]
  s_waitcnt lgkmcnt(4)
  v_mfma_f32_16x16x32_bf16 v[48:51], a[48:51], a[160:163], v[48:51]
  v_mfma_f32_16x16x32_bf16 v[48:51], a[52:55], a[168:171], v[48:51]
  v_mfma_f32_16x16x32_bf16 v[52:55], a[52:55], a[172:175], v[52:55]
  v_mfma_f32_16x16x32_bf16 v[52:55], a[48:51], a[164:167], v[52:55]
  s_waitcnt lgkmcnt(0)
  v_mfma_f32_16x16x32_bf16 v[60:63], a[56:59], a[164:167], v[60:63]
  v_mfma_f32_16x16x32_bf16 v[60:63], a[60:63], a[172:175], v[60:63]
  v_mfma_f32_16x16x32_bf16 v[56:59], a[60:63], a[168:171], v[56:59]
  v_mfma_f32_16x16x32_bf16 v[56:59], a[56:59], a[160:163], v[56:59]
  v_lshlrev_b32 v80, 16, v84
  v_and_b32 v81, s63, v84
  v_lshlrev_b32 v82, 16, v85
  v_and_b32 v83, s63, v85
  v_lshlrev_b32 v192, 16, v86
  v_and_b32 v193, s63, v86
  v_lshlrev_b32 v194, 16, v87
  v_and_b32 v195, s63, v87
  v_lshlrev_b32 v88, 16, v92
  v_and_b32 v89, s63, v92
  v_lshlrev_b32 v90, 16, v93
  v_and_b32 v91, s63, v93
  v_lshlrev_b32 v200, 16, v94
  v_and_b32 v201, s63, v94
  v_lshlrev_b32 v202, 16, v95
  v_and_b32 v203, s63, v95
  v_lshlrev_b32 v112, 16, v116
  v_and_b32 v113, s63, v116
  v_lshlrev_b32 v114, 16, v117
  v_and_b32 v115, s63, v117
  v_lshlrev_b32 v208, 16, v118
  v_and_b32 v209, s63, v118
  v_lshlrev_b32 v210, 16, v119
  v_and_b32 v211, s63, v119
  v_lshlrev_b32 v120, 16, v124
  v_and_b32 v121, s63, v124
  v_lshlrev_b32 v122, 16, v125
  v_and_b32 v123, s63, v125
  v_lshlrev_b32 v216, 16, v126
  v_and_b32 v217, s63, v126
  v_lshlrev_b32 v218, 16, v127
  v_and_b32 v219, s63, v127
  v_lshlrev_b32 v64, 16, v196
  v_and_b32 v65, s63, v196
  v_lshlrev_b32 v66, 16, v197
  v_and_b32 v67, s63, v197
  v_pk_add_f32 v[80:81], v[80:81], v[64:65]
  v_pk_add_f32 v[82:83], v[82:83], v[66:67]
  v_lshlrev_b32 v68, 16, v198
  v_and_b32 v69, s63, v198
  v_lshlrev_b32 v70, 16, v199
  v_and_b32 v71, s63, v199
  v_pk_add_f32 v[192:193], v[192:193], v[68:69]
  v_pk_add_f32 v[194:195], v[194:195], v[70:71]
  v_lshlrev_b32 v72, 16, v204
  v_and_b32 v73, s63, v204
  v_lshlrev_b32 v74, 16, v205
  v_and_b32 v75, s63, v205
  v_pk_add_f32 v[88:89], v[88:89], v[72:73]
  v_pk_add_f32 v[90:91], v[90:91], v[74:75]
  v_lshlrev_b32 v76, 16, v206
  v_and_b32 v77, s63, v206
  v_lshlrev_b32 v78, 16, v207
  v_and_b32 v79, s63, v207
  v_pk_add_f32 v[200:201], v[200:201], v[76:77]
  v_pk_add_f32 v[202:203], v[202:203], v[78:79]
  v_lshlrev_b32 v64, 16, v212
  v_and_b32 v65, s63, v212
  v_lshlrev_b32 v66, 16, v213
  v_and_b32 v67, s63, v213
  v_pk_add_f32 v[112:113], v[112:113], v[64:65]
  v_pk_add_f32 v[114:115], v[114:115], v[66:67]
  v_lshlrev_b32 v68, 16, v214
  v_and_b32 v69, s63, v214
  v_lshlrev_b32 v70, 16, v215
  v_and_b32 v71, s63, v215
  v_pk_add_f32 v[208:209], v[208:209], v[68:69]
  v_pk_add_f32 v[210:211], v[210:211], v[70:71]
  v_lshlrev_b32 v72, 16, v220
  v_and_b32 v73, s63, v220
  v_lshlrev_b32 v74, 16, v221
  v_and_b32 v75, s63, v221
  v_pk_add_f32 v[120:121], v[120:121], v[72:73]
  v_pk_add_f32 v[122:123], v[122:123], v[74:75]
  v_lshlrev_b32 v76, 16, v222
  v_and_b32 v77, s63, v222
  v_lshlrev_b32 v78, 16, v223
  v_and_b32 v79, s63, v223
  v_pk_add_f32 v[216:217], v[216:217], v[76:77]
  v_pk_add_f32 v[218:219], v[218:219], v[78:79]
  s_waitcnt vmcnt(0)
  v_lshlrev_b32 v64, 16, v148
  v_and_b32 v65, s63, v148
  v_lshlrev_b32 v66, 16, v149
  v_and_b32 v67, s63, v149
  v_pk_add_f32 v[80:81], v[80:81], v[64:65]
  v_pk_add_f32 v[82:83], v[82:83], v[66:67]
  v_lshlrev_b32 v68, 16, v150
  v_and_b32 v69, s63, v150
  v_lshlrev_b32 v70, 16, v151
  v_and_b32 v71, s63, v151
  v_pk_add_f32 v[192:193], v[192:193], v[68:69]
  v_pk_add_f32 v[194:195], v[194:195], v[70:71]
  v_lshlrev_b32 v72, 16, v156
  v_and_b32 v73, s63, v156
  v_lshlrev_b32 v74, 16, v157
  v_and_b32 v75, s63, v157
  v_pk_add_f32 v[88:89], v[88:89], v[72:73]
  v_pk_add_f32 v[90:91], v[90:91], v[74:75]
  v_lshlrev_b32 v76, 16, v158
  v_and_b32 v77, s63, v158
  v_lshlrev_b32 v78, 16, v159
  v_and_b32 v79, s63, v159
  v_pk_add_f32 v[200:201], v[200:201], v[76:77]
  v_pk_add_f32 v[202:203], v[202:203], v[78:79]
  v_lshlrev_b32 v64, 16, v180
  v_and_b32 v65, s63, v180
  v_lshlrev_b32 v66, 16, v181
  v_and_b32 v67, s63, v181
  v_pk_add_f32 v[112:113], v[112:113], v[64:65]
  v_pk_add_f32 v[114:115], v[114:115], v[66:67]
  v_lshlrev_b32 v68, 16, v182
  v_and_b32 v69, s63, v182
  v_lshlrev_b32 v70, 16, v183
  v_and_b32 v71, s63, v183
  v_pk_add_f32 v[208:209], v[208:209], v[68:69]
  v_pk_add_f32 v[210:211], v[210:211], v[70:71]
  v_lshlrev_b32 v72, 16, v188
  v_and_b32 v73, s63, v188
  v_lshlrev_b32 v74, 16, v189
  v_and_b32 v75, s63, v189
  v_pk_add_f32 v[120:121], v[120:121], v[72:73]
  v_pk_add_f32 v[122:123], v[122:123], v[74:75]
  v_lshlrev_b32 v76, 16, v190
  v_and_b32 v77, s63, v190
  v_lshlrev_b32 v78, 16, v191
  v_and_b32 v79, s63, v191
  v_pk_add_f32 v[216:217], v[216:217], v[76:77]
  v_pk_add_f32 v[218:219], v[218:219], v[78:79]
  s_nop 7
  v_pk_add_f32 v[16:17], v[16:17], v[80:81]
  v_pk_add_f32 v[18:19], v[18:19], v[82:83]
  v_pk_mul_f32 v[16:17], v[16:17], v[108:109] op_sel_hi:[1,0]
  v_pk_mul_f32 v[18:19], v[18:19], v[108:109] op_sel_hi:[1,0]
  ds_write_b128 v224, v[16:19] offset:0
  v_pk_add_f32 v[20:21], v[20:21], v[192:193]
  v_pk_add_f32 v[22:23], v[22:23], v[194:195]
  v_pk_mul_f32 v[20:21], v[20:21], v[108:109] op_sel:[0,1]
  v_pk_mul_f32 v[22:23], v[22:23], v[108:109] op_sel:[0,1]
  ds_write_b128 v224, v[20:23] offset:4096
  v_pk_add_f32 v[24:25], v[24:25], v[88:89]
  v_pk_add_f32 v[26:27], v[26:27], v[90:91]
  v_pk_mul_f32 v[24:25], v[24:25], v[108:109] op_sel_hi:[1,0]
  v_pk_mul_f32 v[26:27], v[26:27], v[108:109] op_sel_hi:[1,0]
  ds_write_b128 v225, v[24:27] offset:0
  v_pk_add_f32 v[28:29], v[28:29], v[200:201]
  v_pk_add_f32 v[30:31], v[30:31], v[202:203]
  v_pk_mul_f32 v[28:29], v[28:29], v[108:109] op_sel:[0,1]
  v_pk_mul_f32 v[30:31], v[30:31], v[108:109] op_sel:[0,1]
  ds_write_b128 v225, v[28:31] offset:4096
  v_pk_add_f32 v[48:49], v[48:49], v[112:113]
  v_pk_add_f32 v[50:51], v[50:51], v[114:115]
  v_pk_mul_f32 v[48:49], v[48:49], v[108:109] op_sel_hi:[1,0]
  v_pk_mul_f32 v[50:51], v[50:51], v[108:109] op_sel_hi:[1,0]
  ds_write_b128 v224, v[48:51] offset:128
  v_pk_add_f32 v[52:53], v[52:53], v[208:209]
  v_pk_add_f32 v[54:55], v[54:55], v[210:211]
  v_pk_mul_f32 v[52:53], v[52:53], v[108:109] op_sel:[0,1]
  v_pk_mul_f32 v[54:55], v[54:55], v[108:109] op_sel:[0,1]
  ds_write_b128 v224, v[52:55] offset:4224
  v_pk_add_f32 v[56:57], v[56:57], v[120:121]
  v_pk_add_f32 v[58:59], v[58:59], v[122:123]
  v_pk_mul_f32 v[56:57], v[56:57], v[108:109] op_sel_hi:[1,0]
  v_pk_mul_f32 v[58:59], v[58:59], v[108:109] op_sel_hi:[1,0]
  ds_write_b128 v225, v[56:59] offset:128
  v_pk_add_f32 v[60:61], v[60:61], v[216:217]
  v_pk_add_f32 v[62:63], v[62:63], v[218:219]
  v_pk_mul_f32 v[60:61], v[60:61], v[108:109] op_sel:[0,1]
  v_pk_mul_f32 v[62:63], v[62:63], v[108:109] op_sel:[0,1]
  ds_write_b128 v225, v[60:63] offset:4224
  s_waitcnt lgkmcnt(0)
  ds_read_b128 v[32:35], v229 offset:0
  ds_read_b128 v[36:39], v230 offset:0
  ds_read_b128 v[40:43], v229 offset:2048
  ds_read_b128 v[44:47], v230 offset:2048
  ds_read_b128 v[48:51], v229 offset:4096
  ds_read_b128 v[52:55], v230 offset:4096
  ds_read_b128 v[56:59], v229 offset:6144
  ds_read_b128 v[60:63], v230 offset:6144
  s_waitcnt lgkmcnt(6)
  v_pk_add_f32 v[128:129], v[128:129], v[32:33]
  v_pk_add_f32 v[130:131], v[130:131], v[34:35]
  v_pk_add_f32 v[132:133], v[132:133], v[36:37]
  v_pk_add_f32 v[134:135], v[134:135], v[38:39]
  v_cvt_pk_bf16_f32 v8, v128, v129
  v_cvt_pk_bf16_f32 v9, v130, v131
  v_cvt_pk_bf16_f32 v10, v132, v133
  v_cvt_pk_bf16_f32 v11, v134, v135
  s_mov_b32 s60, 0x0
  buffer_store_dwordx4 v[8:11], v110, s[44:47], s60 offen sc1
  s_waitcnt lgkmcnt(4)
  v_pk_add_f32 v[136:137], v[136:137], v[40:41]
  v_pk_add_f32 v[138:139], v[138:139], v[42:43]
  v_pk_add_f32 v[140:141], v[140:141], v[44:45]
  v_pk_add_f32 v[142:143], v[142:143], v[46:47]
  v_cvt_pk_bf16_f32 v12, v136, v137
  v_cvt_pk_bf16_f32 v13, v138, v139
  v_cvt_pk_bf16_f32 v14, v140, v141
  v_cvt_pk_bf16_f32 v15, v142, v143
  s_mov_b32 s60, 0x4000
  buffer_store_dwordx4 v[12:15], v110, s[44:47], s60 offen sc1
  s_waitcnt lgkmcnt(2)
  v_pk_add_f32 v[160:161], v[160:161], v[48:49]
  v_pk_add_f32 v[162:163], v[162:163], v[50:51]
  v_pk_add_f32 v[164:165], v[164:165], v[52:53]
  v_pk_add_f32 v[166:167], v[166:167], v[54:55]
  v_cvt_pk_bf16_f32 v16, v160, v161
  v_cvt_pk_bf16_f32 v17, v162, v163
  v_cvt_pk_bf16_f32 v18, v164, v165
  v_cvt_pk_bf16_f32 v19, v166, v167
  s_mov_b32 s60, 0x8000
  buffer_store_dwordx4 v[16:19], v110, s[44:47], s60 offen sc1
  s_waitcnt lgkmcnt(0)
  v_pk_add_f32 v[168:169], v[168:169], v[56:57]
  v_pk_add_f32 v[170:171], v[170:171], v[58:59]
  v_pk_add_f32 v[172:173], v[172:173], v[60:61]
  v_pk_add_f32 v[174:175], v[174:175], v[62:63]
  v_cvt_pk_bf16_f32 v20, v168, v169
  v_cvt_pk_bf16_f32 v21, v170, v171
  v_cvt_pk_bf16_f32 v22, v172, v173
  v_cvt_pk_bf16_f32 v23, v174, v175
  s_mov_b32 s60, 0xc000
  buffer_store_dwordx4 v[20:23], v110, s[44:47], s60 offen sc1
  s_endpgm
L_k2_spin:
L_sp_qa:
  s_mov_b32 s61, 0
L_sp1_qa:
  s_sleep 1
  s_mov_b32 exec_lo, 0x3
  s_mov_b32 exec_hi, 0x0
  buffer_load_dwordx2 v[244:245], v231, s[16:19], 0 offen offset:0 sc1
  s_mov_b64 exec, -1
  s_waitcnt vmcnt(0)
  s_add_u32 s61, s61, 1
  s_cmp_gt_u32 s61, 0x20000
  s_cbranch_scc1 L_bk_qa
  v_cmp_ne_u64 vcc, s[56:57], v[244:245]
  s_nop 1
  s_and_b32 s3, vcc_lo, 0x3
  s_cbranch_scc1 L_sp1_qa
  s_branch L_bk_qa
L_sp_c1:
  s_mov_b32 s61, 0
L_sp1_c1:
  s_sleep 1
  s_mov_b32 exec_lo, 0xe
  s_mov_b32 exec_hi, 0x0
  buffer_load_dwordx2 v[244:245], v231, s[16:19], 0 offen offset:0 sc1
  s_mov_b64 exec, -1
  s_waitcnt vmcnt(0)
  s_add_u32 s61, s61, 1
  s_cmp_gt_u32 s61, 0x20000
  s_cbranch_scc1 L_bk_c1
  v_cmp_ne_u64 vcc, s[56:57], v[244:245]
  s_nop 1
  s_and_b32 s3, vcc_lo, 0xe
  s_cbranch_scc1 L_sp1_c1
  s_branch L_bk_c1
L_sp_c2:
  s_mov_b32 s61, 0
L_sp1_c2:
  s_sleep 1
  s_mov_b32 exec_lo, 0xf
  s_mov_b32 exec_hi, 0x0
  buffer_load_dwordx2 v[244:245], v231, s[16:19], 0 offen offset:8 sc1
  s_mov_b64 exec, -1
  s_waitcnt vmcnt(0)
  s_add_u32 s61, s61, 1
  s_cmp_gt_u32 s61, 0x20000
  s_cbranch_scc1 L_bk_c2
  v_cmp_ne_u64 vcc, s[56:57], v[244:245]
  s_nop 1
  s_and_b32 s3, vcc_lo, 0xf
  s_cbranch_scc1 L_sp1_c2
  s_branch L_bk_c2
L_sp_c4:
  s_mov_b32 s61, 0
L_sp1_c4:
  s_sleep 1
  s_mov_b32 exec_lo, 0xf
  s_mov_b32 exec_hi, 0x0
  buffer_load_dwordx2 v[244:245], v231, s[16:19], 0 offen offset:16 sc1
  s_mov_b64 exec, -1
  s_waitcnt vmcnt(0)
  s_add_u32 s61, s61, 1
  s_cmp_gt_u32 s61, 0x20000
  s_cbranch_scc1 L_bk_c4
  v_cmp_ne_u64 vcc, s[56:57], v[244:245]
  s_nop 1
  s_and_b32 s3, vcc_lo, 0xf
  s_cbranch_scc1 L_sp1_c4
  s_branch L_bk_c4
L_sp_c5:
  s_mov_b32 s61, 0
L_sp1_c5:
  s_sleep 1
  s_mov_b32 exec_lo, 0xf0000
  s_mov_b32 exec_hi, 0x0
  buffer_load_dwordx2 v[244:245], v231, s[16:19], 0 offen offset:16 sc1
  s_mov_b64 exec, -1
  s_waitcnt vmcnt(0)
  s_add_u32 s61, s61, 1
  s_cmp_gt_u32 s61, 0x20000
  s_cbranch_scc1 L_bk_c5
  v_cmp_ne_u64 vcc, s[56:57], v[244:245]
  s_nop 1
  s_and_b32 s3, vcc_lo, 0xf0000
  s_cbranch_scc1 L_sp1_c5
  s_branch L_bk_c5
L_sp_x1:
  s_mov_b32 s61, 0
L_sp1_x1:
  s_sleep 1
  s_mov_b32 exec_lo, 0x0
  s_mov_b32 exec_hi, 0xa
  buffer_load_dwordx2 v[244:245], v231, s[16:19], 0 offen offset:32 sc1
  s_mov_b64 exec, -1
  s_waitcnt vmcnt(0)
  s_add_u32 s61, s61, 1
  s_cmp_gt_u32 s61, 0x20000
  s_cbranch_scc1 L_bk_x1
  v_cmp_ne_u64 vcc, s[56:57], v[244:245]
  s_nop 1
  s_and_b32 s3, vcc_hi, 0xa
  s_cbranch_scc1 L_sp1_x1
  s_branch L_bk_x1
L_sp_x2:
  s_mov_b32 s61, 0
L_sp1_x2:
  s_sleep 1
  s_mov_b32 exec_lo, 0x0
  s_mov_b32 exec_hi, 0x4
  buffer_load_dwordx2 v[244:245], v231, s[16:19], 0 offen offset:40 sc1
  s_mov_b64 exec, -1
  s_waitcnt vmcnt(0)
  s_add_u32 s61, s61, 1
  s_cmp_gt_u32 s61, 0x20000
  s_cbranch_scc1 L_bk_x2
  v_cmp_ne_u64 vcc, s[56:57], v[244:245]
  s_nop 1
  s_and_b32 s3, vcc_hi, 0x4
  s_cbranch_scc1 L_sp1_x2
  s_branch L_bk_x2
.section .rodata,"a"
.p2align 6
.amdhsa_kernel parallel_sum__sliding_local_dilated__dense_activation_squared_relu__prompt_kernel
  .amdhsa_next_free_vgpr 512
  .amdhsa_next_free_sgpr 102
  .amdhsa_accum_offset 256
  .amdhsa_group_segment_fixed_size 0
  .amdhsa_kernarg_size 88
  .amdhsa_user_sgpr_count 2
  .amdhsa_user_sgpr_kernarg_segment_ptr 1
  .amdhsa_system_sgpr_workgroup_id_x 1
  .amdhsa_float_denorm_mode_32 3
.end_amdhsa_kernel
```
